```python
import torch

def _softmax(x, axis=-1):
    return torch.softmax(x, dim=axis)
def _gelu(x):
    return torch.nn.functional.gelu(x, approximate="tanh")
def _silu(x):
    return torch.nn.functional.silu(x)
def _sigmoid(x):
    return torch.sigmoid(x)
def _layernorm(x, axis=-1, eps=1e-5):
    m = x.mean(dim=axis, keepdim=True)
    v = x.var(dim=axis, keepdim=True, unbiased=False)
    return (x - m) / torch.sqrt(v + eps)
def _scatter_add(tgt, idx, src, axis=0):
    return tgt.clone().index_add_(axis, idx, src)
def _segment_sum(src, seg, n):
    out = torch.zeros((n,) + src.shape[1:], dtype=src.dtype)
    return out.index_add_(0, seg, src)
def _pad(x, pw):
    flat = tuple(v for pair in reversed(pw) for v in pair)
    return torch.nn.functional.pad(x, flat)

kernel_name = 'recurrent_scan__linear_kernel_hedgehog__dense_activation_silu__prompt'

def setup_inputs():

    _w = (lambda a: (lambda t: t.to(torch.bfloat16) if t.is_floating_point() else t)(torch.as_tensor(a)))
    def _A_setup():
        B, S, D, H = 1, 2048, 1024, 32
        Dh = D // H
        return {
            "x": _w((lambda *s: torch.randn(*s, dtype=torch.bfloat16) * 0.05)(B, S, D)),
            "wqkv": _w((lambda *s: torch.randn(*s, dtype=torch.bfloat16) * 0.4)(D, 3 * D)),
            "w_phi": _w((lambda *s: torch.randn(*s, dtype=torch.bfloat16) * 0.4)(H, Dh, Dh) * (Dh ** -0.5)),
            "wo": _w((lambda *s: torch.randn(*s, dtype=torch.bfloat16) * 0.2)(D, D)),
        }
    _A_in = _A_setup()

    def _B_setup():
        B, S, D, F = 1, 2048, 1024, 3584
        return {
            "x": _w((lambda *s: torch.randn(*s, dtype=torch.bfloat16) * 0.05)(B, S, D)),
            "w1": _w((lambda *s: torch.randn(*s, dtype=torch.bfloat16) * 0.4)(D, F) * (D ** -0.5)),
            "w2": _w((lambda *s: torch.randn(*s, dtype=torch.bfloat16) * 0.1)(F, D) * (F ** -0.5)),
        }
    _B_in = _B_setup()

    return {
        "A_x": _A_in["x"],
        "A_wqkv": _A_in["wqkv"],
        "A_w_phi": _A_in["w_phi"],
        "A_wo": _A_in["wo"],
        "B_x": _B_in["x"],
        "B_w1": _B_in["w1"],
        "B_w2": _B_in["w2"],
    }

def reference(A_x, A_wqkv, A_w_phi, A_wo, B_x, B_w1, B_w2):
    def _A_ref(x, wqkv, w_phi, wo):
        B, S, D = x.shape
        H = 32; Dh = D // H
        qkv = (lambda x, *d: x.permute(*d))((x @ wqkv).reshape(B, S, 3, H, Dh), 2, 0, 3, 1, 4)
        q, k, v = qkv[0], qkv[1], qkv[2]
        pq = torch.einsum("bhsd,hdf->bhsf", q, w_phi)
        pk = torch.einsum("bhsd,hdf->bhsf", k, w_phi)
        phi_q = torch.concatenate([_softmax(pq, axis=-1), _softmax(-pq, axis=-1)], axis=-1)
        phi_k = torch.concatenate([_softmax(pk, axis=-1), _softmax(-pk, axis=-1)], axis=-1)
        kv = torch.einsum("bhsf,bhsd->bhfd", phi_k, v)
        z  = torch.einsum("bhsf->bhf", phi_k)
        num = torch.einsum("bhqf,bhfd->bhqd", phi_q, kv)
        den = torch.einsum("bhqf,bhf->bhq", phi_q, z)[..., None] + 1e-6
        o = num / den
        return (lambda x, *d: x.permute(*d))(o, 0, 2, 1, 3).reshape(B, S, D) @ wo

    def _B_ref(x, w1, w2):
        h = torch.einsum("bsd,df->bsf", x, w1)
        h = _silu(h)
        out = torch.einsum("bsf,fd->bsd", h, w2)
        return out

    x = A_x
    xn = _layernorm(x, axis=-1)
    s = _A_ref(xn, A_wqkv, A_w_phi, A_wo)
    g = _silu(_B_ref(xn, B_w1, B_w2))
    return x + s * g
```

```asm
; @launch grid=(256,1,1) block=(256,1,1) lds=163840
.amdgcn_target "amdgcn-amd-amdhsa--gfx950"
.text
.globl recurrent_scan__linear_kernel_hedgehog__dense_activation_silu__prompt_kernel
.p2align 8
.type recurrent_scan__linear_kernel_hedgehog__dense_activation_silu__prompt_kernel,@function
recurrent_scan__linear_kernel_hedgehog__dense_activation_silu__prompt_kernel:
 s_cmp_ge_u32 s2, 256
 s_cbranch_scc1 L_end
 s_load_dwordx16 s[48:63], s[0:1], 0
 s_load_dwordx4 s[64:67], s[0:1], 64
 v_and_b32 v255, 63, v0
 v_lshrrev_b32 v1, 6, v0
 s_nop 0
 v_readfirstlane_b32 s28, v1
 s_getpc_b64 s[90:91]
L_pc:
 s_lshr_b32 s3, s2, 1
 s_and_b32 s3, s3, 12
 s_add_u32 s3, s3, s28
 s_lshl_b32 s3, s3, 6
 v_add_lshl_u32 v1, v255, s3, 7
 v_min_u32 v1, L_end-L_pc, v1
 global_load_dword v251, v1, s[90:91]
 s_and_b32 s3, s2, 1
 s_lshl_b32 s40, s3, 2
 s_lshl_b32 s31, s3, 10
 s_bfe_u32 s4, s2, 0x20004
 s_add_u32 s40, s40, s4
 s_bfe_u32 s4, s2, 0x20001
 s_lshl_b32 s41, s4, 2
 s_bfe_u32 s4, s2, 0x20006
 s_add_u32 s41, s41, s4
 s_and_b32 s30, s28, 1
 s_bfe_u32 s81, s2, 0x10003
 s_lshl_b32 s37, s28, 13
 v_lshrrev_b32_e64 v241, 3, v255
 v_lshl_add_u32 v224, v241, 11, 0
 s_lshl_b32 s4, s28, 17
 v_add_u32 v224, s4, v224
 v_lshrrev_b32 v242, 4, v255
 v_and_b32 v243, 7, v255
 v_xor_b32_e64 v244, v242, v243
 v_lshl_add_u32 v224, v244, 4, v224
 v_xor_b32_e64 v244, 64, v224
 v_add_u32 v225, 15360, v244
 v_add_u32 v226, 30720, v224
 v_add_u32 v227, 46080, v244
 v_add_u32 v228, 65536, v224
 v_add_u32 v229, 80896, v244
 v_add_u32 v230, 96256, v224
 v_add_u32 v231, 111616, v244
 s_mul_i32 s68, s41, 448
 s_and_b32 s69, s41, 1
 s_lshl_b32 s70, s69, 6
 s_add_u32 s70, s70, s68
 s_mul_i32 s69, s69, 384
 s_sub_u32 s71, s68, s69
 s_add_u32 s71, s71, 4480
 s_lshl_b32 s4, s41, 7
 s_lshl_b32 s6, s30, 1
 s_lshl_b32 s74, s81, 10
 s_nop 0
 s_add_u32 s74, s74, 6144
 s_mul_i32 s75, s81, 1920
 s_sub_u32 s75, 1024, s75
 s_cmp_eq_u32 s81, 1
 s_cselect_b32 s4, s70, s4
 s_cselect_b32 s6, s30, s6
 s_add_u32 s4, s4, 4096
 s_lshl_b32 s7, s28, 3
 v_add_u32_e64 v241, s7, v241
 v_mul_lo_u32 v232, v241, s74
 v_and_b32_e64 v241, 1, v242
 v_lshl_or_b32 v241, v241, 2, s6
 v_xor_b32_e64 v241, v241, v243
 v_lshl_add_u32 v232, v241, 4, v232
 v_add_u32 v232, s4, v232
 v_add_u32 v233, s75, v232
 v_add_u32 v234, s75, v233
 v_lshrrev_b32 v241, 2, v255
 s_lshl_b32 s7, s7, 1
 v_add_u32 v241, s7, v241
 v_mul_u32_u24 v235, 7168, v241
 v_lshrrev_b32 v241, 4, v255
 v_and_b32 v241, 2, v241
 v_and_b32 v242, 3, v255
 v_xor_b32 v241, v241, v242
 v_lshl_add_u32 v235, v241, 4, v235
 v_add_u32 v235, s71, v235
 s_lshl_b32 s42, s28, 10
 s_add_u32 s42, s42, 32768
 s_mul_i32 s38, s28, 3072
 s_add_u32 s38, s38, 110592
 s_lshl_b32 s7, s74, 9
 s_mul_i32 s32, s3, s7
 s_mov_b32 s43, s32
 s_sub_u32 s45, s7, s32
 s_xor_b32 s44, s31, 1024
 s_mov_b32 s5, 0x40000000
 s_lshl_b32 s6, s74, 5
 s_lshl_b32 s7, s7, 1
 s_lshl_b32 s3, s40, 19
 s_add_u32 s14, s7, 4096
 s_mov_b32 s15, 0x20000
 s_mov_b32 s10, 0x80000
 s_mov_b32 s11, 0x20000
 s_mov_b32 m0, s37
 s_cmp_eq_u32 s81, 1
 s_cselect_b32 s33, s32, s5
 s_waitcnt lgkmcnt(0)
 s_cselect_b32 s12, s58, s50
 s_cselect_b32 s13, s59, s51
 s_add_u32 s8, s48, s3
 s_addc_u32 s9, s49, 0
 buffer_load_dwordx4 v224, s[8:11], s31 offen lds
 buffer_load_dwordx4 v225, s[8:11], s31 offen offset:1024 lds
 buffer_load_dwordx4 v226, s[8:11], s31 offen offset:2048 lds
 buffer_load_dwordx4 v227, s[8:11], s31 offen offset:3072 lds
 s_mov_b32 m0, s38
 s_sub_u32 s12, s12, 4096
 s_subb_u32 s13, s13, 0
 buffer_load_dwordx4 v232, s[12:15], s32 offen lds
 buffer_load_dwordx4 v233, s[12:15], s32 offen offset:1024 lds
 buffer_load_dwordx4 v234, s[12:15], s32 offen offset:2048 lds
 s_add_u32 s32, s32, s6
 s_add_u32 m0, s37, 4096
 s_nop 0
 buffer_load_dwordx4 v228, s[8:11], s31 offen lds
 buffer_load_dwordx4 v229, s[8:11], s31 offen offset:1024 lds
 buffer_load_dwordx4 v230, s[8:11], s31 offen offset:2048 lds
 buffer_load_dwordx4 v231, s[8:11], s31 offen offset:3072 lds
 s_mov_b32 m0, s42
 s_nop 0
 s_add_u32 s31, s31, 128
 buffer_load_dwordx4 v235, s[12:15], s33 offen lds
 s_add_u32 m0, s38, 12288
 s_add_u32 s33, s33, 458752
 buffer_load_dwordx4 v232, s[12:15], s32 offen lds
 buffer_load_dwordx4 v233, s[12:15], s32 offen offset:1024 lds
 buffer_load_dwordx4 v234, s[12:15], s32 offen offset:2048 lds
 s_add_u32 s32, s32, s6
 s_add_u32 m0, s37, 36864
 s_nop 0
 buffer_load_dwordx4 v224, s[8:11], s31 offen lds
 buffer_load_dwordx4 v225, s[8:11], s31 offen offset:1024 lds
 buffer_load_dwordx4 v226, s[8:11], s31 offen offset:2048 lds
 buffer_load_dwordx4 v227, s[8:11], s31 offen offset:3072 lds
 s_lshr_b32 s29, s28, 1
 s_bfe_u32 s39, s2, 0x20001
 s_and_b32 s83, s41, 3
 s_lshl_b32 s3, s81, 2
 s_add_u32 s83, s83, s3
 s_mov_b32 s16, s66
 s_mov_b32 s17, s67
 s_mov_b32 s18, 0x1500000
 s_mov_b32 s19, 0x20000
 s_add_u32 s76, s66, 0x1b00000
 s_addc_u32 s77, s67, 0
 s_nop 0
 s_mov_b32 s78, 0x10000
 s_mov_b32 s79, 0x20000
 s_add_u32 s92, s66, 0x1a00000
 s_addc_u32 s93, s67, 0
 s_mov_b32 s94, 0x72000
 s_mov_b32 s95, 0x20000
 s_mov_b32 s96, s64
 s_mov_b32 s97, s65
 s_mov_b32 s98, 0x100
 s_mov_b32 s99, 0x20000
 s_lshl_b32 s3, s81, 4
 s_add_u32 s7, s3, s41
 s_lshl_b32 s3, s7, 14
 s_lshl_b32 s4, s28, 12
 s_add_u32 s3, s3, s4
 v_lshl_add_u32 v199, v255, 4, s3
 v_and_b32 v241, 15, v255
 s_lshl_b32 s3, s29, 7
 v_add_u32 v241, s3, v241
 v_lshlrev_b32 v241, 7, v241
 v_lshrrev_b32_e64 v242, 4, v255
 v_bfe_u32 v243, v255, 1, 3
 v_xor_b32_e64 v242, v242, v243
 v_lshl_add_u32 v236, v242, 4, v241
 v_xor_b32_e64 v237, 64, v236
 s_cmp_eq_u32 s81, 1
 s_cbranch_scc1 L1_ffn
L1_qkv:
 s_mov_b32 s20, s52
 s_mov_b32 s21, s53
 s_mov_b32 s22, 0x10000
 s_mov_b32 s23, 0x20000
 s_lshl_b32 s3, s41, 12
 s_lshl_b32 s68, s28, 10
 s_add_u32 s3, s3, s68
 s_add_u32 m0, s68, 159744
 v_lshlrev_b32 v2, 4, v255
 buffer_load_dwordx4 v2, s[20:23], s3 offen lds
 v_lshrrev_b32_e64 v241, 4, v255
 v_mul_u32_u24 v238, 3072, v241
 v_and_b32_e64 v241, 1, v241
 v_bfe_u32 v242, v255, 3, 1
 v_lshl_or_b32 v241, v242, 1, v241
 s_lshl_b32 s3, s30, 1
 v_xor_b32 v241, s3, v241
 v_lshl_add_u32 v238, v241, 5, v238
 v_and_b32_e64 v242, 3, v255
 v_lshl_add_u32 v238, v242, 3, v238
 v_bfe_u32 v242, v255, 2, 2
 v_lshl_add_u32 v238, v242, 7, v238
 v_add_u32 v238, 110592, v238
 v_xor_b32 v239, 32, v238
 v_lshrrev_b32 v242, 5, v255
 v_lshlrev_b32_e64 v240, 9, v242
 v_bfe_u32 v242, v255, 2, 2
 v_lshl_add_u32 v240, v242, 6, v240
 v_bfe_u32 v242, v255, 4, 1
 v_lshl_add_u32 v240, v242, 5, v240
 v_and_b32_e64 v242, 3, v255
 v_lshl_add_u32 v240, v242, 3, v240
 s_lshl_b32 s3, s30, 11
 s_add_u32 s3, s3, 159744
 v_add_u32 v240, s3, v240
 s_and_b32 s3, s83, 3
 s_lshl_b32 s4, s81, 2
 s_add_u32 s3, s3, s4
 s_lshl_b32 s3, s3, 2
 s_add_u32 s3, s3, s28
 s_lshl_b32 s3, s3, 14
 v_lshrrev_b32 v2, 0, v255
 v_lshlrev_b32 v247, 11, v2
 v_and_b32_e64 v2, 0, v255
 v_lshl_add_u32 v247, v2, 7, v247
 v_lshrrev_b32_e64 v2, 3, v255
 v_lshl_add_u32 v247, v2, 28, v247
 v_add_u32 v247, s3, v247
 s_and_b32 s3, s40, 3
 s_lshl_b32 s3, s3, 2
 s_add_u32 s3, s3, s28
 s_mul_i32 s3, s3, 24576
 v_lshrrev_b32_e64 v2, 2, v255
 v_mul_u32_u24 v252, 6144, v2
 v_and_b32_e64 v2, 3, v255
 v_lshl_add_u32 v252, v2, 11, v252
 s_lshl_b32 s4, s41, 7
 v_add_u32 v2, 1, v2
 v_lshrrev_b32 v2, 2, v2
 v_lshrrev_b32 v3, 4, v255
 v_or_b32 v2, v2, v3
 s_add_u32 s3, s3, s4
 s_add_u32 s3, s3, 4096
 v_lshl_add_u32 v252, v2, 28, v252
 v_add_u32_e64 v252, s3, v252
 s_xor_b32 s6, s44, 1024
 s_add_u32 s6, s6, 256
 buffer_load_dword v251, v247, s[8:11], s6 offen
 s_add_u32 s6, s43, 786432
 buffer_load_dword v251, v252, s[12:15], s6 offen
 v_add_u32 v241, 73728, v236
 v_add_u32 v242, 73728, v237
 v_mov_b32 v28, 0
 v_mov_b32 v29, 0
 v_mov_b32 v30, 0
 v_mov_b32 v31, 0
 v_lshrrev_b32 v2, 4, v0
 v_lshlrev_b32 v2, 20, v2
 v_and_b32_e64 v3, 15, v0
 v_lshl_add_u32 v2, v3, 4, v2
 s_lshl_b32 s3, s2, 8
 buffer_store_dwordx4 v[28:31], v2, s[76:79], s3 offen sc1
 s_lshl_b32 s3, s81, 4
 s_add_u32 s3, s3, s41
 s_lshl_b32 s73, s3, 13
 s_add_u32 s73, s73, 73728
 s_lshl_b32 s75, s40, 10
 s_add_u32 s75, s75, s73
 s_lshl_b32 s72, s40, 14
 s_add_u32 s72, s72, 335872
 s_and_b32 s88, s40, 3
 s_lshl_b32 s3, s7, 9
 s_add_u32 s3, s3, s72
 s_lshl_b32 s74, s28, 7
 s_add_u32 s74, s74, s3
 s_mov_b32 s20, s12
 s_mov_b32 s21, s13
 s_mov_b32 s22, s14
 s_mov_b32 s23, 0x20000
 s_lshr_b32 s3, s40, 2
 s_mul_i32 s24, s3, 3145728
 s_add_u32 s24, s24, 790528
 s_add_u32 s3, s3, 0
 s_mul_i32 s26, s3, 524288
 s_lshl_b32 s3, s41, 2
 s_add_u32 s3, s3, s88
 s_lshl_b32 s3, s3, 2
 s_add_u32 s3, s3, s28
 s_mul_i32 s3, s3, 2048
 v_lshlrev_b32 v250, 7, v255
 v_lshrrev_b32_e64 v3, 4, v255
 v_lshl_add_u32 v250, v3, 26, v250
 v_add_u32 v250, s3, v250
 v_and_b32 v3, 15, v255
 v_mov_b32 v4, 0x3f803f80
 v_cmp_eq_u32 vcc, 0, v3
 s_nop 1
 v_cndmask_b32 v8, 0, v4, vcc
 v_cmp_eq_u32 vcc, 1, v3
 s_nop 1
 v_cndmask_b32 v9, 0, v4, vcc
 v_cmp_eq_u32 vcc, 2, v3
 s_nop 1
 v_cndmask_b32 v10, 0, v4, vcc
 v_cmp_eq_u32 vcc, 3, v3
 s_nop 1
 v_cndmask_b32 v11, 0, v4, vcc
 v_cmp_eq_u32 vcc, 4, v3
 s_nop 1
 v_cndmask_b32 v12, 0, v4, vcc
 v_cmp_eq_u32 vcc, 5, v3
 s_nop 1
 v_cndmask_b32 v13, 0, v4, vcc
 v_accvgpr_write_b32 a128, v8
 v_accvgpr_write_b32 a129, v8
 v_accvgpr_write_b32 a130, v8
 v_accvgpr_write_b32 a131, v8
 v_accvgpr_write_b32 a132, v9
 v_accvgpr_write_b32 a133, v9
 v_accvgpr_write_b32 a134, v9
 v_accvgpr_write_b32 a135, v9
 v_accvgpr_write_b32 a136, v10
 v_accvgpr_write_b32 a137, v10
 v_accvgpr_write_b32 a138, v10
 v_accvgpr_write_b32 a139, v10
 v_accvgpr_write_b32 a140, v11
 v_accvgpr_write_b32 a141, v11
 v_accvgpr_write_b32 a142, v11
 v_accvgpr_write_b32 a143, v11
 v_accvgpr_write_b32 a144, v12
 v_accvgpr_write_b32 a145, v12
 v_accvgpr_write_b32 a146, v12
 v_accvgpr_write_b32 a147, v12
 v_accvgpr_write_b32 a148, v13
 v_accvgpr_write_b32 a149, v13
 v_accvgpr_write_b32 a150, v13
 v_accvgpr_write_b32 a151, v13
 v_lshrrev_b32 v4, 1, v3
 v_lshlrev_b32 v192, 8, v4
 v_and_b32_e64 v4, 1, v3
 v_lshl_add_u32 v192, v4, 6, v192
 v_lshrrev_b32_e64 v4, 4, v255
 v_lshl_add_u32 v192, v4, 4, v192
 s_lshl_b32 s3, s30, 7
 s_lshl_b32 s4, s29, 24
 s_add_u32 s3, s3, s4
 v_add_u32 v192, s3, v192
 v_add_u32 v4, 10, v3
 v_lshrrev_b32 v4, 4, v4
 v_lshl_add_u32 v192, v4, 20, v192
 v_lshlrev_b32 v193, 12, v0
 s_lshl_b32 s3, s81, 4
 s_add_u32 s3, s3, s41
 s_add_u32 s3, s3, 32
 s_lshl_b32 s3, s3, 2
 v_add_u32 v195, s3, v193
 s_lshl_b32 s3, s40, 2
 v_add_u32 v193, s3, v193
 v_mov_b32_e64 v194, 1
 s_waitcnt vmcnt(11)
 s_barrier
 ds_read_b64_tr_b16 a[32:33], v238
 ds_read_b64_tr_b16 a[34:35], v238 offset:512
 ds_read_b128 a[0:3], v236
 ds_read_b128 a[4:7], v236 offset:2048
 ds_read_b128 a[8:11], v236 offset:4096
 ds_read_b128 a[12:15], v236 offset:6144
 ds_read_b128 a[16:19], v236 offset:8192
 ds_read_b128 a[20:23], v236 offset:10240
 ds_read_b128 a[24:27], v236 offset:12288
 ds_read_b128 a[28:31], v236 offset:14336
 ds_read_b64_tr_b16 a[36:37], v239
 ds_read_b64_tr_b16 a[38:39], v239 offset:512
 ds_read_b64_tr_b16 a[40:41], v238 offset:1024
 ds_read_b64_tr_b16 a[42:43], v238 offset:1536
 ds_read_b64_tr_b16 a[44:45], v239 offset:1024
 ds_read_b64_tr_b16 a[46:47], v239 offset:1536
 ds_read_b64_tr_b16 a[48:49], v238 offset:2048
 ds_read_b64_tr_b16 a[50:51], v238 offset:2560
 ds_read_b64_tr_b16 a[52:53], v239 offset:2048
 ds_read_b64_tr_b16 a[54:55], v239 offset:2560
 s_waitcnt vmcnt(8) lgkmcnt(0)
 s_barrier
 v_mfma_f32_16x16x32_bf16 v[0:3], a[32:35], a[0:3], 0
 ds_read_b64_tr_b16 a[92:93], v238 offset:12288
 v_mfma_f32_16x16x32_bf16 v[8:11], a[32:35], a[4:7], 0
 ds_read_b64_tr_b16 a[94:95], v238 offset:12800
 v_mfma_f32_16x16x32_bf16 v[16:19], a[32:35], a[8:11], 0
 ds_read_b128 a[60:63], v237
 v_mfma_f32_16x16x32_bf16 v[24:27], a[32:35], a[12:15], 0
 ds_read_b128 a[64:67], v237 offset:2048
 v_mfma_f32_16x16x32_bf16 v[32:35], a[32:35], a[16:19], 0
 ds_read_b128 a[68:71], v237 offset:4096
 v_mfma_f32_16x16x32_bf16 v[40:43], a[32:35], a[20:23], 0
 ds_read_b128 a[72:75], v237 offset:6144
 v_mfma_f32_16x16x32_bf16 v[48:51], a[32:35], a[24:27], 0
 ds_read_b128 a[76:79], v237 offset:8192
 v_mfma_f32_16x16x32_bf16 v[56:59], a[32:35], a[28:31], 0
 ds_read_b128 a[80:83], v237 offset:10240
 v_mfma_f32_16x16x32_bf16 v[60:63], a[36:39], a[28:31], 0
 ds_read_b128 a[84:87], v237 offset:12288
 v_mfma_f32_16x16x32_bf16 v[52:55], a[36:39], a[24:27], 0
 ds_read_b128 a[88:91], v237 offset:14336
 v_mfma_f32_16x16x32_bf16 v[44:47], a[36:39], a[20:23], 0
 ds_read_b64_tr_b16 a[96:97], v239 offset:12288
 v_mfma_f32_16x16x32_bf16 v[36:39], a[36:39], a[16:19], 0
 ds_read_b64_tr_b16 a[98:99], v239 offset:12800
 v_mfma_f32_16x16x32_bf16 v[28:31], a[36:39], a[12:15], 0
 ds_read_b64_tr_b16 a[100:101], v238 offset:13312
 v_mfma_f32_16x16x32_bf16 v[20:23], a[36:39], a[8:11], 0
 ds_read_b64_tr_b16 a[102:103], v238 offset:13824
 v_mfma_f32_16x16x32_bf16 v[12:15], a[36:39], a[4:7], 0
 ds_read_b64_tr_b16 a[104:105], v239 offset:13312
 v_mfma_f32_16x16x32_bf16 v[4:7], a[36:39], a[0:3], 0
 ds_read_b64_tr_b16 a[106:107], v239 offset:13824
 v_mfma_f32_16x16x32_bf16 v[64:67], a[40:43], a[0:3], 0
 ds_read_b64_tr_b16 a[108:109], v238 offset:14336
 v_mfma_f32_16x16x32_bf16 v[72:75], a[40:43], a[4:7], 0
 ds_read_b64_tr_b16 a[110:111], v238 offset:14848
 v_mfma_f32_16x16x32_bf16 v[80:83], a[40:43], a[8:11], 0
 ds_read_b64_tr_b16 a[112:113], v239 offset:14336
 v_mfma_f32_16x16x32_bf16 v[88:91], a[40:43], a[12:15], 0
 ds_read_b64_tr_b16 a[114:115], v239 offset:14848
 v_mfma_f32_16x16x32_bf16 v[96:99], a[40:43], a[16:19], 0
 s_add_u32 m0, s37, 40960
 v_mfma_f32_16x16x32_bf16 v[104:107], a[40:43], a[20:23], 0
 buffer_load_dwordx4 v228, s[8:11], s31 offen lds
 v_mfma_f32_16x16x32_bf16 v[112:115], a[40:43], a[24:27], 0
 s_cmp_eq_u32 s88, 0
 s_cbranch_scc1 L1Q_d0
L1Q_d0_r:
 v_mfma_f32_16x16x32_bf16 v[120:123], a[40:43], a[28:31], 0
 buffer_load_dwordx4 v229, s[8:11], s31 offen offset:1024 lds
 v_mfma_f32_16x16x32_bf16 v[124:127], a[44:47], a[28:31], 0
 v_mfma_f32_16x16x32_bf16 v[116:119], a[44:47], a[24:27], 0
 buffer_load_dwordx4 v230, s[8:11], s31 offen offset:2048 lds
 v_mfma_f32_16x16x32_bf16 v[108:111], a[44:47], a[20:23], 0
 v_mfma_f32_16x16x32_bf16 v[100:103], a[44:47], a[16:19], 0
 buffer_load_dwordx4 v231, s[8:11], s31 offen offset:3072 lds
 v_mfma_f32_16x16x32_bf16 v[92:95], a[44:47], a[12:15], 0
 s_add_u32 s31, s31, 128
 v_mfma_f32_16x16x32_bf16 v[84:87], a[44:47], a[8:11], 0
 v_mfma_f32_16x16x32_bf16 v[76:79], a[44:47], a[4:7], 0
 s_add_u32 m0, s38, 24576
 v_mfma_f32_16x16x32_bf16 v[68:71], a[44:47], a[0:3], 0
 v_mfma_f32_16x16x32_bf16 v[128:131], a[0:3], a[48:51], 0
 buffer_load_dwordx4 v232, s[12:15], s32 offen lds
 v_mfma_f32_16x16x32_bf16 v[136:139], a[4:7], a[48:51], 0
 v_mfma_f32_16x16x32_bf16 v[144:147], a[8:11], a[48:51], 0
 buffer_load_dwordx4 v233, s[12:15], s32 offen offset:1024 lds
 v_mfma_f32_16x16x32_bf16 v[152:155], a[12:15], a[48:51], 0
 buffer_load_dwordx4 v234, s[12:15], s32 offen offset:2048 lds
 v_mfma_f32_16x16x32_bf16 v[160:163], a[16:19], a[48:51], 0
 v_mfma_f32_16x16x32_bf16 v[168:171], a[20:23], a[48:51], 0
 s_add_u32 s32, s32, 196608
 v_mfma_f32_16x16x32_bf16 v[176:179], a[24:27], a[48:51], 0
 v_mfma_f32_16x16x32_bf16 v[184:187], a[28:31], a[48:51], 0
 s_add_u32 m0, s38, 36864
 v_mfma_f32_16x16x32_bf16 v[188:191], a[28:31], a[52:55], 0
 v_mfma_f32_16x16x32_bf16 v[180:183], a[24:27], a[52:55], 0
 buffer_load_dwordx4 v232, s[12:15], s32 offen lds
 v_mfma_f32_16x16x32_bf16 v[172:175], a[20:23], a[52:55], 0
 buffer_load_dwordx4 v233, s[12:15], s32 offen offset:1024 lds
 v_mfma_f32_16x16x32_bf16 v[164:167], a[16:19], a[52:55], 0
 v_mfma_f32_16x16x32_bf16 v[156:159], a[12:15], a[52:55], 0
 buffer_load_dwordx4 v234, s[12:15], s32 offen offset:2048 lds
 v_mfma_f32_16x16x32_bf16 v[148:151], a[8:11], a[52:55], 0
 v_mfma_f32_16x16x32_bf16 v[140:143], a[4:7], a[52:55], 0
 s_add_u32 s32, s32, 196608
 v_mfma_f32_16x16x32_bf16 v[132:135], a[0:3], a[52:55], 0
 s_waitcnt vmcnt(3) lgkmcnt(0)
 s_barrier
 v_mfma_f32_16x16x32_bf16 v[0:3], a[92:95], a[60:63], v[0:3]
 ds_read_b64_tr_b16 a[32:33], v238 offset:24576
 v_mfma_f32_16x16x32_bf16 v[8:11], a[92:95], a[64:67], v[8:11]
 ds_read_b64_tr_b16 a[34:35], v238 offset:25088
 v_mfma_f32_16x16x32_bf16 v[16:19], a[92:95], a[68:71], v[16:19]
 ds_read_b128 a[0:3], v236 offset:36864
 v_mfma_f32_16x16x32_bf16 v[24:27], a[92:95], a[72:75], v[24:27]
 ds_read_b128 a[4:7], v236 offset:38912
 v_mfma_f32_16x16x32_bf16 v[32:35], a[92:95], a[76:79], v[32:35]
 ds_read_b128 a[8:11], v236 offset:40960
 v_mfma_f32_16x16x32_bf16 v[40:43], a[92:95], a[80:83], v[40:43]
 ds_read_b128 a[12:15], v236 offset:43008
 v_mfma_f32_16x16x32_bf16 v[48:51], a[92:95], a[84:87], v[48:51]
 ds_read_b128 a[16:19], v236 offset:45056
 v_mfma_f32_16x16x32_bf16 v[56:59], a[92:95], a[88:91], v[56:59]
 ds_read_b128 a[20:23], v236 offset:47104
 v_mfma_f32_16x16x32_bf16 v[60:63], a[96:99], a[88:91], v[60:63]
 ds_read_b128 a[24:27], v236 offset:49152
 v_mfma_f32_16x16x32_bf16 v[52:55], a[96:99], a[84:87], v[52:55]
 ds_read_b128 a[28:31], v236 offset:51200
 v_mfma_f32_16x16x32_bf16 v[44:47], a[96:99], a[80:83], v[44:47]
 ds_read_b64_tr_b16 a[36:37], v239 offset:24576
 v_mfma_f32_16x16x32_bf16 v[36:39], a[96:99], a[76:79], v[36:39]
 ds_read_b64_tr_b16 a[38:39], v239 offset:25088
 v_mfma_f32_16x16x32_bf16 v[28:31], a[96:99], a[72:75], v[28:31]
 ds_read_b64_tr_b16 a[40:41], v238 offset:25600
 v_mfma_f32_16x16x32_bf16 v[20:23], a[96:99], a[68:71], v[20:23]
 ds_read_b64_tr_b16 a[42:43], v238 offset:26112
 v_mfma_f32_16x16x32_bf16 v[12:15], a[96:99], a[64:67], v[12:15]
 ds_read_b64_tr_b16 a[44:45], v239 offset:25600
 v_mfma_f32_16x16x32_bf16 v[4:7], a[96:99], a[60:63], v[4:7]
 ds_read_b64_tr_b16 a[46:47], v239 offset:26112
 v_mfma_f32_16x16x32_bf16 v[64:67], a[100:103], a[60:63], v[64:67]
 ds_read_b64_tr_b16 a[48:49], v238 offset:26624
 v_mfma_f32_16x16x32_bf16 v[72:75], a[100:103], a[64:67], v[72:75]
 ds_read_b64_tr_b16 a[50:51], v238 offset:27136
 v_mfma_f32_16x16x32_bf16 v[80:83], a[100:103], a[68:71], v[80:83]
 ds_read_b64_tr_b16 a[52:53], v239 offset:26624
 v_mfma_f32_16x16x32_bf16 v[88:91], a[100:103], a[72:75], v[88:91]
 ds_read_b64_tr_b16 a[54:55], v239 offset:27136
 v_mfma_f32_16x16x32_bf16 v[96:99], a[100:103], a[76:79], v[96:99]
 s_add_u32 m0, s37, 73728
 v_mfma_f32_16x16x32_bf16 v[104:107], a[100:103], a[80:83], v[104:107]
 buffer_load_dwordx4 v224, s[8:11], s31 offen lds
 v_mfma_f32_16x16x32_bf16 v[112:115], a[100:103], a[84:87], v[112:115]
 buffer_load_dwordx4 v225, s[8:11], s31 offen offset:1024 lds
 v_mfma_f32_16x16x32_bf16 v[120:123], a[100:103], a[88:91], v[120:123]
 s_cmp_eq_u32 s88, 0
 s_cbranch_scc1 L1Q_d1
L1Q_d1_r:
 v_mfma_f32_16x16x32_bf16 v[124:127], a[104:107], a[88:91], v[124:127]
 buffer_load_dwordx4 v226, s[8:11], s31 offen offset:2048 lds
 v_mfma_f32_16x16x32_bf16 v[116:119], a[104:107], a[84:87], v[116:119]
 buffer_load_dwordx4 v227, s[8:11], s31 offen offset:3072 lds
 v_mfma_f32_16x16x32_bf16 v[108:111], a[104:107], a[80:83], v[108:111]
 s_add_u32 m0, s37, 77824
 v_mfma_f32_16x16x32_bf16 v[100:103], a[104:107], a[76:79], v[100:103]
 v_mfma_f32_16x16x32_bf16 v[92:95], a[104:107], a[72:75], v[92:95]
 buffer_load_dwordx4 v228, s[8:11], s31 offen lds
 v_mfma_f32_16x16x32_bf16 v[84:87], a[104:107], a[68:71], v[84:87]
 buffer_load_dwordx4 v229, s[8:11], s31 offen offset:1024 lds
 v_mfma_f32_16x16x32_bf16 v[76:79], a[104:107], a[64:67], v[76:79]
 buffer_load_dwordx4 v230, s[8:11], s31 offen offset:2048 lds
 v_mfma_f32_16x16x32_bf16 v[68:71], a[104:107], a[60:63], v[68:71]
 v_mfma_f32_16x16x32_bf16 v[128:131], a[60:63], a[108:111], v[128:131]
 buffer_load_dwordx4 v231, s[8:11], s31 offen offset:3072 lds
 v_mfma_f32_16x16x32_bf16 v[136:139], a[64:67], a[108:111], v[136:139]
 s_add_u32 s31, s31, 128
 v_mfma_f32_16x16x32_bf16 v[144:147], a[68:71], a[108:111], v[144:147]
 s_add_u32 m0, s38, 0
 v_mfma_f32_16x16x32_bf16 v[152:155], a[72:75], a[108:111], v[152:155]
 v_mfma_f32_16x16x32_bf16 v[160:163], a[76:79], a[108:111], v[160:163]
 buffer_load_dwordx4 v232, s[12:15], s32 offen lds
 v_mfma_f32_16x16x32_bf16 v[168:171], a[80:83], a[108:111], v[168:171]
 buffer_load_dwordx4 v233, s[12:15], s32 offen offset:1024 lds
 v_mfma_f32_16x16x32_bf16 v[176:179], a[84:87], a[108:111], v[176:179]
 buffer_load_dwordx4 v234, s[12:15], s32 offen offset:2048 lds
 v_mfma_f32_16x16x32_bf16 v[184:187], a[88:91], a[108:111], v[184:187]
 v_mfma_f32_16x16x32_bf16 v[188:191], a[88:91], a[112:115], v[188:191]
 s_add_u32 s32, s32, 196608
 v_mfma_f32_16x16x32_bf16 v[180:183], a[84:87], a[112:115], v[180:183]
 s_xor_b32 s6, s44, 1024
 v_mfma_f32_16x16x32_bf16 v[172:175], a[80:83], a[112:115], v[172:175]
 s_add_u32 s6, s6, 384
 v_mfma_f32_16x16x32_bf16 v[164:167], a[76:79], a[112:115], v[164:167]
 v_mfma_f32_16x16x32_bf16 v[156:159], a[72:75], a[112:115], v[156:159]
 buffer_load_dword v251, v247, s[8:11], s6 offen
 v_mfma_f32_16x16x32_bf16 v[148:151], a[68:71], a[112:115], v[148:151]
 s_add_u32 s6, s43, 1179648
 v_mfma_f32_16x16x32_bf16 v[140:143], a[64:67], a[112:115], v[140:143]
 buffer_load_dword v251, v252, s[12:15], s6 offen
 v_mfma_f32_16x16x32_bf16 v[132:135], a[60:63], a[112:115], v[132:135]
 s_waitcnt vmcnt(13) lgkmcnt(0)
 s_barrier
 v_mfma_f32_16x16x32_bf16 v[0:3], a[32:35], a[0:3], v[0:3]
 ds_read_b64_tr_b16 a[92:93], v238 offset:36864
 v_mfma_f32_16x16x32_bf16 v[8:11], a[32:35], a[4:7], v[8:11]
 ds_read_b64_tr_b16 a[94:95], v238 offset:37376
 v_mfma_f32_16x16x32_bf16 v[16:19], a[32:35], a[8:11], v[16:19]
 ds_read_b128 a[60:63], v237 offset:36864
 v_mfma_f32_16x16x32_bf16 v[24:27], a[32:35], a[12:15], v[24:27]
 ds_read_b128 a[64:67], v237 offset:38912
 v_mfma_f32_16x16x32_bf16 v[32:35], a[32:35], a[16:19], v[32:35]
 ds_read_b128 a[68:71], v237 offset:40960
 v_mfma_f32_16x16x32_bf16 v[40:43], a[32:35], a[20:23], v[40:43]
 ds_read_b128 a[72:75], v237 offset:43008
 v_mfma_f32_16x16x32_bf16 v[48:51], a[32:35], a[24:27], v[48:51]
 ds_read_b128 a[76:79], v237 offset:45056
 v_mfma_f32_16x16x32_bf16 v[56:59], a[32:35], a[28:31], v[56:59]
 ds_read_b128 a[80:83], v237 offset:47104
 v_mfma_f32_16x16x32_bf16 v[60:63], a[36:39], a[28:31], v[60:63]
 ds_read_b128 a[84:87], v237 offset:49152
 v_mfma_f32_16x16x32_bf16 v[52:55], a[36:39], a[24:27], v[52:55]
 ds_read_b128 a[88:91], v237 offset:51200
 v_mfma_f32_16x16x32_bf16 v[44:47], a[36:39], a[20:23], v[44:47]
 ds_read_b64_tr_b16 a[96:97], v239 offset:36864
 v_mfma_f32_16x16x32_bf16 v[36:39], a[36:39], a[16:19], v[36:39]
 ds_read_b64_tr_b16 a[98:99], v239 offset:37376
 v_mfma_f32_16x16x32_bf16 v[28:31], a[36:39], a[12:15], v[28:31]
 ds_read_b64_tr_b16 a[100:101], v238 offset:37888
 v_mfma_f32_16x16x32_bf16 v[20:23], a[36:39], a[8:11], v[20:23]
 ds_read_b64_tr_b16 a[102:103], v238 offset:38400
 v_mfma_f32_16x16x32_bf16 v[12:15], a[36:39], a[4:7], v[12:15]
 ds_read_b64_tr_b16 a[104:105], v239 offset:37888
 v_mfma_f32_16x16x32_bf16 v[4:7], a[36:39], a[0:3], v[4:7]
 ds_read_b64_tr_b16 a[106:107], v239 offset:38400
 v_mfma_f32_16x16x32_bf16 v[64:67], a[40:43], a[0:3], v[64:67]
 ds_read_b64_tr_b16 a[108:109], v238 offset:38912
 v_mfma_f32_16x16x32_bf16 v[72:75], a[40:43], a[4:7], v[72:75]
 ds_read_b64_tr_b16 a[110:111], v238 offset:39424
 v_mfma_f32_16x16x32_bf16 v[80:83], a[40:43], a[8:11], v[80:83]
 ds_read_b64_tr_b16 a[112:113], v239 offset:38912
 v_mfma_f32_16x16x32_bf16 v[88:91], a[40:43], a[12:15], v[88:91]
 ds_read_b64_tr_b16 a[114:115], v239 offset:39424
 v_mfma_f32_16x16x32_bf16 v[96:99], a[40:43], a[16:19], v[96:99]
 s_add_u32 m0, s38, 12288
 v_mfma_f32_16x16x32_bf16 v[104:107], a[40:43], a[20:23], v[104:107]
 buffer_load_dwordx4 v232, s[12:15], s32 offen lds
 v_mfma_f32_16x16x32_bf16 v[112:115], a[40:43], a[24:27], v[112:115]
 s_cmp_eq_u32 s88, 0
 s_cbranch_scc1 L1Q_d2
L1Q_d2_r:
 v_mfma_f32_16x16x32_bf16 v[120:123], a[40:43], a[28:31], v[120:123]
 buffer_load_dwordx4 v233, s[12:15], s32 offen offset:1024 lds
 v_mfma_f32_16x16x32_bf16 v[124:127], a[44:47], a[28:31], v[124:127]
 buffer_load_dwordx4 v234, s[12:15], s32 offen offset:2048 lds
 v_mfma_f32_16x16x32_bf16 v[116:119], a[44:47], a[24:27], v[116:119]
 v_mfma_f32_16x16x32_bf16 v[108:111], a[44:47], a[20:23], v[108:111]
 s_add_u32 s32, s32, 196608
 v_mfma_f32_16x16x32_bf16 v[100:103], a[44:47], a[16:19], v[100:103]
 ds_read_b64_tr_b16 a[120:121], v240
 v_mfma_f32_16x16x32_bf16 v[92:95], a[44:47], a[12:15], v[92:95]
 s_add_u32 m0, s37, 0
 v_mfma_f32_16x16x32_bf16 v[84:87], a[44:47], a[8:11], v[84:87]
 buffer_load_dwordx4 v224, s[8:11], s31 offen lds
 v_mfma_f32_16x16x32_bf16 v[76:79], a[44:47], a[4:7], v[76:79]
 v_mfma_f32_16x16x32_bf16 v[68:71], a[44:47], a[0:3], v[68:71]
 buffer_load_dwordx4 v225, s[8:11], s31 offen offset:1024 lds
 v_mfma_f32_16x16x32_bf16 v[128:131], a[0:3], a[48:51], v[128:131]
 ds_read_b64_tr_b16 a[122:123], v240 offset:256
 v_mfma_f32_16x16x32_bf16 v[136:139], a[4:7], a[48:51], v[136:139]
 buffer_load_dwordx4 v226, s[8:11], s31 offen offset:2048 lds
 v_mfma_f32_16x16x32_bf16 v[144:147], a[8:11], a[48:51], v[144:147]
 buffer_load_dwordx4 v227, s[8:11], s31 offen offset:3072 lds
 v_mfma_f32_16x16x32_bf16 v[152:155], a[12:15], a[48:51], v[152:155]
 v_mfma_f32_16x16x32_bf16 v[160:163], a[16:19], a[48:51], v[160:163]
 s_add_u32 m0, s38, 24576
 v_mfma_f32_16x16x32_bf16 v[168:171], a[20:23], a[48:51], v[168:171]
 ds_read_b64_tr_b16 a[124:125], v240 offset:1024
 v_mfma_f32_16x16x32_bf16 v[176:179], a[24:27], a[48:51], v[176:179]
 buffer_load_dwordx4 v232, s[12:15], s32 offen lds
 v_mfma_f32_16x16x32_bf16 v[184:187], a[28:31], a[48:51], v[184:187]
 buffer_load_dwordx4 v233, s[12:15], s32 offen offset:1024 lds
 v_mfma_f32_16x16x32_bf16 v[188:191], a[28:31], a[52:55], v[188:191]
 v_mfma_f32_16x16x32_bf16 v[180:183], a[24:27], a[52:55], v[180:183]
 buffer_load_dwordx4 v234, s[12:15], s32 offen offset:2048 lds
 v_mfma_f32_16x16x32_bf16 v[172:175], a[20:23], a[52:55], v[172:175]
 ds_read_b64_tr_b16 a[126:127], v240 offset:1280
 v_mfma_f32_16x16x32_bf16 v[164:167], a[16:19], a[52:55], v[164:167]
 s_add_u32 s32, s32, 196608
 v_mfma_f32_16x16x32_bf16 v[156:159], a[12:15], a[52:55], v[156:159]
 buffer_load_dwordx4 v[200:203], v199, s[8:11], 0 offen
 v_mfma_f32_16x16x32_bf16 v[148:151], a[8:11], a[52:55], v[148:151]
 v_mfma_f32_16x16x32_bf16 v[140:143], a[4:7], a[52:55], v[140:143]
 buffer_load_dwordx4 v[204:207], v199, s[8:11], 0 offen offset:1024
 v_mfma_f32_16x16x32_bf16 v[132:135], a[0:3], a[52:55], v[132:135]
 s_waitcnt vmcnt(14) lgkmcnt(0)
 s_barrier
 v_mfma_f32_16x16x32_bf16 v[0:3], a[92:95], a[60:63], v[0:3]
 ds_read_b64_tr_b16 a[32:33], v238
 v_mfma_f32_16x16x32_bf16 v[8:11], a[92:95], a[64:67], v[8:11]
 ds_read_b64_tr_b16 a[34:35], v238 offset:512
 v_mfma_f32_16x16x32_bf16 v[16:19], a[92:95], a[68:71], v[16:19]
 ds_read_b128 a[0:3], v241
 v_mfma_f32_16x16x32_bf16 v[24:27], a[92:95], a[72:75], v[24:27]
 ds_read_b128 a[4:7], v241 offset:2048
 v_mfma_f32_16x16x32_bf16 v[32:35], a[92:95], a[76:79], v[32:35]
 ds_read_b128 a[8:11], v241 offset:4096
 v_mfma_f32_16x16x32_bf16 v[40:43], a[92:95], a[80:83], v[40:43]
 ds_read_b128 a[12:15], v241 offset:6144
 v_mfma_f32_16x16x32_bf16 v[48:51], a[92:95], a[84:87], v[48:51]
 ds_read_b128 a[16:19], v241 offset:8192
 v_mfma_f32_16x16x32_bf16 v[56:59], a[92:95], a[88:91], v[56:59]
 ds_read_b128 a[20:23], v241 offset:10240
 v_mfma_f32_16x16x32_bf16 v[60:63], a[96:99], a[88:91], v[60:63]
 ds_read_b128 a[24:27], v241 offset:12288
 v_mfma_f32_16x16x32_bf16 v[52:55], a[96:99], a[84:87], v[52:55]
 ds_read_b128 a[28:31], v241 offset:14336
 v_mfma_f32_16x16x32_bf16 v[44:47], a[96:99], a[80:83], v[44:47]
 ds_read_b64_tr_b16 a[36:37], v239
 v_mfma_f32_16x16x32_bf16 v[36:39], a[96:99], a[76:79], v[36:39]
 ds_read_b64_tr_b16 a[38:39], v239 offset:512
 v_mfma_f32_16x16x32_bf16 v[28:31], a[96:99], a[72:75], v[28:31]
 ds_read_b64_tr_b16 a[40:41], v238 offset:1024
 v_mfma_f32_16x16x32_bf16 v[20:23], a[96:99], a[68:71], v[20:23]
 ds_read_b64_tr_b16 a[42:43], v238 offset:1536
 v_mfma_f32_16x16x32_bf16 v[12:15], a[96:99], a[64:67], v[12:15]
 ds_read_b64_tr_b16 a[44:45], v239 offset:1024
 v_mfma_f32_16x16x32_bf16 v[4:7], a[96:99], a[60:63], v[4:7]
 ds_read_b64_tr_b16 a[46:47], v239 offset:1536
 v_mfma_f32_16x16x32_bf16 v[64:67], a[100:103], a[60:63], v[64:67]
 ds_read_b64_tr_b16 a[48:49], v238 offset:2048
 v_mfma_f32_16x16x32_bf16 v[72:75], a[100:103], a[64:67], v[72:75]
 ds_read_b64_tr_b16 a[50:51], v238 offset:2560
 v_mfma_f32_16x16x32_bf16 v[80:83], a[100:103], a[68:71], v[80:83]
 ds_read_b64_tr_b16 a[52:53], v239 offset:2048
 v_mfma_f32_16x16x32_bf16 v[88:91], a[100:103], a[72:75], v[88:91]
 ds_read_b64_tr_b16 a[54:55], v239 offset:2560
 v_mfma_f32_16x16x32_bf16 v[96:99], a[100:103], a[76:79], v[96:99]
 s_add_u32 m0, s37, 4096
 v_mfma_f32_16x16x32_bf16 v[104:107], a[100:103], a[80:83], v[104:107]
 buffer_load_dwordx4 v228, s[8:11], s31 offen lds
 v_mfma_f32_16x16x32_bf16 v[112:115], a[100:103], a[84:87], v[112:115]
 buffer_load_dwordx4 v229, s[8:11], s31 offen offset:1024 lds
 v_mfma_f32_16x16x32_bf16 v[120:123], a[100:103], a[88:91], v[120:123]
 buffer_load_dwordx4 v230, s[8:11], s31 offen offset:2048 lds
 v_mfma_f32_16x16x32_bf16 v[124:127], a[104:107], a[88:91], v[124:127]
 buffer_load_dwordx4 v231, s[8:11], s31 offen offset:3072 lds
 v_mfma_f32_16x16x32_bf16 v[116:119], a[104:107], a[84:87], v[116:119]
 s_cmp_eq_u32 s88, 0
 s_cbranch_scc1 L1Q_d3
L1Q_d3_r:
 v_mfma_f32_16x16x32_bf16 v[108:111], a[104:107], a[80:83], v[108:111]
 s_add_u32 s31, s31, 128
 v_mfma_f32_16x16x32_bf16 v[100:103], a[104:107], a[76:79], v[100:103]
 s_add_u32 m0, s38, 36864
 v_mfma_f32_16x16x32_bf16 v[92:95], a[104:107], a[72:75], v[92:95]
 buffer_load_dwordx4 v232, s[12:15], s32 offen lds
 v_mfma_f32_16x16x32_bf16 v[84:87], a[104:107], a[68:71], v[84:87]
 buffer_load_dwordx4 v233, s[12:15], s32 offen offset:1024 lds
 v_mfma_f32_16x16x32_bf16 v[76:79], a[104:107], a[64:67], v[76:79]
 buffer_load_dwordx4 v234, s[12:15], s32 offen offset:2048 lds
 v_mfma_f32_16x16x32_bf16 v[68:71], a[104:107], a[60:63], v[68:71]
 v_mfma_f32_16x16x32_bf16 v[128:131], a[60:63], a[108:111], v[128:131]
 s_add_u32 s32, s32, 196608
 v_mfma_f32_16x16x32_bf16 v[136:139], a[64:67], a[108:111], v[136:139]
 s_add_u32 m0, s37, 36864
 v_mfma_f32_16x16x32_bf16 v[144:147], a[68:71], a[108:111], v[144:147]
 buffer_load_dwordx4 v224, s[8:11], s31 offen lds
 v_mfma_f32_16x16x32_bf16 v[152:155], a[72:75], a[108:111], v[152:155]
 buffer_load_dwordx4 v225, s[8:11], s31 offen offset:1024 lds
 v_mfma_f32_16x16x32_bf16 v[160:163], a[76:79], a[108:111], v[160:163]
 v_mfma_f32_16x16x32_bf16 v[168:171], a[80:83], a[108:111], v[168:171]
 buffer_load_dwordx4 v226, s[8:11], s31 offen offset:2048 lds
 v_mfma_f32_16x16x32_bf16 v[176:179], a[84:87], a[108:111], v[176:179]
 buffer_load_dwordx4 v227, s[8:11], s31 offen offset:3072 lds
 v_mfma_f32_16x16x32_bf16 v[184:187], a[88:91], a[108:111], v[184:187]
 buffer_load_dwordx4 v[208:211], v199, s[8:11], 0 offen offset:2048
 v_mfma_f32_16x16x32_bf16 v[188:191], a[88:91], a[112:115], v[188:191]
 buffer_load_dwordx4 v[212:215], v199, s[8:11], 0 offen offset:3072
 v_mfma_f32_16x16x32_bf16 v[180:183], a[84:87], a[112:115], v[180:183]
 s_xor_b32 s6, s44, 1024
 v_mfma_f32_16x16x32_bf16 v[172:175], a[80:83], a[112:115], v[172:175]
 v_mfma_f32_16x16x32_bf16 v[164:167], a[76:79], a[112:115], v[164:167]
 s_add_u32 s6, s6, 512
 v_mfma_f32_16x16x32_bf16 v[156:159], a[72:75], a[112:115], v[156:159]
 buffer_load_dword v251, v247, s[8:11], s6 offen
 v_mfma_f32_16x16x32_bf16 v[148:151], a[68:71], a[112:115], v[148:151]
 s_add_u32 s6, s43, 1572864
 v_mfma_f32_16x16x32_bf16 v[140:143], a[64:67], a[112:115], v[140:143]
 buffer_load_dword v251, v252, s[12:15], s6 offen
 v_mfma_f32_16x16x32_bf16 v[132:135], a[60:63], a[112:115], v[132:135]
 s_waitcnt vmcnt(24) lgkmcnt(0)
 s_barrier
 v_mfma_f32_16x16x32_bf16 v[0:3], a[32:35], a[0:3], v[0:3]
 ds_read_b64_tr_b16 a[92:93], v238 offset:12288
 v_mfma_f32_16x16x32_bf16 v[8:11], a[32:35], a[4:7], v[8:11]
 ds_read_b64_tr_b16 a[94:95], v238 offset:12800
 v_mfma_f32_16x16x32_bf16 v[16:19], a[32:35], a[8:11], v[16:19]
 ds_read_b128 a[60:63], v242
 v_mfma_f32_16x16x32_bf16 v[24:27], a[32:35], a[12:15], v[24:27]
 ds_read_b128 a[64:67], v242 offset:2048
 v_mfma_f32_16x16x32_bf16 v[32:35], a[32:35], a[16:19], v[32:35]
 ds_read_b128 a[68:71], v242 offset:4096
 v_mfma_f32_16x16x32_bf16 v[40:43], a[32:35], a[20:23], v[40:43]
 ds_read_b128 a[72:75], v242 offset:6144
 v_mfma_f32_16x16x32_bf16 v[48:51], a[32:35], a[24:27], v[48:51]
 ds_read_b128 a[76:79], v242 offset:8192
 v_mfma_f32_16x16x32_bf16 v[56:59], a[32:35], a[28:31], v[56:59]
 ds_read_b128 a[80:83], v242 offset:10240
 v_mfma_f32_16x16x32_bf16 v[60:63], a[36:39], a[28:31], v[60:63]
 ds_read_b128 a[84:87], v242 offset:12288
 v_mfma_f32_16x16x32_bf16 v[52:55], a[36:39], a[24:27], v[52:55]
 ds_read_b128 a[88:91], v242 offset:14336
 v_mfma_f32_16x16x32_bf16 v[44:47], a[36:39], a[20:23], v[44:47]
 ds_read_b64_tr_b16 a[96:97], v239 offset:12288
 v_mfma_f32_16x16x32_bf16 v[36:39], a[36:39], a[16:19], v[36:39]
 ds_read_b64_tr_b16 a[98:99], v239 offset:12800
 v_mfma_f32_16x16x32_bf16 v[28:31], a[36:39], a[12:15], v[28:31]
 ds_read_b64_tr_b16 a[100:101], v238 offset:13312
 v_mfma_f32_16x16x32_bf16 v[20:23], a[36:39], a[8:11], v[20:23]
 ds_read_b64_tr_b16 a[102:103], v238 offset:13824
 v_mfma_f32_16x16x32_bf16 v[12:15], a[36:39], a[4:7], v[12:15]
 ds_read_b64_tr_b16 a[104:105], v239 offset:13312
 v_mfma_f32_16x16x32_bf16 v[4:7], a[36:39], a[0:3], v[4:7]
 ds_read_b64_tr_b16 a[106:107], v239 offset:13824
 v_mfma_f32_16x16x32_bf16 v[64:67], a[40:43], a[0:3], v[64:67]
 ds_read_b64_tr_b16 a[108:109], v238 offset:14336
 v_mfma_f32_16x16x32_bf16 v[72:75], a[40:43], a[4:7], v[72:75]
 ds_read_b64_tr_b16 a[110:111], v238 offset:14848
 v_mfma_f32_16x16x32_bf16 v[80:83], a[40:43], a[8:11], v[80:83]
 ds_read_b64_tr_b16 a[112:113], v239 offset:14336
 v_mfma_f32_16x16x32_bf16 v[88:91], a[40:43], a[12:15], v[88:91]
 ds_read_b64_tr_b16 a[114:115], v239 offset:14848
 v_mfma_f32_16x16x32_bf16 v[96:99], a[40:43], a[16:19], v[96:99]
 s_cmp_eq_u32 s88, 0
 s_cselect_b32 s4, s75, s5
 v_mfma_f32_16x16x32_bf16 v[104:107], a[40:43], a[20:23], v[104:107]
 s_cmp_eq_u32 s88, 1
 s_cbranch_scc1 L1Q_d4
L1Q_d4_r:
 v_mfma_f32_16x16x32_bf16 v[112:115], a[40:43], a[24:27], v[112:115]
 buffer_store_dwordx4 a[156:159], v192, s[92:95], s4 offen sc1
 v_mfma_f32_16x16x32_bf16 v[120:123], a[40:43], a[28:31], v[120:123]
 v_mfma_f32_16x16x32_bf16 v[124:127], a[44:47], a[28:31], v[124:127]
 s_add_u32 m0, s38, 0
 v_mfma_f32_16x16x32_bf16 v[116:119], a[44:47], a[24:27], v[116:119]
 v_mfma_f32_16x16x32_bf16 v[108:111], a[44:47], a[20:23], v[108:111]
 buffer_load_dwordx4 v232, s[12:15], s32 offen lds
 v_mfma_f32_16x16x32_bf16 v[100:103], a[44:47], a[16:19], v[100:103]
 v_mfma_f32_16x16x32_bf16 v[92:95], a[44:47], a[12:15], v[92:95]
 buffer_load_dwordx4 v233, s[12:15], s32 offen offset:1024 lds
 v_mfma_f32_16x16x32_bf16 v[84:87], a[44:47], a[8:11], v[84:87]
 v_mfma_f32_16x16x32_bf16 v[76:79], a[44:47], a[4:7], v[76:79]
 buffer_load_dwordx4 v234, s[12:15], s32 offen offset:2048 lds
 v_mfma_f32_16x16x32_bf16 v[68:71], a[44:47], a[0:3], v[68:71]
 v_mfma_f32_16x16x32_bf16 v[128:131], a[0:3], a[48:51], v[128:131]
 s_add_u32 s32, s32, 196608
 v_mfma_f32_16x16x32_bf16 v[136:139], a[4:7], a[48:51], v[136:139]
 v_mfma_f32_16x16x32_bf16 v[144:147], a[8:11], a[48:51], v[144:147]
 v_mfma_f32_16x16x32_bf16 v[152:155], a[12:15], a[48:51], v[152:155]
 s_add_u32 m0, s37, 40960
 v_mfma_f32_16x16x32_bf16 v[160:163], a[16:19], a[48:51], v[160:163]
 v_mfma_f32_16x16x32_bf16 v[168:171], a[20:23], a[48:51], v[168:171]
 buffer_load_dwordx4 v228, s[8:11], s31 offen lds
 v_mfma_f32_16x16x32_bf16 v[176:179], a[24:27], a[48:51], v[176:179]
 v_mfma_f32_16x16x32_bf16 v[184:187], a[28:31], a[48:51], v[184:187]
 buffer_load_dwordx4 v229, s[8:11], s31 offen offset:1024 lds
 v_mfma_f32_16x16x32_bf16 v[188:191], a[28:31], a[52:55], v[188:191]
 v_mfma_f32_16x16x32_bf16 v[180:183], a[24:27], a[52:55], v[180:183]
 buffer_load_dwordx4 v230, s[8:11], s31 offen offset:2048 lds
 v_mfma_f32_16x16x32_bf16 v[172:175], a[20:23], a[52:55], v[172:175]
 v_mfma_f32_16x16x32_bf16 v[164:167], a[16:19], a[52:55], v[164:167]
 buffer_load_dwordx4 v231, s[8:11], s31 offen offset:3072 lds
 v_mfma_f32_16x16x32_bf16 v[156:159], a[12:15], a[52:55], v[156:159]
 v_mfma_f32_16x16x32_bf16 v[148:151], a[8:11], a[52:55], v[148:151]
 s_add_u32 s31, s31, 128
 v_mfma_f32_16x16x32_bf16 v[140:143], a[4:7], a[52:55], v[140:143]
 v_mfma_f32_16x16x32_bf16 v[132:135], a[0:3], a[52:55], v[132:135]
 s_waitcnt vmcnt(19) lgkmcnt(0)
 s_barrier
 v_mfma_f32_16x16x32_bf16 v[0:3], a[92:95], a[60:63], v[0:3]
 ds_read_b64_tr_b16 a[32:33], v238 offset:24576
 v_mfma_f32_16x16x32_bf16 v[8:11], a[92:95], a[64:67], v[8:11]
 ds_read_b64_tr_b16 a[34:35], v238 offset:25088
 v_mfma_f32_16x16x32_bf16 v[16:19], a[92:95], a[68:71], v[16:19]
 ds_read_b128 a[0:3], v236
 v_mfma_f32_16x16x32_bf16 v[24:27], a[92:95], a[72:75], v[24:27]
 ds_read_b128 a[4:7], v236 offset:2048
 v_mfma_f32_16x16x32_bf16 v[32:35], a[92:95], a[76:79], v[32:35]
 ds_read_b128 a[8:11], v236 offset:4096
 v_mfma_f32_16x16x32_bf16 v[40:43], a[92:95], a[80:83], v[40:43]
 ds_read_b128 a[12:15], v236 offset:6144
 s_cmp_eq_u32 s88, 1
 s_cbranch_scc1 L1Q_d5
L1Q_d5_r:
 v_mfma_f32_16x16x32_bf16 v[48:51], a[92:95], a[84:87], v[48:51]
 ds_read_b128 a[16:19], v236 offset:8192
 v_and_b32 v216, 0xffff0000, v200
 v_mfma_f32_16x16x32_bf16 v[56:59], a[92:95], a[88:91], v[56:59]
 ds_read_b128 a[20:23], v236 offset:10240
 v_lshlrev_b32 v200, 16, v200
 v_mfma_f32_16x16x32_bf16 v[60:63], a[96:99], a[88:91], v[60:63]
 ds_read_b128 a[24:27], v236 offset:12288
 v_and_b32 v217, 0xffff0000, v201
 v_mfma_f32_16x16x32_bf16 v[52:55], a[96:99], a[84:87], v[52:55]
 ds_read_b128 a[28:31], v236 offset:14336
 v_lshlrev_b32_e64 v201, 16, v201
 v_mfma_f32_16x16x32_bf16 v[44:47], a[96:99], a[80:83], v[44:47]
 ds_read_b64_tr_b16 a[36:37], v239 offset:24576
 v_and_b32 v218, 0xffff0000, v202
 v_mfma_f32_16x16x32_bf16 v[36:39], a[96:99], a[76:79], v[36:39]
 ds_read_b64_tr_b16 a[38:39], v239 offset:25088
 v_lshlrev_b32_e64 v202, 16, v202
 v_mfma_f32_16x16x32_bf16 v[28:31], a[96:99], a[72:75], v[28:31]
 ds_read_b64_tr_b16 a[40:41], v238 offset:25600
 v_and_b32 v219, 0xffff0000, v203
 v_mfma_f32_16x16x32_bf16 v[20:23], a[96:99], a[68:71], v[20:23]
 ds_read_b64_tr_b16 a[42:43], v238 offset:26112
 v_lshlrev_b32_e64 v203, 16, v203
 v_mfma_f32_16x16x32_bf16 v[12:15], a[96:99], a[64:67], v[12:15]
 ds_read_b64_tr_b16 a[44:45], v239 offset:25600
 v_and_b32 v220, 0xffff0000, v204
 v_mfma_f32_16x16x32_bf16 v[4:7], a[96:99], a[60:63], v[4:7]
 ds_read_b64_tr_b16 a[46:47], v239 offset:26112
 v_lshlrev_b32_e64 v204, 16, v204
 v_mfma_f32_16x16x32_bf16 v[64:67], a[100:103], a[60:63], v[64:67]
 ds_read_b64_tr_b16 a[48:49], v238 offset:26624
 v_and_b32 v221, 0xffff0000, v205
 v_mfma_f32_16x16x32_bf16 v[72:75], a[100:103], a[64:67], v[72:75]
 ds_read_b64_tr_b16 a[50:51], v238 offset:27136
 v_lshlrev_b32_e64 v205, 16, v205
 v_mfma_f32_16x16x32_bf16 v[80:83], a[100:103], a[68:71], v[80:83]
 ds_read_b64_tr_b16 a[52:53], v239 offset:26624
 v_and_b32 v222, 0xffff0000, v206
 v_mfma_f32_16x16x32_bf16 v[88:91], a[100:103], a[72:75], v[88:91]
 ds_read_b64_tr_b16 a[54:55], v239 offset:27136
 v_lshlrev_b32_e64 v206, 16, v206
 v_mfma_f32_16x16x32_bf16 v[96:99], a[100:103], a[76:79], v[96:99]
 s_add_u32 m0, s38, 12288
 v_mfma_f32_16x16x32_bf16 v[104:107], a[100:103], a[80:83], v[104:107]
 buffer_load_dwordx4 v232, s[12:15], s32 offen lds
 v_mfma_f32_16x16x32_bf16 v[112:115], a[100:103], a[84:87], v[112:115]
 v_and_b32 v223, 0xffff0000, v207
 v_mfma_f32_16x16x32_bf16 v[120:123], a[100:103], a[88:91], v[120:123]
 buffer_load_dwordx4 v233, s[12:15], s32 offen offset:1024 lds
 v_mfma_f32_16x16x32_bf16 v[124:127], a[104:107], a[88:91], v[124:127]
 v_lshlrev_b32_e64 v207, 16, v207
 v_mfma_f32_16x16x32_bf16 v[116:119], a[104:107], a[84:87], v[116:119]
 buffer_load_dwordx4 v234, s[12:15], s32 offen offset:2048 lds
 v_mfma_f32_16x16x32_bf16 v[108:111], a[104:107], a[80:83], v[108:111]
 v_add_f32_e64 v244, v200, v201
 v_mfma_f32_16x16x32_bf16 v[100:103], a[104:107], a[76:79], v[100:103]
 s_add_u32 s32, s32, 196608
 v_mfma_f32_16x16x32_bf16 v[92:95], a[104:107], a[72:75], v[92:95]
 v_add_f32_e64 v245, v216, v217
 v_mfma_f32_16x16x32_bf16 v[84:87], a[104:107], a[68:71], v[84:87]
 s_add_u32 m0, s37, 73728
 v_mfma_f32_16x16x32_bf16 v[76:79], a[104:107], a[64:67], v[76:79]
 v_add_f32_e64 v244, v244, v202
 v_mfma_f32_16x16x32_bf16 v[68:71], a[104:107], a[60:63], v[68:71]
 buffer_load_dwordx4 v224, s[8:11], s31 offen lds
 v_mfma_f32_16x16x32_bf16 v[128:131], a[60:63], a[108:111], v[128:131]
 v_add_f32_e64 v245, v245, v218
 v_mfma_f32_16x16x32_bf16 v[136:139], a[64:67], a[108:111], v[136:139]
 buffer_load_dwordx4 v225, s[8:11], s31 offen offset:1024 lds
 v_mfma_f32_16x16x32_bf16 v[144:147], a[68:71], a[108:111], v[144:147]
 buffer_load_dwordx4 v226, s[8:11], s31 offen offset:2048 lds
 v_mfma_f32_16x16x32_bf16 v[152:155], a[72:75], a[108:111], v[152:155]
 v_add_f32_e64 v244, v244, v203
 v_mfma_f32_16x16x32_bf16 v[160:163], a[76:79], a[108:111], v[160:163]
 buffer_load_dwordx4 v227, s[8:11], s31 offen offset:3072 lds
 v_mfma_f32_16x16x32_bf16 v[168:171], a[80:83], a[108:111], v[168:171]
 v_add_f32_e64 v245, v245, v219
 v_mfma_f32_16x16x32_bf16 v[176:179], a[84:87], a[108:111], v[176:179]
 s_xor_b32 s6, s44, 1024
 v_mfma_f32_16x16x32_bf16 v[184:187], a[88:91], a[108:111], v[184:187]
 v_add_f32_e64 v244, v244, v204
 v_mfma_f32_16x16x32_bf16 v[188:191], a[88:91], a[112:115], v[188:191]
 s_add_u32 s6, s6, 640
 v_mfma_f32_16x16x32_bf16 v[180:183], a[84:87], a[112:115], v[180:183]
 v_add_f32_e64 v245, v245, v220
 v_mfma_f32_16x16x32_bf16 v[172:175], a[80:83], a[112:115], v[172:175]
 buffer_load_dword v251, v247, s[8:11], s6 offen
 v_mfma_f32_16x16x32_bf16 v[164:167], a[76:79], a[112:115], v[164:167]
 v_add_f32_e64 v244, v244, v205
 v_mfma_f32_16x16x32_bf16 v[156:159], a[72:75], a[112:115], v[156:159]
 s_add_u32 s6, s43, 1966080
 v_mfma_f32_16x16x32_bf16 v[148:151], a[68:71], a[112:115], v[148:151]
 v_add_f32_e64 v245, v245, v221
 v_mfma_f32_16x16x32_bf16 v[140:143], a[64:67], a[112:115], v[140:143]
 buffer_load_dword v251, v252, s[12:15], s6 offen
 v_mfma_f32_16x16x32_bf16 v[132:135], a[60:63], a[112:115], v[132:135]
 v_add_f32_e64 v244, v244, v206
 s_waitcnt vmcnt(16) lgkmcnt(0)
 s_barrier
 v_mfma_f32_16x16x32_bf16 v[0:3], a[32:35], a[0:3], v[0:3]
 ds_read_b64_tr_b16 a[92:93], v238 offset:36864
 v_mfma_f32_16x16x32_bf16 v[8:11], a[32:35], a[4:7], v[8:11]
 ds_read_b64_tr_b16 a[94:95], v238 offset:37376
 v_mfma_f32_16x16x32_bf16 v[16:19], a[32:35], a[8:11], v[16:19]
 ds_read_b128 a[60:63], v237
 v_mfma_f32_16x16x32_bf16 v[24:27], a[32:35], a[12:15], v[24:27]
 ds_read_b128 a[64:67], v237 offset:2048
 v_mfma_f32_16x16x32_bf16 v[32:35], a[32:35], a[16:19], v[32:35]
 ds_read_b128 a[68:71], v237 offset:4096
 v_mfma_f32_16x16x32_bf16 v[40:43], a[32:35], a[20:23], v[40:43]
 ds_read_b128 a[72:75], v237 offset:6144
 v_mfma_f32_16x16x32_bf16 v[48:51], a[32:35], a[24:27], v[48:51]
 ds_read_b128 a[76:79], v237 offset:8192
 v_mfma_f32_16x16x32_bf16 v[56:59], a[32:35], a[28:31], v[56:59]
 ds_read_b128 a[80:83], v237 offset:10240
 s_cmp_eq_u32 s88, 1
 s_cbranch_scc1 L1Q_d6
L1Q_d6_r:
 v_mfma_f32_16x16x32_bf16 v[60:63], a[36:39], a[28:31], v[60:63]
 ds_read_b128 a[84:87], v237 offset:12288
 v_add_f32_e64 v245, v245, v222
 v_mfma_f32_16x16x32_bf16 v[52:55], a[36:39], a[24:27], v[52:55]
 ds_read_b128 a[88:91], v237 offset:14336
 v_add_f32_e64 v244, v244, v207
 v_mfma_f32_16x16x32_bf16 v[44:47], a[36:39], a[20:23], v[44:47]
 ds_read_b64_tr_b16 a[96:97], v239 offset:36864
 v_add_f32_e64 v245, v245, v223
 v_mfma_f32_16x16x32_bf16 v[36:39], a[36:39], a[16:19], v[36:39]
 ds_read_b64_tr_b16 a[98:99], v239 offset:37376
 v_add_f32_e64 v244, v244, v245
 v_mfma_f32_16x16x32_bf16 v[28:31], a[36:39], a[12:15], v[28:31]
 ds_read_b64_tr_b16 a[100:101], v238 offset:37888
 v_add_f32_dpp v244, v244, v244 quad_perm:[1,0,3,2] row_mask:0xf bank_mask:0xf
 v_mfma_f32_16x16x32_bf16 v[20:23], a[36:39], a[8:11], v[20:23]
 ds_read_b64_tr_b16 a[102:103], v238 offset:38400
 v_add_f32_dpp v244, v244, v244 quad_perm:[2,3,0,1] row_mask:0xf bank_mask:0xf
 v_mfma_f32_16x16x32_bf16 v[12:15], a[36:39], a[4:7], v[12:15]
 ds_read_b64_tr_b16 a[104:105], v239 offset:37888
 v_add_f32_dpp v244, v244, v244 row_half_mirror row_mask:0xf bank_mask:0xf
 v_mfma_f32_16x16x32_bf16 v[4:7], a[36:39], a[0:3], v[4:7]
 ds_read_b64_tr_b16 a[106:107], v239 offset:38400
 v_add_f32_dpp v244, v244, v244 row_mirror row_mask:0xf bank_mask:0xf
 v_mfma_f32_16x16x32_bf16 v[64:67], a[40:43], a[0:3], v[64:67]
 ds_read_b64_tr_b16 a[108:109], v238 offset:38912
 v_mov_b32_e64 v245, v244
 v_mfma_f32_16x16x32_bf16 v[72:75], a[40:43], a[4:7], v[72:75]
 ds_read_b64_tr_b16 a[110:111], v238 offset:39424
 v_permlane16_swap_b32_e64 v244, v245
 v_mfma_f32_16x16x32_bf16 v[80:83], a[40:43], a[8:11], v[80:83]
 ds_read_b64_tr_b16 a[112:113], v239 offset:38912
 v_add_f32_e64 v244, v244, v245
 v_mfma_f32_16x16x32_bf16 v[88:91], a[40:43], a[12:15], v[88:91]
 ds_read_b64_tr_b16 a[114:115], v239 offset:39424
 v_mov_b32_e64 v245, v244
 v_mfma_f32_16x16x32_bf16 v[96:99], a[40:43], a[16:19], v[96:99]
 s_cmp_eq_u32 s88, 0
 s_cselect_b32 s4, 0, s5
 v_mfma_f32_16x16x32_bf16 v[104:107], a[40:43], a[20:23], v[104:107]
 v_permlane32_swap_b32_e64 v244, v245
 v_mfma_f32_16x16x32_bf16 v[112:115], a[40:43], a[24:27], v[112:115]
 buffer_atomic_add v194, v195, s[96:99], s4 offen sc1
 v_mfma_f32_16x16x32_bf16 v[120:123], a[40:43], a[28:31], v[120:123]
 v_add_f32_e64 v244, v244, v245
 v_mfma_f32_16x16x32_bf16 v[124:127], a[44:47], a[28:31], v[124:127]
 s_add_u32 m0, s38, 24576
 v_mfma_f32_16x16x32_bf16 v[116:119], a[44:47], a[24:27], v[116:119]
 v_mul_f32 v246, 0x3a800000, v244
 v_mfma_f32_16x16x32_bf16 v[108:111], a[44:47], a[20:23], v[108:111]
 buffer_load_dwordx4 v232, s[12:15], s32 offen lds
 v_mfma_f32_16x16x32_bf16 v[100:103], a[44:47], a[16:19], v[100:103]
 v_sub_f32_e64 v200, v200, v246
 v_mfma_f32_16x16x32_bf16 v[92:95], a[44:47], a[12:15], v[92:95]
 buffer_load_dwordx4 v233, s[12:15], s32 offen offset:1024 lds
 v_mfma_f32_16x16x32_bf16 v[84:87], a[44:47], a[8:11], v[84:87]
 v_sub_f32_e64 v216, v216, v246
 v_mfma_f32_16x16x32_bf16 v[76:79], a[44:47], a[4:7], v[76:79]
 buffer_load_dwordx4 v234, s[12:15], s32 offen offset:2048 lds
 v_mfma_f32_16x16x32_bf16 v[68:71], a[44:47], a[0:3], v[68:71]
 v_sub_f32_e64 v201, v201, v246
 v_mfma_f32_16x16x32_bf16 v[128:131], a[0:3], a[48:51], v[128:131]
 s_add_u32 s32, s32, 196608
 v_mfma_f32_16x16x32_bf16 v[136:139], a[4:7], a[48:51], v[136:139]
 v_sub_f32_e64 v217, v217, v246
 v_mfma_f32_16x16x32_bf16 v[144:147], a[8:11], a[48:51], v[144:147]
 v_sub_f32_e64 v202, v202, v246
 v_mfma_f32_16x16x32_bf16 v[152:155], a[12:15], a[48:51], v[152:155]
 s_add_u32 m0, s37, 77824
 v_mfma_f32_16x16x32_bf16 v[160:163], a[16:19], a[48:51], v[160:163]
 v_sub_f32_e64 v218, v218, v246
 v_mfma_f32_16x16x32_bf16 v[168:171], a[20:23], a[48:51], v[168:171]
 buffer_load_dwordx4 v228, s[8:11], s31 offen lds
 v_mfma_f32_16x16x32_bf16 v[176:179], a[24:27], a[48:51], v[176:179]
 v_sub_f32_e64 v203, v203, v246
 v_mfma_f32_16x16x32_bf16 v[184:187], a[28:31], a[48:51], v[184:187]
 buffer_load_dwordx4 v229, s[8:11], s31 offen offset:1024 lds
 v_mfma_f32_16x16x32_bf16 v[188:191], a[28:31], a[52:55], v[188:191]
 v_sub_f32_e64 v219, v219, v246
 v_mfma_f32_16x16x32_bf16 v[180:183], a[24:27], a[52:55], v[180:183]
 buffer_load_dwordx4 v230, s[8:11], s31 offen offset:2048 lds
 v_mfma_f32_16x16x32_bf16 v[172:175], a[20:23], a[52:55], v[172:175]
 v_sub_f32_e64 v204, v204, v246
 v_mfma_f32_16x16x32_bf16 v[164:167], a[16:19], a[52:55], v[164:167]
 buffer_load_dwordx4 v231, s[8:11], s31 offen offset:3072 lds
 v_mfma_f32_16x16x32_bf16 v[156:159], a[12:15], a[52:55], v[156:159]
 v_sub_f32_e64 v220, v220, v246
 v_mfma_f32_16x16x32_bf16 v[148:151], a[8:11], a[52:55], v[148:151]
 s_add_u32 s31, s31, 128
 v_mfma_f32_16x16x32_bf16 v[140:143], a[4:7], a[52:55], v[140:143]
 v_sub_f32_e64 v205, v205, v246
 v_mfma_f32_16x16x32_bf16 v[132:135], a[0:3], a[52:55], v[132:135]
 v_sub_f32_e64 v221, v221, v246
 s_waitcnt vmcnt(17) lgkmcnt(0)
 s_barrier
 v_mfma_f32_16x16x32_bf16 v[0:3], a[92:95], a[60:63], v[0:3]
 ds_read_b64_tr_b16 a[32:33], v238
 v_mfma_f32_16x16x32_bf16 v[8:11], a[92:95], a[64:67], v[8:11]
 ds_read_b64_tr_b16 a[34:35], v238 offset:512
 v_mfma_f32_16x16x32_bf16 v[16:19], a[92:95], a[68:71], v[16:19]
 ds_read_b128 a[0:3], v236 offset:36864
 v_mfma_f32_16x16x32_bf16 v[24:27], a[92:95], a[72:75], v[24:27]
 ds_read_b128 a[4:7], v236 offset:38912
 v_mfma_f32_16x16x32_bf16 v[32:35], a[92:95], a[76:79], v[32:35]
 ds_read_b128 a[8:11], v236 offset:40960
 v_mfma_f32_16x16x32_bf16 v[40:43], a[92:95], a[80:83], v[40:43]
 ds_read_b128 a[12:15], v236 offset:43008
 s_cmp_eq_u32 s88, 1
 s_cbranch_scc1 L1Q_d7
L1Q_d7_r:
 v_mfma_f32_16x16x32_bf16 v[48:51], a[92:95], a[84:87], v[48:51]
 ds_read_b128 a[16:19], v236 offset:45056
 v_sub_f32_e64 v206, v206, v246
 v_mfma_f32_16x16x32_bf16 v[56:59], a[92:95], a[88:91], v[56:59]
 ds_read_b128 a[20:23], v236 offset:47104
 v_sub_f32_e64 v222, v222, v246
 v_mfma_f32_16x16x32_bf16 v[60:63], a[96:99], a[88:91], v[60:63]
 ds_read_b128 a[24:27], v236 offset:49152
 v_sub_f32_e64 v207, v207, v246
 v_mfma_f32_16x16x32_bf16 v[52:55], a[96:99], a[84:87], v[52:55]
 ds_read_b128 a[28:31], v236 offset:51200
 v_sub_f32_e64 v223, v223, v246
 v_mfma_f32_16x16x32_bf16 v[44:47], a[96:99], a[80:83], v[44:47]
 ds_read_b64_tr_b16 a[36:37], v239
 v_mul_f32_e64 v244, v200, v200
 v_mfma_f32_16x16x32_bf16 v[36:39], a[96:99], a[76:79], v[36:39]
 ds_read_b64_tr_b16 a[38:39], v239 offset:512
 v_mul_f32_e64 v245, v216, v216
 v_mfma_f32_16x16x32_bf16 v[28:31], a[96:99], a[72:75], v[28:31]
 ds_read_b64_tr_b16 a[40:41], v238 offset:1024
 v_fmac_f32_e64 v244, v201, v201
 v_mfma_f32_16x16x32_bf16 v[20:23], a[96:99], a[68:71], v[20:23]
 ds_read_b64_tr_b16 a[42:43], v238 offset:1536
 v_fmac_f32_e64 v245, v217, v217
 v_mfma_f32_16x16x32_bf16 v[12:15], a[96:99], a[64:67], v[12:15]
 ds_read_b64_tr_b16 a[44:45], v239 offset:1024
 v_fmac_f32_e64 v244, v202, v202
 v_mfma_f32_16x16x32_bf16 v[4:7], a[96:99], a[60:63], v[4:7]
 ds_read_b64_tr_b16 a[46:47], v239 offset:1536
 v_fmac_f32_e64 v245, v218, v218
 v_mfma_f32_16x16x32_bf16 v[64:67], a[100:103], a[60:63], v[64:67]
 ds_read_b64_tr_b16 a[48:49], v238 offset:2048
 v_fmac_f32_e64 v244, v203, v203
 v_mfma_f32_16x16x32_bf16 v[72:75], a[100:103], a[64:67], v[72:75]
 ds_read_b64_tr_b16 a[50:51], v238 offset:2560
 v_fmac_f32_e64 v245, v219, v219
 v_mfma_f32_16x16x32_bf16 v[80:83], a[100:103], a[68:71], v[80:83]
 ds_read_b64_tr_b16 a[52:53], v239 offset:2048
 v_fmac_f32_e64 v244, v204, v204
 v_mfma_f32_16x16x32_bf16 v[88:91], a[100:103], a[72:75], v[88:91]
 ds_read_b64_tr_b16 a[54:55], v239 offset:2560
 v_fmac_f32_e64 v245, v220, v220
 v_mfma_f32_16x16x32_bf16 v[96:99], a[100:103], a[76:79], v[96:99]
 s_add_u32 m0, s38, 36864
 v_mfma_f32_16x16x32_bf16 v[104:107], a[100:103], a[80:83], v[104:107]
 buffer_load_dwordx4 v232, s[12:15], s32 offen lds
 v_mfma_f32_16x16x32_bf16 v[112:115], a[100:103], a[84:87], v[112:115]
 v_fmac_f32_e64 v244, v205, v205
 v_mfma_f32_16x16x32_bf16 v[120:123], a[100:103], a[88:91], v[120:123]
 buffer_load_dwordx4 v233, s[12:15], s32 offen offset:1024 lds
 v_mfma_f32_16x16x32_bf16 v[124:127], a[104:107], a[88:91], v[124:127]
 v_fmac_f32_e64 v245, v221, v221
 v_mfma_f32_16x16x32_bf16 v[116:119], a[104:107], a[84:87], v[116:119]
 buffer_load_dwordx4 v234, s[12:15], s32 offen offset:2048 lds
 v_mfma_f32_16x16x32_bf16 v[108:111], a[104:107], a[80:83], v[108:111]
 v_fmac_f32_e64 v244, v206, v206
 v_mfma_f32_16x16x32_bf16 v[100:103], a[104:107], a[76:79], v[100:103]
 s_add_u32 s32, s32, 196608
 v_mfma_f32_16x16x32_bf16 v[92:95], a[104:107], a[72:75], v[92:95]
 v_fmac_f32_e64 v245, v222, v222
 v_mfma_f32_16x16x32_bf16 v[84:87], a[104:107], a[68:71], v[84:87]
 s_add_u32 m0, s37, 0
 v_mfma_f32_16x16x32_bf16 v[76:79], a[104:107], a[64:67], v[76:79]
 v_fmac_f32 v244, v207, v207
 v_mfma_f32_16x16x32_bf16 v[68:71], a[104:107], a[60:63], v[68:71]
 buffer_load_dwordx4 v224, s[8:11], s31 offen lds
 v_mfma_f32_16x16x32_bf16 v[128:131], a[60:63], a[108:111], v[128:131]
 v_fmac_f32_e64 v245, v223, v223
 v_mfma_f32_16x16x32_bf16 v[136:139], a[64:67], a[108:111], v[136:139]
 buffer_load_dwordx4 v225, s[8:11], s31 offen offset:1024 lds
 v_mfma_f32_16x16x32_bf16 v[144:147], a[68:71], a[108:111], v[144:147]
 buffer_load_dwordx4 v226, s[8:11], s31 offen offset:2048 lds
 v_mfma_f32_16x16x32_bf16 v[152:155], a[72:75], a[108:111], v[152:155]
 v_add_f32_e64 v244, v244, v245
 v_mfma_f32_16x16x32_bf16 v[160:163], a[76:79], a[108:111], v[160:163]
 buffer_load_dwordx4 v227, s[8:11], s31 offen offset:3072 lds
 v_mfma_f32_16x16x32_bf16 v[168:171], a[80:83], a[108:111], v[168:171]
 v_add_f32_dpp v244, v244, v244 quad_perm:[1,0,3,2] row_mask:0xf bank_mask:0xf
 v_mfma_f32_16x16x32_bf16 v[176:179], a[84:87], a[108:111], v[176:179]
 s_xor_b32 s6, s44, 1024
 v_mfma_f32_16x16x32_bf16 v[184:187], a[88:91], a[108:111], v[184:187]
 v_add_f32_dpp v244, v244, v244 quad_perm:[2,3,0,1] row_mask:0xf bank_mask:0xf
 v_mfma_f32_16x16x32_bf16 v[188:191], a[88:91], a[112:115], v[188:191]
 s_add_u32 s6, s6, 768
 v_mfma_f32_16x16x32_bf16 v[180:183], a[84:87], a[112:115], v[180:183]
 v_add_f32_dpp v244, v244, v244 row_half_mirror row_mask:0xf bank_mask:0xf
 v_mfma_f32_16x16x32_bf16 v[172:175], a[80:83], a[112:115], v[172:175]
 buffer_load_dword v251, v247, s[8:11], s6 offen
 v_mfma_f32_16x16x32_bf16 v[164:167], a[76:79], a[112:115], v[164:167]
 v_add_f32_dpp v244, v244, v244 row_mirror row_mask:0xf bank_mask:0xf
 v_mfma_f32_16x16x32_bf16 v[156:159], a[72:75], a[112:115], v[156:159]
 s_add_u32 s6, s43, 2359296
 v_mfma_f32_16x16x32_bf16 v[148:151], a[68:71], a[112:115], v[148:151]
 v_mov_b32_e64 v245, v244
 v_mfma_f32_16x16x32_bf16 v[140:143], a[64:67], a[112:115], v[140:143]
 buffer_load_dword v251, v252, s[12:15], s6 offen
 v_mfma_f32_16x16x32_bf16 v[132:135], a[60:63], a[112:115], v[132:135]
 v_permlane16_swap_b32_e64 v244, v245
 s_waitcnt vmcnt(23) lgkmcnt(0)
 s_barrier
 v_mfma_f32_16x16x32_bf16 v[0:3], a[32:35], a[0:3], v[0:3]
 ds_read_b64_tr_b16 a[92:93], v238 offset:12288
 v_mfma_f32_16x16x32_bf16 v[8:11], a[32:35], a[4:7], v[8:11]
 ds_read_b64_tr_b16 a[94:95], v238 offset:12800
 v_mfma_f32_16x16x32_bf16 v[16:19], a[32:35], a[8:11], v[16:19]
 ds_read_b128 a[60:63], v237 offset:36864
 v_mfma_f32_16x16x32_bf16 v[24:27], a[32:35], a[12:15], v[24:27]
 ds_read_b128 a[64:67], v237 offset:38912
 v_mfma_f32_16x16x32_bf16 v[32:35], a[32:35], a[16:19], v[32:35]
 ds_read_b128 a[68:71], v237 offset:40960
 v_mfma_f32_16x16x32_bf16 v[40:43], a[32:35], a[20:23], v[40:43]
 ds_read_b128 a[72:75], v237 offset:43008
 v_mfma_f32_16x16x32_bf16 v[48:51], a[32:35], a[24:27], v[48:51]
 ds_read_b128 a[76:79], v237 offset:45056
 s_cmp_eq_u32 s88, 2
 s_cbranch_scc1 L1Q_d8
L1Q_d8_r:
 v_mfma_f32_16x16x32_bf16 v[56:59], a[32:35], a[28:31], v[56:59]
 ds_read_b128 a[80:83], v237 offset:47104
 v_add_f32_e64 v244, v244, v245
 v_mfma_f32_16x16x32_bf16 v[60:63], a[36:39], a[28:31], v[60:63]
 ds_read_b128 a[84:87], v237 offset:49152
 v_mov_b32_e64 v245, v244
 v_mfma_f32_16x16x32_bf16 v[52:55], a[36:39], a[24:27], v[52:55]
 ds_read_b128 a[88:91], v237 offset:51200
 v_permlane32_swap_b32_e64 v244, v245
 v_mfma_f32_16x16x32_bf16 v[44:47], a[36:39], a[20:23], v[44:47]
 ds_read_b64_tr_b16 a[96:97], v239 offset:12288
 v_add_f32_e64 v244, v244, v245
 v_mfma_f32_16x16x32_bf16 v[36:39], a[36:39], a[16:19], v[36:39]
 ds_read_b64_tr_b16 a[98:99], v239 offset:12800
 v_mul_f32 v244, 0x3a800000, v244
 v_mfma_f32_16x16x32_bf16 v[28:31], a[36:39], a[12:15], v[28:31]
 ds_read_b64_tr_b16 a[100:101], v238 offset:13312
 v_cvt_pk_bf16_f32 v244, v244, v244
 v_mfma_f32_16x16x32_bf16 v[20:23], a[36:39], a[8:11], v[20:23]
 ds_read_b64_tr_b16 a[102:103], v238 offset:13824
 v_and_b32 v244, 0xffff0000, v244
 v_mfma_f32_16x16x32_bf16 v[12:15], a[36:39], a[4:7], v[12:15]
 ds_read_b64_tr_b16 a[104:105], v239 offset:13312
 v_add_f32 v244, 0x3727c5ac, v244
 v_mfma_f32_16x16x32_bf16 v[4:7], a[36:39], a[0:3], v[4:7]
 ds_read_b64_tr_b16 a[106:107], v239 offset:13824
 v_cvt_pk_bf16_f32 v244, v244, v244
 v_mfma_f32_16x16x32_bf16 v[64:67], a[40:43], a[0:3], v[64:67]
 ds_read_b64_tr_b16 a[108:109], v238 offset:14336
 v_and_b32 v244, 0xffff0000, v244
 v_mfma_f32_16x16x32_bf16 v[72:75], a[40:43], a[4:7], v[72:75]
 ds_read_b64_tr_b16 a[110:111], v238 offset:14848
 v_sqrt_f32_e64 v244, v244
 v_mfma_f32_16x16x32_bf16 v[80:83], a[40:43], a[8:11], v[80:83]
 ds_read_b64_tr_b16 a[112:113], v239 offset:14336
 v_lshrrev_b32_e64 v245, 3, v255
 v_mfma_f32_16x16x32_bf16 v[88:91], a[40:43], a[12:15], v[88:91]
 ds_read_b64_tr_b16 a[114:115], v239 offset:14848
 v_cvt_pk_bf16_f32 v248, v246, v244
 v_mfma_f32_16x16x32_bf16 v[96:99], a[40:43], a[16:19], v[96:99]
 s_cmp_eq_u32 s88, 1
 s_cselect_b32 s4, s75, s5
 v_mfma_f32_16x16x32_bf16 v[104:107], a[40:43], a[20:23], v[104:107]
 v_and_b32 v216, 0xffff0000, v208
 v_mfma_f32_16x16x32_bf16 v[112:115], a[40:43], a[24:27], v[112:115]
 buffer_store_dwordx4 a[156:159], v192, s[92:95], s4 offen sc1
 v_mfma_f32_16x16x32_bf16 v[120:123], a[40:43], a[28:31], v[120:123]
 v_lshlrev_b32_e64 v208, 16, v208
 v_mfma_f32_16x16x32_bf16 v[124:127], a[44:47], a[28:31], v[124:127]
 s_add_u32 m0, s38, 0
 v_mfma_f32_16x16x32_bf16 v[116:119], a[44:47], a[24:27], v[116:119]
 v_and_b32 v217, 0xffff0000, v209
 v_mfma_f32_16x16x32_bf16 v[108:111], a[44:47], a[20:23], v[108:111]
 buffer_load_dwordx4 v232, s[12:15], s32 offen lds
 v_mfma_f32_16x16x32_bf16 v[100:103], a[44:47], a[16:19], v[100:103]
 v_lshlrev_b32 v209, 16, v209
 v_mfma_f32_16x16x32_bf16 v[92:95], a[44:47], a[12:15], v[92:95]
 buffer_load_dwordx4 v233, s[12:15], s32 offen offset:1024 lds
 v_mfma_f32_16x16x32_bf16 v[84:87], a[44:47], a[8:11], v[84:87]
 v_and_b32 v218, 0xffff0000, v210
 v_mfma_f32_16x16x32_bf16 v[76:79], a[44:47], a[4:7], v[76:79]
 buffer_load_dwordx4 v234, s[12:15], s32 offen offset:2048 lds
 v_mfma_f32_16x16x32_bf16 v[68:71], a[44:47], a[0:3], v[68:71]
 v_lshlrev_b32_e64 v210, 16, v210
 v_mfma_f32_16x16x32_bf16 v[128:131], a[0:3], a[48:51], v[128:131]
 s_add_u32 s32, s32, 196608
 v_mfma_f32_16x16x32_bf16 v[136:139], a[4:7], a[48:51], v[136:139]
 v_and_b32 v219, 0xffff0000, v211
 v_mfma_f32_16x16x32_bf16 v[144:147], a[8:11], a[48:51], v[144:147]
 v_lshlrev_b32_e64 v211, 16, v211
 v_mfma_f32_16x16x32_bf16 v[152:155], a[12:15], a[48:51], v[152:155]
 s_add_u32 m0, s37, 4096
 v_mfma_f32_16x16x32_bf16 v[160:163], a[16:19], a[48:51], v[160:163]
 v_and_b32 v220, 0xffff0000, v212
 v_mfma_f32_16x16x32_bf16 v[168:171], a[20:23], a[48:51], v[168:171]
 buffer_load_dwordx4 v228, s[8:11], s31 offen lds
 v_mfma_f32_16x16x32_bf16 v[176:179], a[24:27], a[48:51], v[176:179]
 v_lshlrev_b32_e64 v212, 16, v212
 v_mfma_f32_16x16x32_bf16 v[184:187], a[28:31], a[48:51], v[184:187]
 buffer_load_dwordx4 v229, s[8:11], s31 offen offset:1024 lds
 v_mfma_f32_16x16x32_bf16 v[188:191], a[28:31], a[52:55], v[188:191]
 v_and_b32 v221, 0xffff0000, v213
 v_mfma_f32_16x16x32_bf16 v[180:183], a[24:27], a[52:55], v[180:183]
 buffer_load_dwordx4 v230, s[8:11], s31 offen offset:2048 lds
 v_mfma_f32_16x16x32_bf16 v[172:175], a[20:23], a[52:55], v[172:175]
 v_lshlrev_b32_e64 v213, 16, v213
 v_mfma_f32_16x16x32_bf16 v[164:167], a[16:19], a[52:55], v[164:167]
 buffer_load_dwordx4 v231, s[8:11], s31 offen offset:3072 lds
 v_mfma_f32_16x16x32_bf16 v[156:159], a[12:15], a[52:55], v[156:159]
 v_and_b32 v222, 0xffff0000, v214
 v_mfma_f32_16x16x32_bf16 v[148:151], a[8:11], a[52:55], v[148:151]
 s_add_u32 s31, s31, 128
 v_mfma_f32_16x16x32_bf16 v[140:143], a[4:7], a[52:55], v[140:143]
 v_lshlrev_b32_e64 v214, 16, v214
 v_mfma_f32_16x16x32_bf16 v[132:135], a[0:3], a[52:55], v[132:135]
 v_and_b32 v223, 0xffff0000, v215
 s_waitcnt vmcnt(17) lgkmcnt(0)
 s_barrier
 v_mfma_f32_16x16x32_bf16 v[0:3], a[92:95], a[60:63], v[0:3]
 ds_read_b64_tr_b16 a[32:33], v238 offset:24576
 v_mfma_f32_16x16x32_bf16 v[8:11], a[92:95], a[64:67], v[8:11]
 ds_read_b64_tr_b16 a[34:35], v238 offset:25088
 v_mfma_f32_16x16x32_bf16 v[16:19], a[92:95], a[68:71], v[16:19]
 ds_read_b128 a[0:3], v241
 v_mfma_f32_16x16x32_bf16 v[24:27], a[92:95], a[72:75], v[24:27]
 ds_read_b128 a[4:7], v241 offset:2048
 v_mfma_f32_16x16x32_bf16 v[32:35], a[92:95], a[76:79], v[32:35]
 ds_read_b128 a[8:11], v241 offset:4096
 v_mfma_f32_16x16x32_bf16 v[40:43], a[92:95], a[80:83], v[40:43]
 ds_read_b128 a[12:15], v241 offset:6144
 s_cmp_eq_u32 s88, 2
 s_cbranch_scc1 L1Q_d9
L1Q_d9_r:
 v_mfma_f32_16x16x32_bf16 v[48:51], a[92:95], a[84:87], v[48:51]
 ds_read_b128 a[16:19], v241 offset:8192
 v_lshlrev_b32_e64 v215, 16, v215
 v_mfma_f32_16x16x32_bf16 v[56:59], a[92:95], a[88:91], v[56:59]
 ds_read_b128 a[20:23], v241 offset:10240
 v_add_f32_e64 v244, v208, v209
 v_mfma_f32_16x16x32_bf16 v[60:63], a[96:99], a[88:91], v[60:63]
 ds_read_b128 a[24:27], v241 offset:12288
 v_add_f32_e64 v245, v216, v217
 v_mfma_f32_16x16x32_bf16 v[52:55], a[96:99], a[84:87], v[52:55]
 ds_read_b128 a[28:31], v241 offset:14336
 v_add_f32_e64 v244, v244, v210
 v_mfma_f32_16x16x32_bf16 v[44:47], a[96:99], a[80:83], v[44:47]
 ds_read_b64_tr_b16 a[36:37], v239 offset:24576
 v_add_f32_e64 v245, v245, v218
 v_mfma_f32_16x16x32_bf16 v[36:39], a[96:99], a[76:79], v[36:39]
 ds_read_b64_tr_b16 a[38:39], v239 offset:25088
 v_add_f32_e64 v244, v244, v211
 v_mfma_f32_16x16x32_bf16 v[28:31], a[96:99], a[72:75], v[28:31]
 ds_read_b64_tr_b16 a[40:41], v238 offset:25600
 v_add_f32_e64 v245, v245, v219
 v_mfma_f32_16x16x32_bf16 v[20:23], a[96:99], a[68:71], v[20:23]
 ds_read_b64_tr_b16 a[42:43], v238 offset:26112
 v_add_f32_e64 v244, v244, v212
 v_mfma_f32_16x16x32_bf16 v[12:15], a[96:99], a[64:67], v[12:15]
 ds_read_b64_tr_b16 a[44:45], v239 offset:25600
 v_add_f32_e64 v245, v245, v220
 v_mfma_f32_16x16x32_bf16 v[4:7], a[96:99], a[60:63], v[4:7]
 ds_read_b64_tr_b16 a[46:47], v239 offset:26112
 v_add_f32_e64 v244, v244, v213
 v_mfma_f32_16x16x32_bf16 v[64:67], a[100:103], a[60:63], v[64:67]
 ds_read_b64_tr_b16 a[48:49], v238 offset:26624
 v_add_f32_e64 v245, v245, v221
 v_mfma_f32_16x16x32_bf16 v[72:75], a[100:103], a[64:67], v[72:75]
 ds_read_b64_tr_b16 a[50:51], v238 offset:27136
 v_add_f32_e64 v244, v244, v214
 v_mfma_f32_16x16x32_bf16 v[80:83], a[100:103], a[68:71], v[80:83]
 ds_read_b64_tr_b16 a[52:53], v239 offset:26624
 v_add_f32_e64 v245, v245, v222
 v_mfma_f32_16x16x32_bf16 v[88:91], a[100:103], a[72:75], v[88:91]
 ds_read_b64_tr_b16 a[54:55], v239 offset:27136
 v_add_f32_e64 v244, v244, v215
 v_mfma_f32_16x16x32_bf16 v[96:99], a[100:103], a[76:79], v[96:99]
 s_add_u32 m0, s38, 12288
 v_mfma_f32_16x16x32_bf16 v[104:107], a[100:103], a[80:83], v[104:107]
 buffer_load_dwordx4 v232, s[12:15], s32 offen lds
 v_mfma_f32_16x16x32_bf16 v[112:115], a[100:103], a[84:87], v[112:115]
 v_add_f32_e64 v245, v245, v223
 v_mfma_f32_16x16x32_bf16 v[120:123], a[100:103], a[88:91], v[120:123]
 buffer_load_dwordx4 v233, s[12:15], s32 offen offset:1024 lds
 v_mfma_f32_16x16x32_bf16 v[124:127], a[104:107], a[88:91], v[124:127]
 v_add_f32_e64 v244, v244, v245
 v_mfma_f32_16x16x32_bf16 v[116:119], a[104:107], a[84:87], v[116:119]
 buffer_load_dwordx4 v234, s[12:15], s32 offen offset:2048 lds
 v_mfma_f32_16x16x32_bf16 v[108:111], a[104:107], a[80:83], v[108:111]
 v_add_f32_dpp v244, v244, v244 quad_perm:[1,0,3,2] row_mask:0xf bank_mask:0xf
 v_mfma_f32_16x16x32_bf16 v[100:103], a[104:107], a[76:79], v[100:103]
 s_add_u32 s32, s32, 196608
 v_mfma_f32_16x16x32_bf16 v[92:95], a[104:107], a[72:75], v[92:95]
 v_add_f32_dpp v244, v244, v244 quad_perm:[2,3,0,1] row_mask:0xf bank_mask:0xf
 v_mfma_f32_16x16x32_bf16 v[84:87], a[104:107], a[68:71], v[84:87]
 s_add_u32 m0, s37, 36864
 v_mfma_f32_16x16x32_bf16 v[76:79], a[104:107], a[64:67], v[76:79]
 v_add_f32_dpp v244, v244, v244 row_half_mirror row_mask:0xf bank_mask:0xf
 v_mfma_f32_16x16x32_bf16 v[68:71], a[104:107], a[60:63], v[68:71]
 buffer_load_dwordx4 v224, s[8:11], s31 offen lds
 v_mfma_f32_16x16x32_bf16 v[128:131], a[60:63], a[108:111], v[128:131]
 v_add_f32_dpp v244, v244, v244 row_mirror row_mask:0xf bank_mask:0xf
 v_mfma_f32_16x16x32_bf16 v[136:139], a[64:67], a[108:111], v[136:139]
 buffer_load_dwordx4 v225, s[8:11], s31 offen offset:1024 lds
 v_mfma_f32_16x16x32_bf16 v[144:147], a[68:71], a[108:111], v[144:147]
 buffer_load_dwordx4 v226, s[8:11], s31 offen offset:2048 lds
 v_mfma_f32_16x16x32_bf16 v[152:155], a[72:75], a[108:111], v[152:155]
 v_mov_b32_e64 v245, v244
 v_mfma_f32_16x16x32_bf16 v[160:163], a[76:79], a[108:111], v[160:163]
 buffer_load_dwordx4 v227, s[8:11], s31 offen offset:3072 lds
 v_mfma_f32_16x16x32_bf16 v[168:171], a[80:83], a[108:111], v[168:171]
 v_permlane16_swap_b32_e64 v244, v245
 v_mfma_f32_16x16x32_bf16 v[176:179], a[84:87], a[108:111], v[176:179]
 s_xor_b32 s6, s44, 1024
 v_mfma_f32_16x16x32_bf16 v[184:187], a[88:91], a[108:111], v[184:187]
 v_add_f32_e64 v244, v244, v245
 v_mfma_f32_16x16x32_bf16 v[188:191], a[88:91], a[112:115], v[188:191]
 s_add_u32 s6, s6, 896
 v_mfma_f32_16x16x32_bf16 v[180:183], a[84:87], a[112:115], v[180:183]
 v_mov_b32_e64 v245, v244
 v_mfma_f32_16x16x32_bf16 v[172:175], a[80:83], a[112:115], v[172:175]
 buffer_load_dword v251, v247, s[8:11], s6 offen
 v_mfma_f32_16x16x32_bf16 v[164:167], a[76:79], a[112:115], v[164:167]
 v_permlane32_swap_b32_e64 v244, v245
 v_mfma_f32_16x16x32_bf16 v[156:159], a[72:75], a[112:115], v[156:159]
 s_add_u32 s6, s43, 2752512
 v_mfma_f32_16x16x32_bf16 v[148:151], a[68:71], a[112:115], v[148:151]
 v_add_f32_e64 v244, v244, v245
 v_mfma_f32_16x16x32_bf16 v[140:143], a[64:67], a[112:115], v[140:143]
 buffer_load_dword v251, v252, s[12:15], s6 offen
 v_mfma_f32_16x16x32_bf16 v[132:135], a[60:63], a[112:115], v[132:135]
 v_mul_f32 v246, 0x3a800000, v244
 s_waitcnt vmcnt(16) lgkmcnt(0)
 s_barrier
 v_mfma_f32_16x16x32_bf16 v[0:3], a[32:35], a[0:3], v[0:3]
 ds_read_b64_tr_b16 a[92:93], v238 offset:36864
 v_mfma_f32_16x16x32_bf16 v[8:11], a[32:35], a[4:7], v[8:11]
 ds_read_b64_tr_b16 a[94:95], v238 offset:37376
 v_mfma_f32_16x16x32_bf16 v[16:19], a[32:35], a[8:11], v[16:19]
 ds_read_b128 a[60:63], v242
 v_mfma_f32_16x16x32_bf16 v[24:27], a[32:35], a[12:15], v[24:27]
 ds_read_b128 a[64:67], v242 offset:2048
 v_mfma_f32_16x16x32_bf16 v[32:35], a[32:35], a[16:19], v[32:35]
 ds_read_b128 a[68:71], v242 offset:4096
 v_mfma_f32_16x16x32_bf16 v[40:43], a[32:35], a[20:23], v[40:43]
 ds_read_b128 a[72:75], v242 offset:6144
 v_mfma_f32_16x16x32_bf16 v[48:51], a[32:35], a[24:27], v[48:51]
 ds_read_b128 a[76:79], v242 offset:8192
 v_mfma_f32_16x16x32_bf16 v[56:59], a[32:35], a[28:31], v[56:59]
 ds_read_b128 a[80:83], v242 offset:10240
 s_cmp_eq_u32 s88, 2
 s_cbranch_scc1 L1Q_d10
L1Q_d10_r:
 v_mfma_f32_16x16x32_bf16 v[60:63], a[36:39], a[28:31], v[60:63]
 ds_read_b128 a[84:87], v242 offset:12288
 v_sub_f32_e64 v208, v208, v246
 v_mfma_f32_16x16x32_bf16 v[52:55], a[36:39], a[24:27], v[52:55]
 ds_read_b128 a[88:91], v242 offset:14336
 v_sub_f32_e64 v216, v216, v246
 v_mfma_f32_16x16x32_bf16 v[44:47], a[36:39], a[20:23], v[44:47]
 ds_read_b64_tr_b16 a[96:97], v239 offset:36864
 v_sub_f32_e64 v209, v209, v246
 v_mfma_f32_16x16x32_bf16 v[36:39], a[36:39], a[16:19], v[36:39]
 ds_read_b64_tr_b16 a[98:99], v239 offset:37376
 v_sub_f32_e64 v217, v217, v246
 v_mfma_f32_16x16x32_bf16 v[28:31], a[36:39], a[12:15], v[28:31]
 ds_read_b64_tr_b16 a[100:101], v238 offset:37888
 v_sub_f32_e64 v210, v210, v246
 v_mfma_f32_16x16x32_bf16 v[20:23], a[36:39], a[8:11], v[20:23]
 ds_read_b64_tr_b16 a[102:103], v238 offset:38400
 v_sub_f32_e64 v218, v218, v246
 v_mfma_f32_16x16x32_bf16 v[12:15], a[36:39], a[4:7], v[12:15]
 ds_read_b64_tr_b16 a[104:105], v239 offset:37888
 v_sub_f32_e64 v211, v211, v246
 v_mfma_f32_16x16x32_bf16 v[4:7], a[36:39], a[0:3], v[4:7]
 ds_read_b64_tr_b16 a[106:107], v239 offset:38400
 v_sub_f32_e64 v219, v219, v246
 v_mfma_f32_16x16x32_bf16 v[64:67], a[40:43], a[0:3], v[64:67]
 ds_read_b64_tr_b16 a[108:109], v238 offset:38912
 v_sub_f32_e64 v212, v212, v246
 v_mfma_f32_16x16x32_bf16 v[72:75], a[40:43], a[4:7], v[72:75]
 ds_read_b64_tr_b16 a[110:111], v238 offset:39424
 v_sub_f32_e64 v220, v220, v246
 v_mfma_f32_16x16x32_bf16 v[80:83], a[40:43], a[8:11], v[80:83]
 ds_read_b64_tr_b16 a[112:113], v239 offset:38912
 v_sub_f32_e64 v213, v213, v246
 v_mfma_f32_16x16x32_bf16 v[88:91], a[40:43], a[12:15], v[88:91]
 ds_read_b64_tr_b16 a[114:115], v239 offset:39424
 v_sub_f32_e64 v221, v221, v246
 v_mfma_f32_16x16x32_bf16 v[96:99], a[40:43], a[16:19], v[96:99]
 s_cmp_eq_u32 s88, 1
 s_cselect_b32 s4, 0, s5
 v_mfma_f32_16x16x32_bf16 v[104:107], a[40:43], a[20:23], v[104:107]
 v_sub_f32_e64 v214, v214, v246
 v_mfma_f32_16x16x32_bf16 v[112:115], a[40:43], a[24:27], v[112:115]
 buffer_atomic_add v194, v195, s[96:99], s4 offen sc1
 v_mfma_f32_16x16x32_bf16 v[120:123], a[40:43], a[28:31], v[120:123]
 v_sub_f32_e64 v222, v222, v246
 v_mfma_f32_16x16x32_bf16 v[124:127], a[44:47], a[28:31], v[124:127]
 s_add_u32 m0, s38, 24576
 v_mfma_f32_16x16x32_bf16 v[116:119], a[44:47], a[24:27], v[116:119]
 v_sub_f32_e64 v215, v215, v246
 v_mfma_f32_16x16x32_bf16 v[108:111], a[44:47], a[20:23], v[108:111]
 buffer_load_dwordx4 v232, s[12:15], s32 offen lds
 v_mfma_f32_16x16x32_bf16 v[100:103], a[44:47], a[16:19], v[100:103]
 v_sub_f32_e64 v223, v223, v246
 v_mfma_f32_16x16x32_bf16 v[92:95], a[44:47], a[12:15], v[92:95]
 buffer_load_dwordx4 v233, s[12:15], s32 offen offset:1024 lds
 v_mfma_f32_16x16x32_bf16 v[84:87], a[44:47], a[8:11], v[84:87]
 v_mul_f32_e64 v244, v208, v208
 v_mfma_f32_16x16x32_bf16 v[76:79], a[44:47], a[4:7], v[76:79]
 buffer_load_dwordx4 v234, s[12:15], s32 offen offset:2048 lds
 v_mfma_f32_16x16x32_bf16 v[68:71], a[44:47], a[0:3], v[68:71]
 v_mul_f32_e64 v245, v216, v216
 v_mfma_f32_16x16x32_bf16 v[128:131], a[0:3], a[48:51], v[128:131]
 s_add_u32 s32, s32, 196608
 v_mfma_f32_16x16x32_bf16 v[136:139], a[4:7], a[48:51], v[136:139]
 v_fmac_f32_e64 v244, v209, v209
 v_mfma_f32_16x16x32_bf16 v[144:147], a[8:11], a[48:51], v[144:147]
 v_fmac_f32_e64 v245, v217, v217
 v_mfma_f32_16x16x32_bf16 v[152:155], a[12:15], a[48:51], v[152:155]
 s_add_u32 m0, s37, 40960
 v_mfma_f32_16x16x32_bf16 v[160:163], a[16:19], a[48:51], v[160:163]
 v_fmac_f32_e64 v244, v210, v210
 v_mfma_f32_16x16x32_bf16 v[168:171], a[20:23], a[48:51], v[168:171]
 buffer_load_dwordx4 v228, s[8:11], s31 offen lds
 v_mfma_f32_16x16x32_bf16 v[176:179], a[24:27], a[48:51], v[176:179]
 v_fmac_f32_e64 v245, v218, v218
 v_mfma_f32_16x16x32_bf16 v[184:187], a[28:31], a[48:51], v[184:187]
 buffer_load_dwordx4 v229, s[8:11], s31 offen offset:1024 lds
 v_mfma_f32_16x16x32_bf16 v[188:191], a[28:31], a[52:55], v[188:191]
 v_fmac_f32_e64 v244, v211, v211
 v_mfma_f32_16x16x32_bf16 v[180:183], a[24:27], a[52:55], v[180:183]
 buffer_load_dwordx4 v230, s[8:11], s31 offen offset:2048 lds
 v_mfma_f32_16x16x32_bf16 v[172:175], a[20:23], a[52:55], v[172:175]
 v_fmac_f32_e64 v245, v219, v219
 v_mfma_f32_16x16x32_bf16 v[164:167], a[16:19], a[52:55], v[164:167]
 buffer_load_dwordx4 v231, s[8:11], s31 offen offset:3072 lds
 v_mfma_f32_16x16x32_bf16 v[156:159], a[12:15], a[52:55], v[156:159]
 v_fmac_f32_e64 v244, v212, v212
 v_mfma_f32_16x16x32_bf16 v[148:151], a[8:11], a[52:55], v[148:151]
 s_mov_b32 s31, s44
 v_mfma_f32_16x16x32_bf16 v[140:143], a[4:7], a[52:55], v[140:143]
 v_fmac_f32 v245, v220, v220
 v_mfma_f32_16x16x32_bf16 v[132:135], a[0:3], a[52:55], v[132:135]
 v_fmac_f32_e64 v244, v213, v213
 s_waitcnt vmcnt(17) lgkmcnt(0)
 s_barrier
 v_mfma_f32_16x16x32_bf16 v[0:3], a[92:95], a[60:63], v[0:3]
 ds_read_b64_tr_b16 a[32:33], v238
 v_mfma_f32_16x16x32_bf16 v[8:11], a[92:95], a[64:67], v[8:11]
 ds_read_b64_tr_b16 a[34:35], v238 offset:512
 v_mfma_f32_16x16x32_bf16 v[16:19], a[92:95], a[68:71], v[16:19]
 ds_read_b128 a[0:3], v236
 v_mfma_f32_16x16x32_bf16 v[24:27], a[92:95], a[72:75], v[24:27]
 ds_read_b128 a[4:7], v236 offset:2048
 v_mfma_f32_16x16x32_bf16 v[32:35], a[92:95], a[76:79], v[32:35]
 ds_read_b128 a[8:11], v236 offset:4096
 v_mfma_f32_16x16x32_bf16 v[40:43], a[92:95], a[80:83], v[40:43]
 ds_read_b128 a[12:15], v236 offset:6144
 v_mfma_f32_16x16x32_bf16 v[48:51], a[92:95], a[84:87], v[48:51]
 ds_read_b128 a[16:19], v236 offset:8192
 v_mfma_f32_16x16x32_bf16 v[56:59], a[92:95], a[88:91], v[56:59]
 ds_read_b128 a[20:23], v236 offset:10240
 v_mfma_f32_16x16x32_bf16 v[60:63], a[96:99], a[88:91], v[60:63]
 ds_read_b128 a[24:27], v236 offset:12288
 v_mfma_f32_16x16x32_bf16 v[52:55], a[96:99], a[84:87], v[52:55]
 ds_read_b128 a[28:31], v236 offset:14336
 s_cmp_eq_u32 s88, 2
 s_cbranch_scc1 L1Q_d11
L1Q_d11_r:
 v_mfma_f32_16x16x32_bf16 v[44:47], a[96:99], a[80:83], v[44:47]
 ds_read_b64_tr_b16 a[36:37], v239
 v_fmac_f32_e64 v245, v221, v221
 v_mfma_f32_16x16x32_bf16 v[36:39], a[96:99], a[76:79], v[36:39]
 ds_read_b64_tr_b16 a[38:39], v239 offset:512
 v_fmac_f32_e64 v244, v214, v214
 v_mfma_f32_16x16x32_bf16 v[28:31], a[96:99], a[72:75], v[28:31]
 ds_read_b64_tr_b16 a[40:41], v238 offset:1024
 v_fmac_f32_e64 v245, v222, v222
 v_mfma_f32_16x16x32_bf16 v[20:23], a[96:99], a[68:71], v[20:23]
 ds_read_b64_tr_b16 a[42:43], v238 offset:1536
 v_fmac_f32_e64 v244, v215, v215
 v_mfma_f32_16x16x32_bf16 v[12:15], a[96:99], a[64:67], v[12:15]
 ds_read_b64_tr_b16 a[44:45], v239 offset:1024
 v_fmac_f32_e64 v245, v223, v223
 v_mfma_f32_16x16x32_bf16 v[4:7], a[96:99], a[60:63], v[4:7]
 ds_read_b64_tr_b16 a[46:47], v239 offset:1536
 v_add_f32_e64 v244, v244, v245
 v_mfma_f32_16x16x32_bf16 v[64:67], a[100:103], a[60:63], v[64:67]
 ds_read_b64_tr_b16 a[48:49], v238 offset:2048
 v_add_f32_dpp v244, v244, v244 quad_perm:[1,0,3,2] row_mask:0xf bank_mask:0xf
 v_mfma_f32_16x16x32_bf16 v[72:75], a[100:103], a[64:67], v[72:75]
 ds_read_b64_tr_b16 a[50:51], v238 offset:2560
 v_add_f32_dpp v244, v244, v244 quad_perm:[2,3,0,1] row_mask:0xf bank_mask:0xf
 v_mfma_f32_16x16x32_bf16 v[80:83], a[100:103], a[68:71], v[80:83]
 ds_read_b64_tr_b16 a[52:53], v239 offset:2048
 v_add_f32_dpp v244, v244, v244 row_half_mirror row_mask:0xf bank_mask:0xf
 v_mfma_f32_16x16x32_bf16 v[88:91], a[100:103], a[72:75], v[88:91]
 ds_read_b64_tr_b16 a[54:55], v239 offset:2560
 v_add_f32_dpp v244, v244, v244 row_mirror row_mask:0xf bank_mask:0xf
 v_mfma_f32_16x16x32_bf16 v[96:99], a[100:103], a[76:79], v[96:99]
 s_add_u32 m0, s38, 36864
 v_mfma_f32_16x16x32_bf16 v[104:107], a[100:103], a[80:83], v[104:107]
 v_mov_b32_e64 v245, v244
 v_mfma_f32_16x16x32_bf16 v[112:115], a[100:103], a[84:87], v[112:115]
 buffer_load_dwordx4 v232, s[12:15], s32 offen lds
 v_mfma_f32_16x16x32_bf16 v[120:123], a[100:103], a[88:91], v[120:123]
 v_permlane16_swap_b32_e64 v244, v245
 v_mfma_f32_16x16x32_bf16 v[124:127], a[104:107], a[88:91], v[124:127]
 v_add_f32_e64 v244, v244, v245
 v_mfma_f32_16x16x32_bf16 v[116:119], a[104:107], a[84:87], v[116:119]
 buffer_load_dwordx4 v233, s[12:15], s32 offen offset:1024 lds
 v_mfma_f32_16x16x32_bf16 v[108:111], a[104:107], a[80:83], v[108:111]
 v_mov_b32_e64 v245, v244
 v_mfma_f32_16x16x32_bf16 v[100:103], a[104:107], a[76:79], v[100:103]
 s_nop 0
 v_permlane32_swap_b32 v244, v245
 v_mfma_f32_16x16x32_bf16 v[92:95], a[104:107], a[72:75], v[92:95]
 buffer_load_dwordx4 v234, s[12:15], s32 offen offset:2048 lds
 v_mfma_f32_16x16x32_bf16 v[84:87], a[104:107], a[68:71], v[84:87]
 v_add_f32_e64 v244, v244, v245
 v_mfma_f32_16x16x32_bf16 v[76:79], a[104:107], a[64:67], v[76:79]
 v_mul_f32 v244, 0x3a800000, v244
 v_mfma_f32_16x16x32_bf16 v[68:71], a[104:107], a[60:63], v[68:71]
 s_mov_b32 s32, s45
 v_mfma_f32_16x16x32_bf16 v[128:131], a[60:63], a[108:111], v[128:131]
 v_cvt_pk_bf16_f32 v244, v244, v244
 v_mfma_f32_16x16x32_bf16 v[136:139], a[64:67], a[108:111], v[136:139]
 v_and_b32 v244, 0xffff0000, v244
 v_mfma_f32_16x16x32_bf16 v[144:147], a[68:71], a[108:111], v[144:147]
 s_add_u32 m0, s37, 73728
 v_mfma_f32_16x16x32_bf16 v[152:155], a[72:75], a[108:111], v[152:155]
 v_add_f32 v244, 0x3727c5ac, v244
 v_mfma_f32_16x16x32_bf16 v[160:163], a[76:79], a[108:111], v[160:163]
 buffer_load_dwordx4 v224, s[8:11], s31 offen lds
 v_mfma_f32_16x16x32_bf16 v[168:171], a[80:83], a[108:111], v[168:171]
 v_cvt_pk_bf16_f32 v244, v244, v244
 v_mfma_f32_16x16x32_bf16 v[176:179], a[84:87], a[108:111], v[176:179]
 v_and_b32 v244, 0xffff0000, v244
 v_mfma_f32_16x16x32_bf16 v[184:187], a[88:91], a[108:111], v[184:187]
 buffer_load_dwordx4 v225, s[8:11], s31 offen offset:1024 lds
 v_mfma_f32_16x16x32_bf16 v[188:191], a[88:91], a[112:115], v[188:191]
 v_sqrt_f32 v244, v244
 v_mfma_f32_16x16x32_bf16 v[180:183], a[84:87], a[112:115], v[180:183]
 v_lshrrev_b32_e64 v245, 3, v255
 v_mfma_f32_16x16x32_bf16 v[172:175], a[80:83], a[112:115], v[172:175]
 buffer_load_dwordx4 v226, s[8:11], s31 offen offset:2048 lds
 v_mfma_f32_16x16x32_bf16 v[164:167], a[76:79], a[112:115], v[164:167]
 v_cvt_pk_bf16_f32 v249, v246, v244
 v_mfma_f32_16x16x32_bf16 v[156:159], a[72:75], a[112:115], v[156:159]
 v_lshlrev_b32_e64 v245, 20, v245
 v_mfma_f32_16x16x32_bf16 v[148:151], a[68:71], a[112:115], v[148:151]
 buffer_load_dwordx4 v227, s[8:11], s31 offen offset:3072 lds
 v_mfma_f32_16x16x32_bf16 v[140:143], a[64:67], a[112:115], v[140:143]
 v_lshl_add_u32 v245, v255, 4, v245
 v_mfma_f32_16x16x32_bf16 v[132:135], a[60:63], a[112:115], v[132:135]
 buffer_store_dwordx4 v[248:251], v245, s[92:95], s74 offen sc1
 s_waitcnt vmcnt(22) lgkmcnt(0)
 s_barrier
 v_mfma_f32_16x16x32_bf16 v[0:3], a[32:35], a[0:3], v[0:3]
 ds_read_b64_tr_b16 a[92:93], v238 offset:12288
 v_mfma_f32_16x16x32_bf16 v[8:11], a[32:35], a[4:7], v[8:11]
 ds_read_b64_tr_b16 a[94:95], v238 offset:12800
 v_mfma_f32_16x16x32_bf16 v[16:19], a[32:35], a[8:11], v[16:19]
 ds_read_b128 a[60:63], v237
 v_mfma_f32_16x16x32_bf16 v[24:27], a[32:35], a[12:15], v[24:27]
 ds_read_b128 a[64:67], v237 offset:2048
 v_mfma_f32_16x16x32_bf16 v[32:35], a[32:35], a[16:19], v[32:35]
 ds_read_b128 a[68:71], v237 offset:4096
 v_mfma_f32_16x16x32_bf16 v[40:43], a[32:35], a[20:23], v[40:43]
 ds_read_b128 a[72:75], v237 offset:6144
 v_mfma_f32_16x16x32_bf16 v[48:51], a[32:35], a[24:27], v[48:51]
 ds_read_b128 a[76:79], v237 offset:8192
 v_mfma_f32_16x16x32_bf16 v[56:59], a[32:35], a[28:31], v[56:59]
 ds_read_b128 a[80:83], v237 offset:10240
 v_mfma_f32_16x16x32_bf16 v[60:63], a[36:39], a[28:31], v[60:63]
 ds_read_b128 a[84:87], v237 offset:12288
 v_mfma_f32_16x16x32_bf16 v[52:55], a[36:39], a[24:27], v[52:55]
 ds_read_b128 a[88:91], v237 offset:14336
 v_mfma_f32_16x16x32_bf16 v[44:47], a[36:39], a[20:23], v[44:47]
 ds_read_b64_tr_b16 a[96:97], v239 offset:12288
 v_mfma_f32_16x16x32_bf16 v[36:39], a[36:39], a[16:19], v[36:39]
 ds_read_b64_tr_b16 a[98:99], v239 offset:12800
 v_mfma_f32_16x16x32_bf16 v[28:31], a[36:39], a[12:15], v[28:31]
 ds_read_b64_tr_b16 a[100:101], v238 offset:13312
 v_mfma_f32_16x16x32_bf16 v[20:23], a[36:39], a[8:11], v[20:23]
 ds_read_b64_tr_b16 a[102:103], v238 offset:13824
 v_mfma_f32_16x16x32_bf16 v[12:15], a[36:39], a[4:7], v[12:15]
 ds_read_b64_tr_b16 a[104:105], v239 offset:13312
 v_mfma_f32_16x16x32_bf16 v[4:7], a[36:39], a[0:3], v[4:7]
 ds_read_b64_tr_b16 a[106:107], v239 offset:13824
 v_mfma_f32_16x16x32_bf16 v[64:67], a[40:43], a[0:3], v[64:67]
 ds_read_b64_tr_b16 a[108:109], v238 offset:14336
 v_mfma_f32_16x16x32_bf16 v[72:75], a[40:43], a[4:7], v[72:75]
 ds_read_b64_tr_b16 a[110:111], v238 offset:14848
 v_mfma_f32_16x16x32_bf16 v[80:83], a[40:43], a[8:11], v[80:83]
 ds_read_b64_tr_b16 a[112:113], v239 offset:14336
 v_mfma_f32_16x16x32_bf16 v[88:91], a[40:43], a[12:15], v[88:91]
 ds_read_b64_tr_b16 a[114:115], v239 offset:14848
 v_mfma_f32_16x16x32_bf16 v[96:99], a[40:43], a[16:19], v[96:99]
 s_cmp_eq_u32 s88, 2
 s_cselect_b32 s4, s75, s5
 v_mfma_f32_16x16x32_bf16 v[104:107], a[40:43], a[20:23], v[104:107]
 buffer_store_dwordx4 a[156:159], v192, s[92:95], s4 offen sc1
 v_mfma_f32_16x16x32_bf16 v[112:115], a[40:43], a[24:27], v[112:115]
 s_add_u32 m0, s38, 0
 v_mfma_f32_16x16x32_bf16 v[120:123], a[40:43], a[28:31], v[120:123]
 s_cmp_eq_u32 s88, 3
 s_cbranch_scc1 L1Q_d12
L1Q_d12_r:
 v_mfma_f32_16x16x32_bf16 v[124:127], a[44:47], a[28:31], v[124:127]
 buffer_load_dwordx4 v232, s[12:15], s32 offen lds
 v_mfma_f32_16x16x32_bf16 v[116:119], a[44:47], a[24:27], v[116:119]
 buffer_load_dwordx4 v233, s[12:15], s32 offen offset:1024 lds
 v_mfma_f32_16x16x32_bf16 v[108:111], a[44:47], a[20:23], v[108:111]
 v_mfma_f32_16x16x32_bf16 v[100:103], a[44:47], a[16:19], v[100:103]
 buffer_load_dwordx4 v234, s[12:15], s32 offen offset:2048 lds
 v_mfma_f32_16x16x32_bf16 v[92:95], a[44:47], a[12:15], v[92:95]
 s_add_u32 s32, s32, 196608
 v_mfma_f32_16x16x32_bf16 v[84:87], a[44:47], a[8:11], v[84:87]
 s_add_u32 m0, s37, 77824
 v_mfma_f32_16x16x32_bf16 v[76:79], a[44:47], a[4:7], v[76:79]
 v_mfma_f32_16x16x32_bf16 v[68:71], a[44:47], a[0:3], v[68:71]
 buffer_load_dwordx4 v228, s[8:11], s31 offen lds
 v_mfma_f32_16x16x32_bf16 v[128:131], a[0:3], a[48:51], v[128:131]
 buffer_load_dwordx4 v229, s[8:11], s31 offen offset:1024 lds
 v_mfma_f32_16x16x32_bf16 v[136:139], a[4:7], a[48:51], v[136:139]
 v_mfma_f32_16x16x32_bf16 v[144:147], a[8:11], a[48:51], v[144:147]
 buffer_load_dwordx4 v230, s[8:11], s31 offen offset:2048 lds
 v_mfma_f32_16x16x32_bf16 v[152:155], a[12:15], a[48:51], v[152:155]
 buffer_load_dwordx4 v231, s[8:11], s31 offen offset:3072 lds
 v_mfma_f32_16x16x32_bf16 v[160:163], a[16:19], a[48:51], v[160:163]
 s_add_u32 s31, s31, 128
 v_mfma_f32_16x16x32_bf16 v[168:171], a[20:23], a[48:51], v[168:171]
 v_mfma_f32_16x16x32_bf16 v[176:179], a[24:27], a[48:51], v[176:179]
 v_min_u32 v223, 15, v255
 v_mfma_f32_16x16x32_bf16 v[184:187], a[28:31], a[48:51], v[184:187]
 s_bfe_u32 s6, s2, 0x20006
 s_lshl_b32 s6, s6, 2
 v_mfma_f32_16x16x32_bf16 v[188:191], a[28:31], a[52:55], v[188:191]
 v_mfma_f32_16x16x32_bf16 v[180:183], a[24:27], a[52:55], v[180:183]
 s_add_u32 s6, s6, s28
 s_lshl_b32 s6, s6, 4
 v_mfma_f32_16x16x32_bf16 v[172:175], a[20:23], a[52:55], v[172:175]
 v_add_lshl_u32 v223, v223, s6, 7
 v_mfma_f32_16x16x32_bf16 v[164:167], a[16:19], a[52:55], v[164:167]
 v_min_u32 v223, L_end-L_ct1-2048, v223
 v_mfma_f32_16x16x32_bf16 v[156:159], a[12:15], a[52:55], v[156:159]
 v_mfma_f32_16x16x32_bf16 v[148:151], a[8:11], a[52:55], v[148:151]
 s_getpc_b64 s[6:7]
L_ct1:
 s_add_u32 s6, s6, 2048
 s_addc_u32 s7, s7, 0
 v_mfma_f32_16x16x32_bf16 v[140:143], a[4:7], a[52:55], v[140:143]
 global_load_dword v251, v223, s[6:7]
 v_mfma_f32_16x16x32_bf16 v[132:135], a[0:3], a[52:55], v[132:135]
 s_waitcnt vmcnt(9) lgkmcnt(0)
 s_barrier
 v_mfma_f32_16x16x32_bf16 v[0:3], a[92:95], a[60:63], v[0:3]
 ds_read_b64_tr_b16 a[32:33], v238 offset:24576
 v_mfma_f32_16x16x32_bf16 v[8:11], a[92:95], a[64:67], v[8:11]
 ds_read_b64_tr_b16 a[34:35], v238 offset:25088
 v_mfma_f32_16x16x32_bf16 v[16:19], a[92:95], a[68:71], v[16:19]
 ds_read_b128 a[0:3], v236 offset:36864
 v_mfma_f32_16x16x32_bf16 v[24:27], a[92:95], a[72:75], v[24:27]
 ds_read_b128 a[4:7], v236 offset:38912
 v_mfma_f32_16x16x32_bf16 v[32:35], a[92:95], a[76:79], v[32:35]
 ds_read_b128 a[8:11], v236 offset:40960
 v_mfma_f32_16x16x32_bf16 v[40:43], a[92:95], a[80:83], v[40:43]
 ds_read_b128 a[12:15], v236 offset:43008
 v_mfma_f32_16x16x32_bf16 v[48:51], a[92:95], a[84:87], v[48:51]
 ds_read_b128 a[16:19], v236 offset:45056
 v_mfma_f32_16x16x32_bf16 v[56:59], a[92:95], a[88:91], v[56:59]
 ds_read_b128 a[20:23], v236 offset:47104
 v_mfma_f32_16x16x32_bf16 v[60:63], a[96:99], a[88:91], v[60:63]
 ds_read_b128 a[24:27], v236 offset:49152
 v_mfma_f32_16x16x32_bf16 v[52:55], a[96:99], a[84:87], v[52:55]
 ds_read_b128 a[28:31], v236 offset:51200
 v_mfma_f32_16x16x32_bf16 v[44:47], a[96:99], a[80:83], v[44:47]
 ds_read_b64_tr_b16 a[36:37], v239 offset:24576
 v_mfma_f32_16x16x32_bf16 v[36:39], a[96:99], a[76:79], v[36:39]
 ds_read_b64_tr_b16 a[38:39], v239 offset:25088
 v_mfma_f32_16x16x32_bf16 v[28:31], a[96:99], a[72:75], v[28:31]
 ds_read_b64_tr_b16 a[40:41], v238 offset:25600
 v_mfma_f32_16x16x32_bf16 v[20:23], a[96:99], a[68:71], v[20:23]
 ds_read_b64_tr_b16 a[42:43], v238 offset:26112
 v_mfma_f32_16x16x32_bf16 v[12:15], a[96:99], a[64:67], v[12:15]
 ds_read_b64_tr_b16 a[44:45], v239 offset:25600
 v_mfma_f32_16x16x32_bf16 v[4:7], a[96:99], a[60:63], v[4:7]
 ds_read_b64_tr_b16 a[46:47], v239 offset:26112
 v_mfma_f32_16x16x32_bf16 v[64:67], a[100:103], a[60:63], v[64:67]
 ds_read_b64_tr_b16 a[48:49], v238 offset:26624
 v_mfma_f32_16x16x32_bf16 v[72:75], a[100:103], a[64:67], v[72:75]
 ds_read_b64_tr_b16 a[50:51], v238 offset:27136
 v_mfma_f32_16x16x32_bf16 v[80:83], a[100:103], a[68:71], v[80:83]
 ds_read_b64_tr_b16 a[52:53], v239 offset:26624
 v_mfma_f32_16x16x32_bf16 v[88:91], a[100:103], a[72:75], v[88:91]
 ds_read_b64_tr_b16 a[54:55], v239 offset:27136
 v_mfma_f32_16x16x32_bf16 v[96:99], a[100:103], a[76:79], v[96:99]
 s_cmp_eq_u32 s88, 0
 s_cselect_b32 s4, 0, s5
 v_mfma_f32_16x16x32_bf16 v[104:107], a[100:103], a[80:83], v[104:107]
 buffer_atomic_add v194, v193, s[96:99], s4 offen sc1
 v_mfma_f32_16x16x32_bf16 v[112:115], a[100:103], a[84:87], v[112:115]
 s_cmp_eq_u32 s88, 3
 s_cbranch_scc1 L1Q_d13
L1Q_d13_r:
 v_mfma_f32_16x16x32_bf16 v[120:123], a[100:103], a[88:91], v[120:123]
 s_add_u32 m0, s38, 12288
 v_mfma_f32_16x16x32_bf16 v[124:127], a[104:107], a[88:91], v[124:127]
 buffer_load_dwordx4 v232, s[12:15], s32 offen lds
 v_mfma_f32_16x16x32_bf16 v[116:119], a[104:107], a[84:87], v[116:119]
 v_mfma_f32_16x16x32_bf16 v[108:111], a[104:107], a[80:83], v[108:111]
 buffer_load_dwordx4 v233, s[12:15], s32 offen offset:1024 lds
 v_mfma_f32_16x16x32_bf16 v[100:103], a[104:107], a[76:79], v[100:103]
 v_mfma_f32_16x16x32_bf16 v[92:95], a[104:107], a[72:75], v[92:95]
 buffer_load_dwordx4 v234, s[12:15], s32 offen offset:2048 lds
 v_mfma_f32_16x16x32_bf16 v[84:87], a[104:107], a[68:71], v[84:87]
 s_add_u32 s32, s32, 196608
 v_mfma_f32_16x16x32_bf16 v[76:79], a[104:107], a[64:67], v[76:79]
 v_mfma_f32_16x16x32_bf16 v[68:71], a[104:107], a[60:63], v[68:71]
 s_add_u32 m0, s37, 0
 v_mfma_f32_16x16x32_bf16 v[128:131], a[60:63], a[108:111], v[128:131]
 v_mfma_f32_16x16x32_bf16 v[136:139], a[64:67], a[108:111], v[136:139]
 buffer_load_dwordx4 v224, s[8:11], s31 offen lds
 v_mfma_f32_16x16x32_bf16 v[144:147], a[68:71], a[108:111], v[144:147]
 buffer_load_dwordx4 v225, s[8:11], s31 offen offset:1024 lds
 v_mfma_f32_16x16x32_bf16 v[152:155], a[72:75], a[108:111], v[152:155]
 v_mfma_f32_16x16x32_bf16 v[160:163], a[76:79], a[108:111], v[160:163]
 buffer_load_dwordx4 v226, s[8:11], s31 offen offset:2048 lds
 v_mfma_f32_16x16x32_bf16 v[168:171], a[80:83], a[108:111], v[168:171]
 v_mfma_f32_16x16x32_bf16 v[176:179], a[84:87], a[108:111], v[176:179]
 buffer_load_dwordx4 v227, s[8:11], s31 offen offset:3072 lds
 v_mfma_f32_16x16x32_bf16 v[184:187], a[88:91], a[108:111], v[184:187]
 s_mov_b32 s20, s60
 v_mfma_f32_16x16x32_bf16 v[188:191], a[88:91], a[112:115], v[188:191]
 v_mfma_f32_16x16x32_bf16 v[180:183], a[84:87], a[112:115], v[180:183]
 s_mov_b32 s21, s61
 v_mfma_f32_16x16x32_bf16 v[172:175], a[80:83], a[112:115], v[172:175]
 v_mfma_f32_16x16x32_bf16 v[164:167], a[76:79], a[112:115], v[164:167]
 s_mov_b32 s22, 0x700000
 v_mfma_f32_16x16x32_bf16 v[156:159], a[72:75], a[112:115], v[156:159]
 s_mov_b32 s24, s26
 v_mfma_f32_16x16x32_bf16 v[148:151], a[68:71], a[112:115], v[148:151]
 v_mfma_f32_16x16x32_bf16 v[140:143], a[64:67], a[112:115], v[140:143]
 buffer_load_dword v251, v250, s[20:23], s24 offen
 v_mfma_f32_16x16x32_bf16 v[132:135], a[60:63], a[112:115], v[132:135]
 s_waitcnt vmcnt(17) lgkmcnt(0)
 s_barrier
 v_mfma_f32_16x16x32_bf16 v[0:3], a[32:35], a[0:3], v[0:3]
 ds_read_b64_tr_b16 a[92:93], v238 offset:36864
 v_mfma_f32_16x16x32_bf16 v[8:11], a[32:35], a[4:7], v[8:11]
 ds_read_b64_tr_b16 a[94:95], v238 offset:37376
 v_mfma_f32_16x16x32_bf16 v[16:19], a[32:35], a[8:11], v[16:19]
 ds_read_b128 a[60:63], v237 offset:36864
 v_mfma_f32_16x16x32_bf16 v[24:27], a[32:35], a[12:15], v[24:27]
 ds_read_b128 a[64:67], v237 offset:38912
 v_mfma_f32_16x16x32_bf16 v[32:35], a[32:35], a[16:19], v[32:35]
 ds_read_b128 a[68:71], v237 offset:40960
 v_mfma_f32_16x16x32_bf16 v[40:43], a[32:35], a[20:23], v[40:43]
 ds_read_b128 a[72:75], v237 offset:43008
 v_mfma_f32_16x16x32_bf16 v[48:51], a[32:35], a[24:27], v[48:51]
 ds_read_b128 a[76:79], v237 offset:45056
 v_mfma_f32_16x16x32_bf16 v[56:59], a[32:35], a[28:31], v[56:59]
 ds_read_b128 a[80:83], v237 offset:47104
 v_mfma_f32_16x16x32_bf16 v[60:63], a[36:39], a[28:31], v[60:63]
 ds_read_b128 a[84:87], v237 offset:49152
 v_mfma_f32_16x16x32_bf16 v[52:55], a[36:39], a[24:27], v[52:55]
 ds_read_b128 a[88:91], v237 offset:51200
 v_mfma_f32_16x16x32_bf16 v[44:47], a[36:39], a[20:23], v[44:47]
 ds_read_b64_tr_b16 a[96:97], v239 offset:36864
 v_mfma_f32_16x16x32_bf16 v[36:39], a[36:39], a[16:19], v[36:39]
 ds_read_b64_tr_b16 a[98:99], v239 offset:37376
 v_mfma_f32_16x16x32_bf16 v[28:31], a[36:39], a[12:15], v[28:31]
 ds_read_b64_tr_b16 a[100:101], v238 offset:37888
 v_mfma_f32_16x16x32_bf16 v[20:23], a[36:39], a[8:11], v[20:23]
 ds_read_b64_tr_b16 a[102:103], v238 offset:38400
 v_mfma_f32_16x16x32_bf16 v[12:15], a[36:39], a[4:7], v[12:15]
 ds_read_b64_tr_b16 a[104:105], v239 offset:37888
 v_mfma_f32_16x16x32_bf16 v[4:7], a[36:39], a[0:3], v[4:7]
 ds_read_b64_tr_b16 a[106:107], v239 offset:38400
 v_mfma_f32_16x16x32_bf16 v[64:67], a[40:43], a[0:3], v[64:67]
 ds_read_b64_tr_b16 a[108:109], v238 offset:38912
 v_mfma_f32_16x16x32_bf16 v[72:75], a[40:43], a[4:7], v[72:75]
 ds_read_b64_tr_b16 a[110:111], v238 offset:39424
 v_mfma_f32_16x16x32_bf16 v[80:83], a[40:43], a[8:11], v[80:83]
 ds_read_b64_tr_b16 a[112:113], v239 offset:38912
 v_mfma_f32_16x16x32_bf16 v[88:91], a[40:43], a[12:15], v[88:91]
 ds_read_b64_tr_b16 a[114:115], v239 offset:39424
 v_mfma_f32_16x16x32_bf16 v[96:99], a[40:43], a[16:19], v[96:99]
 s_cmp_eq_u32 s88, 1
 s_cselect_b32 s4, 0, s5
 v_mfma_f32_16x16x32_bf16 v[104:107], a[40:43], a[20:23], v[104:107]
 buffer_atomic_add v194, v193, s[96:99], s4 offen sc1
 v_mfma_f32_16x16x32_bf16 v[112:115], a[40:43], a[24:27], v[112:115]
 s_cmp_eq_u32 s88, 3
 s_cbranch_scc1 L1Q_d14
L1Q_d14_r:
 v_mfma_f32_16x16x32_bf16 v[120:123], a[40:43], a[28:31], v[120:123]
 s_cmp_eq_u32 s88, 2
 s_cselect_b32 s4, 0, s5
 v_mfma_f32_16x16x32_bf16 v[124:127], a[44:47], a[28:31], v[124:127]
 v_mfma_f32_16x16x32_bf16 v[116:119], a[44:47], a[24:27], v[116:119]
 buffer_atomic_add v194, v195, s[96:99], s4 offen sc1
 v_mfma_f32_16x16x32_bf16 v[108:111], a[44:47], a[20:23], v[108:111]
 v_mfma_f32_16x16x32_bf16 v[100:103], a[44:47], a[16:19], v[100:103]
 s_add_u32 m0, s38, 24576
 v_mfma_f32_16x16x32_bf16 v[92:95], a[44:47], a[12:15], v[92:95]
 v_mfma_f32_16x16x32_bf16 v[84:87], a[44:47], a[8:11], v[84:87]
 buffer_load_dwordx4 v232, s[12:15], s32 offen lds
 v_mfma_f32_16x16x32_bf16 v[76:79], a[44:47], a[4:7], v[76:79]
 v_mfma_f32_16x16x32_bf16 v[68:71], a[44:47], a[0:3], v[68:71]
 buffer_load_dwordx4 v233, s[12:15], s32 offen offset:1024 lds
 v_mfma_f32_16x16x32_bf16 v[128:131], a[0:3], a[48:51], v[128:131]
 v_mfma_f32_16x16x32_bf16 v[136:139], a[4:7], a[48:51], v[136:139]
 buffer_load_dwordx4 v234, s[12:15], s32 offen offset:2048 lds
 v_mfma_f32_16x16x32_bf16 v[144:147], a[8:11], a[48:51], v[144:147]
 s_add_u32 s32, s32, 196608
 v_mfma_f32_16x16x32_bf16 v[152:155], a[12:15], a[48:51], v[152:155]
 v_mfma_f32_16x16x32_bf16 v[160:163], a[16:19], a[48:51], v[160:163]
 s_add_u32 m0, s37, 4096
 v_mfma_f32_16x16x32_bf16 v[168:171], a[20:23], a[48:51], v[168:171]
 v_mfma_f32_16x16x32_bf16 v[176:179], a[24:27], a[48:51], v[176:179]
 buffer_load_dwordx4 v228, s[8:11], s31 offen lds
 v_mfma_f32_16x16x32_bf16 v[184:187], a[28:31], a[48:51], v[184:187]
 v_mfma_f32_16x16x32_bf16 v[188:191], a[28:31], a[52:55], v[188:191]
 buffer_load_dwordx4 v229, s[8:11], s31 offen offset:1024 lds
 v_mfma_f32_16x16x32_bf16 v[180:183], a[24:27], a[52:55], v[180:183]
 v_mfma_f32_16x16x32_bf16 v[172:175], a[20:23], a[52:55], v[172:175]
 buffer_load_dwordx4 v230, s[8:11], s31 offen offset:2048 lds
 v_mfma_f32_16x16x32_bf16 v[164:167], a[16:19], a[52:55], v[164:167]
 v_mfma_f32_16x16x32_bf16 v[156:159], a[12:15], a[52:55], v[156:159]
 buffer_load_dwordx4 v231, s[8:11], s31 offen offset:3072 lds
 v_mfma_f32_16x16x32_bf16 v[148:151], a[8:11], a[52:55], v[148:151]
 v_mfma_f32_16x16x32_bf16 v[140:143], a[4:7], a[52:55], v[140:143]
 s_add_u32 s31, s31, 128
 v_mfma_f32_16x16x32_bf16 v[132:135], a[0:3], a[52:55], v[132:135]
 s_waitcnt vmcnt(19) lgkmcnt(0)
 s_barrier
 v_mfma_f32_16x16x32_bf16 v[0:3], a[92:95], a[60:63], v[0:3]
 ds_read_b64_tr_b16 a[32:33], v238
 v_mfma_f32_16x16x32_bf16 v[8:11], a[92:95], a[64:67], v[8:11]
 ds_read_b64_tr_b16 a[34:35], v238 offset:512
 v_mfma_f32_16x16x32_bf16 v[16:19], a[92:95], a[68:71], v[16:19]
 ds_read_b128 a[0:3], v241
 v_mfma_f32_16x16x32_bf16 v[24:27], a[92:95], a[72:75], v[24:27]
 ds_read_b128 a[4:7], v241 offset:2048
 v_mfma_f32_16x16x32_bf16 v[32:35], a[92:95], a[76:79], v[32:35]
 ds_read_b128 a[8:11], v241 offset:4096
 v_mfma_f32_16x16x32_bf16 v[40:43], a[92:95], a[80:83], v[40:43]
 ds_read_b128 a[12:15], v241 offset:6144
 v_mfma_f32_16x16x32_bf16 v[48:51], a[92:95], a[84:87], v[48:51]
 ds_read_b128 a[16:19], v241 offset:8192
 v_mfma_f32_16x16x32_bf16 v[56:59], a[92:95], a[88:91], v[56:59]
 ds_read_b128 a[20:23], v241 offset:10240
 v_mfma_f32_16x16x32_bf16 v[60:63], a[96:99], a[88:91], v[60:63]
 ds_read_b128 a[24:27], v241 offset:12288
 v_mfma_f32_16x16x32_bf16 v[52:55], a[96:99], a[84:87], v[52:55]
 ds_read_b128 a[28:31], v241 offset:14336
 v_mfma_f32_16x16x32_bf16 v[44:47], a[96:99], a[80:83], v[44:47]
 ds_read_b64_tr_b16 a[36:37], v239
 v_mfma_f32_16x16x32_bf16 v[36:39], a[96:99], a[76:79], v[36:39]
 ds_read_b64_tr_b16 a[38:39], v239 offset:512
 v_mfma_f32_16x16x32_bf16 v[28:31], a[96:99], a[72:75], v[28:31]
 ds_read_b64_tr_b16 a[40:41], v238 offset:1024
 v_mfma_f32_16x16x32_bf16 v[20:23], a[96:99], a[68:71], v[20:23]
 ds_read_b64_tr_b16 a[42:43], v238 offset:1536
 v_mfma_f32_16x16x32_bf16 v[12:15], a[96:99], a[64:67], v[12:15]
 ds_read_b64_tr_b16 a[44:45], v239 offset:1024
 v_mfma_f32_16x16x32_bf16 v[4:7], a[96:99], a[60:63], v[4:7]
 ds_read_b64_tr_b16 a[46:47], v239 offset:1536
 v_mfma_f32_16x16x32_bf16 v[64:67], a[100:103], a[60:63], v[64:67]
 ds_read_b64_tr_b16 a[48:49], v238 offset:2048
 v_mfma_f32_16x16x32_bf16 v[72:75], a[100:103], a[64:67], v[72:75]
 ds_read_b64_tr_b16 a[50:51], v238 offset:2560
 v_mfma_f32_16x16x32_bf16 v[80:83], a[100:103], a[68:71], v[80:83]
 ds_read_b64_tr_b16 a[52:53], v239 offset:2048
 v_mfma_f32_16x16x32_bf16 v[88:91], a[100:103], a[72:75], v[88:91]
 ds_read_b64_tr_b16 a[54:55], v239 offset:2560
 v_mfma_f32_16x16x32_bf16 v[96:99], a[100:103], a[76:79], v[96:99]
 s_cmp_eq_u32 s88, 2
 s_cselect_b32 s4, 0, s5
 v_mfma_f32_16x16x32_bf16 v[104:107], a[100:103], a[80:83], v[104:107]
 s_cmp_eq_u32 s88, 3
 s_cbranch_scc1 L1Q_d15
L1Q_d15_r:
 v_mfma_f32_16x16x32_bf16 v[112:115], a[100:103], a[84:87], v[112:115]
 buffer_atomic_add v194, v193, s[96:99], s4 offen sc1
 v_mfma_f32_16x16x32_bf16 v[120:123], a[100:103], a[88:91], v[120:123]
 v_mfma_f32_16x16x32_bf16 v[124:127], a[104:107], a[88:91], v[124:127]
 s_add_u32 m0, s38, 36864
 v_mfma_f32_16x16x32_bf16 v[116:119], a[104:107], a[84:87], v[116:119]
 v_mfma_f32_16x16x32_bf16 v[108:111], a[104:107], a[80:83], v[108:111]
 buffer_load_dwordx4 v232, s[12:15], s32 offen lds
 v_mfma_f32_16x16x32_bf16 v[100:103], a[104:107], a[76:79], v[100:103]
 v_mfma_f32_16x16x32_bf16 v[92:95], a[104:107], a[72:75], v[92:95]
 buffer_load_dwordx4 v233, s[12:15], s32 offen offset:1024 lds
 v_mfma_f32_16x16x32_bf16 v[84:87], a[104:107], a[68:71], v[84:87]
 v_mfma_f32_16x16x32_bf16 v[76:79], a[104:107], a[64:67], v[76:79]
 buffer_load_dwordx4 v234, s[12:15], s32 offen offset:2048 lds
 v_mfma_f32_16x16x32_bf16 v[68:71], a[104:107], a[60:63], v[68:71]
 v_mfma_f32_16x16x32_bf16 v[128:131], a[60:63], a[108:111], v[128:131]
 s_add_u32 s32, s32, 196608
 v_mfma_f32_16x16x32_bf16 v[136:139], a[64:67], a[108:111], v[136:139]
 v_mfma_f32_16x16x32_bf16 v[144:147], a[68:71], a[108:111], v[144:147]
 s_add_u32 m0, s37, 36864
 v_mfma_f32_16x16x32_bf16 v[152:155], a[72:75], a[108:111], v[152:155]
 v_mfma_f32_16x16x32_bf16 v[160:163], a[76:79], a[108:111], v[160:163]
 buffer_load_dwordx4 v224, s[8:11], s31 offen lds
 v_mfma_f32_16x16x32_bf16 v[168:171], a[80:83], a[108:111], v[168:171]
 v_mfma_f32_16x16x32_bf16 v[176:179], a[84:87], a[108:111], v[176:179]
 buffer_load_dwordx4 v225, s[8:11], s31 offen offset:1024 lds
 v_mfma_f32_16x16x32_bf16 v[184:187], a[88:91], a[108:111], v[184:187]
 v_mfma_f32_16x16x32_bf16 v[188:191], a[88:91], a[112:115], v[188:191]
 buffer_load_dwordx4 v226, s[8:11], s31 offen offset:2048 lds
 v_mfma_f32_16x16x32_bf16 v[180:183], a[84:87], a[112:115], v[180:183]
 v_mfma_f32_16x16x32_bf16 v[172:175], a[80:83], a[112:115], v[172:175]
 buffer_load_dwordx4 v227, s[8:11], s31 offen offset:3072 lds
 v_mfma_f32_16x16x32_bf16 v[164:167], a[76:79], a[112:115], v[164:167]
 v_mfma_f32_16x16x32_bf16 v[156:159], a[72:75], a[112:115], v[156:159]
 s_add_u32 s24, s24, 2097152
 v_mfma_f32_16x16x32_bf16 v[148:151], a[68:71], a[112:115], v[148:151]
 v_mfma_f32_16x16x32_bf16 v[140:143], a[64:67], a[112:115], v[140:143]
 buffer_load_dword v251, v250, s[20:23], s24 offen
 v_mfma_f32_16x16x32_bf16 v[132:135], a[60:63], a[112:115], v[132:135]
 s_waitcnt vmcnt(23) lgkmcnt(0)
 s_barrier
 v_mfma_f32_16x16x32_bf16 v[0:3], a[32:35], a[0:3], v[0:3]
 ds_read_b64_tr_b16 a[92:93], v238 offset:12288
 v_mfma_f32_16x16x32_bf16 v[8:11], a[32:35], a[4:7], v[8:11]
 ds_read_b64_tr_b16 a[94:95], v238 offset:12800
 v_mfma_f32_16x16x32_bf16 v[16:19], a[32:35], a[8:11], v[16:19]
 ds_read_b128 a[60:63], v242
 v_mfma_f32_16x16x32_bf16 v[24:27], a[32:35], a[12:15], v[24:27]
 ds_read_b128 a[64:67], v242 offset:2048
 v_mfma_f32_16x16x32_bf16 v[32:35], a[32:35], a[16:19], v[32:35]
 ds_read_b128 a[68:71], v242 offset:4096
 v_mfma_f32_16x16x32_bf16 v[40:43], a[32:35], a[20:23], v[40:43]
 ds_read_b128 a[72:75], v242 offset:6144
 v_mfma_f32_16x16x32_bf16 v[48:51], a[32:35], a[24:27], v[48:51]
 ds_read_b128 a[76:79], v242 offset:8192
 v_mfma_f32_16x16x32_bf16 v[56:59], a[32:35], a[28:31], v[56:59]
 ds_read_b128 a[80:83], v242 offset:10240
 v_mfma_f32_16x16x32_bf16 v[60:63], a[36:39], a[28:31], v[60:63]
 ds_read_b128 a[84:87], v242 offset:12288
 v_mfma_f32_16x16x32_bf16 v[52:55], a[36:39], a[24:27], v[52:55]
 ds_read_b128 a[88:91], v242 offset:14336
 v_mfma_f32_16x16x32_bf16 v[44:47], a[36:39], a[20:23], v[44:47]
 ds_read_b64_tr_b16 a[96:97], v239 offset:12288
 v_mfma_f32_16x16x32_bf16 v[36:39], a[36:39], a[16:19], v[36:39]
 ds_read_b64_tr_b16 a[98:99], v239 offset:12800
 v_mfma_f32_16x16x32_bf16 v[28:31], a[36:39], a[12:15], v[28:31]
 ds_read_b64_tr_b16 a[100:101], v238 offset:13312
 v_mfma_f32_16x16x32_bf16 v[20:23], a[36:39], a[8:11], v[20:23]
 ds_read_b64_tr_b16 a[102:103], v238 offset:13824
 v_mfma_f32_16x16x32_bf16 v[12:15], a[36:39], a[4:7], v[12:15]
 ds_read_b64_tr_b16 a[104:105], v239 offset:13312
 v_mfma_f32_16x16x32_bf16 v[4:7], a[36:39], a[0:3], v[4:7]
 ds_read_b64_tr_b16 a[106:107], v239 offset:13824
 v_mfma_f32_16x16x32_bf16 v[64:67], a[40:43], a[0:3], v[64:67]
 ds_read_b64_tr_b16 a[108:109], v238 offset:14336
 v_mfma_f32_16x16x32_bf16 v[72:75], a[40:43], a[4:7], v[72:75]
 ds_read_b64_tr_b16 a[110:111], v238 offset:14848
 v_mfma_f32_16x16x32_bf16 v[80:83], a[40:43], a[8:11], v[80:83]
 ds_read_b64_tr_b16 a[112:113], v239 offset:14336
 v_mfma_f32_16x16x32_bf16 v[88:91], a[40:43], a[12:15], v[88:91]
 ds_read_b64_tr_b16 a[114:115], v239 offset:14848
 v_mfma_f32_16x16x32_bf16 v[96:99], a[40:43], a[16:19], v[96:99]
 s_cmp_eq_u32 s88, 3
 s_cselect_b32 s4, 0, s5
 v_mfma_f32_16x16x32_bf16 v[104:107], a[40:43], a[20:23], v[104:107]
 buffer_atomic_add v194, v193, s[96:99], s4 offen sc1
 v_mfma_f32_16x16x32_bf16 v[112:115], a[40:43], a[24:27], v[112:115]
 v_mfma_f32_16x16x32_bf16 v[120:123], a[40:43], a[28:31], v[120:123]
 s_cmp_eq_u32 s88, 3
 s_cselect_b32 s4, s75, s5
 v_mfma_f32_16x16x32_bf16 v[124:127], a[44:47], a[28:31], v[124:127]
 v_mfma_f32_16x16x32_bf16 v[116:119], a[44:47], a[24:27], v[116:119]
 buffer_store_dwordx4 a[156:159], v192, s[92:95], s4 offen sc1
 v_mfma_f32_16x16x32_bf16 v[108:111], a[44:47], a[20:23], v[108:111]
 v_mfma_f32_16x16x32_bf16 v[100:103], a[44:47], a[16:19], v[100:103]
 s_add_u32 m0, s38, 0
 v_mfma_f32_16x16x32_bf16 v[92:95], a[44:47], a[12:15], v[92:95]
 v_mfma_f32_16x16x32_bf16 v[84:87], a[44:47], a[8:11], v[84:87]
 buffer_load_dwordx4 v232, s[12:15], s32 offen lds
 v_mfma_f32_16x16x32_bf16 v[76:79], a[44:47], a[4:7], v[76:79]
 v_mfma_f32_16x16x32_bf16 v[68:71], a[44:47], a[0:3], v[68:71]
 buffer_load_dwordx4 v233, s[12:15], s32 offen offset:1024 lds
 v_mfma_f32_16x16x32_bf16 v[128:131], a[0:3], a[48:51], v[128:131]
 v_mfma_f32_16x16x32_bf16 v[136:139], a[4:7], a[48:51], v[136:139]
 buffer_load_dwordx4 v234, s[12:15], s32 offen offset:2048 lds
 v_mfma_f32_16x16x32_bf16 v[144:147], a[8:11], a[48:51], v[144:147]
 s_add_u32 s32, s32, 196608
 v_mfma_f32_16x16x32_bf16 v[152:155], a[12:15], a[48:51], v[152:155]
 v_mfma_f32_16x16x32_bf16 v[160:163], a[16:19], a[48:51], v[160:163]
 s_add_u32 m0, s37, 40960
 v_mfma_f32_16x16x32_bf16 v[168:171], a[20:23], a[48:51], v[168:171]
 v_mfma_f32_16x16x32_bf16 v[176:179], a[24:27], a[48:51], v[176:179]
 buffer_load_dwordx4 v228, s[8:11], s31 offen lds
 v_mfma_f32_16x16x32_bf16 v[184:187], a[28:31], a[48:51], v[184:187]
 v_mfma_f32_16x16x32_bf16 v[188:191], a[28:31], a[52:55], v[188:191]
 buffer_load_dwordx4 v229, s[8:11], s31 offen offset:1024 lds
 v_mfma_f32_16x16x32_bf16 v[180:183], a[24:27], a[52:55], v[180:183]
 v_mfma_f32_16x16x32_bf16 v[172:175], a[20:23], a[52:55], v[172:175]
 buffer_load_dwordx4 v230, s[8:11], s31 offen offset:2048 lds
 v_mfma_f32_16x16x32_bf16 v[164:167], a[16:19], a[52:55], v[164:167]
 v_mfma_f32_16x16x32_bf16 v[156:159], a[12:15], a[52:55], v[156:159]
 buffer_load_dwordx4 v231, s[8:11], s31 offen offset:3072 lds
 v_mfma_f32_16x16x32_bf16 v[148:151], a[8:11], a[52:55], v[148:151]
 v_mfma_f32_16x16x32_bf16 v[140:143], a[4:7], a[52:55], v[140:143]
 s_add_u32 s31, s31, 128
 v_mfma_f32_16x16x32_bf16 v[132:135], a[0:3], a[52:55], v[132:135]
 s_waitcnt vmcnt(18) lgkmcnt(0)
 s_barrier
 v_mfma_f32_16x16x32_bf16 v[0:3], a[92:95], a[60:63], v[0:3]
 ds_read_b64_tr_b16 a[32:33], v238 offset:24576
 v_mfma_f32_16x16x32_bf16 v[8:11], a[92:95], a[64:67], v[8:11]
 ds_read_b64_tr_b16 a[34:35], v238 offset:25088
 v_mfma_f32_16x16x32_bf16 v[16:19], a[92:95], a[68:71], v[16:19]
 ds_read_b128 a[0:3], v236
 v_mfma_f32_16x16x32_bf16 v[24:27], a[92:95], a[72:75], v[24:27]
 ds_read_b128 a[4:7], v236 offset:2048
 v_mfma_f32_16x16x32_bf16 v[32:35], a[92:95], a[76:79], v[32:35]
 ds_read_b128 a[8:11], v236 offset:4096
 v_mfma_f32_16x16x32_bf16 v[40:43], a[92:95], a[80:83], v[40:43]
 ds_read_b128 a[12:15], v236 offset:6144
 v_mfma_f32_16x16x32_bf16 v[48:51], a[92:95], a[84:87], v[48:51]
 ds_read_b128 a[16:19], v236 offset:8192
 v_mfma_f32_16x16x32_bf16 v[56:59], a[92:95], a[88:91], v[56:59]
 ds_read_b128 a[20:23], v236 offset:10240
 v_mfma_f32_16x16x32_bf16 v[60:63], a[96:99], a[88:91], v[60:63]
 ds_read_b128 a[24:27], v236 offset:12288
 v_mfma_f32_16x16x32_bf16 v[52:55], a[96:99], a[84:87], v[52:55]
 ds_read_b128 a[28:31], v236 offset:14336
 v_mfma_f32_16x16x32_bf16 v[44:47], a[96:99], a[80:83], v[44:47]
 ds_read_b64_tr_b16 a[36:37], v239 offset:24576
 v_mfma_f32_16x16x32_bf16 v[36:39], a[96:99], a[76:79], v[36:39]
 ds_read_b64_tr_b16 a[38:39], v239 offset:25088
 v_mfma_f32_16x16x32_bf16 v[28:31], a[96:99], a[72:75], v[28:31]
 ds_read_b64_tr_b16 a[40:41], v238 offset:25600
 v_mfma_f32_16x16x32_bf16 v[20:23], a[96:99], a[68:71], v[20:23]
 ds_read_b64_tr_b16 a[42:43], v238 offset:26112
 v_mfma_f32_16x16x32_bf16 v[12:15], a[96:99], a[64:67], v[12:15]
 ds_read_b64_tr_b16 a[44:45], v239 offset:25600
 v_mfma_f32_16x16x32_bf16 v[4:7], a[96:99], a[60:63], v[4:7]
 ds_read_b64_tr_b16 a[46:47], v239 offset:26112
 v_mfma_f32_16x16x32_bf16 v[64:67], a[100:103], a[60:63], v[64:67]
 ds_read_b64_tr_b16 a[48:49], v238 offset:26624
 v_mfma_f32_16x16x32_bf16 v[72:75], a[100:103], a[64:67], v[72:75]
 ds_read_b64_tr_b16 a[50:51], v238 offset:27136
 v_mfma_f32_16x16x32_bf16 v[80:83], a[100:103], a[68:71], v[80:83]
 ds_read_b64_tr_b16 a[52:53], v239 offset:26624
 v_mfma_f32_16x16x32_bf16 v[88:91], a[100:103], a[72:75], v[88:91]
 ds_read_b64_tr_b16 a[54:55], v239 offset:27136
 v_mfma_f32_16x16x32_bf16 v[96:99], a[100:103], a[76:79], v[96:99]
 s_add_u32 m0, s38, 12288
 v_mfma_f32_16x16x32_bf16 v[104:107], a[100:103], a[80:83], v[104:107]
 v_mfma_f32_16x16x32_bf16 v[112:115], a[100:103], a[84:87], v[112:115]
 buffer_load_dwordx4 v232, s[12:15], s32 offen lds
 v_mfma_f32_16x16x32_bf16 v[120:123], a[100:103], a[88:91], v[120:123]
 v_mfma_f32_16x16x32_bf16 v[124:127], a[104:107], a[88:91], v[124:127]
 buffer_load_dwordx4 v233, s[12:15], s32 offen offset:1024 lds
 v_mfma_f32_16x16x32_bf16 v[116:119], a[104:107], a[84:87], v[116:119]
 v_mfma_f32_16x16x32_bf16 v[108:111], a[104:107], a[80:83], v[108:111]
 v_mfma_f32_16x16x32_bf16 v[100:103], a[104:107], a[76:79], v[100:103]
 buffer_load_dwordx4 v234, s[12:15], s32 offen offset:2048 lds
 v_mfma_f32_16x16x32_bf16 v[92:95], a[104:107], a[72:75], v[92:95]
 v_mfma_f32_16x16x32_bf16 v[84:87], a[104:107], a[68:71], v[84:87]
 s_add_u32 s32, s32, 196608
 v_mfma_f32_16x16x32_bf16 v[76:79], a[104:107], a[64:67], v[76:79]
 v_mfma_f32_16x16x32_bf16 v[68:71], a[104:107], a[60:63], v[68:71]
 s_add_u32 m0, s37, 73728
 v_mfma_f32_16x16x32_bf16 v[128:131], a[60:63], a[108:111], v[128:131]
 v_mfma_f32_16x16x32_bf16 v[136:139], a[64:67], a[108:111], v[136:139]
 v_mfma_f32_16x16x32_bf16 v[144:147], a[68:71], a[108:111], v[144:147]
 buffer_load_dwordx4 v224, s[8:11], s31 offen lds
 v_mfma_f32_16x16x32_bf16 v[152:155], a[72:75], a[108:111], v[152:155]
 v_mfma_f32_16x16x32_bf16 v[160:163], a[76:79], a[108:111], v[160:163]
 buffer_load_dwordx4 v225, s[8:11], s31 offen offset:1024 lds
 v_mfma_f32_16x16x32_bf16 v[168:171], a[80:83], a[108:111], v[168:171]
 v_mfma_f32_16x16x32_bf16 v[176:179], a[84:87], a[108:111], v[176:179]
 buffer_load_dwordx4 v226, s[8:11], s31 offen offset:2048 lds
 v_mfma_f32_16x16x32_bf16 v[184:187], a[88:91], a[108:111], v[184:187]
 v_mfma_f32_16x16x32_bf16 v[188:191], a[88:91], a[112:115], v[188:191]
 v_mfma_f32_16x16x32_bf16 v[180:183], a[84:87], a[112:115], v[180:183]
 buffer_load_dwordx4 v227, s[8:11], s31 offen offset:3072 lds
 v_mfma_f32_16x16x32_bf16 v[172:175], a[80:83], a[112:115], v[172:175]
 v_mfma_f32_16x16x32_bf16 v[164:167], a[76:79], a[112:115], v[164:167]
 s_add_u32 s24, s24, 2097152
 v_mfma_f32_16x16x32_bf16 v[156:159], a[72:75], a[112:115], v[156:159]
 v_mfma_f32_16x16x32_bf16 v[148:151], a[68:71], a[112:115], v[148:151]
 buffer_load_dword v251, v250, s[20:23], s24 offen
 v_mfma_f32_16x16x32_bf16 v[140:143], a[64:67], a[112:115], v[140:143]
 v_mfma_f32_16x16x32_bf16 v[132:135], a[60:63], a[112:115], v[132:135]
 s_waitcnt vmcnt(15) lgkmcnt(0)
 s_barrier
 v_mfma_f32_16x16x32_bf16 v[0:3], a[32:35], a[0:3], v[0:3]
 ds_read_b64_tr_b16 a[92:93], v238 offset:36864
 v_mfma_f32_16x16x32_bf16 v[8:11], a[32:35], a[4:7], v[8:11]
 ds_read_b64_tr_b16 a[94:95], v238 offset:37376
 v_mfma_f32_16x16x32_bf16 v[16:19], a[32:35], a[8:11], v[16:19]
 ds_read_b128 a[60:63], v237
 v_mfma_f32_16x16x32_bf16 v[24:27], a[32:35], a[12:15], v[24:27]
 ds_read_b128 a[64:67], v237 offset:2048
 v_mfma_f32_16x16x32_bf16 v[32:35], a[32:35], a[16:19], v[32:35]
 ds_read_b128 a[68:71], v237 offset:4096
 v_mfma_f32_16x16x32_bf16 v[40:43], a[32:35], a[20:23], v[40:43]
 ds_read_b128 a[72:75], v237 offset:6144
 v_mfma_f32_16x16x32_bf16 v[48:51], a[32:35], a[24:27], v[48:51]
 ds_read_b128 a[76:79], v237 offset:8192
 v_mfma_f32_16x16x32_bf16 v[56:59], a[32:35], a[28:31], v[56:59]
 ds_read_b128 a[80:83], v237 offset:10240
 v_mfma_f32_16x16x32_bf16 v[60:63], a[36:39], a[28:31], v[60:63]
 ds_read_b128 a[84:87], v237 offset:12288
 v_mfma_f32_16x16x32_bf16 v[52:55], a[36:39], a[24:27], v[52:55]
 ds_read_b128 a[88:91], v237 offset:14336
 v_mfma_f32_16x16x32_bf16 v[44:47], a[36:39], a[20:23], v[44:47]
 ds_read_b64_tr_b16 a[96:97], v239 offset:36864
 v_mfma_f32_16x16x32_bf16 v[36:39], a[36:39], a[16:19], v[36:39]
 ds_read_b64_tr_b16 a[98:99], v239 offset:37376
 v_mfma_f32_16x16x32_bf16 v[28:31], a[36:39], a[12:15], v[28:31]
 ds_read_b64_tr_b16 a[100:101], v238 offset:37888
 v_mfma_f32_16x16x32_bf16 v[20:23], a[36:39], a[8:11], v[20:23]
 ds_read_b64_tr_b16 a[102:103], v238 offset:38400
 v_mfma_f32_16x16x32_bf16 v[12:15], a[36:39], a[4:7], v[12:15]
 ds_read_b64_tr_b16 a[104:105], v239 offset:37888
 v_mfma_f32_16x16x32_bf16 v[4:7], a[36:39], a[0:3], v[4:7]
 ds_read_b64_tr_b16 a[106:107], v239 offset:38400
 v_mfma_f32_16x16x32_bf16 v[64:67], a[40:43], a[0:3], v[64:67]
 ds_read_b64_tr_b16 a[108:109], v238 offset:38912
 v_mfma_f32_16x16x32_bf16 v[72:75], a[40:43], a[4:7], v[72:75]
 ds_read_b64_tr_b16 a[110:111], v238 offset:39424
 v_mfma_f32_16x16x32_bf16 v[80:83], a[40:43], a[8:11], v[80:83]
 ds_read_b64_tr_b16 a[112:113], v239 offset:38912
 v_mfma_f32_16x16x32_bf16 v[88:91], a[40:43], a[12:15], v[88:91]
 ds_read_b64_tr_b16 a[114:115], v239 offset:39424
 v_mfma_f32_16x16x32_bf16 v[96:99], a[40:43], a[16:19], v[96:99]
 s_cmp_eq_u32 s88, 3
 s_cselect_b32 s4, 0, s5
 v_mfma_f32_16x16x32_bf16 v[104:107], a[40:43], a[20:23], v[104:107]
 v_mfma_f32_16x16x32_bf16 v[112:115], a[40:43], a[24:27], v[112:115]
 buffer_atomic_add v194, v195, s[96:99], s4 offen sc1
 v_mfma_f32_16x16x32_bf16 v[120:123], a[40:43], a[28:31], v[120:123]
 v_mfma_f32_16x16x32_bf16 v[124:127], a[44:47], a[28:31], v[124:127]
 s_add_u32 m0, s38, 24576
 v_mfma_f32_16x16x32_bf16 v[116:119], a[44:47], a[24:27], v[116:119]
 v_mfma_f32_16x16x32_bf16 v[108:111], a[44:47], a[20:23], v[108:111]
 buffer_load_dwordx4 v232, s[12:15], s32 offen lds
 v_mfma_f32_16x16x32_bf16 v[100:103], a[44:47], a[16:19], v[100:103]
 v_mfma_f32_16x16x32_bf16 v[92:95], a[44:47], a[12:15], v[92:95]
 buffer_load_dwordx4 v233, s[12:15], s32 offen offset:1024 lds
 v_mfma_f32_16x16x32_bf16 v[84:87], a[44:47], a[8:11], v[84:87]
 v_mfma_f32_16x16x32_bf16 v[76:79], a[44:47], a[4:7], v[76:79]
 buffer_load_dwordx4 v234, s[12:15], s32 offen offset:2048 lds
 v_mfma_f32_16x16x32_bf16 v[68:71], a[44:47], a[0:3], v[68:71]
 v_mfma_f32_16x16x32_bf16 v[128:131], a[0:3], a[48:51], v[128:131]
 s_add_u32 s32, s32, 196608
 v_mfma_f32_16x16x32_bf16 v[136:139], a[4:7], a[48:51], v[136:139]
 v_mfma_f32_16x16x32_bf16 v[144:147], a[8:11], a[48:51], v[144:147]
 v_mfma_f32_16x16x32_bf16 v[152:155], a[12:15], a[48:51], v[152:155]
 s_add_u32 m0, s37, 77824
 v_mfma_f32_16x16x32_bf16 v[160:163], a[16:19], a[48:51], v[160:163]
 v_mfma_f32_16x16x32_bf16 v[168:171], a[20:23], a[48:51], v[168:171]
 buffer_load_dwordx4 v228, s[8:11], s31 offen lds
 v_mfma_f32_16x16x32_bf16 v[176:179], a[24:27], a[48:51], v[176:179]
 v_mfma_f32_16x16x32_bf16 v[184:187], a[28:31], a[48:51], v[184:187]
 buffer_load_dwordx4 v229, s[8:11], s31 offen offset:1024 lds
 v_mfma_f32_16x16x32_bf16 v[188:191], a[28:31], a[52:55], v[188:191]
 v_mfma_f32_16x16x32_bf16 v[180:183], a[24:27], a[52:55], v[180:183]
 buffer_load_dwordx4 v230, s[8:11], s31 offen offset:2048 lds
 v_mfma_f32_16x16x32_bf16 v[172:175], a[20:23], a[52:55], v[172:175]
 v_mfma_f32_16x16x32_bf16 v[164:167], a[16:19], a[52:55], v[164:167]
 buffer_load_dwordx4 v231, s[8:11], s31 offen offset:3072 lds
 v_mfma_f32_16x16x32_bf16 v[156:159], a[12:15], a[52:55], v[156:159]
 v_mfma_f32_16x16x32_bf16 v[148:151], a[8:11], a[52:55], v[148:151]
 s_add_u32 s31, s31, 128
 v_mfma_f32_16x16x32_bf16 v[140:143], a[4:7], a[52:55], v[140:143]
 v_mfma_f32_16x16x32_bf16 v[132:135], a[0:3], a[52:55], v[132:135]
 s_waitcnt vmcnt(16) lgkmcnt(0)
 s_barrier
 v_mfma_f32_16x16x32_bf16 v[0:3], a[92:95], a[60:63], v[0:3]
 ds_read_b64_tr_b16 a[32:33], v238
 v_mfma_f32_16x16x32_bf16 v[8:11], a[92:95], a[64:67], v[8:11]
 ds_read_b64_tr_b16 a[34:35], v238 offset:512
 v_mfma_f32_16x16x32_bf16 v[16:19], a[92:95], a[68:71], v[16:19]
 ds_read_b128 a[0:3], v236 offset:36864
 v_mfma_f32_16x16x32_bf16 v[24:27], a[92:95], a[72:75], v[24:27]
 ds_read_b128 a[4:7], v236 offset:38912
 v_mfma_f32_16x16x32_bf16 v[32:35], a[92:95], a[76:79], v[32:35]
 ds_read_b128 a[8:11], v236 offset:40960
 v_mfma_f32_16x16x32_bf16 v[40:43], a[92:95], a[80:83], v[40:43]
 ds_read_b128 a[12:15], v236 offset:43008
 v_mfma_f32_16x16x32_bf16 v[48:51], a[92:95], a[84:87], v[48:51]
 ds_read_b128 a[16:19], v236 offset:45056
 v_mfma_f32_16x16x32_bf16 v[56:59], a[92:95], a[88:91], v[56:59]
 ds_read_b128 a[20:23], v236 offset:47104
 v_mfma_f32_16x16x32_bf16 v[60:63], a[96:99], a[88:91], v[60:63]
 ds_read_b128 a[24:27], v236 offset:49152
 v_mfma_f32_16x16x32_bf16 v[52:55], a[96:99], a[84:87], v[52:55]
 ds_read_b128 a[28:31], v236 offset:51200
 v_mfma_f32_16x16x32_bf16 v[44:47], a[96:99], a[80:83], v[44:47]
 ds_read_b64_tr_b16 a[36:37], v239
 v_mfma_f32_16x16x32_bf16 v[36:39], a[96:99], a[76:79], v[36:39]
 ds_read_b64_tr_b16 a[38:39], v239 offset:512
 v_mfma_f32_16x16x32_bf16 v[28:31], a[96:99], a[72:75], v[28:31]
 ds_read_b64_tr_b16 a[40:41], v238 offset:1024
 v_mfma_f32_16x16x32_bf16 v[20:23], a[96:99], a[68:71], v[20:23]
 ds_read_b64_tr_b16 a[42:43], v238 offset:1536
 v_mfma_f32_16x16x32_bf16 v[12:15], a[96:99], a[64:67], v[12:15]
 ds_read_b64_tr_b16 a[44:45], v239 offset:1024
 v_mfma_f32_16x16x32_bf16 v[4:7], a[96:99], a[60:63], v[4:7]
 ds_read_b64_tr_b16 a[46:47], v239 offset:1536
 v_mfma_f32_16x16x32_bf16 v[64:67], a[100:103], a[60:63], v[64:67]
 ds_read_b64_tr_b16 a[48:49], v238 offset:2048
 v_mfma_f32_16x16x32_bf16 v[72:75], a[100:103], a[64:67], v[72:75]
 ds_read_b64_tr_b16 a[50:51], v238 offset:2560
 v_mfma_f32_16x16x32_bf16 v[80:83], a[100:103], a[68:71], v[80:83]
 ds_read_b64_tr_b16 a[52:53], v239 offset:2048
 v_mfma_f32_16x16x32_bf16 v[88:91], a[100:103], a[72:75], v[88:91]
 ds_read_b64_tr_b16 a[54:55], v239 offset:2560
 v_mfma_f32_16x16x32_bf16 v[96:99], a[100:103], a[76:79], v[96:99]
 s_add_u32 m0, s38, 36864
 v_mfma_f32_16x16x32_bf16 v[104:107], a[100:103], a[80:83], v[104:107]
 v_mfma_f32_16x16x32_bf16 v[112:115], a[100:103], a[84:87], v[112:115]
 buffer_load_dwordx4 v232, s[12:15], s32 offen lds
 v_mfma_f32_16x16x32_bf16 v[120:123], a[100:103], a[88:91], v[120:123]
 v_mfma_f32_16x16x32_bf16 v[124:127], a[104:107], a[88:91], v[124:127]
 buffer_load_dwordx4 v233, s[12:15], s32 offen offset:1024 lds
 v_mfma_f32_16x16x32_bf16 v[116:119], a[104:107], a[84:87], v[116:119]
 v_mfma_f32_16x16x32_bf16 v[108:111], a[104:107], a[80:83], v[108:111]
 v_mfma_f32_16x16x32_bf16 v[100:103], a[104:107], a[76:79], v[100:103]
 buffer_load_dwordx4 v234, s[12:15], s32 offen offset:2048 lds
 v_mfma_f32_16x16x32_bf16 v[92:95], a[104:107], a[72:75], v[92:95]
 v_mfma_f32_16x16x32_bf16 v[84:87], a[104:107], a[68:71], v[84:87]
 s_add_u32 s32, s32, 196608
 v_mfma_f32_16x16x32_bf16 v[76:79], a[104:107], a[64:67], v[76:79]
 v_mfma_f32_16x16x32_bf16 v[68:71], a[104:107], a[60:63], v[68:71]
 s_add_u32 m0, s37, 0
 v_mfma_f32_16x16x32_bf16 v[128:131], a[60:63], a[108:111], v[128:131]
 v_mfma_f32_16x16x32_bf16 v[136:139], a[64:67], a[108:111], v[136:139]
 v_mfma_f32_16x16x32_bf16 v[144:147], a[68:71], a[108:111], v[144:147]
 buffer_load_dwordx4 v224, s[8:11], s31 offen lds
 v_mfma_f32_16x16x32_bf16 v[152:155], a[72:75], a[108:111], v[152:155]
 v_mfma_f32_16x16x32_bf16 v[160:163], a[76:79], a[108:111], v[160:163]
 buffer_load_dwordx4 v225, s[8:11], s31 offen offset:1024 lds
 v_mfma_f32_16x16x32_bf16 v[168:171], a[80:83], a[108:111], v[168:171]
 v_mfma_f32_16x16x32_bf16 v[176:179], a[84:87], a[108:111], v[176:179]
 buffer_load_dwordx4 v226, s[8:11], s31 offen offset:2048 lds
 v_mfma_f32_16x16x32_bf16 v[184:187], a[88:91], a[108:111], v[184:187]
 v_mfma_f32_16x16x32_bf16 v[188:191], a[88:91], a[112:115], v[188:191]
 v_mfma_f32_16x16x32_bf16 v[180:183], a[84:87], a[112:115], v[180:183]
 buffer_load_dwordx4 v227, s[8:11], s31 offen offset:3072 lds
 v_mfma_f32_16x16x32_bf16 v[172:175], a[80:83], a[112:115], v[172:175]
 v_mfma_f32_16x16x32_bf16 v[164:167], a[76:79], a[112:115], v[164:167]
 s_add_u32 s24, s24, 2097152
 v_mfma_f32_16x16x32_bf16 v[156:159], a[72:75], a[112:115], v[156:159]
 v_mfma_f32_16x16x32_bf16 v[148:151], a[68:71], a[112:115], v[148:151]
 buffer_load_dword v251, v250, s[20:23], s24 offen
 v_mfma_f32_16x16x32_bf16 v[140:143], a[64:67], a[112:115], v[140:143]
 v_mfma_f32_16x16x32_bf16 v[132:135], a[60:63], a[112:115], v[132:135]
 s_waitcnt vmcnt(21) lgkmcnt(0)
 s_barrier
 v_mfma_f32_16x16x32_bf16 v[0:3], a[32:35], a[0:3], v[0:3]
 ds_read_b64_tr_b16 a[92:93], v238 offset:12288
 v_mfma_f32_16x16x32_bf16 v[8:11], a[32:35], a[4:7], v[8:11]
 ds_read_b64_tr_b16 a[94:95], v238 offset:12800
 v_mfma_f32_16x16x32_bf16 v[16:19], a[32:35], a[8:11], v[16:19]
 ds_read_b128 a[60:63], v237 offset:36864
 v_mfma_f32_16x16x32_bf16 v[24:27], a[32:35], a[12:15], v[24:27]
 ds_read_b128 a[64:67], v237 offset:38912
 v_mfma_f32_16x16x32_bf16 v[32:35], a[32:35], a[16:19], v[32:35]
 ds_read_b128 a[68:71], v237 offset:40960
 v_mfma_f32_16x16x32_bf16 v[40:43], a[32:35], a[20:23], v[40:43]
 ds_read_b128 a[72:75], v237 offset:43008
 v_mfma_f32_16x16x32_bf16 v[48:51], a[32:35], a[24:27], v[48:51]
 ds_read_b128 a[76:79], v237 offset:45056
 v_mfma_f32_16x16x32_bf16 v[56:59], a[32:35], a[28:31], v[56:59]
 ds_read_b128 a[80:83], v237 offset:47104
 v_mfma_f32_16x16x32_bf16 v[60:63], a[36:39], a[28:31], v[60:63]
 ds_read_b128 a[84:87], v237 offset:49152
 v_mfma_f32_16x16x32_bf16 v[52:55], a[36:39], a[24:27], v[52:55]
 ds_read_b128 a[88:91], v237 offset:51200
 v_mfma_f32_16x16x32_bf16 v[44:47], a[36:39], a[20:23], v[44:47]
 ds_read_b64_tr_b16 a[96:97], v239 offset:12288
 v_mfma_f32_16x16x32_bf16 v[36:39], a[36:39], a[16:19], v[36:39]
 ds_read_b64_tr_b16 a[98:99], v239 offset:12800
 v_mfma_f32_16x16x32_bf16 v[28:31], a[36:39], a[12:15], v[28:31]
 ds_read_b64_tr_b16 a[100:101], v238 offset:13312
 v_mfma_f32_16x16x32_bf16 v[20:23], a[36:39], a[8:11], v[20:23]
 ds_read_b64_tr_b16 a[102:103], v238 offset:13824
 v_mfma_f32_16x16x32_bf16 v[12:15], a[36:39], a[4:7], v[12:15]
 ds_read_b64_tr_b16 a[104:105], v239 offset:13312
 v_mfma_f32_16x16x32_bf16 v[4:7], a[36:39], a[0:3], v[4:7]
 ds_read_b64_tr_b16 a[106:107], v239 offset:13824
 v_mfma_f32_16x16x32_bf16 v[64:67], a[40:43], a[0:3], v[64:67]
 ds_read_b64_tr_b16 a[108:109], v238 offset:14336
 v_mfma_f32_16x16x32_bf16 v[72:75], a[40:43], a[4:7], v[72:75]
 ds_read_b64_tr_b16 a[110:111], v238 offset:14848
 v_mfma_f32_16x16x32_bf16 v[80:83], a[40:43], a[8:11], v[80:83]
 ds_read_b64_tr_b16 a[112:113], v239 offset:14336
 v_mfma_f32_16x16x32_bf16 v[88:91], a[40:43], a[12:15], v[88:91]
 ds_read_b64_tr_b16 a[114:115], v239 offset:14848
 v_mfma_f32_16x16x32_bf16 v[96:99], a[40:43], a[16:19], v[96:99]
 s_add_u32 m0, s38, 0
 v_mfma_f32_16x16x32_bf16 v[104:107], a[40:43], a[20:23], v[104:107]
 v_mfma_f32_16x16x32_bf16 v[112:115], a[40:43], a[24:27], v[112:115]
 buffer_load_dwordx4 v232, s[12:15], s32 offen lds
 v_mfma_f32_16x16x32_bf16 v[120:123], a[40:43], a[28:31], v[120:123]
 v_mfma_f32_16x16x32_bf16 v[124:127], a[44:47], a[28:31], v[124:127]
 v_mfma_f32_16x16x32_bf16 v[116:119], a[44:47], a[24:27], v[116:119]
 buffer_load_dwordx4 v233, s[12:15], s32 offen offset:1024 lds
 v_mfma_f32_16x16x32_bf16 v[108:111], a[44:47], a[20:23], v[108:111]
 v_mfma_f32_16x16x32_bf16 v[100:103], a[44:47], a[16:19], v[100:103]
 buffer_load_dwordx4 v234, s[12:15], s32 offen offset:2048 lds
 v_mfma_f32_16x16x32_bf16 v[92:95], a[44:47], a[12:15], v[92:95]
 v_mfma_f32_16x16x32_bf16 v[84:87], a[44:47], a[8:11], v[84:87]
 v_mfma_f32_16x16x32_bf16 v[76:79], a[44:47], a[4:7], v[76:79]
 s_add_u32 s32, s32, 196608
 v_mfma_f32_16x16x32_bf16 v[68:71], a[44:47], a[0:3], v[68:71]
 v_mfma_f32_16x16x32_bf16 v[128:131], a[0:3], a[48:51], v[128:131]
 s_add_u32 m0, s37, 4096
 v_mfma_f32_16x16x32_bf16 v[136:139], a[4:7], a[48:51], v[136:139]
 v_mfma_f32_16x16x32_bf16 v[144:147], a[8:11], a[48:51], v[144:147]
 v_mfma_f32_16x16x32_bf16 v[152:155], a[12:15], a[48:51], v[152:155]
 buffer_load_dwordx4 v228, s[8:11], s31 offen lds
 v_mfma_f32_16x16x32_bf16 v[160:163], a[16:19], a[48:51], v[160:163]
 v_mfma_f32_16x16x32_bf16 v[168:171], a[20:23], a[48:51], v[168:171]
 buffer_load_dwordx4 v229, s[8:11], s31 offen offset:1024 lds
 v_mfma_f32_16x16x32_bf16 v[176:179], a[24:27], a[48:51], v[176:179]
 v_mfma_f32_16x16x32_bf16 v[184:187], a[28:31], a[48:51], v[184:187]
 v_mfma_f32_16x16x32_bf16 v[188:191], a[28:31], a[52:55], v[188:191]
 buffer_load_dwordx4 v230, s[8:11], s31 offen offset:2048 lds
 v_mfma_f32_16x16x32_bf16 v[180:183], a[24:27], a[52:55], v[180:183]
 v_mfma_f32_16x16x32_bf16 v[172:175], a[20:23], a[52:55], v[172:175]
 buffer_load_dwordx4 v231, s[8:11], s31 offen offset:3072 lds
 v_mfma_f32_16x16x32_bf16 v[164:167], a[16:19], a[52:55], v[164:167]
 v_mfma_f32_16x16x32_bf16 v[156:159], a[12:15], a[52:55], v[156:159]
 v_mfma_f32_16x16x32_bf16 v[148:151], a[8:11], a[52:55], v[148:151]
 s_add_u32 s31, s31, 128
 v_mfma_f32_16x16x32_bf16 v[140:143], a[4:7], a[52:55], v[140:143]
 v_mfma_f32_16x16x32_bf16 v[132:135], a[0:3], a[52:55], v[132:135]
 s_waitcnt vmcnt(15) lgkmcnt(0)
 s_barrier
 v_mfma_f32_16x16x32_bf16 v[0:3], a[92:95], a[60:63], v[0:3]
 ds_read_b64_tr_b16 a[32:33], v238 offset:24576
 v_mfma_f32_16x16x32_bf16 v[8:11], a[92:95], a[64:67], v[8:11]
 ds_read_b64_tr_b16 a[34:35], v238 offset:25088
 v_mfma_f32_16x16x32_bf16 v[16:19], a[92:95], a[68:71], v[16:19]
 ds_read_b128 a[0:3], v241
 v_mfma_f32_16x16x32_bf16 v[24:27], a[92:95], a[72:75], v[24:27]
 ds_read_b128 a[4:7], v241 offset:2048
 v_mfma_f32_16x16x32_bf16 v[32:35], a[92:95], a[76:79], v[32:35]
 ds_read_b128 a[8:11], v241 offset:4096
 v_mfma_f32_16x16x32_bf16 v[40:43], a[92:95], a[80:83], v[40:43]
 ds_read_b128 a[12:15], v241 offset:6144
 v_mfma_f32_16x16x32_bf16 v[48:51], a[92:95], a[84:87], v[48:51]
 ds_read_b128 a[16:19], v241 offset:8192
 v_mfma_f32_16x16x32_bf16 v[56:59], a[92:95], a[88:91], v[56:59]
 ds_read_b128 a[20:23], v241 offset:10240
 v_mfma_f32_16x16x32_bf16 v[60:63], a[96:99], a[88:91], v[60:63]
 ds_read_b128 a[24:27], v241 offset:12288
 v_mfma_f32_16x16x32_bf16 v[52:55], a[96:99], a[84:87], v[52:55]
 ds_read_b128 a[28:31], v241 offset:14336
 v_mfma_f32_16x16x32_bf16 v[44:47], a[96:99], a[80:83], v[44:47]
 ds_read_b64_tr_b16 a[36:37], v239 offset:24576
 v_mfma_f32_16x16x32_bf16 v[36:39], a[96:99], a[76:79], v[36:39]
 ds_read_b64_tr_b16 a[38:39], v239 offset:25088
 v_mfma_f32_16x16x32_bf16 v[28:31], a[96:99], a[72:75], v[28:31]
 ds_read_b64_tr_b16 a[40:41], v238 offset:25600
 v_mfma_f32_16x16x32_bf16 v[20:23], a[96:99], a[68:71], v[20:23]
 ds_read_b64_tr_b16 a[42:43], v238 offset:26112
 v_mfma_f32_16x16x32_bf16 v[12:15], a[96:99], a[64:67], v[12:15]
 ds_read_b64_tr_b16 a[44:45], v239 offset:25600
 v_mfma_f32_16x16x32_bf16 v[4:7], a[96:99], a[60:63], v[4:7]
 ds_read_b64_tr_b16 a[46:47], v239 offset:26112
 v_mfma_f32_16x16x32_bf16 v[64:67], a[100:103], a[60:63], v[64:67]
 ds_read_b64_tr_b16 a[48:49], v238 offset:26624
 v_mfma_f32_16x16x32_bf16 v[72:75], a[100:103], a[64:67], v[72:75]
 ds_read_b64_tr_b16 a[50:51], v238 offset:27136
 v_mfma_f32_16x16x32_bf16 v[80:83], a[100:103], a[68:71], v[80:83]
 ds_read_b64_tr_b16 a[52:53], v239 offset:26624
 v_mfma_f32_16x16x32_bf16 v[88:91], a[100:103], a[72:75], v[88:91]
 ds_read_b64_tr_b16 a[54:55], v239 offset:27136
 v_and_b32_e64 v205, 31, v255
 v_mfma_f32_16x16x32_bf16 v[96:99], a[100:103], a[76:79], v[96:99]
 s_add_u32 m0, s38, 12288
 v_mfma_f32_16x16x32_bf16 v[104:107], a[100:103], a[80:83], v[104:107]
 buffer_load_dwordx4 v232, s[12:15], s32 offen lds
 v_mfma_f32_16x16x32_bf16 v[112:115], a[100:103], a[84:87], v[112:115]
 v_lshrrev_b32_e64 v206, 5, v255
 v_mfma_f32_16x16x32_bf16 v[120:123], a[100:103], a[88:91], v[120:123]
 buffer_load_dwordx4 v233, s[12:15], s32 offen offset:1024 lds
 v_mfma_f32_16x16x32_bf16 v[124:127], a[104:107], a[88:91], v[124:127]
 v_bfe_u32 v207, v255, 1, 1
 v_mfma_f32_16x16x32_bf16 v[116:119], a[104:107], a[84:87], v[116:119]
 buffer_load_dwordx4 v234, s[12:15], s32 offen offset:2048 lds
 v_mfma_f32_16x16x32_bf16 v[108:111], a[104:107], a[80:83], v[108:111]
 v_lshlrev_b32_e64 v207, 2, v207
 v_mfma_f32_16x16x32_bf16 v[100:103], a[104:107], a[76:79], v[100:103]
 s_add_u32 s32, s32, 196608
 v_mfma_f32_16x16x32_bf16 v[92:95], a[104:107], a[72:75], v[92:95]
 v_bfe_u32 v208, v255, 2, 1
 v_mfma_f32_16x16x32_bf16 v[84:87], a[104:107], a[68:71], v[84:87]
 s_add_u32 m0, s37, 36864
 v_mfma_f32_16x16x32_bf16 v[76:79], a[104:107], a[64:67], v[76:79]
 v_lshl_or_b32 v207, v208, 1, v207
 v_mfma_f32_16x16x32_bf16 v[68:71], a[104:107], a[60:63], v[68:71]
 buffer_load_dwordx4 v224, s[8:11], s31 offen lds
 v_mfma_f32_16x16x32_bf16 v[128:131], a[60:63], a[108:111], v[128:131]
 v_and_b32_e64 v208, 1, v255
 v_mfma_f32_16x16x32_bf16 v[136:139], a[64:67], a[108:111], v[136:139]
 buffer_load_dwordx4 v225, s[8:11], s31 offen offset:1024 lds
 v_mfma_f32_16x16x32_bf16 v[144:147], a[68:71], a[108:111], v[144:147]
 buffer_load_dwordx4 v226, s[8:11], s31 offen offset:2048 lds
 v_mfma_f32_16x16x32_bf16 v[152:155], a[72:75], a[108:111], v[152:155]
 v_or_b32_e64 v207, v208, v207
 v_mfma_f32_16x16x32_bf16 v[160:163], a[76:79], a[108:111], v[160:163]
 buffer_load_dwordx4 v227, s[8:11], s31 offen offset:3072 lds
 v_mfma_f32_16x16x32_bf16 v[168:171], a[80:83], a[108:111], v[168:171]
 v_xor_b32_e64 v207, v207, v206
 v_mfma_f32_16x16x32_bf16 v[176:179], a[84:87], a[108:111], v[176:179]
 s_mov_b32 s20, s54
 v_mfma_f32_16x16x32_bf16 v[184:187], a[88:91], a[108:111], v[184:187]
 v_lshlrev_b32 v207, 4, v207
 v_mfma_f32_16x16x32_bf16 v[188:191], a[88:91], a[112:115], v[188:191]
 s_mov_b32 s21, s55
 v_mfma_f32_16x16x32_bf16 v[180:183], a[84:87], a[112:115], v[180:183]
 v_lshl_add_u32 v235, v205, 7, v207
 v_mfma_f32_16x16x32_bf16 v[172:175], a[80:83], a[112:115], v[172:175]
 s_mov_b32 s22, 0x200000
 v_mfma_f32_16x16x32_bf16 v[164:167], a[76:79], a[112:115], v[164:167]
 s_lshl_b32 s3, s28, 14
 v_mfma_f32_16x16x32_bf16 v[156:159], a[72:75], a[112:115], v[156:159]
 s_mov_b32 s24, s26
 v_mfma_f32_16x16x32_bf16 v[148:151], a[68:71], a[112:115], v[148:151]
 s_add_u32 s3, s3, 65536
 v_mfma_f32_16x16x32_bf16 v[140:143], a[64:67], a[112:115], v[140:143]
 buffer_load_dword v251, v250, s[20:23], s24 offen
 v_mfma_f32_16x16x32_bf16 v[132:135], a[60:63], a[112:115], v[132:135]
 v_add_u32 v235, s3, v235
 s_waitcnt vmcnt(20) lgkmcnt(0)
 s_barrier
 v_mfma_f32_16x16x32_bf16 v[0:3], a[32:35], a[0:3], v[0:3]
 ds_read_b64_tr_b16 a[92:93], v238 offset:36864
 v_mfma_f32_16x16x32_bf16 v[8:11], a[32:35], a[4:7], v[8:11]
 ds_read_b64_tr_b16 a[94:95], v238 offset:37376
 s_lshl_b32 s6, s41, 1
 v_mfma_f32_16x16x32_bf16 v[16:19], a[32:35], a[8:11], v[16:19]
 ds_read_b128 a[60:63], v242
 s_add_u32 s6, s6, s30
 v_mfma_f32_16x16x32_bf16 v[24:27], a[32:35], a[12:15], v[24:27]
 ds_read_b128 a[64:67], v242 offset:2048
 s_mul_i32 s6, s6, 37
 v_mfma_f32_16x16x32_bf16 v[32:35], a[32:35], a[16:19], v[32:35]
 ds_read_b128 a[68:71], v242 offset:4096
 s_lshr_b32 s6, s6, 8
 v_mfma_f32_16x16x32_bf16 v[40:43], a[32:35], a[20:23], v[40:43]
 ds_read_b128 a[72:75], v242 offset:6144
 s_add_u32 s6, s6, 16
 v_mfma_f32_16x16x32_bf16 v[48:51], a[32:35], a[24:27], v[48:51]
 ds_read_b128 a[76:79], v242 offset:8192
 s_lshl_b32 s6, s6, 13
 v_mfma_f32_16x16x32_bf16 v[56:59], a[32:35], a[28:31], v[56:59]
 ds_read_b128 a[80:83], v242 offset:10240
 s_lshl_b32 s3, s40, 4
 v_mfma_f32_16x16x32_bf16 v[60:63], a[36:39], a[28:31], v[60:63]
 ds_read_b128 a[84:87], v242 offset:12288
 s_lshl_b32 s7, s29, 3
 v_mfma_f32_16x16x32_bf16 v[52:55], a[36:39], a[24:27], v[52:55]
 ds_read_b128 a[88:91], v242 offset:14336
 s_add_u32 s3, s3, s7
 v_mfma_f32_16x16x32_bf16 v[44:47], a[36:39], a[20:23], v[44:47]
 ds_read_b64_tr_b16 a[96:97], v239 offset:36864
 s_mul_i32 s3, s3, 172032
 v_mfma_f32_16x16x32_bf16 v[36:39], a[36:39], a[16:19], v[36:39]
 ds_read_b64_tr_b16 a[98:99], v239 offset:37376
 s_add_u32 s6, s6, s3
 v_mfma_f32_16x16x32_bf16 v[28:31], a[36:39], a[12:15], v[28:31]
 ds_read_b64_tr_b16 a[100:101], v238 offset:37888
 s_mov_b32 s3, 172032
 v_mfma_f32_16x16x32_bf16 v[20:23], a[36:39], a[8:11], v[20:23]
 ds_read_b64_tr_b16 a[102:103], v238 offset:38400
 v_mul_u32_u24_e64 v247, s3, v255
 v_mfma_f32_16x16x32_bf16 v[12:15], a[36:39], a[4:7], v[12:15]
 ds_read_b64_tr_b16 a[104:105], v239 offset:37888
 v_add_u32_e64 v247, s6, v247
 v_mfma_f32_16x16x32_bf16 v[4:7], a[36:39], a[0:3], v[4:7]
 ds_read_b64_tr_b16 a[106:107], v239 offset:38400
 v_bfe_u32 v246, v255, 1, 2
 v_mfma_f32_16x16x32_bf16 v[64:67], a[40:43], a[0:3], v[64:67]
 ds_read_b64_tr_b16 a[108:109], v238 offset:38912
 v_mul_u32_u24_e64 v246, s3, v246
 v_mfma_f32_16x16x32_bf16 v[72:75], a[40:43], a[4:7], v[72:75]
 ds_read_b64_tr_b16 a[110:111], v238 offset:39424
 v_and_b32_e64 v245, 1, v255
 v_mfma_f32_16x16x32_bf16 v[80:83], a[40:43], a[8:11], v[80:83]
 ds_read_b64_tr_b16 a[112:113], v239 offset:38912
 v_lshl_add_u32 v246, v245, 14, v246
 v_mfma_f32_16x16x32_bf16 v[88:91], a[40:43], a[12:15], v[88:91]
 ds_read_b64_tr_b16 a[114:115], v239 offset:39424
 s_lshl_b32 s6, s40, 4
 v_mfma_f32_16x16x32_bf16 v[96:99], a[40:43], a[16:19], v[96:99]
 s_add_u32 m0, s38, 24576
 s_lshl_b32 s7, s28, 2
 v_mfma_f32_16x16x32_bf16 v[104:107], a[40:43], a[20:23], v[104:107]
 s_add_u32 s6, s6, s7
 v_mfma_f32_16x16x32_bf16 v[112:115], a[40:43], a[24:27], v[112:115]
 buffer_load_dwordx4 v232, s[12:15], s32 offen lds
 s_mul_i32 s6, s6, 172032
 v_mfma_f32_16x16x32_bf16 v[120:123], a[40:43], a[28:31], v[120:123]
 s_lshl_b32 s7, s39, 15
 v_mfma_f32_16x16x32_bf16 v[124:127], a[44:47], a[28:31], v[124:127]
 s_add_u32 s6, s6, s7
 v_mfma_f32_16x16x32_bf16 v[116:119], a[44:47], a[24:27], v[116:119]
 buffer_load_dwordx4 v233, s[12:15], s32 offen offset:1024 lds
 v_add_u32 v246, s6, v246
 v_mfma_f32_16x16x32_bf16 v[108:111], a[44:47], a[20:23], v[108:111]
 v_cmp_gt_u32 vcc, 8, v255
 v_mfma_f32_16x16x32_bf16 v[100:103], a[44:47], a[16:19], v[100:103]
 buffer_load_dwordx4 v234, s[12:15], s32 offen offset:2048 lds
 v_lshrrev_b32 v245, 4, v255
 v_mfma_f32_16x16x32_bf16 v[92:95], a[44:47], a[12:15], v[92:95]
 v_cndmask_b32_e64 v247, v246, v247, vcc
 v_mfma_f32_16x16x32_bf16 v[84:87], a[44:47], a[8:11], v[84:87]
 v_lshl_add_u32 v247, v245, 28, v247
 v_mfma_f32_16x16x32_bf16 v[76:79], a[44:47], a[4:7], v[76:79]
 s_add_u32 s32, s32, 196608
 v_bfe_u32 v205, v255, 2, 2
 v_mfma_f32_16x16x32_bf16 v[68:71], a[44:47], a[0:3], v[68:71]
 v_lshlrev_b32_e64 v240, 10, v206
 v_mfma_f32_16x16x32_bf16 v[128:131], a[0:3], a[48:51], v[128:131]
 s_add_u32 m0, s37, 40960
 v_lshl_add_u32 v240, v205, 7, v240
 v_mfma_f32_16x16x32_bf16 v[136:139], a[4:7], a[48:51], v[136:139]
 v_lshrrev_b32_e64 v207, 1, v205
 v_mfma_f32_16x16x32_bf16 v[144:147], a[8:11], a[48:51], v[144:147]
 v_lshlrev_b32_e64 v207, 2, v207
 v_mfma_f32_16x16x32_bf16 v[152:155], a[12:15], a[48:51], v[152:155]
 buffer_load_dwordx4 v228, s[8:11], s31 offen lds
 v_and_b32_e64 v208, 1, v205
 v_mfma_f32_16x16x32_bf16 v[160:163], a[16:19], a[48:51], v[160:163]
 v_or_b32_e64 v207, v207, v208
 v_mfma_f32_16x16x32_bf16 v[168:171], a[20:23], a[48:51], v[168:171]
 buffer_load_dwordx4 v229, s[8:11], s31 offen offset:1024 lds
 v_bfe_u32 v208, v255, 4, 1
 v_mfma_f32_16x16x32_bf16 v[176:179], a[24:27], a[48:51], v[176:179]
 v_lshlrev_b32_e64 v208, 1, v208
 v_mfma_f32_16x16x32_bf16 v[184:187], a[28:31], a[48:51], v[184:187]
 v_xor_b32_e64 v207, v207, v208
 v_mfma_f32_16x16x32_bf16 v[188:191], a[28:31], a[52:55], v[188:191]
 buffer_load_dwordx4 v230, s[8:11], s31 offen offset:2048 lds
 v_and_b32_e64 v208, 1, v255
 v_mfma_f32_16x16x32_bf16 v[180:183], a[24:27], a[52:55], v[180:183]
 v_xor_b32_e64 v207, v207, v208
 v_mfma_f32_16x16x32_bf16 v[172:175], a[20:23], a[52:55], v[172:175]
 buffer_load_dwordx4 v231, s[8:11], s31 offen offset:3072 lds
 v_lshl_add_u32 v240, v207, 4, v240
 v_mfma_f32_16x16x32_bf16 v[164:167], a[16:19], a[52:55], v[164:167]
 v_bfe_u32 v208, v255, 1, 1
 v_mfma_f32_16x16x32_bf16 v[156:159], a[12:15], a[52:55], v[156:159]
 v_lshl_add_u32 v240, v208, 3, v240
 v_mfma_f32_16x16x32_bf16 v[148:151], a[8:11], a[52:55], v[148:151]
 s_add_u32 s31, s31, 128
 s_lshl_b32 s3, s28, 14
 v_mfma_f32_16x16x32_bf16 v[140:143], a[4:7], a[52:55], v[140:143]
 s_add_u32 s3, s3, 65536
 v_add_u32 v240, s3, v240
 v_mfma_f32_16x16x32_bf16 v[132:135], a[0:3], a[52:55], v[132:135]
 s_lshl_b32 s3, s29, 6
 v_xor_b32 v240, s3, v240
 s_waitcnt vmcnt(15) lgkmcnt(0)
 s_barrier
 v_mfma_f32_16x16x32_bf16 v[0:3], a[92:95], a[60:63], v[0:3]
 ds_read_b64_tr_b16 a[32:33], v238
 v_mfma_f32_16x16x32_bf16 v[8:11], a[92:95], a[64:67], v[8:11]
 ds_read_b64_tr_b16 a[34:35], v238 offset:512
 v_mfma_f32_16x16x32_bf16 v[16:19], a[92:95], a[68:71], v[16:19]
 ds_read_b128 a[0:3], v236
 v_mfma_f32_16x16x32_bf16 v[24:27], a[92:95], a[72:75], v[24:27]
 ds_read_b128 a[4:7], v236 offset:2048
 v_mfma_f32_16x16x32_bf16 v[32:35], a[92:95], a[76:79], v[32:35]
 ds_read_b128 a[8:11], v236 offset:4096
 v_mfma_f32_16x16x32_bf16 v[40:43], a[92:95], a[80:83], v[40:43]
 ds_read_b128 a[12:15], v236 offset:6144
 v_mfma_f32_16x16x32_bf16 v[48:51], a[92:95], a[84:87], v[48:51]
 ds_read_b128 a[16:19], v236 offset:8192
 v_mfma_f32_16x16x32_bf16 v[56:59], a[92:95], a[88:91], v[56:59]
 ds_read_b128 a[20:23], v236 offset:10240
 v_mfma_f32_16x16x32_bf16 v[60:63], a[96:99], a[88:91], v[60:63]
 ds_read_b128 a[24:27], v236 offset:12288
 v_mfma_f32_16x16x32_bf16 v[52:55], a[96:99], a[84:87], v[52:55]
 ds_read_b128 a[28:31], v236 offset:14336
 v_mfma_f32_16x16x32_bf16 v[44:47], a[96:99], a[80:83], v[44:47]
 ds_read_b64_tr_b16 a[36:37], v239
 v_mfma_f32_16x16x32_bf16 v[36:39], a[96:99], a[76:79], v[36:39]
 ds_read_b64_tr_b16 a[38:39], v239 offset:512
 v_mfma_f32_16x16x32_bf16 v[28:31], a[96:99], a[72:75], v[28:31]
 ds_read_b64_tr_b16 a[40:41], v238 offset:1024
 v_mfma_f32_16x16x32_bf16 v[20:23], a[96:99], a[68:71], v[20:23]
 ds_read_b64_tr_b16 a[42:43], v238 offset:1536
 v_mfma_f32_16x16x32_bf16 v[12:15], a[96:99], a[64:67], v[12:15]
 ds_read_b64_tr_b16 a[44:45], v239 offset:1024
 v_mfma_f32_16x16x32_bf16 v[4:7], a[96:99], a[60:63], v[4:7]
 ds_read_b64_tr_b16 a[46:47], v239 offset:1536
 v_mfma_f32_16x16x32_bf16 v[64:67], a[100:103], a[60:63], v[64:67]
 ds_read_b64_tr_b16 a[48:49], v238 offset:2048
 v_mfma_f32_16x16x32_bf16 v[72:75], a[100:103], a[64:67], v[72:75]
 ds_read_b64_tr_b16 a[50:51], v238 offset:2560
 v_mfma_f32_16x16x32_bf16 v[80:83], a[100:103], a[68:71], v[80:83]
 ds_read_b64_tr_b16 a[52:53], v239 offset:2048
 v_mfma_f32_16x16x32_bf16 v[88:91], a[100:103], a[72:75], v[88:91]
 ds_read_b64_tr_b16 a[54:55], v239 offset:2560
 v_mfma_f32_16x16x32_bf16 v[96:99], a[100:103], a[76:79], v[96:99]
 s_add_u32 m0, s38, 36864
 v_mfma_f32_16x16x32_bf16 v[104:107], a[100:103], a[80:83], v[104:107]
 v_min_u32_e64 v196, 8, v255
 v_mfma_f32_16x16x32_bf16 v[112:115], a[100:103], a[84:87], v[112:115]
 buffer_load_dwordx4 v232, s[12:15], s32 offen lds
 v_mfma_f32_16x16x32_bf16 v[120:123], a[100:103], a[88:91], v[120:123]
 s_lshl_b32 s3, s81, 4
 v_mfma_f32_16x16x32_bf16 v[124:127], a[104:107], a[88:91], v[124:127]
 v_mfma_f32_16x16x32_bf16 v[116:119], a[104:107], a[84:87], v[116:119]
 buffer_load_dwordx4 v233, s[12:15], s32 offen offset:1024 lds
 v_mfma_f32_16x16x32_bf16 v[108:111], a[104:107], a[80:83], v[108:111]
 s_add_u32 s3, s3, s41
 v_mfma_f32_16x16x32_bf16 v[100:103], a[104:107], a[76:79], v[100:103]
 buffer_load_dwordx4 v234, s[12:15], s32 offen offset:2048 lds
 v_mfma_f32_16x16x32_bf16 v[92:95], a[104:107], a[72:75], v[92:95]
 v_mfma_f32_16x16x32_bf16 v[84:87], a[104:107], a[68:71], v[84:87]
 s_add_u32 s3, s3, 24
 v_mfma_f32_16x16x32_bf16 v[76:79], a[104:107], a[64:67], v[76:79]
 s_add_u32 s32, s32, 196608
 v_mfma_f32_16x16x32_bf16 v[68:71], a[104:107], a[60:63], v[68:71]
 v_mfma_f32_16x16x32_bf16 v[128:131], a[60:63], a[108:111], v[128:131]
 s_add_u32 m0, s37, 73728
 v_mfma_f32_16x16x32_bf16 v[136:139], a[64:67], a[108:111], v[136:139]
 v_lshrrev_b32 v197, 3, v196
 v_mfma_f32_16x16x32_bf16 v[144:147], a[68:71], a[108:111], v[144:147]
 v_mfma_f32_16x16x32_bf16 v[152:155], a[72:75], a[108:111], v[152:155]
 buffer_load_dwordx4 v224, s[8:11], s31 offen lds
 v_mfma_f32_16x16x32_bf16 v[160:163], a[76:79], a[108:111], v[160:163]
 v_mad_u32_u24 v196, v197, s3, v196
 v_mfma_f32_16x16x32_bf16 v[168:171], a[80:83], a[108:111], v[168:171]
 buffer_load_dwordx4 v225, s[8:11], s31 offen offset:1024 lds
 v_mfma_f32_16x16x32_bf16 v[176:179], a[84:87], a[108:111], v[176:179]
 v_mfma_f32_16x16x32_bf16 v[184:187], a[88:91], a[108:111], v[184:187]
 v_mul_u32_u24_e64 v197, 24, v197
 v_mfma_f32_16x16x32_bf16 v[188:191], a[88:91], a[112:115], v[188:191]
 buffer_load_dwordx4 v226, s[8:11], s31 offen offset:2048 lds
 v_mfma_f32_16x16x32_bf16 v[180:183], a[84:87], a[112:115], v[180:183]
 v_mfma_f32_16x16x32_bf16 v[172:175], a[80:83], a[112:115], v[172:175]
 buffer_load_dwordx4 v227, s[8:11], s31 offen offset:3072 lds
 v_mfma_f32_16x16x32_bf16 v[164:167], a[76:79], a[112:115], v[164:167]
 v_lshlrev_b32_e64 v196, 2, v196
 v_mfma_f32_16x16x32_bf16 v[156:159], a[72:75], a[112:115], v[156:159]
 v_mfma_f32_16x16x32_bf16 v[148:151], a[68:71], a[112:115], v[148:151]
 buffer_load_dword v251, v247, s[16:19], 0 offen offset:384
 v_mfma_f32_16x16x32_bf16 v[140:143], a[64:67], a[112:115], v[140:143]
 v_sub_u32_e64 v197, 32, v197
 v_mfma_f32_16x16x32_bf16 v[132:135], a[60:63], a[112:115], v[132:135]
 s_waitcnt vmcnt(20) lgkmcnt(0)
 s_barrier
 v_mfma_f32_16x16x32_bf16 v[0:3], a[32:35], a[0:3], v[0:3]
 ds_read_b64_tr_b16 a[92:93], v238 offset:12288
 v_mfma_f32_16x16x32_bf16 v[8:11], a[32:35], a[4:7], v[8:11]
 ds_read_b64_tr_b16 a[94:95], v238 offset:12800
 v_mfma_f32_16x16x32_bf16 v[16:19], a[32:35], a[8:11], v[16:19]
 ds_read_b128 a[60:63], v237
 v_mfma_f32_16x16x32_bf16 v[24:27], a[32:35], a[12:15], v[24:27]
 ds_read_b128 a[64:67], v237 offset:2048
 v_mfma_f32_16x16x32_bf16 v[32:35], a[32:35], a[16:19], v[32:35]
 ds_read_b128 a[68:71], v237 offset:4096
 v_mfma_f32_16x16x32_bf16 v[40:43], a[32:35], a[20:23], v[40:43]
 ds_read_b128 a[72:75], v237 offset:6144
 v_mfma_f32_16x16x32_bf16 v[48:51], a[32:35], a[24:27], v[48:51]
 ds_read_b128 a[76:79], v237 offset:8192
 v_mfma_f32_16x16x32_bf16 v[56:59], a[32:35], a[28:31], v[56:59]
 ds_read_b128 a[80:83], v237 offset:10240
 v_mfma_f32_16x16x32_bf16 v[60:63], a[36:39], a[28:31], v[60:63]
 ds_read_b128 a[84:87], v237 offset:12288
 v_mfma_f32_16x16x32_bf16 v[52:55], a[36:39], a[24:27], v[52:55]
 ds_read_b128 a[88:91], v237 offset:14336
 v_mfma_f32_16x16x32_bf16 v[44:47], a[36:39], a[20:23], v[44:47]
 ds_read_b64_tr_b16 a[96:97], v239 offset:12288
 v_mfma_f32_16x16x32_bf16 v[36:39], a[36:39], a[16:19], v[36:39]
 ds_read_b64_tr_b16 a[98:99], v239 offset:12800
 v_mfma_f32_16x16x32_bf16 v[28:31], a[36:39], a[12:15], v[28:31]
 ds_read_b64_tr_b16 a[100:101], v238 offset:13312
 v_mfma_f32_16x16x32_bf16 v[20:23], a[36:39], a[8:11], v[20:23]
 ds_read_b64_tr_b16 a[102:103], v238 offset:13824
 v_mfma_f32_16x16x32_bf16 v[12:15], a[36:39], a[4:7], v[12:15]
 ds_read_b64_tr_b16 a[104:105], v239 offset:13312
 v_mfma_f32_16x16x32_bf16 v[4:7], a[36:39], a[0:3], v[4:7]
 ds_read_b64_tr_b16 a[106:107], v239 offset:13824
 v_mfma_f32_16x16x32_bf16 v[64:67], a[40:43], a[0:3], v[64:67]
 ds_read_b64_tr_b16 a[108:109], v238 offset:14336
 v_mfma_f32_16x16x32_bf16 v[72:75], a[40:43], a[4:7], v[72:75]
 ds_read_b64_tr_b16 a[110:111], v238 offset:14848
 v_mfma_f32_16x16x32_bf16 v[80:83], a[40:43], a[8:11], v[80:83]
 ds_read_b64_tr_b16 a[112:113], v239 offset:14336
 v_mfma_f32_16x16x32_bf16 v[88:91], a[40:43], a[12:15], v[88:91]
 ds_read_b64_tr_b16 a[114:115], v239 offset:14848
 v_mfma_f32_16x16x32_bf16 v[96:99], a[40:43], a[16:19], v[96:99]
 s_add_u32 m0, s38, 0
 v_mfma_f32_16x16x32_bf16 v[104:107], a[40:43], a[20:23], v[104:107]
 v_mfma_f32_16x16x32_bf16 v[112:115], a[40:43], a[24:27], v[112:115]
 buffer_load_dwordx4 v232, s[12:15], s32 offen lds
 v_mfma_f32_16x16x32_bf16 v[120:123], a[40:43], a[28:31], v[120:123]
 v_mfma_f32_16x16x32_bf16 v[124:127], a[44:47], a[28:31], v[124:127]
 buffer_load_dwordx4 v233, s[12:15], s32 offen offset:1024 lds
 v_mfma_f32_16x16x32_bf16 v[116:119], a[44:47], a[24:27], v[116:119]
 v_mfma_f32_16x16x32_bf16 v[108:111], a[44:47], a[20:23], v[108:111]
 v_mfma_f32_16x16x32_bf16 v[100:103], a[44:47], a[16:19], v[100:103]
 buffer_load_dwordx4 v234, s[12:15], s32 offen offset:2048 lds
 v_mfma_f32_16x16x32_bf16 v[92:95], a[44:47], a[12:15], v[92:95]
 v_mfma_f32_16x16x32_bf16 v[84:87], a[44:47], a[8:11], v[84:87]
 s_add_u32 s32, s32, 196608
 v_mfma_f32_16x16x32_bf16 v[76:79], a[44:47], a[4:7], v[76:79]
 v_mfma_f32_16x16x32_bf16 v[68:71], a[44:47], a[0:3], v[68:71]
 s_add_u32 m0, s37, 77824
 v_mfma_f32_16x16x32_bf16 v[128:131], a[0:3], a[48:51], v[128:131]
 v_mfma_f32_16x16x32_bf16 v[136:139], a[4:7], a[48:51], v[136:139]
 v_mfma_f32_16x16x32_bf16 v[144:147], a[8:11], a[48:51], v[144:147]
 buffer_load_dwordx4 v228, s[8:11], s31 offen lds
 v_mfma_f32_16x16x32_bf16 v[152:155], a[12:15], a[48:51], v[152:155]
 v_mfma_f32_16x16x32_bf16 v[160:163], a[16:19], a[48:51], v[160:163]
 buffer_load_dwordx4 v229, s[8:11], s31 offen offset:1024 lds
 v_mfma_f32_16x16x32_bf16 v[168:171], a[20:23], a[48:51], v[168:171]
 v_mfma_f32_16x16x32_bf16 v[176:179], a[24:27], a[48:51], v[176:179]
 buffer_load_dwordx4 v230, s[8:11], s31 offen offset:2048 lds
 v_mfma_f32_16x16x32_bf16 v[184:187], a[28:31], a[48:51], v[184:187]
 v_mfma_f32_16x16x32_bf16 v[188:191], a[28:31], a[52:55], v[188:191]
 v_mfma_f32_16x16x32_bf16 v[180:183], a[24:27], a[52:55], v[180:183]
 buffer_load_dwordx4 v231, s[8:11], s31 offen offset:3072 lds
 v_mfma_f32_16x16x32_bf16 v[172:175], a[20:23], a[52:55], v[172:175]
 v_mfma_f32_16x16x32_bf16 v[164:167], a[16:19], a[52:55], v[164:167]
 s_add_u32 s31, s31, 128
 v_mfma_f32_16x16x32_bf16 v[156:159], a[12:15], a[52:55], v[156:159]
 v_mfma_f32_16x16x32_bf16 v[148:151], a[8:11], a[52:55], v[148:151]
 buffer_load_dword v195, v196, s[96:99], 0 offen sc1
 v_mfma_f32_16x16x32_bf16 v[140:143], a[4:7], a[52:55], v[140:143]
 v_mfma_f32_16x16x32_bf16 v[132:135], a[0:3], a[52:55], v[132:135]
 s_waitcnt vmcnt(16) lgkmcnt(0)
 s_barrier
 v_mfma_f32_16x16x32_bf16 v[0:3], a[92:95], a[60:63], v[0:3]
 ds_read_b64_tr_b16 a[32:33], v238 offset:24576
 v_mfma_f32_16x16x32_bf16 v[8:11], a[92:95], a[64:67], v[8:11]
 ds_read_b64_tr_b16 a[34:35], v238 offset:25088
 v_mfma_f32_16x16x32_bf16 v[16:19], a[92:95], a[68:71], v[16:19]
 ds_read_b128 a[0:3], v236 offset:36864
 v_mfma_f32_16x16x32_bf16 v[24:27], a[92:95], a[72:75], v[24:27]
 ds_read_b128 a[4:7], v236 offset:38912
 v_mfma_f32_16x16x32_bf16 v[32:35], a[92:95], a[76:79], v[32:35]
 ds_read_b128 a[8:11], v236 offset:40960
 v_mfma_f32_16x16x32_bf16 v[40:43], a[92:95], a[80:83], v[40:43]
 ds_read_b128 a[12:15], v236 offset:43008
 v_mfma_f32_16x16x32_bf16 v[48:51], a[92:95], a[84:87], v[48:51]
 ds_read_b128 a[16:19], v236 offset:45056
 v_mfma_f32_16x16x32_bf16 v[56:59], a[92:95], a[88:91], v[56:59]
 ds_read_b128 a[20:23], v236 offset:47104
 v_mfma_f32_16x16x32_bf16 v[60:63], a[96:99], a[88:91], v[60:63]
 ds_read_b128 a[24:27], v236 offset:49152
 v_mfma_f32_16x16x32_bf16 v[52:55], a[96:99], a[84:87], v[52:55]
 ds_read_b128 a[28:31], v236 offset:51200
 v_mfma_f32_16x16x32_bf16 v[44:47], a[96:99], a[80:83], v[44:47]
 ds_read_b64_tr_b16 a[36:37], v239 offset:24576
 v_mfma_f32_16x16x32_bf16 v[36:39], a[96:99], a[76:79], v[36:39]
 ds_read_b64_tr_b16 a[38:39], v239 offset:25088
 v_mfma_f32_16x16x32_bf16 v[28:31], a[96:99], a[72:75], v[28:31]
 ds_read_b64_tr_b16 a[40:41], v238 offset:25600
 v_mfma_f32_16x16x32_bf16 v[20:23], a[96:99], a[68:71], v[20:23]
 ds_read_b64_tr_b16 a[42:43], v238 offset:26112
 v_mfma_f32_16x16x32_bf16 v[12:15], a[96:99], a[64:67], v[12:15]
 ds_read_b64_tr_b16 a[44:45], v239 offset:25600
 v_mfma_f32_16x16x32_bf16 v[4:7], a[96:99], a[60:63], v[4:7]
 ds_read_b64_tr_b16 a[46:47], v239 offset:26112
 v_mfma_f32_16x16x32_bf16 v[64:67], a[100:103], a[60:63], v[64:67]
 ds_read_b64_tr_b16 a[48:49], v238 offset:26624
 v_mfma_f32_16x16x32_bf16 v[72:75], a[100:103], a[64:67], v[72:75]
 ds_read_b64_tr_b16 a[50:51], v238 offset:27136
 v_mfma_f32_16x16x32_bf16 v[80:83], a[100:103], a[68:71], v[80:83]
 ds_read_b64_tr_b16 a[52:53], v239 offset:26624
 v_mfma_f32_16x16x32_bf16 v[88:91], a[100:103], a[72:75], v[88:91]
 ds_read_b64_tr_b16 a[54:55], v239 offset:27136
 v_mfma_f32_16x16x32_bf16 v[96:99], a[100:103], a[76:79], v[96:99]
 s_add_u32 m0, s38, 12288
 v_mfma_f32_16x16x32_bf16 v[104:107], a[100:103], a[80:83], v[104:107]
 buffer_load_dwordx4 v232, s[12:15], s32 offen lds
 v_mfma_f32_16x16x32_bf16 v[112:115], a[100:103], a[84:87], v[112:115]
 v_mfma_f32_16x16x32_bf16 v[120:123], a[100:103], a[88:91], v[120:123]
 buffer_load_dwordx4 v233, s[12:15], s32 offen offset:1024 lds
 v_mfma_f32_16x16x32_bf16 v[124:127], a[104:107], a[88:91], v[124:127]
 buffer_load_dwordx4 v234, s[12:15], s32 offen offset:2048 lds
 v_mfma_f32_16x16x32_bf16 v[116:119], a[104:107], a[84:87], v[116:119]
 v_mfma_f32_16x16x32_bf16 v[108:111], a[104:107], a[80:83], v[108:111]
 s_add_u32 s32, s32, 196608
 v_mfma_f32_16x16x32_bf16 v[100:103], a[104:107], a[76:79], v[100:103]
 v_mfma_f32_16x16x32_bf16 v[92:95], a[104:107], a[72:75], v[92:95]
 s_add_u32 m0, s37, 0
 v_mfma_f32_16x16x32_bf16 v[84:87], a[104:107], a[68:71], v[84:87]
 buffer_load_dwordx4 v224, s[8:11], s31 offen lds
 v_mfma_f32_16x16x32_bf16 v[76:79], a[104:107], a[64:67], v[76:79]
 v_mfma_f32_16x16x32_bf16 v[68:71], a[104:107], a[60:63], v[68:71]
 buffer_load_dwordx4 v225, s[8:11], s31 offen offset:1024 lds
 v_mfma_f32_16x16x32_bf16 v[128:131], a[60:63], a[108:111], v[128:131]
 v_mfma_f32_16x16x32_bf16 v[136:139], a[64:67], a[108:111], v[136:139]
 buffer_load_dwordx4 v226, s[8:11], s31 offen offset:2048 lds
 v_mfma_f32_16x16x32_bf16 v[144:147], a[68:71], a[108:111], v[144:147]
 buffer_load_dwordx4 v227, s[8:11], s31 offen offset:3072 lds
 v_mfma_f32_16x16x32_bf16 v[152:155], a[72:75], a[108:111], v[152:155]
 v_mfma_f32_16x16x32_bf16 v[160:163], a[76:79], a[108:111], v[160:163]
 v_min_u32_e64 v247, 15, v255
 v_mfma_f32_16x16x32_bf16 v[168:171], a[80:83], a[108:111], v[168:171]
 v_mfma_f32_16x16x32_bf16 v[176:179], a[84:87], a[108:111], v[176:179]
 s_bfe_u32 s6, s2, 0x20006
 s_lshl_b32 s6, s6, 2
 v_mfma_f32_16x16x32_bf16 v[184:187], a[88:91], a[108:111], v[184:187]
 s_add_u32 s6, s6, s28
 s_lshl_b32 s6, s6, 4
 v_mfma_f32_16x16x32_bf16 v[188:191], a[88:91], a[112:115], v[188:191]
 v_mfma_f32_16x16x32_bf16 v[180:183], a[84:87], a[112:115], v[180:183]
 v_add_lshl_u32 v247, v247, s6, 7
 v_mfma_f32_16x16x32_bf16 v[172:175], a[80:83], a[112:115], v[172:175]
 v_mfma_f32_16x16x32_bf16 v[164:167], a[76:79], a[112:115], v[164:167]
 v_min_u32 v247, L_end-L_ct2-2048, v247
 v_mfma_f32_16x16x32_bf16 v[156:159], a[72:75], a[112:115], v[156:159]
 s_getpc_b64 s[6:7]
L_ct2:
 s_add_u32 s6, s6, 2048
 s_addc_u32 s7, s7, 0
 v_mfma_f32_16x16x32_bf16 v[148:151], a[68:71], a[112:115], v[148:151]
 v_mfma_f32_16x16x32_bf16 v[140:143], a[64:67], a[112:115], v[140:143]
 global_load_dword v251, v247, s[6:7]
 v_mfma_f32_16x16x32_bf16 v[132:135], a[60:63], a[112:115], v[132:135]
 s_waitcnt vmcnt(21) lgkmcnt(0)
 s_barrier
 v_mfma_f32_16x16x32_bf16 v[0:3], a[32:35], a[0:3], v[0:3]
 ds_read_b64_tr_b16 a[92:93], v238 offset:36864
 v_mfma_f32_16x16x32_bf16 v[8:11], a[32:35], a[4:7], v[8:11]
 ds_read_b64_tr_b16 a[94:95], v238 offset:37376
 v_mfma_f32_16x16x32_bf16 v[16:19], a[32:35], a[8:11], v[16:19]
 ds_read_b128 a[60:63], v237 offset:36864
 v_mfma_f32_16x16x32_bf16 v[24:27], a[32:35], a[12:15], v[24:27]
 ds_read_b128 a[64:67], v237 offset:38912
 v_mfma_f32_16x16x32_bf16 v[32:35], a[32:35], a[16:19], v[32:35]
 ds_read_b128 a[68:71], v237 offset:40960
 v_mfma_f32_16x16x32_bf16 v[40:43], a[32:35], a[20:23], v[40:43]
 ds_read_b128 a[72:75], v237 offset:43008
 v_mfma_f32_16x16x32_bf16 v[48:51], a[32:35], a[24:27], v[48:51]
 ds_read_b128 a[76:79], v237 offset:45056
 v_mfma_f32_16x16x32_bf16 v[56:59], a[32:35], a[28:31], v[56:59]
 ds_read_b128 a[80:83], v237 offset:47104
 v_mfma_f32_16x16x32_bf16 v[60:63], a[36:39], a[28:31], v[60:63]
 ds_read_b128 a[84:87], v237 offset:49152
 v_mfma_f32_16x16x32_bf16 v[52:55], a[36:39], a[24:27], v[52:55]
 ds_read_b128 a[88:91], v237 offset:51200
 v_mfma_f32_16x16x32_bf16 v[44:47], a[36:39], a[20:23], v[44:47]
 ds_read_b64_tr_b16 a[96:97], v239 offset:36864
 v_mfma_f32_16x16x32_bf16 v[36:39], a[36:39], a[16:19], v[36:39]
 ds_read_b64_tr_b16 a[98:99], v239 offset:37376
 v_mfma_f32_16x16x32_bf16 v[28:31], a[36:39], a[12:15], v[28:31]
 ds_read_b64_tr_b16 a[100:101], v238 offset:37888
 v_mfma_f32_16x16x32_bf16 v[20:23], a[36:39], a[8:11], v[20:23]
 ds_read_b64_tr_b16 a[102:103], v238 offset:38400
 v_mfma_f32_16x16x32_bf16 v[12:15], a[36:39], a[4:7], v[12:15]
 ds_read_b64_tr_b16 a[104:105], v239 offset:37888
 v_mfma_f32_16x16x32_bf16 v[4:7], a[36:39], a[0:3], v[4:7]
 ds_read_b64_tr_b16 a[106:107], v239 offset:38400
 v_mfma_f32_16x16x32_bf16 v[64:67], a[40:43], a[0:3], v[64:67]
 ds_read_b64_tr_b16 a[108:109], v238 offset:38912
 v_mfma_f32_16x16x32_bf16 v[72:75], a[40:43], a[4:7], v[72:75]
 ds_read_b64_tr_b16 a[110:111], v238 offset:39424
 v_mfma_f32_16x16x32_bf16 v[80:83], a[40:43], a[8:11], v[80:83]
 ds_read_b64_tr_b16 a[112:113], v239 offset:38912
 v_mfma_f32_16x16x32_bf16 v[88:91], a[40:43], a[12:15], v[88:91]
 ds_read_b64_tr_b16 a[114:115], v239 offset:39424
 v_mfma_f32_16x16x32_bf16 v[96:99], a[40:43], a[16:19], v[96:99]
 s_add_u32 m0, s38, 24576
 v_mfma_f32_16x16x32_bf16 v[104:107], a[40:43], a[20:23], v[104:107]
 v_mfma_f32_16x16x32_bf16 v[112:115], a[40:43], a[24:27], v[112:115]
 buffer_load_dwordx4 v232, s[12:15], s32 offen lds
 v_mfma_f32_16x16x32_bf16 v[120:123], a[40:43], a[28:31], v[120:123]
 v_mfma_f32_16x16x32_bf16 v[124:127], a[44:47], a[28:31], v[124:127]
 v_mfma_f32_16x16x32_bf16 v[116:119], a[44:47], a[24:27], v[116:119]
 buffer_load_dwordx4 v233, s[12:15], s32 offen offset:1024 lds
 v_mfma_f32_16x16x32_bf16 v[108:111], a[44:47], a[20:23], v[108:111]
 v_mfma_f32_16x16x32_bf16 v[100:103], a[44:47], a[16:19], v[100:103]
 v_mfma_f32_16x16x32_bf16 v[92:95], a[44:47], a[12:15], v[92:95]
 buffer_load_dwordx4 v234, s[12:15], s32 offen offset:2048 lds
 v_mfma_f32_16x16x32_bf16 v[84:87], a[44:47], a[8:11], v[84:87]
 v_mfma_f32_16x16x32_bf16 v[76:79], a[44:47], a[4:7], v[76:79]
 v_mfma_f32_16x16x32_bf16 v[68:71], a[44:47], a[0:3], v[68:71]
 s_add_u32 s32, s32, 196608
 v_mfma_f32_16x16x32_bf16 v[128:131], a[0:3], a[48:51], v[128:131]
 v_mfma_f32_16x16x32_bf16 v[136:139], a[4:7], a[48:51], v[136:139]
 v_mfma_f32_16x16x32_bf16 v[144:147], a[8:11], a[48:51], v[144:147]
 s_add_u32 m0, s37, 4096
 v_mfma_f32_16x16x32_bf16 v[152:155], a[12:15], a[48:51], v[152:155]
 v_mfma_f32_16x16x32_bf16 v[160:163], a[16:19], a[48:51], v[160:163]
 buffer_load_dwordx4 v228, s[8:11], s31 offen lds
 v_mfma_f32_16x16x32_bf16 v[168:171], a[20:23], a[48:51], v[168:171]
 v_mfma_f32_16x16x32_bf16 v[176:179], a[24:27], a[48:51], v[176:179]
 v_mfma_f32_16x16x32_bf16 v[184:187], a[28:31], a[48:51], v[184:187]
 buffer_load_dwordx4 v229, s[8:11], s31 offen offset:1024 lds
 v_mfma_f32_16x16x32_bf16 v[188:191], a[28:31], a[52:55], v[188:191]
 v_mfma_f32_16x16x32_bf16 v[180:183], a[24:27], a[52:55], v[180:183]
 v_mfma_f32_16x16x32_bf16 v[172:175], a[20:23], a[52:55], v[172:175]
 buffer_load_dwordx4 v230, s[8:11], s31 offen offset:2048 lds
 v_mfma_f32_16x16x32_bf16 v[164:167], a[16:19], a[52:55], v[164:167]
 v_mfma_f32_16x16x32_bf16 v[156:159], a[12:15], a[52:55], v[156:159]
 v_mfma_f32_16x16x32_bf16 v[148:151], a[8:11], a[52:55], v[148:151]
 buffer_load_dwordx4 v231, s[8:11], s31 offen offset:3072 lds
 v_mfma_f32_16x16x32_bf16 v[140:143], a[4:7], a[52:55], v[140:143]
 v_mfma_f32_16x16x32_bf16 v[132:135], a[0:3], a[52:55], v[132:135]
 s_waitcnt vmcnt(15) lgkmcnt(0)
 s_barrier
 v_mfma_f32_16x16x32_bf16 v[0:3], a[92:95], a[60:63], v[0:3]
 v_cmp_gt_u32 vcc, v197, v195
 v_mfma_f32_16x16x32_bf16 v[8:11], a[92:95], a[64:67], v[8:11]
 s_lshl_b32 s74, s28, 8
 v_mfma_f32_16x16x32_bf16 v[16:19], a[92:95], a[68:71], v[16:19]
 s_nop 0
 v_mfma_f32_16x16x32_bf16 v[24:27], a[92:95], a[72:75], v[24:27]
 s_cbranch_vccnz L1Q_sp0
L1Q_sok:
 v_mfma_f32_16x16x32_bf16 v[32:35], a[92:95], a[76:79], v[32:35]
 v_lshl_add_u32 v195, v255, 2, s74
 v_mfma_f32_16x16x32_bf16 v[40:43], a[92:95], a[80:83], v[40:43]
 ds_read_b64_tr_b16 a[32:33], v238
 v_mfma_f32_16x16x32_bf16 v[48:51], a[92:95], a[84:87], v[48:51]
 ds_read_b64_tr_b16 a[34:35], v238 offset:512
 v_mfma_f32_16x16x32_bf16 v[56:59], a[92:95], a[88:91], v[56:59]
 ds_read_b128 a[0:3], v241
 v_mfma_f32_16x16x32_bf16 v[60:63], a[96:99], a[88:91], v[60:63]
 ds_read_b128 a[4:7], v241 offset:2048
 v_mfma_f32_16x16x32_bf16 v[52:55], a[96:99], a[84:87], v[52:55]
 ds_read_b128 a[8:11], v241 offset:4096
 v_mfma_f32_16x16x32_bf16 v[44:47], a[96:99], a[80:83], v[44:47]
 ds_read_b128 a[12:15], v241 offset:6144
 v_mfma_f32_16x16x32_bf16 v[36:39], a[96:99], a[76:79], v[36:39]
 ds_read_b128 a[16:19], v241 offset:8192
 v_mfma_f32_16x16x32_bf16 v[28:31], a[96:99], a[72:75], v[28:31]
 ds_read_b128 a[20:23], v241 offset:10240
 v_mfma_f32_16x16x32_bf16 v[20:23], a[96:99], a[68:71], v[20:23]
 ds_read_b128 a[24:27], v241 offset:12288
 v_mfma_f32_16x16x32_bf16 v[12:15], a[96:99], a[64:67], v[12:15]
 ds_read_b128 a[28:31], v241 offset:14336
 v_mfma_f32_16x16x32_bf16 v[4:7], a[96:99], a[60:63], v[4:7]
 ds_read_b64_tr_b16 a[36:37], v239
 v_mfma_f32_16x16x32_bf16 v[64:67], a[100:103], a[60:63], v[64:67]
 ds_read_b64_tr_b16 a[38:39], v239 offset:512
 v_mfma_f32_16x16x32_bf16 v[72:75], a[100:103], a[64:67], v[72:75]
 ds_read_b64_tr_b16 a[40:41], v238 offset:1024
 v_mfma_f32_16x16x32_bf16 v[80:83], a[100:103], a[68:71], v[80:83]
 ds_read_b64_tr_b16 a[42:43], v238 offset:1536
 v_mfma_f32_16x16x32_bf16 v[88:91], a[100:103], a[72:75], v[88:91]
 ds_read_b64_tr_b16 a[44:45], v239 offset:1024
 v_mfma_f32_16x16x32_bf16 v[96:99], a[100:103], a[76:79], v[96:99]
 ds_read_b64_tr_b16 a[46:47], v239 offset:1536
 v_mfma_f32_16x16x32_bf16 v[104:107], a[100:103], a[80:83], v[104:107]
 ds_read_b64_tr_b16 a[48:49], v238 offset:2048
 v_mfma_f32_16x16x32_bf16 v[112:115], a[100:103], a[84:87], v[112:115]
 ds_read_b64_tr_b16 a[50:51], v238 offset:2560
 v_mfma_f32_16x16x32_bf16 v[120:123], a[100:103], a[88:91], v[120:123]
 ds_read_b64_tr_b16 a[52:53], v239 offset:2048
 v_mfma_f32_16x16x32_bf16 v[124:127], a[104:107], a[88:91], v[124:127]
 ds_read_b64_tr_b16 a[54:55], v239 offset:2560
 v_mfma_f32_16x16x32_bf16 v[116:119], a[104:107], a[84:87], v[116:119]
 s_add_u32 m0, s38, 36864
 v_mfma_f32_16x16x32_bf16 v[108:111], a[104:107], a[80:83], v[108:111]
 buffer_load_dwordx4 v232, s[12:15], s32 offen lds
 v_mfma_f32_16x16x32_bf16 v[100:103], a[104:107], a[76:79], v[100:103]
 buffer_load_dwordx4 v233, s[12:15], s32 offen offset:1024 lds
 v_mfma_f32_16x16x32_bf16 v[92:95], a[104:107], a[72:75], v[92:95]
 v_mfma_f32_16x16x32_bf16 v[84:87], a[104:107], a[68:71], v[84:87]
 buffer_load_dwordx4 v234, s[12:15], s32 offen offset:2048 lds
 v_mfma_f32_16x16x32_bf16 v[76:79], a[104:107], a[64:67], v[76:79]
 v_and_b32 v204, 4, v195
 v_mfma_f32_16x16x32_bf16 v[68:71], a[104:107], a[60:63], v[68:71]
 v_and_b32_e64 v203, -8, v195
 v_mfma_f32_16x16x32_bf16 v[128:131], a[60:63], a[108:111], v[128:131]
 v_mfma_f32_16x16x32_bf16 v[136:139], a[64:67], a[108:111], v[136:139]
 v_lshl_add_u32 v204, v203, 4, v204
 v_mfma_f32_16x16x32_bf16 v[144:147], a[68:71], a[108:111], v[144:147]
 buffer_load_dword v204, v204, s[92:95], s72 offen sc1
 v_mfma_f32_16x16x32_bf16 v[152:155], a[72:75], a[108:111], v[152:155]
 buffer_load_dword v196, v195, s[92:95], s73 offen sc1
 v_mfma_f32_16x16x32_bf16 v[160:163], a[76:79], a[108:111], v[160:163]
 v_mfma_f32_16x16x32_bf16 v[168:171], a[80:83], a[108:111], v[168:171]
 buffer_load_dword v197, v195, s[92:95], s73 offen offset:1024 sc1
 v_mfma_f32_16x16x32_bf16 v[176:179], a[84:87], a[108:111], v[176:179]
 buffer_load_dword v198, v195, s[92:95], s73 offen offset:2048 sc1
 v_mfma_f32_16x16x32_bf16 v[184:187], a[88:91], a[108:111], v[184:187]
 buffer_load_dword v199, v195, s[92:95], s73 offen offset:3072 sc1
 v_mfma_f32_16x16x32_bf16 v[188:191], a[88:91], a[112:115], v[188:191]
 v_mfma_f32_16x16x32_bf16 v[180:183], a[84:87], a[112:115], v[180:183]
 s_add_u32 s73, s73, 4096
 v_mfma_f32_16x16x32_bf16 v[172:175], a[80:83], a[112:115], v[172:175]
 buffer_load_dword v200, v195, s[92:95], s73 offen sc1
 v_mfma_f32_16x16x32_bf16 v[164:167], a[76:79], a[112:115], v[164:167]
 buffer_load_dword v201, v195, s[92:95], s73 offen offset:1024 sc1
 v_mfma_f32_16x16x32_bf16 v[156:159], a[72:75], a[112:115], v[156:159]
 v_mfma_f32_16x16x32_bf16 v[148:151], a[68:71], a[112:115], v[148:151]
 buffer_load_dword v202, v195, s[92:95], s73 offen offset:2048 sc1
 v_mfma_f32_16x16x32_bf16 v[140:143], a[64:67], a[112:115], v[140:143]
 buffer_load_dword v203, v195, s[92:95], s73 offen offset:3072 sc1
 v_mfma_f32_16x16x32_bf16 v[132:135], a[60:63], a[112:115], v[132:135]
 s_waitcnt vmcnt(24) lgkmcnt(0)
 s_barrier
 v_mfma_f32_16x16x32_bf16 v[0:3], a[32:35], a[0:3], v[0:3]
 ds_read_b64_tr_b16 a[92:93], v238 offset:12288
 v_mfma_f32_16x16x32_bf16 v[8:11], a[32:35], a[4:7], v[8:11]
 ds_read_b64_tr_b16 a[94:95], v238 offset:12800
 v_mfma_f32_16x16x32_bf16 v[16:19], a[32:35], a[8:11], v[16:19]
 ds_read_b128 a[60:63], v242
 v_mfma_f32_16x16x32_bf16 v[24:27], a[32:35], a[12:15], v[24:27]
 ds_read_b128 a[64:67], v242 offset:2048
 v_mfma_f32_16x16x32_bf16 v[32:35], a[32:35], a[16:19], v[32:35]
 ds_read_b128 a[68:71], v242 offset:4096
 v_mfma_f32_16x16x32_bf16 v[40:43], a[32:35], a[20:23], v[40:43]
 ds_read_b128 a[72:75], v242 offset:6144
 v_mfma_f32_16x16x32_bf16 v[48:51], a[32:35], a[24:27], v[48:51]
 ds_read_b128 a[76:79], v242 offset:8192
 v_mfma_f32_16x16x32_bf16 v[56:59], a[32:35], a[28:31], v[56:59]
 ds_read_b128 a[80:83], v242 offset:10240
 v_mfma_f32_16x16x32_bf16 v[60:63], a[36:39], a[28:31], v[60:63]
 ds_read_b128 a[84:87], v242 offset:12288
 v_mfma_f32_16x16x32_bf16 v[52:55], a[36:39], a[24:27], v[52:55]
 ds_read_b128 a[88:91], v242 offset:14336
 v_mfma_f32_16x16x32_bf16 v[44:47], a[36:39], a[20:23], v[44:47]
 ds_read_b64_tr_b16 a[96:97], v239 offset:12288
 v_mfma_f32_16x16x32_bf16 v[36:39], a[36:39], a[16:19], v[36:39]
 ds_read_b64_tr_b16 a[98:99], v239 offset:12800
 v_mfma_f32_16x16x32_bf16 v[28:31], a[36:39], a[12:15], v[28:31]
 ds_read_b64_tr_b16 a[100:101], v238 offset:13312
 v_mfma_f32_16x16x32_bf16 v[20:23], a[36:39], a[8:11], v[20:23]
 ds_read_b64_tr_b16 a[102:103], v238 offset:13824
 v_mfma_f32_16x16x32_bf16 v[12:15], a[36:39], a[4:7], v[12:15]
 ds_read_b64_tr_b16 a[104:105], v239 offset:13312
 v_mfma_f32_16x16x32_bf16 v[4:7], a[36:39], a[0:3], v[4:7]
 ds_read_b64_tr_b16 a[106:107], v239 offset:13824
 v_mfma_f32_16x16x32_bf16 v[64:67], a[40:43], a[0:3], v[64:67]
 ds_read_b64_tr_b16 a[108:109], v238 offset:14336
 v_mfma_f32_16x16x32_bf16 v[72:75], a[40:43], a[4:7], v[72:75]
 ds_read_b64_tr_b16 a[110:111], v238 offset:14848
 v_mfma_f32_16x16x32_bf16 v[80:83], a[40:43], a[8:11], v[80:83]
 ds_read_b64_tr_b16 a[112:113], v239 offset:14336
 v_mfma_f32_16x16x32_bf16 v[88:91], a[40:43], a[12:15], v[88:91]
 ds_read_b64_tr_b16 a[114:115], v239 offset:14848
 v_mfma_f32_16x16x32_bf16 v[96:99], a[40:43], a[16:19], v[96:99]
 v_and_b32_e64 v218, 15, v255
 v_mfma_f32_16x16x32_bf16 v[104:107], a[40:43], a[20:23], v[104:107]
 s_lshl_b32 s3, s29, 9
 v_mfma_f32_16x16x32_bf16 v[112:115], a[40:43], a[24:27], v[112:115]
 s_add_u32 s3, s3, 160768
 v_mfma_f32_16x16x32_bf16 v[120:123], a[40:43], a[28:31], v[120:123]
 v_mfma_f32_16x16x32_bf16 v[124:127], a[44:47], a[28:31], v[124:127]
 v_lshl_add_u32 v218, v218, 2, s3
 v_mfma_f32_16x16x32_bf16 v[116:119], a[44:47], a[24:27], v[116:119]
 v_lshrrev_b32 v219, 4, v255
 v_mfma_f32_16x16x32_bf16 v[108:111], a[44:47], a[20:23], v[108:111]
 v_mfma_f32_16x16x32_bf16 v[100:103], a[44:47], a[16:19], v[100:103]
 v_lshl_add_u32 v234, v219, 4, s3
 v_mfma_f32_16x16x32_bf16 v[92:95], a[44:47], a[12:15], v[92:95]
 s_lshl_b32 s3, s30, 7
 v_mfma_f32_16x16x32_bf16 v[84:87], a[44:47], a[8:11], v[84:87]
 v_mfma_f32_16x16x32_bf16 v[76:79], a[44:47], a[4:7], v[76:79]
 s_add_u32 s3, s3, 159744
 v_mfma_f32_16x16x32_bf16 v[68:71], a[44:47], a[0:3], v[68:71]
 v_lshl_add_u32 v219, v219, 4, s3
 v_mfma_f32_16x16x32_bf16 v[128:131], a[0:3], a[48:51], v[128:131]
 v_mfma_f32_16x16x32_bf16 v[136:139], a[4:7], a[48:51], v[136:139]
 v_and_b32 v220, 15, v255
 v_mfma_f32_16x16x32_bf16 v[144:147], a[8:11], a[48:51], v[144:147]
 v_lshl_add_u32 v220, v220, 2, s3
 v_mfma_f32_16x16x32_bf16 v[152:155], a[12:15], a[48:51], v[152:155]
 v_mfma_f32_16x16x32_bf16 v[160:163], a[16:19], a[48:51], v[160:163]
 v_and_b32_e64 v252, 31, v255
 v_mfma_f32_16x16x32_bf16 v[168:171], a[20:23], a[48:51], v[168:171]
 s_lshl_b32 s3, s29, 9
 v_mfma_f32_16x16x32_bf16 v[176:179], a[24:27], a[48:51], v[176:179]
 v_mfma_f32_16x16x32_bf16 v[184:187], a[28:31], a[48:51], v[184:187]
 s_add_u32 s3, s3, 161792
 v_mfma_f32_16x16x32_bf16 v[188:191], a[28:31], a[52:55], v[188:191]
 v_lshl_add_u32 v252, v252, 2, s3
 v_mfma_f32_16x16x32_bf16 v[180:183], a[24:27], a[52:55], v[180:183]
 v_mfma_f32_16x16x32_bf16 v[172:175], a[20:23], a[52:55], v[172:175]
 v_lshrrev_b32 v243, 5, v255
 v_mfma_f32_16x16x32_bf16 v[164:167], a[16:19], a[52:55], v[164:167]
 s_lshl_b32 s3, s29, 8
 v_mfma_f32_16x16x32_bf16 v[156:159], a[12:15], a[52:55], v[156:159]
 v_mfma_f32_16x16x32_bf16 v[148:151], a[8:11], a[52:55], v[148:151]
 s_add_u32 s3, s3, 162816
 v_mfma_f32_16x16x32_bf16 v[140:143], a[4:7], a[52:55], v[140:143]
 v_lshl_add_u32 v243, v243, 4, s3
 v_mfma_f32_16x16x32_bf16 v[132:135], a[0:3], a[52:55], v[132:135]
 s_waitcnt vmcnt(12) lgkmcnt(0)
 s_barrier
 v_mfma_f32_16x16x32_bf16 v[0:3], a[92:95], a[60:63], v[0:3]
 ds_read_b64_tr_b16 a[32:33], v238 offset:24576
 s_waitcnt vmcnt(0)
 v_add_f32_e64 v196, v196, v197
 v_mfma_f32_16x16x32_bf16 v[8:11], a[92:95], a[64:67], v[8:11]
 ds_read_b64_tr_b16 a[34:35], v238 offset:25088
 v_add_f32_e64 v198, v198, v199
 v_mfma_f32_16x16x32_bf16 v[16:19], a[92:95], a[68:71], v[16:19]
 ds_read_b128 a[0:3], v236
 v_add_f32_e64 v200, v200, v201
 v_mfma_f32_16x16x32_bf16 v[24:27], a[92:95], a[72:75], v[24:27]
 ds_read_b128 a[4:7], v236 offset:2048
 v_add_f32_e64 v202, v202, v203
 v_mfma_f32_16x16x32_bf16 v[32:35], a[92:95], a[76:79], v[32:35]
 ds_read_b128 a[8:11], v236 offset:4096
 v_add_f32_e64 v196, v196, v198
 v_mfma_f32_16x16x32_bf16 v[40:43], a[92:95], a[80:83], v[40:43]
 ds_read_b128 a[12:15], v236 offset:6144
 v_add_f32_e64 v200, v200, v202
 v_mfma_f32_16x16x32_bf16 v[48:51], a[92:95], a[84:87], v[48:51]
 ds_read_b128 a[16:19], v236 offset:8192
 v_and_b32 v198, 0xffff0000, v204
 v_mfma_f32_16x16x32_bf16 v[56:59], a[92:95], a[88:91], v[56:59]
 ds_read_b128 a[20:23], v236 offset:10240
 v_add_f32_e64 v196, v196, v200
 v_mfma_f32_16x16x32_bf16 v[60:63], a[96:99], a[88:91], v[60:63]
 ds_read_b128 a[24:27], v236 offset:12288
 v_rcp_f32_e64 v198, v198
 v_mfma_f32_16x16x32_bf16 v[52:55], a[96:99], a[84:87], v[52:55]
 ds_read_b128 a[28:31], v236 offset:14336
 v_lshlrev_b32_e64 v197, 16, v204
 v_mfma_f32_16x16x32_bf16 v[44:47], a[96:99], a[80:83], v[44:47]
 ds_read_b64_tr_b16 a[36:37], v239 offset:24576
 v_add_u32 v195, 159744, v195
 v_mfma_f32_16x16x32_bf16 v[36:39], a[96:99], a[76:79], v[36:39]
 ds_read_b64_tr_b16 a[38:39], v239 offset:25088
 ds_write_b32 v195, v196
 v_mfma_f32_16x16x32_bf16 v[28:31], a[96:99], a[72:75], v[28:31]
 ds_read_b64_tr_b16 a[40:41], v238 offset:25600
 ds_write_b32 v195, v197 offset:1024
 v_mfma_f32_16x16x32_bf16 v[20:23], a[96:99], a[68:71], v[20:23]
 ds_read_b64_tr_b16 a[42:43], v238 offset:26112
 ds_write_b32 v195, v198 offset:2048
 v_mfma_f32_16x16x32_bf16 v[12:15], a[96:99], a[64:67], v[12:15]
 ds_read_b64_tr_b16 a[44:45], v239 offset:25600
 v_lshrrev_b32_e64 v195, 1, v195
 v_mfma_f32_16x16x32_bf16 v[4:7], a[96:99], a[60:63], v[4:7]
 ds_read_b64_tr_b16 a[46:47], v239 offset:26112
 v_add_u32 v195, 82944, v195
 v_mfma_f32_16x16x32_bf16 v[64:67], a[100:103], a[60:63], v[64:67]
 ds_read_b64_tr_b16 a[48:49], v238 offset:26624
 ds_write_b16_d16_hi v195, v204
 v_mfma_f32_16x16x32_bf16 v[72:75], a[100:103], a[64:67], v[72:75]
 ds_read_b64_tr_b16 a[50:51], v238 offset:27136
 s_sub_u32 s12, s60, 4096
 v_mfma_f32_16x16x32_bf16 v[80:83], a[100:103], a[68:71], v[80:83]
 ds_read_b64_tr_b16 a[52:53], v239 offset:26624
 s_subb_u32 s13, s61, 0
 v_mfma_f32_16x16x32_bf16 v[88:91], a[100:103], a[72:75], v[88:91]
 ds_read_b64_tr_b16 a[54:55], v239 offset:27136
 s_mov_b32 s14, 0x701000
 v_mfma_f32_16x16x32_bf16 v[96:99], a[100:103], a[76:79], v[96:99]
 s_mov_b32 s15, 0x20000
 v_mfma_f32_16x16x32_bf16 v[104:107], a[100:103], a[80:83], v[104:107]
 v_lshrrev_b32 v221, 3, v255
 v_mfma_f32_16x16x32_bf16 v[112:115], a[100:103], a[84:87], v[112:115]
 s_lshl_b32 s3, s28, 4
 v_mfma_f32_16x16x32_bf16 v[120:123], a[100:103], a[88:91], v[120:123]
 v_add_u32 v221, s3, v221
 v_mfma_f32_16x16x32_bf16 v[124:127], a[104:107], a[88:91], v[124:127]
 v_lshlrev_b32_e64 v244, 11, v221
 v_mfma_f32_16x16x32_bf16 v[116:119], a[104:107], a[84:87], v[116:119]
 v_lshrrev_b32_e64 v221, 4, v255
 v_mfma_f32_16x16x32_bf16 v[108:111], a[104:107], a[80:83], v[108:111]
 v_lshlrev_b32_e64 v221, 1, v221
 v_mfma_f32_16x16x32_bf16 v[100:103], a[104:107], a[76:79], v[100:103]
 v_and_b32_e64 v222, 7, v255
 v_mfma_f32_16x16x32_bf16 v[92:95], a[104:107], a[72:75], v[92:95]
 v_xor_b32_e64 v221, v221, v222
 v_mfma_f32_16x16x32_bf16 v[84:87], a[104:107], a[68:71], v[84:87]
 v_lshl_add_u32 v244, v221, 4, v244
 v_mfma_f32_16x16x32_bf16 v[76:79], a[104:107], a[64:67], v[76:79]
 s_lshl_b32 s3, s83, 8
 v_mfma_f32_16x16x32_bf16 v[68:71], a[104:107], a[60:63], v[68:71]
 s_add_u32 s3, s3, 4096
 v_mfma_f32_16x16x32_bf16 v[128:131], a[60:63], a[108:111], v[128:131]
 s_and_b32 s4, s39, 1
 v_mfma_f32_16x16x32_bf16 v[136:139], a[64:67], a[108:111], v[136:139]
 s_lshl_b32 s4, s4, 7
 v_mfma_f32_16x16x32_bf16 v[144:147], a[68:71], a[108:111], v[144:147]
 s_sub_u32 s6, s3, s4
 v_mfma_f32_16x16x32_bf16 v[152:155], a[72:75], a[108:111], v[152:155]
 s_add_u32 s3, s3, s4
 v_mfma_f32_16x16x32_bf16 v[160:163], a[76:79], a[108:111], v[160:163]
 v_add_u32 v245, s6, v244
 v_mfma_f32_16x16x32_bf16 v[168:171], a[80:83], a[108:111], v[168:171]
 v_add_u32_e64 v244, s3, v244
 v_mfma_f32_16x16x32_bf16 v[176:179], a[84:87], a[108:111], v[176:179]
 v_add_u32 v245, 0xfffffc80, v245
 v_mfma_f32_16x16x32_bf16 v[184:187], a[88:91], a[108:111], v[184:187]
 v_add_u32 v246, 14336, v244
 v_mfma_f32_16x16x32_bf16 v[188:191], a[88:91], a[112:115], v[188:191]
 v_add_u32 v247, 14336, v245
 v_mfma_f32_16x16x32_bf16 v[180:183], a[84:87], a[112:115], v[180:183]
 s_mul_i32 s33, s39, 1835008
 v_mfma_f32_16x16x32_bf16 v[172:175], a[80:83], a[112:115], v[172:175]
 s_lshl_b32 s34, s28, 12
 v_mfma_f32_16x16x32_bf16 v[164:167], a[76:79], a[112:115], v[164:167]
 s_mov_b32 s37, s34
 v_mfma_f32_16x16x32_bf16 v[156:159], a[72:75], a[112:115], v[156:159]
 s_add_u32 s4, s37, 49152
 s_and_b32 m0, s4, 0x1ffff
 s_add_u32 s35, s33, 393216
 buffer_load_dwordx4 v244, s[12:15], s35 offen lds
 v_mfma_f32_16x16x32_bf16 v[148:151], a[68:71], a[112:115], v[148:151]
 buffer_load_dwordx4 v245, s[12:15], s35 offen offset:1024 lds
 v_mfma_f32_16x16x32_bf16 v[140:143], a[64:67], a[112:115], v[140:143]
 buffer_load_dwordx4 v246, s[12:15], s35 offen offset:2048 lds
 v_mfma_f32_16x16x32_bf16 v[132:135], a[60:63], a[112:115], v[132:135]
 buffer_load_dwordx4 v247, s[12:15], s35 offen offset:3072 lds
 s_waitcnt vmcnt(9) lgkmcnt(0)
 s_barrier
 v_mfma_f32_16x16x32_bf16 v[0:3], a[32:35], a[0:3], v[0:3]
 ds_read_b64_tr_b16 a[92:93], v238 offset:36864
 v_mfma_f32_16x16x32_bf16 v[8:11], a[32:35], a[4:7], v[8:11]
 ds_read_b64_tr_b16 a[94:95], v238 offset:37376
 v_mfma_f32_16x16x32_bf16 v[16:19], a[32:35], a[8:11], v[16:19]
 ds_read_b128 a[60:63], v237
 v_mfma_f32_16x16x32_bf16 v[24:27], a[32:35], a[12:15], v[24:27]
 ds_read_b128 a[64:67], v237 offset:2048
 v_mfma_f32_16x16x32_bf16 v[32:35], a[32:35], a[16:19], v[32:35]
 ds_read_b128 a[68:71], v237 offset:4096
 v_mfma_f32_16x16x32_bf16 v[40:43], a[32:35], a[20:23], v[40:43]
 ds_read_b128 a[72:75], v237 offset:6144
 v_mfma_f32_16x16x32_bf16 v[48:51], a[32:35], a[24:27], v[48:51]
 ds_read_b128 a[76:79], v237 offset:8192
 v_mfma_f32_16x16x32_bf16 v[56:59], a[32:35], a[28:31], v[56:59]
 ds_read_b128 a[80:83], v237 offset:10240
 v_mfma_f32_16x16x32_bf16 v[60:63], a[36:39], a[28:31], v[60:63]
 ds_read_b128 a[84:87], v237 offset:12288
 v_mfma_f32_16x16x32_bf16 v[52:55], a[36:39], a[24:27], v[52:55]
 ds_read_b128 a[88:91], v237 offset:14336
 v_mfma_f32_16x16x32_bf16 v[44:47], a[36:39], a[20:23], v[44:47]
 ds_read_b64_tr_b16 a[96:97], v239 offset:36864
 v_mfma_f32_16x16x32_bf16 v[36:39], a[36:39], a[16:19], v[36:39]
 ds_read_b64_tr_b16 a[98:99], v239 offset:37376
 v_mfma_f32_16x16x32_bf16 v[28:31], a[36:39], a[12:15], v[28:31]
 ds_read_b64_tr_b16 a[100:101], v238 offset:37888
 v_mfma_f32_16x16x32_bf16 v[20:23], a[36:39], a[8:11], v[20:23]
 ds_read_b64_tr_b16 a[102:103], v238 offset:38400
 v_mfma_f32_16x16x32_bf16 v[12:15], a[36:39], a[4:7], v[12:15]
 ds_read_b64_tr_b16 a[104:105], v239 offset:37888
 v_mfma_f32_16x16x32_bf16 v[4:7], a[36:39], a[0:3], v[4:7]
 ds_read_b64_tr_b16 a[106:107], v239 offset:38400
 v_mfma_f32_16x16x32_bf16 v[64:67], a[40:43], a[0:3], v[64:67]
 ds_read_b64_tr_b16 a[108:109], v238 offset:38912
 v_mfma_f32_16x16x32_bf16 v[72:75], a[40:43], a[4:7], v[72:75]
 ds_read_b64_tr_b16 a[110:111], v238 offset:39424
 v_mfma_f32_16x16x32_bf16 v[80:83], a[40:43], a[8:11], v[80:83]
 ds_read_b64_tr_b16 a[112:113], v239 offset:38912
 v_mfma_f32_16x16x32_bf16 v[88:91], a[40:43], a[12:15], v[88:91]
 ds_read_b64_tr_b16 a[114:115], v239 offset:39424
 v_mfma_f32_16x16x32_bf16 v[96:99], a[40:43], a[16:19], v[96:99]
 ds_read_b32 v192, v218
 v_mfma_f32_16x16x32_bf16 v[104:107], a[40:43], a[20:23], v[104:107]
 ds_read_b32 v193, v218 offset:64
 v_mfma_f32_16x16x32_bf16 v[112:115], a[40:43], a[24:27], v[112:115]
 ds_read_b32 v194, v218 offset:128
 v_mfma_f32_16x16x32_bf16 v[120:123], a[40:43], a[28:31], v[120:123]
 ds_read_b32 v195, v218 offset:192
 v_mfma_f32_16x16x32_bf16 v[124:127], a[44:47], a[28:31], v[124:127]
 v_mfma_f32_16x16x32_bf16 v[116:119], a[44:47], a[24:27], v[116:119]
 ds_read_b32 v196, v218 offset:256
 v_mfma_f32_16x16x32_bf16 v[108:111], a[44:47], a[20:23], v[108:111]
 ds_read_b32 v197, v218 offset:320
 v_mfma_f32_16x16x32_bf16 v[100:103], a[44:47], a[16:19], v[100:103]
 ds_read_b32 v198, v218 offset:384
 v_mfma_f32_16x16x32_bf16 v[92:95], a[44:47], a[12:15], v[92:95]
 ds_read_b32 v199, v218 offset:448
 v_mfma_f32_16x16x32_bf16 v[84:87], a[44:47], a[8:11], v[84:87]
 v_mfma_f32_16x16x32_bf16 v[76:79], a[44:47], a[4:7], v[76:79]
 ds_read_b128 v[200:203], v219 offset:256
 v_mfma_f32_16x16x32_bf16 v[68:71], a[44:47], a[0:3], v[68:71]
 ds_read_b128 v[204:207], v219 offset:320
 v_mfma_f32_16x16x32_bf16 v[128:131], a[0:3], a[48:51], v[128:131]
 ds_read_b128 v[208:211], v219
 v_mfma_f32_16x16x32_bf16 v[136:139], a[4:7], a[48:51], v[136:139]
 v_mfma_f32_16x16x32_bf16 v[144:147], a[8:11], a[48:51], v[144:147]
 ds_read_b128 v[212:215], v219 offset:64
 v_mfma_f32_16x16x32_bf16 v[152:155], a[12:15], a[48:51], v[152:155]
 ds_read_b32 v216, v220 offset:512
 v_mfma_f32_16x16x32_bf16 v[160:163], a[16:19], a[48:51], v[160:163]
 ds_read_b32 v217, v220 offset:576
 v_mfma_f32_16x16x32_bf16 v[168:171], a[20:23], a[48:51], v[168:171]
 ds_read_b128 v[218:221], v234
 v_mfma_f32_16x16x32_bf16 v[176:179], a[24:27], a[48:51], v[176:179]
 v_mfma_f32_16x16x32_bf16 v[184:187], a[28:31], a[48:51], v[184:187]
 ds_read_b128 v[222:225], v234 offset:64
 v_mfma_f32_16x16x32_bf16 v[188:191], a[28:31], a[52:55], v[188:191]
 ds_read_b128 v[226:229], v234 offset:128
 v_mfma_f32_16x16x32_bf16 v[180:183], a[24:27], a[52:55], v[180:183]
 ds_read_b128 v[230:233], v234 offset:192
 v_mfma_f32_16x16x32_bf16 v[172:175], a[20:23], a[52:55], v[172:175]
 ds_read_b32 v248, v252
 v_mfma_f32_16x16x32_bf16 v[164:167], a[16:19], a[52:55], v[164:167]
 v_mfma_f32_16x16x32_bf16 v[156:159], a[12:15], a[52:55], v[156:159]
 ds_read_b32 v249, v252 offset:128
 v_mfma_f32_16x16x32_bf16 v[148:151], a[8:11], a[52:55], v[148:151]
 ds_read_b32 v250, v252 offset:256
 v_mfma_f32_16x16x32_bf16 v[140:143], a[4:7], a[52:55], v[140:143]
 ds_read_b32 v251, v252 offset:384
 v_mfma_f32_16x16x32_bf16 v[132:135], a[0:3], a[52:55], v[132:135]
 s_waitcnt lgkmcnt(0)
 s_barrier
 v_mfma_f32_16x16x32_bf16 v[0:3], a[92:95], a[60:63], v[0:3]
 ds_read_b128 a[160:163], v243
 v_mfma_f32_16x16x32_bf16 v[8:11], a[92:95], a[64:67], v[8:11]
 v_mfma_f32_16x16x32_bf16 v[16:19], a[92:95], a[68:71], v[16:19]
 ds_read_b128 a[164:167], v243 offset:32
 v_mfma_f32_16x16x32_bf16 v[24:27], a[92:95], a[72:75], v[24:27]
 v_mfma_f32_16x16x32_bf16 v[32:35], a[92:95], a[76:79], v[32:35]
 ds_read_b128 a[168:171], v243 offset:64
 v_mfma_f32_16x16x32_bf16 v[40:43], a[92:95], a[80:83], v[40:43]
 v_mfma_f32_16x16x32_bf16 v[48:51], a[92:95], a[84:87], v[48:51]
 ds_read_b128 a[172:175], v243 offset:96
 v_mfma_f32_16x16x32_bf16 v[56:59], a[92:95], a[88:91], v[56:59]
 v_mfma_f32_16x16x32_bf16 v[60:63], a[96:99], a[88:91], v[60:63]
 ds_read_b128 a[176:179], v243 offset:128
 v_mfma_f32_16x16x32_bf16 v[52:55], a[96:99], a[84:87], v[52:55]
 v_mfma_f32_16x16x32_bf16 v[44:47], a[96:99], a[80:83], v[44:47]
 ds_read_b128 a[180:183], v243 offset:160
 v_mfma_f32_16x16x32_bf16 v[36:39], a[96:99], a[76:79], v[36:39]
 v_mfma_f32_16x16x32_bf16 v[28:31], a[96:99], a[72:75], v[28:31]
 ds_read_b128 a[184:187], v243 offset:192
 v_mfma_f32_16x16x32_bf16 v[20:23], a[96:99], a[68:71], v[20:23]
 v_mfma_f32_16x16x32_bf16 v[12:15], a[96:99], a[64:67], v[12:15]
 ds_read_b128 a[188:191], v243 offset:224
 v_mfma_f32_16x16x32_bf16 v[4:7], a[96:99], a[60:63], v[4:7]
 v_mfma_f32_16x16x32_bf16 v[64:67], a[100:103], a[60:63], v[64:67]
 s_add_u32 s20, s66, 0x1800000
 v_mfma_f32_16x16x32_bf16 v[72:75], a[100:103], a[64:67], v[72:75]
 v_mfma_f32_16x16x32_bf16 v[80:83], a[100:103], a[68:71], v[80:83]
 s_addc_u32 s21, s67, 0
 v_mfma_f32_16x16x32_bf16 v[88:91], a[100:103], a[72:75], v[88:91]
 v_mfma_f32_16x16x32_bf16 v[96:99], a[100:103], a[76:79], v[96:99]
 s_mov_b32 s22, 0x200000
 v_mfma_f32_16x16x32_bf16 v[104:107], a[100:103], a[80:83], v[104:107]
 v_mfma_f32_16x16x32_bf16 v[112:115], a[100:103], a[84:87], v[112:115]
 s_mov_b32 s23, 0x20000
 v_mfma_f32_16x16x32_bf16 v[120:123], a[100:103], a[88:91], v[120:123]
 v_mfma_f32_16x16x32_bf16 v[124:127], a[104:107], a[88:91], v[124:127]
 s_add_u32 s4, s37, 0
 s_and_b32 m0, s4, 0x1ffff
 s_add_u32 s35, s33, 0
 buffer_load_dwordx4 v244, s[12:15], s35 offen lds
 v_mfma_f32_16x16x32_bf16 v[116:119], a[104:107], a[84:87], v[116:119]
 v_mfma_f32_16x16x32_bf16 v[108:111], a[104:107], a[80:83], v[108:111]
 buffer_load_dwordx4 v245, s[12:15], s35 offen offset:1024 lds
 v_mfma_f32_16x16x32_bf16 v[100:103], a[104:107], a[76:79], v[100:103]
 v_mfma_f32_16x16x32_bf16 v[92:95], a[104:107], a[72:75], v[92:95]
 buffer_load_dwordx4 v246, s[12:15], s35 offen offset:2048 lds
 v_mfma_f32_16x16x32_bf16 v[84:87], a[104:107], a[68:71], v[84:87]
 v_mfma_f32_16x16x32_bf16 v[76:79], a[104:107], a[64:67], v[76:79]
 buffer_load_dwordx4 v247, s[12:15], s35 offen offset:3072 lds
 v_mfma_f32_16x16x32_bf16 v[68:71], a[104:107], a[60:63], v[68:71]
 v_mfma_f32_16x16x32_bf16 v[128:131], a[60:63], a[108:111], v[128:131]
 s_add_u32 s4, s37, 16384
 s_and_b32 m0, s4, 0x1ffff
 s_add_u32 s35, s33, 131072
 buffer_load_dwordx4 v244, s[12:15], s35 offen lds
 v_mfma_f32_16x16x32_bf16 v[136:139], a[64:67], a[108:111], v[136:139]
 v_mfma_f32_16x16x32_bf16 v[144:147], a[68:71], a[108:111], v[144:147]
 buffer_load_dwordx4 v245, s[12:15], s35 offen offset:1024 lds
 v_mfma_f32_16x16x32_bf16 v[152:155], a[72:75], a[108:111], v[152:155]
 v_mfma_f32_16x16x32_bf16 v[160:163], a[76:79], a[108:111], v[160:163]
 buffer_load_dwordx4 v246, s[12:15], s35 offen offset:2048 lds
 v_mfma_f32_16x16x32_bf16 v[168:171], a[80:83], a[108:111], v[168:171]
 v_mfma_f32_16x16x32_bf16 v[176:179], a[84:87], a[108:111], v[176:179]
 buffer_load_dwordx4 v247, s[12:15], s35 offen offset:3072 lds
 v_mfma_f32_16x16x32_bf16 v[184:187], a[88:91], a[108:111], v[184:187]
 v_mfma_f32_16x16x32_bf16 v[188:191], a[88:91], a[112:115], v[188:191]
 s_add_u32 s4, s37, 32768
 s_and_b32 m0, s4, 0x1ffff
 s_add_u32 s35, s33, 262144
 buffer_load_dwordx4 v244, s[12:15], s35 offen lds
 v_mfma_f32_16x16x32_bf16 v[180:183], a[84:87], a[112:115], v[180:183]
 v_mfma_f32_16x16x32_bf16 v[172:175], a[80:83], a[112:115], v[172:175]
 buffer_load_dwordx4 v245, s[12:15], s35 offen offset:1024 lds
 v_mfma_f32_16x16x32_bf16 v[164:167], a[76:79], a[112:115], v[164:167]
 v_mfma_f32_16x16x32_bf16 v[156:159], a[72:75], a[112:115], v[156:159]
 buffer_load_dwordx4 v246, s[12:15], s35 offen offset:2048 lds
 v_mfma_f32_16x16x32_bf16 v[148:151], a[68:71], a[112:115], v[148:151]
 v_mfma_f32_16x16x32_bf16 v[140:143], a[64:67], a[112:115], v[140:143]
 buffer_load_dwordx4 v247, s[12:15], s35 offen offset:3072 lds
 v_mfma_f32_16x16x32_bf16 v[132:135], a[60:63], a[112:115], v[132:135]
 v_pk_fma_f32 v[64:65], v[200:201], v[192:193], v[64:65] op_sel:[0,0,0] op_sel_hi:[1,0,1] neg_lo:[1,0,0] neg_hi:[1,0,0]
 v_pk_fma_f32 v[66:67], v[202:203], v[192:193], v[66:67] op_sel:[0,0,0] op_sel_hi:[1,0,1] neg_lo:[1,0,0] neg_hi:[1,0,0]
 v_pk_fma_f32 v[68:69], v[204:205], v[192:193], v[68:69] op_sel:[0,0,0] op_sel_hi:[1,0,1] neg_lo:[1,0,0] neg_hi:[1,0,0]
 s_nop 0
 v_pk_fma_f32 v[70:71], v[206:207], v[192:193], v[70:71] op_sel:[0,0,0] op_sel_hi:[1,0,1] neg_lo:[1,0,0] neg_hi:[1,0,0]
 v_pk_fma_f32 v[72:73], v[200:201], v[192:193], v[72:73] op_sel:[0,1,0] op_sel_hi:[1,1,1] neg_lo:[1,0,0] neg_hi:[1,0,0]
 v_pk_fma_f32 v[74:75], v[202:203], v[192:193], v[74:75] op_sel:[0,1,0] op_sel_hi:[1,1,1] neg_lo:[1,0,0] neg_hi:[1,0,0]
 v_pk_fma_f32 v[76:77], v[204:205], v[192:193], v[76:77] op_sel:[0,1,0] op_sel_hi:[1,1,1] neg_lo:[1,0,0] neg_hi:[1,0,0]
 v_pk_fma_f32 v[78:79], v[206:207], v[192:193], v[78:79] op_sel:[0,1,0] op_sel_hi:[1,1,1] neg_lo:[1,0,0] neg_hi:[1,0,0]
 v_pk_fma_f32 v[80:81], v[200:201], v[194:195], v[80:81] op_sel:[0,0,0] op_sel_hi:[1,0,1] neg_lo:[1,0,0] neg_hi:[1,0,0]
 v_pk_fma_f32 v[82:83], v[202:203], v[194:195], v[82:83] op_sel:[0,0,0] op_sel_hi:[1,0,1] neg_lo:[1,0,0] neg_hi:[1,0,0]
 v_pk_fma_f32 v[84:85], v[204:205], v[194:195], v[84:85] op_sel:[0,0,0] op_sel_hi:[1,0,1] neg_lo:[1,0,0] neg_hi:[1,0,0]
 v_pk_fma_f32 v[86:87], v[206:207], v[194:195], v[86:87] op_sel:[0,0,0] op_sel_hi:[1,0,1] neg_lo:[1,0,0] neg_hi:[1,0,0]
 v_pk_fma_f32 v[88:89], v[200:201], v[194:195], v[88:89] op_sel:[0,1,0] op_sel_hi:[1,1,1] neg_lo:[1,0,0] neg_hi:[1,0,0]
 v_pk_fma_f32 v[90:91], v[202:203], v[194:195], v[90:91] op_sel:[0,1,0] op_sel_hi:[1,1,1] neg_lo:[1,0,0] neg_hi:[1,0,0]
 v_pk_fma_f32 v[92:93], v[204:205], v[194:195], v[92:93] op_sel:[0,1,0] op_sel_hi:[1,1,1] neg_lo:[1,0,0] neg_hi:[1,0,0]
 v_pk_fma_f32 v[94:95], v[206:207], v[194:195], v[94:95] op_sel:[0,1,0] op_sel_hi:[1,1,1] neg_lo:[1,0,0] neg_hi:[1,0,0]
 v_pk_fma_f32 v[96:97], v[200:201], v[196:197], v[96:97] op_sel:[0,0,0] op_sel_hi:[1,0,1] neg_lo:[1,0,0] neg_hi:[1,0,0]
 v_pk_fma_f32 v[98:99], v[202:203], v[196:197], v[98:99] op_sel:[0,0,0] op_sel_hi:[1,0,1] neg_lo:[1,0,0] neg_hi:[1,0,0]
 v_pk_fma_f32 v[100:101], v[204:205], v[196:197], v[100:101] op_sel:[0,0,0] op_sel_hi:[1,0,1] neg_lo:[1,0,0] neg_hi:[1,0,0]
 v_pk_fma_f32 v[102:103], v[206:207], v[196:197], v[102:103] op_sel:[0,0,0] op_sel_hi:[1,0,1] neg_lo:[1,0,0] neg_hi:[1,0,0]
 v_pk_fma_f32 v[104:105], v[200:201], v[196:197], v[104:105] op_sel:[0,1,0] op_sel_hi:[1,1,1] neg_lo:[1,0,0] neg_hi:[1,0,0]
 v_pk_fma_f32 v[106:107], v[202:203], v[196:197], v[106:107] op_sel:[0,1,0] op_sel_hi:[1,1,1] neg_lo:[1,0,0] neg_hi:[1,0,0]
 v_pk_fma_f32 v[108:109], v[204:205], v[196:197], v[108:109] op_sel:[0,1,0] op_sel_hi:[1,1,1] neg_lo:[1,0,0] neg_hi:[1,0,0]
 v_pk_fma_f32 v[110:111], v[206:207], v[196:197], v[110:111] op_sel:[0,1,0] op_sel_hi:[1,1,1] neg_lo:[1,0,0] neg_hi:[1,0,0]
 v_pk_fma_f32 v[112:113], v[200:201], v[198:199], v[112:113] op_sel:[0,0,0] op_sel_hi:[1,0,1] neg_lo:[1,0,0] neg_hi:[1,0,0]
 v_pk_fma_f32 v[114:115], v[202:203], v[198:199], v[114:115] op_sel:[0,0,0] op_sel_hi:[1,0,1] neg_lo:[1,0,0] neg_hi:[1,0,0]
 v_pk_fma_f32 v[116:117], v[204:205], v[198:199], v[116:117] op_sel:[0,0,0] op_sel_hi:[1,0,1] neg_lo:[1,0,0] neg_hi:[1,0,0]
 v_pk_fma_f32 v[118:119], v[206:207], v[198:199], v[118:119] op_sel:[0,0,0] op_sel_hi:[1,0,1] neg_lo:[1,0,0] neg_hi:[1,0,0]
 v_pk_fma_f32 v[120:121], v[200:201], v[198:199], v[120:121] op_sel:[0,1,0] op_sel_hi:[1,1,1] neg_lo:[1,0,0] neg_hi:[1,0,0]
 v_pk_fma_f32 v[122:123], v[202:203], v[198:199], v[122:123] op_sel:[0,1,0] op_sel_hi:[1,1,1] neg_lo:[1,0,0] neg_hi:[1,0,0]
 v_pk_fma_f32 v[124:125], v[204:205], v[198:199], v[124:125] op_sel:[0,1,0] op_sel_hi:[1,1,1] neg_lo:[1,0,0] neg_hi:[1,0,0]
 v_pk_fma_f32 v[126:127], v[206:207], v[198:199], v[126:127] op_sel:[0,1,0] op_sel_hi:[1,1,1] neg_lo:[1,0,0] neg_hi:[1,0,0]
 v_pk_fma_f32 v[128:129], v[218:219], v[216:217], v[128:129] op_sel:[0,0,0] op_sel_hi:[1,0,1] neg_lo:[1,0,0] neg_hi:[1,0,0]
 v_pk_fma_f32 v[130:131], v[220:221], v[216:217], v[130:131] op_sel:[0,0,0] op_sel_hi:[1,0,1] neg_lo:[1,0,0] neg_hi:[1,0,0]
 v_pk_fma_f32 v[132:133], v[218:219], v[216:217], v[132:133] op_sel:[0,1,0] op_sel_hi:[1,1,1] neg_lo:[1,0,0] neg_hi:[1,0,0]
 v_pk_fma_f32 v[134:135], v[220:221], v[216:217], v[134:135] op_sel:[0,1,0] op_sel_hi:[1,1,1] neg_lo:[1,0,0] neg_hi:[1,0,0]
 v_pk_fma_f32 v[136:137], v[222:223], v[216:217], v[136:137] op_sel:[0,0,0] op_sel_hi:[1,0,1] neg_lo:[1,0,0] neg_hi:[1,0,0]
 v_pk_fma_f32 v[138:139], v[224:225], v[216:217], v[138:139] op_sel:[0,0,0] op_sel_hi:[1,0,1] neg_lo:[1,0,0] neg_hi:[1,0,0]
 v_pk_fma_f32 v[140:141], v[222:223], v[216:217], v[140:141] op_sel:[0,1,0] op_sel_hi:[1,1,1] neg_lo:[1,0,0] neg_hi:[1,0,0]
 v_pk_fma_f32 v[142:143], v[224:225], v[216:217], v[142:143] op_sel:[0,1,0] op_sel_hi:[1,1,1] neg_lo:[1,0,0] neg_hi:[1,0,0]
 v_pk_fma_f32 v[144:145], v[226:227], v[216:217], v[144:145] op_sel:[0,0,0] op_sel_hi:[1,0,1] neg_lo:[1,0,0] neg_hi:[1,0,0]
 v_pk_fma_f32 v[146:147], v[228:229], v[216:217], v[146:147] op_sel:[0,0,0] op_sel_hi:[1,0,1] neg_lo:[1,0,0] neg_hi:[1,0,0]
 v_pk_fma_f32 v[148:149], v[226:227], v[216:217], v[148:149] op_sel:[0,1,0] op_sel_hi:[1,1,1] neg_lo:[1,0,0] neg_hi:[1,0,0]
 v_pk_fma_f32 v[150:151], v[228:229], v[216:217], v[150:151] op_sel:[0,1,0] op_sel_hi:[1,1,1] neg_lo:[1,0,0] neg_hi:[1,0,0]
 v_pk_fma_f32 v[152:153], v[230:231], v[216:217], v[152:153] op_sel:[0,0,0] op_sel_hi:[1,0,1] neg_lo:[1,0,0] neg_hi:[1,0,0]
 v_pk_fma_f32 v[154:155], v[232:233], v[216:217], v[154:155] op_sel:[0,0,0] op_sel_hi:[1,0,1] neg_lo:[1,0,0] neg_hi:[1,0,0]
 v_pk_fma_f32 v[156:157], v[230:231], v[216:217], v[156:157] op_sel:[0,1,0] op_sel_hi:[1,1,1] neg_lo:[1,0,0] neg_hi:[1,0,0]
 v_pk_fma_f32 v[158:159], v[232:233], v[216:217], v[158:159] op_sel:[0,1,0] op_sel_hi:[1,1,1] neg_lo:[1,0,0] neg_hi:[1,0,0]
 ds_read_b128 v[218:221], v234 offset:256
 ds_read_b128 v[222:225], v234 offset:320
 ds_read_b128 v[226:229], v234 offset:384
 ds_read_b128 v[230:233], v234 offset:448
 v_cvt_pk_bf16_f32 v128, v128, v129
 v_cvt_pk_bf16_f32 v129, v130, v131
 v_cvt_pk_bf16_f32 v130, v132, v133
 v_cvt_pk_bf16_f32 v131, v134, v135
 v_cvt_pk_bf16_f32 v132, v136, v137
 v_cvt_pk_bf16_f32 v133, v138, v139
 v_cvt_pk_bf16_f32 v134, v140, v141
 v_cvt_pk_bf16_f32 v135, v142, v143
 v_permlane16_swap_b32 v128, v130
 v_permlane16_swap_b32 v129, v131
 v_permlane16_swap_b32 v132, v134
 v_permlane16_swap_b32 v133, v135
 v_cvt_pk_bf16_f32 v200, v64, v65
 v_cvt_pk_bf16_f32 v201, v66, v67
 v_cvt_pk_bf16_f32 v204, v68, v69
 v_cvt_pk_bf16_f32 v205, v70, v71
 v_cvt_pk_bf16_f32 v202, v72, v73
 v_cvt_pk_bf16_f32 v203, v74, v75
 v_cvt_pk_bf16_f32 v206, v76, v77
 v_cvt_pk_bf16_f32 v207, v78, v79
 v_permlane16_swap_b32 v200, v202
 v_permlane16_swap_b32 v201, v203
 v_permlane16_swap_b32 v204, v206
 v_permlane16_swap_b32 v205, v207
 v_mfma_f32_32x32x16_bf16 v[64:79], a[120:123], v[200:203], 0
 s_nop 0
 s_nop 0
 v_mfma_f32_32x32x16_bf16 v[64:79], a[124:127], v[204:207], v[64:79]
 v_cvt_pk_bf16_f32 v136, v80, v81
 v_cvt_pk_bf16_f32 v137, v82, v83
 v_cvt_pk_bf16_f32 v140, v84, v85
 v_cvt_pk_bf16_f32 v141, v86, v87
 v_cvt_pk_bf16_f32 v138, v88, v89
 v_cvt_pk_bf16_f32 v139, v90, v91
 v_cvt_pk_bf16_f32 v142, v92, v93
 v_cvt_pk_bf16_f32 v143, v94, v95
 v_permlane16_swap_b32 v136, v138
 v_permlane16_swap_b32 v137, v139
 v_permlane16_swap_b32 v140, v142
 v_permlane16_swap_b32 v141, v143
 v_mfma_f32_32x32x16_bf16 v[80:95], a[120:123], v[136:139], 0
 s_nop 0
 s_nop 0
 v_mfma_f32_32x32x16_bf16 v[80:95], a[124:127], v[140:143], v[80:95]
 v_cvt_pk_bf16_f32 v144, v144, v145
 v_cvt_pk_bf16_f32 v145, v146, v147
 v_cvt_pk_bf16_f32 v146, v148, v149
 v_cvt_pk_bf16_f32 v147, v150, v151
 v_cvt_pk_bf16_f32 v148, v152, v153
 v_cvt_pk_bf16_f32 v149, v154, v155
 v_cvt_pk_bf16_f32 v150, v156, v157
 v_cvt_pk_bf16_f32 v151, v158, v159
 v_permlane16_swap_b32 v144, v146
 v_permlane16_swap_b32 v145, v147
 v_permlane16_swap_b32 v148, v150
 v_permlane16_swap_b32 v149, v151
 v_cvt_pk_bf16_f32 v200, v96, v97
 v_cvt_pk_bf16_f32 v201, v98, v99
 v_cvt_pk_bf16_f32 v204, v100, v101
 v_cvt_pk_bf16_f32 v205, v102, v103
 v_cvt_pk_bf16_f32 v202, v104, v105
 v_cvt_pk_bf16_f32 v203, v106, v107
 v_cvt_pk_bf16_f32 v206, v108, v109
 v_cvt_pk_bf16_f32 v207, v110, v111
 v_permlane16_swap_b32 v200, v202
 v_permlane16_swap_b32 v201, v203
 v_permlane16_swap_b32 v204, v206
 v_permlane16_swap_b32 v205, v207
 v_mfma_f32_32x32x16_bf16 v[96:111], a[120:123], v[200:203], 0
 s_nop 0
 s_nop 0
 v_mfma_f32_32x32x16_bf16 v[96:111], a[124:127], v[204:207], v[96:111]
 v_cvt_pk_bf16_f32 v136, v112, v113
 v_cvt_pk_bf16_f32 v137, v114, v115
 v_cvt_pk_bf16_f32 v140, v116, v117
 v_cvt_pk_bf16_f32 v141, v118, v119
 v_cvt_pk_bf16_f32 v138, v120, v121
 v_cvt_pk_bf16_f32 v139, v122, v123
 v_cvt_pk_bf16_f32 v142, v124, v125
 v_cvt_pk_bf16_f32 v143, v126, v127
 v_permlane16_swap_b32 v136, v138
 v_permlane16_swap_b32 v137, v139
 v_permlane16_swap_b32 v140, v142
 v_permlane16_swap_b32 v141, v143
 v_mfma_f32_32x32x16_bf16 v[112:127], a[120:123], v[136:139], 0
 s_nop 0
 v_mfma_f32_32x32x16_bf16 v[112:127], a[124:127], v[140:143], v[112:127]
 s_waitcnt lgkmcnt(0)
 v_pk_fma_f32 v[160:161], v[218:219], v[216:217], v[160:161] op_sel:[0,0,0] op_sel_hi:[1,0,1] neg_lo:[1,0,0] neg_hi:[1,0,0]
 v_pk_fma_f32 v[162:163], v[220:221], v[216:217], v[162:163] op_sel:[0,0,0] op_sel_hi:[1,0,1] neg_lo:[1,0,0] neg_hi:[1,0,0]
 v_pk_fma_f32 v[164:165], v[218:219], v[216:217], v[164:165] op_sel:[0,1,0] op_sel_hi:[1,1,1] neg_lo:[1,0,0] neg_hi:[1,0,0]
 v_pk_fma_f32 v[166:167], v[220:221], v[216:217], v[166:167] op_sel:[0,1,0] op_sel_hi:[1,1,1] neg_lo:[1,0,0] neg_hi:[1,0,0]
 v_pk_fma_f32 v[168:169], v[222:223], v[216:217], v[168:169] op_sel:[0,0,0] op_sel_hi:[1,0,1] neg_lo:[1,0,0] neg_hi:[1,0,0]
 v_pk_fma_f32 v[170:171], v[224:225], v[216:217], v[170:171] op_sel:[0,0,0] op_sel_hi:[1,0,1] neg_lo:[1,0,0] neg_hi:[1,0,0]
 v_pk_fma_f32 v[172:173], v[222:223], v[216:217], v[172:173] op_sel:[0,1,0] op_sel_hi:[1,1,1] neg_lo:[1,0,0] neg_hi:[1,0,0]
 v_pk_fma_f32 v[174:175], v[224:225], v[216:217], v[174:175] op_sel:[0,1,0] op_sel_hi:[1,1,1] neg_lo:[1,0,0] neg_hi:[1,0,0]
 v_pk_fma_f32 v[176:177], v[226:227], v[216:217], v[176:177] op_sel:[0,0,0] op_sel_hi:[1,0,1] neg_lo:[1,0,0] neg_hi:[1,0,0]
 v_pk_fma_f32 v[178:179], v[228:229], v[216:217], v[178:179] op_sel:[0,0,0] op_sel_hi:[1,0,1] neg_lo:[1,0,0] neg_hi:[1,0,0]
 v_pk_fma_f32 v[180:181], v[226:227], v[216:217], v[180:181] op_sel:[0,1,0] op_sel_hi:[1,1,1] neg_lo:[1,0,0] neg_hi:[1,0,0]
 v_pk_fma_f32 v[182:183], v[228:229], v[216:217], v[182:183] op_sel:[0,1,0] op_sel_hi:[1,1,1] neg_lo:[1,0,0] neg_hi:[1,0,0]
 v_pk_fma_f32 v[184:185], v[230:231], v[216:217], v[184:185] op_sel:[0,0,0] op_sel_hi:[1,0,1] neg_lo:[1,0,0] neg_hi:[1,0,0]
 v_pk_fma_f32 v[186:187], v[232:233], v[216:217], v[186:187] op_sel:[0,0,0] op_sel_hi:[1,0,1] neg_lo:[1,0,0] neg_hi:[1,0,0]
 v_pk_fma_f32 v[188:189], v[230:231], v[216:217], v[188:189] op_sel:[0,1,0] op_sel_hi:[1,1,1] neg_lo:[1,0,0] neg_hi:[1,0,0]
 v_pk_fma_f32 v[190:191], v[232:233], v[216:217], v[190:191] op_sel:[0,1,0] op_sel_hi:[1,1,1] neg_lo:[1,0,0] neg_hi:[1,0,0]
 v_cvt_pk_bf16_f32 v160, v160, v161
 v_cvt_pk_bf16_f32 v161, v162, v163
 v_cvt_pk_bf16_f32 v162, v164, v165
 v_cvt_pk_bf16_f32 v163, v166, v167
 v_cvt_pk_bf16_f32 v164, v168, v169
 v_cvt_pk_bf16_f32 v165, v170, v171
 v_cvt_pk_bf16_f32 v166, v172, v173
 v_cvt_pk_bf16_f32 v167, v174, v175
 v_permlane16_swap_b32 v160, v162
 v_permlane16_swap_b32 v161, v163
 v_permlane16_swap_b32 v164, v166
 v_permlane16_swap_b32 v165, v167
 v_cvt_pk_bf16_f32 v176, v176, v177
 v_cvt_pk_bf16_f32 v177, v178, v179
 v_cvt_pk_bf16_f32 v178, v180, v181
 v_cvt_pk_bf16_f32 v179, v182, v183
 v_cvt_pk_bf16_f32 v180, v184, v185
 v_cvt_pk_bf16_f32 v181, v186, v187
 v_cvt_pk_bf16_f32 v182, v188, v189
 v_cvt_pk_bf16_f32 v183, v190, v191
 v_permlane16_swap_b32 v176, v178
 v_permlane16_swap_b32 v177, v179
 v_permlane16_swap_b32 v180, v182
 v_permlane16_swap_b32 v181, v183
 v_xor_b32 v236, 0, v235
 v_xor_b32 v237, 32, v235
 v_xor_b32_e64 v238, 64, v235
 v_xor_b32 v239, 96, v235
 v_xor_b32 v241, 32, v240
 v_xor_b32 v242, 64, v240
 v_xor_b32 v243, 96, v240
 v_max3_f32 v218, v64, v65, v66
 v_max3_f32 v224, v80, v81, v82
 v_max3_f32 v219, -v64, -v65, -v66
 v_max3_f32 v225, -v80, -v81, -v82
 v_max3_f32 v218, v218, v67, v68
 v_max3_f32 v224, v224, v83, v84
 v_max3_f32 v219, v219, -v67, -v68
 v_max3_f32 v225, v225, -v83, -v84
 v_max3_f32 v218, v218, v69, v70
 v_max3_f32 v224, v224, v85, v86
 v_max3_f32 v219, v219, -v69, -v70
 v_max3_f32 v225, v225, -v85, -v86
 v_max3_f32 v218, v218, v71, v72
 v_max3_f32 v224, v224, v87, v88
 v_max3_f32 v219, v219, -v71, -v72
 v_max3_f32 v225, v225, -v87, -v88
 v_max3_f32 v218, v218, v73, v74
 v_max3_f32 v224, v224, v89, v90
 v_max3_f32 v219, v219, -v73, -v74
 v_max3_f32 v225, v225, -v89, -v90
 v_max3_f32 v218, v218, v75, v76
 v_max3_f32 v224, v224, v91, v92
 v_max3_f32 v219, v219, -v75, -v76
 v_max3_f32 v225, v225, -v91, -v92
 v_max3_f32 v218, v218, v77, v78
 v_max3_f32 v224, v224, v93, v94
 v_max3_f32 v219, v219, -v77, -v78
 v_max3_f32 v225, v225, -v93, -v94
 v_max_f32 v218, v218, v79
 v_max_f32 v224, v224, v95
 v_max_f32_e64 v219, v219, -v79
 v_max_f32_e64 v225, v225, -v95
 v_mul_f32 v222, 0x3fb8aa3b, v248
 v_mul_f32 v228, 0x3fb8aa3b, v249
 v_permlane32_swap_b32 v218, v219
 v_permlane32_swap_b32 v224, v225
 v_max_f32 v218, v218, v219
 v_max_f32 v224, v224, v225
 v_mul_f32 v218, v222, v218
 v_mul_f32 v224, v228, v224
 v_mov_b32 v220, v218
 v_mov_b32 v226, v224
 s_nop 0
 v_permlane32_swap_b32 v218, v220
 v_permlane32_swap_b32_e64 v224, v226
 v_pk_fma_f32 v[136:137], v[64:65], v[222:223], v[218:219] op_sel_hi:[1,0,0] neg_lo:[0,0,1] neg_hi:[0,0,1]
 v_pk_fma_f32 v[168:169], v[80:81], v[228:229], v[224:225] op_sel_hi:[1,0,0] neg_lo:[0,0,1] neg_hi:[0,0,1]
 v_pk_fma_f32 v[138:139], v[66:67], v[222:223], v[218:219] op_sel_hi:[1,0,0] neg_lo:[0,0,1] neg_hi:[0,0,1]
 v_pk_fma_f32 v[170:171], v[82:83], v[228:229], v[224:225] op_sel_hi:[1,0,0] neg_lo:[0,0,1] neg_hi:[0,0,1]
 v_pk_fma_f32 v[140:141], v[68:69], v[222:223], v[218:219] op_sel_hi:[1,0,0] neg_lo:[0,0,1] neg_hi:[0,0,1]
 v_pk_fma_f32 v[172:173], v[84:85], v[228:229], v[224:225] op_sel_hi:[1,0,0] neg_lo:[0,0,1] neg_hi:[0,0,1]
 v_pk_fma_f32 v[142:143], v[70:71], v[222:223], v[218:219] op_sel_hi:[1,0,0] neg_lo:[0,0,1] neg_hi:[0,0,1]
 v_pk_fma_f32 v[174:175], v[86:87], v[228:229], v[224:225] op_sel_hi:[1,0,0] neg_lo:[0,0,1] neg_hi:[0,0,1]
 v_pk_fma_f32 v[152:153], v[72:73], v[222:223], v[218:219] op_sel_hi:[1,0,0] neg_lo:[0,0,1] neg_hi:[0,0,1]
 v_pk_fma_f32 v[184:185], v[88:89], v[228:229], v[224:225] op_sel_hi:[1,0,0] neg_lo:[0,0,1] neg_hi:[0,0,1]
 v_pk_fma_f32 v[154:155], v[74:75], v[222:223], v[218:219] op_sel_hi:[1,0,0] neg_lo:[0,0,1] neg_hi:[0,0,1]
 v_pk_fma_f32 v[186:187], v[90:91], v[228:229], v[224:225] op_sel_hi:[1,0,0] neg_lo:[0,0,1] neg_hi:[0,0,1]
 v_pk_fma_f32 v[156:157], v[76:77], v[222:223], v[218:219] op_sel_hi:[1,0,0] neg_lo:[0,0,1] neg_hi:[0,0,1]
 v_pk_fma_f32 v[188:189], v[92:93], v[228:229], v[224:225] op_sel_hi:[1,0,0] neg_lo:[0,0,1] neg_hi:[0,0,1]
 v_pk_fma_f32 v[158:159], v[78:79], v[222:223], v[218:219] op_sel_hi:[1,0,0] neg_lo:[0,0,1] neg_hi:[0,0,1]
 v_pk_fma_f32 v[190:191], v[94:95], v[228:229], v[224:225] op_sel_hi:[1,0,0] neg_lo:[0,0,1] neg_hi:[0,0,1]
 v_pk_fma_f32 v[64:65], v[64:65], v[222:223], v[220:221] op_sel_hi:[1,0,0] neg_lo:[1,0,1] neg_hi:[1,0,1]
 v_pk_fma_f32 v[80:81], v[80:81], v[228:229], v[226:227] op_sel_hi:[1,0,0] neg_lo:[1,0,1] neg_hi:[1,0,1]
 v_pk_fma_f32 v[66:67], v[66:67], v[222:223], v[220:221] op_sel_hi:[1,0,0] neg_lo:[1,0,1] neg_hi:[1,0,1]
 v_pk_fma_f32 v[82:83], v[82:83], v[228:229], v[226:227] op_sel_hi:[1,0,0] neg_lo:[1,0,1] neg_hi:[1,0,1]
 v_pk_fma_f32 v[68:69], v[68:69], v[222:223], v[220:221] op_sel_hi:[1,0,0] neg_lo:[1,0,1] neg_hi:[1,0,1]
 v_pk_fma_f32 v[84:85], v[84:85], v[228:229], v[226:227] op_sel_hi:[1,0,0] neg_lo:[1,0,1] neg_hi:[1,0,1]
 v_pk_fma_f32 v[70:71], v[70:71], v[222:223], v[220:221] op_sel_hi:[1,0,0] neg_lo:[1,0,1] neg_hi:[1,0,1]
 v_pk_fma_f32 v[86:87], v[86:87], v[228:229], v[226:227] op_sel_hi:[1,0,0] neg_lo:[1,0,1] neg_hi:[1,0,1]
 v_pk_fma_f32 v[72:73], v[72:73], v[222:223], v[220:221] op_sel_hi:[1,0,0] neg_lo:[1,0,1] neg_hi:[1,0,1]
 v_pk_fma_f32 v[88:89], v[88:89], v[228:229], v[226:227] op_sel_hi:[1,0,0] neg_lo:[1,0,1] neg_hi:[1,0,1]
 v_pk_fma_f32 v[74:75], v[74:75], v[222:223], v[220:221] op_sel_hi:[1,0,0] neg_lo:[1,0,1] neg_hi:[1,0,1]
 v_pk_fma_f32 v[90:91], v[90:91], v[228:229], v[226:227] op_sel_hi:[1,0,0] neg_lo:[1,0,1] neg_hi:[1,0,1]
 v_pk_fma_f32 v[76:77], v[76:77], v[222:223], v[220:221] op_sel_hi:[1,0,0] neg_lo:[1,0,1] neg_hi:[1,0,1]
 v_pk_fma_f32 v[92:93], v[92:93], v[228:229], v[226:227] op_sel_hi:[1,0,0] neg_lo:[1,0,1] neg_hi:[1,0,1]
 v_pk_fma_f32 v[78:79], v[78:79], v[222:223], v[220:221] op_sel_hi:[1,0,0] neg_lo:[1,0,1] neg_hi:[1,0,1]
 v_pk_fma_f32 v[94:95], v[94:95], v[228:229], v[226:227] op_sel_hi:[1,0,0] neg_lo:[1,0,1] neg_hi:[1,0,1]
 v_exp_f32 v136, v136
 v_exp_f32 v168, v168
 v_exp_f32 v137, v137
 v_exp_f32 v169, v169
 v_exp_f32 v138, v138
 v_exp_f32 v170, v170
 v_exp_f32 v139, v139
 v_exp_f32 v171, v171
 v_exp_f32 v140, v140
 v_exp_f32 v172, v172
 v_exp_f32 v141, v141
 v_exp_f32 v173, v173
 v_exp_f32 v142, v142
 v_exp_f32 v174, v174
 v_exp_f32 v143, v143
 v_exp_f32 v175, v175
 v_exp_f32 v152, v152
 v_exp_f32 v184, v184
 v_exp_f32 v153, v153
 v_exp_f32 v185, v185
 v_exp_f32 v154, v154
 v_exp_f32 v186, v186
 v_exp_f32 v155, v155
 v_exp_f32 v187, v187
 v_exp_f32 v156, v156
 v_exp_f32 v188, v188
 v_exp_f32 v157, v157
 v_exp_f32 v189, v189
 v_exp_f32 v158, v158
 v_exp_f32 v190, v190
 v_exp_f32 v159, v159
 v_exp_f32 v191, v191
 v_exp_f32 v64, v64
 v_exp_f32 v80, v80
 v_exp_f32 v65, v65
 v_exp_f32 v81, v81
 v_exp_f32 v66, v66
 v_exp_f32 v82, v82
 v_exp_f32 v67, v67
 v_exp_f32 v83, v83
 v_exp_f32 v68, v68
 v_exp_f32 v84, v84
 v_exp_f32 v69, v69
 v_exp_f32 v85, v85
 v_exp_f32 v70, v70
 v_exp_f32 v86, v86
 v_exp_f32 v71, v71
 v_exp_f32 v87, v87
 v_exp_f32 v72, v72
 v_exp_f32 v88, v88
 v_exp_f32 v73, v73
 v_exp_f32 v89, v89
 v_exp_f32 v74, v74
 v_exp_f32 v90, v90
 v_exp_f32 v75, v75
 v_exp_f32 v91, v91
 v_exp_f32 v76, v76
 v_exp_f32 v92, v92
 v_exp_f32 v77, v77
 v_exp_f32 v93, v93
 v_exp_f32 v78, v78
 v_exp_f32 v94, v94
 v_exp_f32 v79, v79
 v_exp_f32 v95, v95
 v_pk_add_f32 v[218:219], v[136:137], v[138:139]
 v_pk_add_f32 v[224:225], v[168:169], v[170:171]
 v_pk_add_f32 v[220:221], v[64:65], v[66:67]
 v_pk_add_f32 v[226:227], v[80:81], v[82:83]
 v_pk_add_f32 v[218:219], v[218:219], v[140:141]
 v_pk_add_f32 v[224:225], v[224:225], v[172:173]
 v_pk_add_f32 v[220:221], v[220:221], v[68:69]
 v_pk_add_f32 v[226:227], v[226:227], v[84:85]
 v_pk_add_f32 v[218:219], v[218:219], v[142:143]
 v_pk_add_f32 v[224:225], v[224:225], v[174:175]
 v_pk_add_f32 v[220:221], v[220:221], v[70:71]
 v_pk_add_f32 v[226:227], v[226:227], v[86:87]
 v_pk_add_f32 v[218:219], v[218:219], v[152:153]
 v_pk_add_f32 v[224:225], v[224:225], v[184:185]
 v_pk_add_f32 v[220:221], v[220:221], v[72:73]
 v_pk_add_f32 v[226:227], v[226:227], v[88:89]
 v_pk_add_f32 v[218:219], v[218:219], v[154:155]
 v_pk_add_f32 v[224:225], v[224:225], v[186:187]
 v_pk_add_f32 v[220:221], v[220:221], v[74:75]
 v_pk_add_f32 v[226:227], v[226:227], v[90:91]
 v_pk_add_f32 v[218:219], v[218:219], v[156:157]
 v_pk_add_f32 v[224:225], v[224:225], v[188:189]
 v_pk_add_f32 v[220:221], v[220:221], v[76:77]
 v_pk_add_f32 v[226:227], v[226:227], v[92:93]
 v_pk_add_f32 v[218:219], v[218:219], v[158:159]
 v_pk_add_f32 v[224:225], v[224:225], v[190:191]
 v_pk_add_f32 v[220:221], v[220:221], v[78:79]
 v_pk_add_f32 v[226:227], v[226:227], v[94:95]
 v_add_f32 v218, v218, v219
 v_add_f32 v224, v224, v225
 v_add_f32 v220, v220, v221
 v_add_f32 v226, v226, v227
 s_nop 0
 v_permlane32_swap_b32 v218, v220
 v_permlane32_swap_b32 v224, v226
 v_add_f32 v218, v218, v220
 v_add_f32 v224, v224, v226
 v_rcp_f32 v218, v218
 v_rcp_f32 v224, v224
 v_mul_f32 v218, v218, v248
 v_mul_f32 v224, v224, v249
 v_mov_b32 v220, v218
 v_mov_b32 v226, v224
 s_nop 0
 v_permlane32_swap_b32 v218, v220
 v_permlane32_swap_b32 v224, v226
 v_pk_mul_f32 v[136:137], v[136:137], v[218:219] op_sel_hi:[1,0]
 v_pk_mul_f32 v[168:169], v[168:169], v[224:225] op_sel_hi:[1,0]
 v_pk_mul_f32 v[138:139], v[138:139], v[218:219] op_sel_hi:[1,0]
 v_pk_mul_f32 v[170:171], v[170:171], v[224:225] op_sel_hi:[1,0]
 v_pk_mul_f32 v[140:141], v[140:141], v[218:219] op_sel_hi:[1,0]
 v_pk_mul_f32 v[172:173], v[172:173], v[224:225] op_sel_hi:[1,0]
 v_pk_mul_f32 v[142:143], v[142:143], v[218:219] op_sel_hi:[1,0]
 v_pk_mul_f32 v[174:175], v[174:175], v[224:225] op_sel_hi:[1,0]
 v_cvt_pk_bf16_f32 v136, v136, v137
 v_cvt_pk_bf16_f32 v168, v168, v169
 v_cvt_pk_bf16_f32 v137, v138, v139
 v_cvt_pk_bf16_f32 v169, v170, v171
 v_cvt_pk_bf16_f32 v138, v140, v141
 v_cvt_pk_bf16_f32 v170, v172, v173
 v_cvt_pk_bf16_f32 v139, v142, v143
 v_cvt_pk_bf16_f32 v171, v174, v175
 v_pk_mul_f32 v[152:153], v[152:153], v[218:219] op_sel_hi:[1,0]
 v_pk_mul_f32 v[184:185], v[184:185], v[224:225] op_sel_hi:[1,0]
 v_pk_mul_f32 v[154:155], v[154:155], v[218:219] op_sel_hi:[1,0]
 v_pk_mul_f32 v[186:187], v[186:187], v[224:225] op_sel_hi:[1,0]
 v_pk_mul_f32 v[156:157], v[156:157], v[218:219] op_sel_hi:[1,0]
 v_pk_mul_f32 v[188:189], v[188:189], v[224:225] op_sel_hi:[1,0]
 v_pk_mul_f32 v[158:159], v[158:159], v[218:219] op_sel_hi:[1,0]
 v_pk_mul_f32 v[190:191], v[190:191], v[224:225] op_sel_hi:[1,0]
 ds_write_b128 v236, v[136:139]
 ds_write_b128 v236, v[168:171] offset:4096
 v_cvt_pk_bf16_f32 v140, v152, v153
 v_cvt_pk_bf16_f32 v172, v184, v185
 v_cvt_pk_bf16_f32 v141, v154, v155
 v_cvt_pk_bf16_f32 v173, v186, v187
 v_cvt_pk_bf16_f32 v142, v156, v157
 v_cvt_pk_bf16_f32 v174, v188, v189
 v_cvt_pk_bf16_f32 v143, v158, v159
 v_cvt_pk_bf16_f32 v175, v190, v191
 v_pk_mul_f32 v[72:73], v[72:73], v[220:221] op_sel_hi:[1,0]
 v_pk_mul_f32 v[88:89], v[88:89], v[226:227] op_sel_hi:[1,0]
 v_pk_mul_f32 v[74:75], v[74:75], v[220:221] op_sel_hi:[1,0]
 v_pk_mul_f32 v[90:91], v[90:91], v[226:227] op_sel_hi:[1,0]
 v_pk_mul_f32 v[76:77], v[76:77], v[220:221] op_sel_hi:[1,0]
 v_pk_mul_f32 v[92:93], v[92:93], v[226:227] op_sel_hi:[1,0]
 v_pk_mul_f32 v[78:79], v[78:79], v[220:221] op_sel_hi:[1,0]
 v_pk_mul_f32 v[94:95], v[94:95], v[226:227] op_sel_hi:[1,0]
 v_cvt_pk_bf16_f32 v79, v78, v79
 v_cvt_pk_bf16_f32 v95, v94, v95
 v_cvt_pk_bf16_f32 v78, v76, v77
 v_cvt_pk_bf16_f32 v94, v92, v93
 v_cvt_pk_bf16_f32 v77, v74, v75
 v_cvt_pk_bf16_f32 v93, v90, v91
 v_cvt_pk_bf16_f32 v76, v72, v73
 v_cvt_pk_bf16_f32 v92, v88, v89
 ds_write_b128 v237, v[140:143]
 ds_write_b128 v237, v[172:175] offset:4096
 v_pk_mul_f32 v[64:65], v[64:65], v[220:221] op_sel_hi:[1,0]
 v_pk_mul_f32 v[80:81], v[80:81], v[226:227] op_sel_hi:[1,0]
 v_pk_mul_f32 v[66:67], v[66:67], v[220:221] op_sel_hi:[1,0]
 v_pk_mul_f32 v[82:83], v[82:83], v[226:227] op_sel_hi:[1,0]
 v_pk_mul_f32 v[68:69], v[68:69], v[220:221] op_sel_hi:[1,0]
 v_pk_mul_f32 v[84:85], v[84:85], v[226:227] op_sel_hi:[1,0]
 v_pk_mul_f32 v[70:71], v[70:71], v[220:221] op_sel_hi:[1,0]
 v_pk_mul_f32 v[86:87], v[86:87], v[226:227] op_sel_hi:[1,0]
 v_cvt_pk_bf16_f32 v75, v70, v71
 v_cvt_pk_bf16_f32 v91, v86, v87
 v_cvt_pk_bf16_f32 v74, v68, v69
 v_cvt_pk_bf16_f32 v90, v84, v85
 v_cvt_pk_bf16_f32 v73, v66, v67
 v_cvt_pk_bf16_f32 v89, v82, v83
 v_cvt_pk_bf16_f32 v72, v64, v65
 v_cvt_pk_bf16_f32 v88, v80, v81
 v_max3_f32 v218, v96, v97, v98
 v_max3_f32 v224, v112, v113, v114
 ds_write_b128 v239, v[76:79]
 v_max3_f32 v219, -v96, -v97, -v98
 v_max3_f32 v225, -v112, -v113, -v114
 v_max3_f32 v218, v218, v99, v100
 v_max3_f32 v224, v224, v115, v116
 v_max3_f32 v219, v219, -v99, -v100
 v_max3_f32 v225, v225, -v115, -v116
 v_max3_f32 v218, v218, v101, v102
 v_max3_f32 v224, v224, v117, v118
 ds_write_b128 v239, v[92:95] offset:4096
 v_max3_f32 v219, v219, -v101, -v102
 v_max3_f32 v225, v225, -v117, -v118
 v_max3_f32 v218, v218, v103, v104
 v_max3_f32 v224, v224, v119, v120
 v_max3_f32 v219, v219, -v103, -v104
 v_max3_f32 v225, v225, -v119, -v120
 v_max3_f32 v218, v218, v105, v106
 v_max3_f32 v224, v224, v121, v122
 v_max3_f32 v219, v219, -v105, -v106
 ds_write_b128 v238, v[72:75]
 v_max3_f32 v225, v225, -v121, -v122
 v_max3_f32 v218, v218, v107, v108
 v_max3_f32 v224, v224, v123, v124
 v_max3_f32 v219, v219, -v107, -v108
 v_max3_f32 v225, v225, -v123, -v124
 v_max3_f32 v218, v218, v109, v110
 v_max3_f32 v224, v224, v125, v126
 v_max3_f32 v219, v219, -v109, -v110
 v_max3_f32 v225, v225, -v125, -v126
 ds_write_b128 v238, v[88:91] offset:4096
 v_max_f32 v218, v218, v111
 v_max_f32 v224, v224, v127
 v_max_f32_e64 v219, v219, -v111
 v_max_f32_e64 v225, v225, -v127
 v_mul_f32 v222, 0x3fb8aa3b, v250
 v_mul_f32 v228, 0x3fb8aa3b, v251
 v_permlane32_swap_b32 v218, v219
 v_permlane32_swap_b32 v224, v225
 v_max_f32 v218, v218, v219
 v_max_f32 v224, v224, v225
 v_mul_f32 v218, v222, v218
 v_mul_f32 v224, v228, v224
 v_mov_b32 v220, v218
 v_mov_b32 v226, v224
 s_nop 0
 v_permlane32_swap_b32 v218, v220
 v_permlane32_swap_b32_e64 v224, v226
 v_pk_fma_f32 v[136:137], v[96:97], v[222:223], v[218:219] op_sel_hi:[1,0,0] neg_lo:[0,0,1] neg_hi:[0,0,1]
 v_pk_fma_f32 v[168:169], v[112:113], v[228:229], v[224:225] op_sel_hi:[1,0,0] neg_lo:[0,0,1] neg_hi:[0,0,1]
 v_pk_fma_f32 v[138:139], v[98:99], v[222:223], v[218:219] op_sel_hi:[1,0,0] neg_lo:[0,0,1] neg_hi:[0,0,1]
 s_waitcnt lgkmcnt(0)
 s_nop 0
 ds_read_b64_tr_b16 a[0:1], v240
 ds_read_b64_tr_b16 a[2:3], v241 offset:512
 v_pk_fma_f32 v[170:171], v[114:115], v[228:229], v[224:225] op_sel_hi:[1,0,0] neg_lo:[0,0,1] neg_hi:[0,0,1]
 ds_read_b64_tr_b16 a[4:5], v240 offset:2048
 v_pk_fma_f32 v[140:141], v[100:101], v[222:223], v[218:219] op_sel_hi:[1,0,0] neg_lo:[0,0,1] neg_hi:[0,0,1]
 ds_read_b64_tr_b16 a[6:7], v241 offset:2560
 v_pk_fma_f32 v[172:173], v[116:117], v[228:229], v[224:225] op_sel_hi:[1,0,0] neg_lo:[0,0,1] neg_hi:[0,0,1]
 v_pk_fma_f32 v[142:143], v[102:103], v[222:223], v[218:219] op_sel_hi:[1,0,0] neg_lo:[0,0,1] neg_hi:[0,0,1]
 ds_read_b64_tr_b16 a[8:9], v242
 v_pk_fma_f32 v[174:175], v[118:119], v[228:229], v[224:225] op_sel_hi:[1,0,0] neg_lo:[0,0,1] neg_hi:[0,0,1]
 ds_read_b64_tr_b16 a[10:11], v243 offset:512
 v_pk_fma_f32 v[152:153], v[104:105], v[222:223], v[218:219] op_sel_hi:[1,0,0] neg_lo:[0,0,1] neg_hi:[0,0,1]
 ds_read_b64_tr_b16 a[12:13], v242 offset:2048
 v_pk_fma_f32 v[184:185], v[120:121], v[228:229], v[224:225] op_sel_hi:[1,0,0] neg_lo:[0,0,1] neg_hi:[0,0,1]
 v_pk_fma_f32 v[154:155], v[106:107], v[222:223], v[218:219] op_sel_hi:[1,0,0] neg_lo:[0,0,1] neg_hi:[0,0,1]
 ds_read_b64_tr_b16 a[14:15], v243 offset:2560
 v_pk_fma_f32 v[186:187], v[122:123], v[228:229], v[224:225] op_sel_hi:[1,0,0] neg_lo:[0,0,1] neg_hi:[0,0,1]
 ds_read_b64_tr_b16 a[16:17], v240 offset:4096
 v_pk_fma_f32 v[156:157], v[108:109], v[222:223], v[218:219] op_sel_hi:[1,0,0] neg_lo:[0,0,1] neg_hi:[0,0,1]
 ds_read_b64_tr_b16 a[18:19], v241 offset:4608
 v_pk_fma_f32 v[188:189], v[124:125], v[228:229], v[224:225] op_sel_hi:[1,0,0] neg_lo:[0,0,1] neg_hi:[0,0,1]
 v_pk_fma_f32 v[158:159], v[110:111], v[222:223], v[218:219] op_sel_hi:[1,0,0] neg_lo:[0,0,1] neg_hi:[0,0,1]
 ds_read_b64_tr_b16 a[20:21], v240 offset:6144
 v_pk_fma_f32 v[190:191], v[126:127], v[228:229], v[224:225] op_sel_hi:[1,0,0] neg_lo:[0,0,1] neg_hi:[0,0,1]
 ds_read_b64_tr_b16 a[22:23], v241 offset:6656
 v_pk_fma_f32 v[96:97], v[96:97], v[222:223], v[220:221] op_sel_hi:[1,0,0] neg_lo:[1,0,1] neg_hi:[1,0,1]
 ds_read_b64_tr_b16 a[24:25], v242 offset:4096
 v_pk_fma_f32 v[112:113], v[112:113], v[228:229], v[226:227] op_sel_hi:[1,0,0] neg_lo:[1,0,1] neg_hi:[1,0,1]
 v_pk_fma_f32 v[98:99], v[98:99], v[222:223], v[220:221] op_sel_hi:[1,0,0] neg_lo:[1,0,1] neg_hi:[1,0,1]
 ds_read_b64_tr_b16 a[26:27], v243 offset:4608
 v_pk_fma_f32 v[114:115], v[114:115], v[228:229], v[226:227] op_sel_hi:[1,0,0] neg_lo:[1,0,1] neg_hi:[1,0,1]
 ds_read_b64_tr_b16 a[28:29], v242 offset:6144
 v_pk_fma_f32 v[100:101], v[100:101], v[222:223], v[220:221] op_sel_hi:[1,0,0] neg_lo:[1,0,1] neg_hi:[1,0,1]
 ds_read_b64_tr_b16 a[30:31], v243 offset:6656
 v_pk_fma_f32 v[116:117], v[116:117], v[228:229], v[226:227] op_sel_hi:[1,0,0] neg_lo:[1,0,1] neg_hi:[1,0,1]
 v_pk_fma_f32 v[102:103], v[102:103], v[222:223], v[220:221] op_sel_hi:[1,0,0] neg_lo:[1,0,1] neg_hi:[1,0,1]
 v_pk_fma_f32 v[118:119], v[118:119], v[228:229], v[226:227] op_sel_hi:[1,0,0] neg_lo:[1,0,1] neg_hi:[1,0,1]
 v_pk_fma_f32 v[104:105], v[104:105], v[222:223], v[220:221] op_sel_hi:[1,0,0] neg_lo:[1,0,1] neg_hi:[1,0,1]
 v_pk_fma_f32 v[120:121], v[120:121], v[228:229], v[226:227] op_sel_hi:[1,0,0] neg_lo:[1,0,1] neg_hi:[1,0,1]
 v_pk_fma_f32 v[106:107], v[106:107], v[222:223], v[220:221] op_sel_hi:[1,0,0] neg_lo:[1,0,1] neg_hi:[1,0,1]
 v_pk_fma_f32 v[122:123], v[122:123], v[228:229], v[226:227] op_sel_hi:[1,0,0] neg_lo:[1,0,1] neg_hi:[1,0,1]
 v_pk_fma_f32 v[108:109], v[108:109], v[222:223], v[220:221] op_sel_hi:[1,0,0] neg_lo:[1,0,1] neg_hi:[1,0,1]
 v_pk_fma_f32 v[124:125], v[124:125], v[228:229], v[226:227] op_sel_hi:[1,0,0] neg_lo:[1,0,1] neg_hi:[1,0,1]
 v_pk_fma_f32 v[110:111], v[110:111], v[222:223], v[220:221] op_sel_hi:[1,0,0] neg_lo:[1,0,1] neg_hi:[1,0,1]
 v_pk_fma_f32 v[126:127], v[126:127], v[228:229], v[226:227] op_sel_hi:[1,0,0] neg_lo:[1,0,1] neg_hi:[1,0,1]
 s_waitcnt lgkmcnt(0)
 v_mfma_f32_32x32x16_bf16 v[64:79], a[0:3], v[128:131], 0
 v_exp_f32 v136, v136
 v_exp_f32 v168, v168
 v_exp_f32 v137, v137
 v_mfma_f32_32x32x16_bf16 v[80:95], a[0:3], a[160:163], 0
 v_exp_f32 v169, v169
 v_exp_f32 v138, v138
 v_exp_f32 v170, v170
 v_exp_f32 v139, v139
 v_mfma_f32_32x32x16_bf16 a[128:143], a[8:11], v[128:131], 0
 v_exp_f32 v171, v171
 v_exp_f32 v140, v140
 v_exp_f32 v172, v172
 v_exp_f32 v141, v141
 v_mfma_f32_32x32x16_bf16 a[144:159], a[8:11], a[160:163], 0
 v_exp_f32 v173, v173
 v_exp_f32 v142, v142
 v_exp_f32 v174, v174
 v_exp_f32 v143, v143
 v_mfma_f32_32x32x16_bf16 v[64:79], a[4:7], v[132:135], v[64:79]
 v_exp_f32 v175, v175
 v_exp_f32 v152, v152
 v_exp_f32 v184, v184
 v_exp_f32 v153, v153
 v_mfma_f32_32x32x16_bf16 v[80:95], a[4:7], a[164:167], v[80:95]
 v_exp_f32 v185, v185
 v_exp_f32 v154, v154
 v_exp_f32 v186, v186
 v_exp_f32 v155, v155
 v_mfma_f32_32x32x16_bf16 a[128:143], a[12:15], v[132:135], a[128:143]
 v_exp_f32 v187, v187
 v_exp_f32 v156, v156
 v_exp_f32 v188, v188
 v_exp_f32 v157, v157
 v_mfma_f32_32x32x16_bf16 a[144:159], a[12:15], a[164:167], a[144:159]
 v_exp_f32 v189, v189
 v_exp_f32 v158, v158
 v_exp_f32 v190, v190
 v_exp_f32 v159, v159
 v_mfma_f32_32x32x16_bf16 v[64:79], a[16:19], v[144:147], v[64:79]
 v_exp_f32 v191, v191
 v_exp_f32 v96, v96
 v_exp_f32_e64 v112, v112
 v_mfma_f32_32x32x16_bf16 v[80:95], a[16:19], a[168:171], v[80:95]
 v_exp_f32 v97, v97
 v_exp_f32 v113, v113
 v_exp_f32 v98, v98
 v_exp_f32 v114, v114
 v_mfma_f32_32x32x16_bf16 a[128:143], a[24:27], v[144:147], a[128:143]
 v_exp_f32 v99, v99
 v_exp_f32 v115, v115
 v_exp_f32 v100, v100
 v_exp_f32 v116, v116
 v_mfma_f32_32x32x16_bf16 a[144:159], a[24:27], a[168:171], a[144:159]
 v_exp_f32 v101, v101
 v_exp_f32 v117, v117
 v_exp_f32 v102, v102
 v_exp_f32 v118, v118
 v_mfma_f32_32x32x16_bf16 v[64:79], a[20:23], v[148:151], v[64:79]
 v_exp_f32 v103, v103
 v_exp_f32 v119, v119
 v_exp_f32 v104, v104
 v_exp_f32 v120, v120
 v_mfma_f32_32x32x16_bf16 v[80:95], a[20:23], a[172:175], v[80:95]
 v_exp_f32 v105, v105
 v_exp_f32 v121, v121
 v_exp_f32 v106, v106
 v_exp_f32 v122, v122
 v_mfma_f32_32x32x16_bf16 a[128:143], a[28:31], v[148:151], a[128:143]
 v_exp_f32 v107, v107
 v_exp_f32 v123, v123
 v_exp_f32 v108, v108
 v_exp_f32 v124, v124
 v_mfma_f32_32x32x16_bf16 a[144:159], a[28:31], a[172:175], a[144:159]
 v_exp_f32 v109, v109
 v_exp_f32 v125, v125
 v_exp_f32 v110, v110
 v_exp_f32 v126, v126
 v_exp_f32 v111, v111
 v_exp_f32 v127, v127
 v_pk_add_f32 v[218:219], v[136:137], v[138:139]
 v_pk_add_f32 v[224:225], v[168:169], v[170:171]
 v_pk_add_f32 v[220:221], v[96:97], v[98:99]
 v_pk_add_f32 v[226:227], v[112:113], v[114:115]
 v_pk_add_f32 v[218:219], v[218:219], v[140:141]
 v_pk_add_f32 v[224:225], v[224:225], v[172:173]
 v_pk_add_f32 v[220:221], v[220:221], v[100:101]
 v_pk_add_f32 v[226:227], v[226:227], v[116:117]
 v_pk_add_f32 v[218:219], v[218:219], v[142:143]
 v_pk_add_f32 v[224:225], v[224:225], v[174:175]
 v_pk_add_f32 v[220:221], v[220:221], v[102:103]
 v_pk_add_f32 v[226:227], v[226:227], v[118:119]
 v_pk_add_f32 v[218:219], v[218:219], v[152:153]
 v_pk_add_f32 v[224:225], v[224:225], v[184:185]
 v_pk_add_f32 v[220:221], v[220:221], v[104:105]
 v_pk_add_f32 v[226:227], v[226:227], v[120:121]
 v_pk_add_f32 v[218:219], v[218:219], v[154:155]
 v_pk_add_f32 v[224:225], v[224:225], v[186:187]
 v_pk_add_f32 v[220:221], v[220:221], v[106:107]
 v_pk_add_f32 v[226:227], v[226:227], v[122:123]
 v_pk_add_f32 v[218:219], v[218:219], v[156:157]
 v_pk_add_f32 v[224:225], v[224:225], v[188:189]
 v_pk_add_f32 v[220:221], v[220:221], v[108:109]
 v_pk_add_f32 v[226:227], v[226:227], v[124:125]
 v_pk_add_f32 v[218:219], v[218:219], v[158:159]
 v_pk_add_f32 v[224:225], v[224:225], v[190:191]
 v_pk_add_f32 v[220:221], v[220:221], v[110:111]
 v_pk_add_f32 v[226:227], v[226:227], v[126:127]
 v_add_f32 v218, v218, v219
 v_add_f32 v224, v224, v225
 v_add_f32 v220, v220, v221
 v_add_f32 v226, v226, v227
 s_nop 0
 v_permlane32_swap_b32 v218, v220
 v_permlane32_swap_b32 v224, v226
 v_add_f32 v218, v218, v220
 v_add_f32 v224, v224, v226
 v_rcp_f32 v218, v218
 v_rcp_f32 v224, v224
 v_mul_f32 v218, v218, v250
 v_mul_f32 v224, v224, v251
 v_mov_b32 v220, v218
 v_mov_b32 v226, v224
 s_nop 0
 v_permlane32_swap_b32 v218, v220
 v_permlane32_swap_b32 v224, v226
 v_pk_mul_f32 v[136:137], v[136:137], v[218:219] op_sel_hi:[1,0]
 v_pk_mul_f32 v[168:169], v[168:169], v[224:225] op_sel_hi:[1,0]
 v_pk_mul_f32 v[138:139], v[138:139], v[218:219] op_sel_hi:[1,0]
 v_pk_mul_f32 v[170:171], v[170:171], v[224:225] op_sel_hi:[1,0]
 v_pk_mul_f32 v[140:141], v[140:141], v[218:219] op_sel_hi:[1,0]
 v_pk_mul_f32 v[172:173], v[172:173], v[224:225] op_sel_hi:[1,0]
 v_pk_mul_f32 v[142:143], v[142:143], v[218:219] op_sel_hi:[1,0]
 v_pk_mul_f32 v[174:175], v[174:175], v[224:225] op_sel_hi:[1,0]
 v_cvt_pk_bf16_f32 v136, v136, v137
 v_cvt_pk_bf16_f32 v168, v168, v169
 v_cvt_pk_bf16_f32 v137, v138, v139
 v_cvt_pk_bf16_f32 v169, v170, v171
 v_cvt_pk_bf16_f32 v138, v140, v141
 v_cvt_pk_bf16_f32 v170, v172, v173
 v_cvt_pk_bf16_f32 v139, v142, v143
 v_cvt_pk_bf16_f32 v171, v174, v175
 v_pk_mul_f32 v[152:153], v[152:153], v[218:219] op_sel_hi:[1,0]
 v_pk_mul_f32 v[184:185], v[184:185], v[224:225] op_sel_hi:[1,0]
 v_pk_mul_f32 v[154:155], v[154:155], v[218:219] op_sel_hi:[1,0]
 v_pk_mul_f32 v[186:187], v[186:187], v[224:225] op_sel_hi:[1,0]
 v_pk_mul_f32 v[156:157], v[156:157], v[218:219] op_sel_hi:[1,0]
 v_pk_mul_f32 v[188:189], v[188:189], v[224:225] op_sel_hi:[1,0]
 v_pk_mul_f32 v[158:159], v[158:159], v[218:219] op_sel_hi:[1,0]
 v_pk_mul_f32 v[190:191], v[190:191], v[224:225] op_sel_hi:[1,0]
 ds_write_b128 v236, v[136:139] offset:8192
 ds_write_b128 v236, v[168:171] offset:12288
 v_cvt_pk_bf16_f32 v140, v152, v153
 v_cvt_pk_bf16_f32 v172, v184, v185
 v_cvt_pk_bf16_f32 v141, v154, v155
 v_cvt_pk_bf16_f32 v173, v186, v187
 v_cvt_pk_bf16_f32 v142, v156, v157
 v_cvt_pk_bf16_f32 v174, v188, v189
 v_cvt_pk_bf16_f32 v143, v158, v159
 v_cvt_pk_bf16_f32 v175, v190, v191
 v_pk_mul_f32 v[104:105], v[104:105], v[220:221] op_sel_hi:[1,0]
 v_pk_mul_f32 v[120:121], v[120:121], v[226:227] op_sel_hi:[1,0]
 v_pk_mul_f32 v[106:107], v[106:107], v[220:221] op_sel_hi:[1,0]
 v_pk_mul_f32 v[122:123], v[122:123], v[226:227] op_sel_hi:[1,0]
 v_pk_mul_f32 v[108:109], v[108:109], v[220:221] op_sel_hi:[1,0]
 v_pk_mul_f32 v[124:125], v[124:125], v[226:227] op_sel_hi:[1,0]
 v_pk_mul_f32 v[110:111], v[110:111], v[220:221] op_sel_hi:[1,0]
 v_pk_mul_f32 v[126:127], v[126:127], v[226:227] op_sel_hi:[1,0]
 v_cvt_pk_bf16_f32 v111, v110, v111
 v_cvt_pk_bf16_f32 v127, v126, v127
 v_cvt_pk_bf16_f32 v110, v108, v109
 v_cvt_pk_bf16_f32 v126, v124, v125
 v_cvt_pk_bf16_f32 v109, v106, v107
 v_cvt_pk_bf16_f32 v125, v122, v123
 v_cvt_pk_bf16_f32 v108, v104, v105
 v_cvt_pk_bf16_f32 v124, v120, v121
 ds_write_b128 v237, v[140:143] offset:8192
 ds_write_b128 v237, v[172:175] offset:12288
 v_pk_mul_f32 v[96:97], v[96:97], v[220:221] op_sel_hi:[1,0]
 v_pk_mul_f32 v[112:113], v[112:113], v[226:227] op_sel_hi:[1,0]
 v_pk_mul_f32 v[98:99], v[98:99], v[220:221] op_sel_hi:[1,0]
 v_pk_mul_f32 v[114:115], v[114:115], v[226:227] op_sel_hi:[1,0]
 v_pk_mul_f32 v[100:101], v[100:101], v[220:221] op_sel_hi:[1,0]
 v_pk_mul_f32 v[116:117], v[116:117], v[226:227] op_sel_hi:[1,0]
 v_pk_mul_f32 v[102:103], v[102:103], v[220:221] op_sel_hi:[1,0]
 v_pk_mul_f32 v[118:119], v[118:119], v[226:227] op_sel_hi:[1,0]
 v_cvt_pk_bf16_f32 v107, v102, v103
 v_cvt_pk_bf16_f32 v123, v118, v119
 v_cvt_pk_bf16_f32 v106, v100, v101
 v_cvt_pk_bf16_f32 v122, v116, v117
 v_cvt_pk_bf16_f32 v105, v98, v99
 v_cvt_pk_bf16_f32 v121, v114, v115
 v_cvt_pk_bf16_f32 v104, v96, v97
 v_cvt_pk_bf16_f32 v120, v112, v113
 v_pk_fma_f32 v[0:1], v[208:209], v[192:193], v[0:1] op_sel:[0,0,0] op_sel_hi:[1,0,1] neg_lo:[1,0,0] neg_hi:[1,0,0]
 ds_write_b128 v239, v[108:111] offset:8192
 v_pk_fma_f32 v[2:3], v[210:211], v[192:193], v[2:3] op_sel:[0,0,0] op_sel_hi:[1,0,1] neg_lo:[1,0,0] neg_hi:[1,0,0]
 v_pk_fma_f32 v[4:5], v[212:213], v[192:193], v[4:5] op_sel:[0,0,0] op_sel_hi:[1,0,1] neg_lo:[1,0,0] neg_hi:[1,0,0]
 v_pk_fma_f32 v[6:7], v[214:215], v[192:193], v[6:7] op_sel:[0,0,0] op_sel_hi:[1,0,1] neg_lo:[1,0,0] neg_hi:[1,0,0]
 v_pk_fma_f32 v[8:9], v[208:209], v[192:193], v[8:9] op_sel:[0,1,0] op_sel_hi:[1,1,1] neg_lo:[1,0,0] neg_hi:[1,0,0]
 v_pk_fma_f32 v[10:11], v[210:211], v[192:193], v[10:11] op_sel:[0,1,0] op_sel_hi:[1,1,1] neg_lo:[1,0,0] neg_hi:[1,0,0]
 v_pk_fma_f32 v[12:13], v[212:213], v[192:193], v[12:13] op_sel:[0,1,0] op_sel_hi:[1,1,1] neg_lo:[1,0,0] neg_hi:[1,0,0]
 ds_write_b128 v239, v[124:127] offset:12288
 v_pk_fma_f32 v[14:15], v[214:215], v[192:193], v[14:15] op_sel:[0,1,0] op_sel_hi:[1,1,1] neg_lo:[1,0,0] neg_hi:[1,0,0]
 v_pk_fma_f32 v[16:17], v[208:209], v[194:195], v[16:17] op_sel:[0,0,0] op_sel_hi:[1,0,1] neg_lo:[1,0,0] neg_hi:[1,0,0]
 v_pk_fma_f32 v[18:19], v[210:211], v[194:195], v[18:19] op_sel:[0,0,0] op_sel_hi:[1,0,1] neg_lo:[1,0,0] neg_hi:[1,0,0]
 v_pk_fma_f32 v[20:21], v[212:213], v[194:195], v[20:21] op_sel:[0,0,0] op_sel_hi:[1,0,1] neg_lo:[1,0,0] neg_hi:[1,0,0]
 v_pk_fma_f32 v[22:23], v[214:215], v[194:195], v[22:23] op_sel:[0,0,0] op_sel_hi:[1,0,1] neg_lo:[1,0,0] neg_hi:[1,0,0]
 v_pk_fma_f32 v[24:25], v[208:209], v[194:195], v[24:25] op_sel:[0,1,0] op_sel_hi:[1,1,1] neg_lo:[1,0,0] neg_hi:[1,0,0]
 v_pk_fma_f32 v[26:27], v[210:211], v[194:195], v[26:27] op_sel:[0,1,0] op_sel_hi:[1,1,1] neg_lo:[1,0,0] neg_hi:[1,0,0]
 ds_write_b128 v238, v[104:107] offset:8192
 v_pk_fma_f32 v[28:29], v[212:213], v[194:195], v[28:29] op_sel:[0,1,0] op_sel_hi:[1,1,1] neg_lo:[1,0,0] neg_hi:[1,0,0]
 v_pk_fma_f32 v[30:31], v[214:215], v[194:195], v[30:31] op_sel:[0,1,0] op_sel_hi:[1,1,1] neg_lo:[1,0,0] neg_hi:[1,0,0]
 v_pk_fma_f32 v[32:33], v[208:209], v[196:197], v[32:33] op_sel:[0,0,0] op_sel_hi:[1,0,1] neg_lo:[1,0,0] neg_hi:[1,0,0]
 v_pk_fma_f32 v[34:35], v[210:211], v[196:197], v[34:35] op_sel:[0,0,0] op_sel_hi:[1,0,1] neg_lo:[1,0,0] neg_hi:[1,0,0]
 v_pk_fma_f32 v[36:37], v[212:213], v[196:197], v[36:37] op_sel:[0,0,0] op_sel_hi:[1,0,1] neg_lo:[1,0,0] neg_hi:[1,0,0]
 v_pk_fma_f32 v[38:39], v[214:215], v[196:197], v[38:39] op_sel:[0,0,0] op_sel_hi:[1,0,1] neg_lo:[1,0,0] neg_hi:[1,0,0]
 ds_write_b128 v238, v[120:123] offset:12288
 v_pk_fma_f32 v[40:41], v[208:209], v[196:197], v[40:41] op_sel:[0,1,0] op_sel_hi:[1,1,1] neg_lo:[1,0,0] neg_hi:[1,0,0]
 v_pk_fma_f32 v[42:43], v[210:211], v[196:197], v[42:43] op_sel:[0,1,0] op_sel_hi:[1,1,1] neg_lo:[1,0,0] neg_hi:[1,0,0]
 v_pk_fma_f32 v[44:45], v[212:213], v[196:197], v[44:45] op_sel:[0,1,0] op_sel_hi:[1,1,1] neg_lo:[1,0,0] neg_hi:[1,0,0]
 v_pk_fma_f32 v[46:47], v[214:215], v[196:197], v[46:47] op_sel:[0,1,0] op_sel_hi:[1,1,1] neg_lo:[1,0,0] neg_hi:[1,0,0]
 v_pk_fma_f32 v[48:49], v[208:209], v[198:199], v[48:49] op_sel:[0,0,0] op_sel_hi:[1,0,1] neg_lo:[1,0,0] neg_hi:[1,0,0]
 v_pk_fma_f32 v[50:51], v[210:211], v[198:199], v[50:51] op_sel:[0,0,0] op_sel_hi:[1,0,1] neg_lo:[1,0,0] neg_hi:[1,0,0]
 v_pk_fma_f32 v[52:53], v[212:213], v[198:199], v[52:53] op_sel:[0,0,0] op_sel_hi:[1,0,1] neg_lo:[1,0,0] neg_hi:[1,0,0]
 v_pk_fma_f32 v[54:55], v[214:215], v[198:199], v[54:55] op_sel:[0,0,0] op_sel_hi:[1,0,1] neg_lo:[1,0,0] neg_hi:[1,0,0]
 v_pk_fma_f32 v[56:57], v[208:209], v[198:199], v[56:57] op_sel:[0,1,0] op_sel_hi:[1,1,1] neg_lo:[1,0,0] neg_hi:[1,0,0]
 v_pk_fma_f32 v[58:59], v[210:211], v[198:199], v[58:59] op_sel:[0,1,0] op_sel_hi:[1,1,1] neg_lo:[1,0,0] neg_hi:[1,0,0]
 v_pk_fma_f32 v[60:61], v[212:213], v[198:199], v[60:61] op_sel:[0,1,0] op_sel_hi:[1,1,1] neg_lo:[1,0,0] neg_hi:[1,0,0]
 v_pk_fma_f32 v[62:63], v[214:215], v[198:199], v[62:63] op_sel:[0,1,0] op_sel_hi:[1,1,1] neg_lo:[1,0,0] neg_hi:[1,0,0]
 v_cvt_pk_bf16_f32 v200, v0, v1
 v_cvt_pk_bf16_f32 v201, v2, v3
 v_cvt_pk_bf16_f32 v204, v4, v5
 s_waitcnt lgkmcnt(0)
 s_nop 0
 ds_read_b64_tr_b16 a[0:1], v240 offset:8192
 ds_read_b64_tr_b16 a[2:3], v241 offset:8704
 ds_read_b64_tr_b16 a[4:5], v240 offset:10240
 v_cvt_pk_bf16_f32 v205, v6, v7
 ds_read_b64_tr_b16 a[6:7], v241 offset:10752
 v_cvt_pk_bf16_f32 v202, v8, v9
 ds_read_b64_tr_b16 a[8:9], v242 offset:8192
 ds_read_b64_tr_b16 a[10:11], v243 offset:8704
 v_cvt_pk_bf16_f32 v203, v10, v11
 ds_read_b64_tr_b16 a[12:13], v242 offset:10240
 v_cvt_pk_bf16_f32 v206, v12, v13
 ds_read_b64_tr_b16 a[14:15], v243 offset:10752
 ds_read_b64_tr_b16 a[16:17], v240 offset:12288
 v_cvt_pk_bf16_f32 v207, v14, v15
 ds_read_b64_tr_b16 a[18:19], v241 offset:12800
 v_permlane16_swap_b32_e64 v200, v202
 ds_read_b64_tr_b16 a[20:21], v240 offset:14336
 ds_read_b64_tr_b16 a[22:23], v241 offset:14848
 v_permlane16_swap_b32_e64 v201, v203
 ds_read_b64_tr_b16 a[24:25], v242 offset:12288
 v_permlane16_swap_b32_e64 v204, v206
 ds_read_b64_tr_b16 a[26:27], v243 offset:12800
 ds_read_b64_tr_b16 a[28:29], v242 offset:14336
 v_permlane16_swap_b32_e64 v205, v207
 ds_read_b64_tr_b16 a[30:31], v243 offset:14848
 v_mfma_f32_32x32x16_bf16 v[0:15], a[120:123], v[200:203], 0
 v_mfma_f32_32x32x16_bf16 v[0:15], a[124:127], v[204:207], v[0:15]
 v_cvt_pk_bf16_f32 v218, v16, v17
 v_cvt_pk_bf16_f32 v219, v18, v19
 v_cvt_pk_bf16_f32 v222, v20, v21
 v_cvt_pk_bf16_f32 v223, v22, v23
 v_cvt_pk_bf16_f32 v220, v24, v25
 v_cvt_pk_bf16_f32 v221, v26, v27
 v_cvt_pk_bf16_f32 v224, v28, v29
 v_cvt_pk_bf16_f32 v225, v30, v31
 v_permlane16_swap_b32 v218, v220
 v_permlane16_swap_b32 v219, v221
 v_permlane16_swap_b32 v222, v224
 v_permlane16_swap_b32 v223, v225
 v_mfma_f32_32x32x16_bf16 v[16:31], a[120:123], v[218:221], 0
 s_nop 0
 v_mfma_f32_32x32x16_bf16 v[16:31], a[124:127], v[222:225], v[16:31]
 s_waitcnt lgkmcnt(0)
 v_cvt_pk_bf16_f32 v200, v32, v33
 v_mfma_f32_32x32x16_bf16 a[128:143], a[8:11], v[160:163], a[128:143]
 v_cvt_pk_bf16_f32 v201, v34, v35
 v_cvt_pk_bf16_f32 v204, v36, v37
 v_cvt_pk_bf16_f32 v205, v38, v39
 v_cvt_pk_bf16_f32 v202, v40, v41
 v_mfma_f32_32x32x16_bf16 a[144:159], a[8:11], a[176:179], a[144:159]
 v_cvt_pk_bf16_f32 v203, v42, v43
 v_cvt_pk_bf16_f32 v206, v44, v45
 v_cvt_pk_bf16_f32 v207, v46, v47
 v_permlane16_swap_b32 v200, v202
 v_permlane16_swap_b32 v201, v203
 v_mfma_f32_32x32x16_bf16 a[128:143], a[12:15], v[164:167], a[128:143]
 v_permlane16_swap_b32 v204, v206
 v_permlane16_swap_b32 v205, v207
 v_lshlrev_b32_e64 v238, 4, v255
 s_mul_i32 s3, s28, 4352
 v_mfma_f32_32x32x16_bf16 a[144:159], a[12:15], a[180:183], a[144:159]
 s_add_u32 s3, s3, 131072
 v_add_u32 v226, s3, v238
 v_lshrrev_b32 v239, 5, v255
 v_lshlrev_b32 v239, 6, v239
 v_add_u32 v228, s3, v239
 v_mfma_f32_32x32x16_bf16 a[128:143], a[24:27], v[176:179], a[128:143]
 s_xor_b32 s3, s28, 2
 s_mul_i32 s3, s3, 4352
 s_add_u32 s3, s3, 131072
 v_add_u32 v227, s3, v238
 v_mfma_f32_32x32x16_bf16 a[144:159], a[24:27], a[184:187], a[144:159]
 v_add_u32_e64 v229, s3, v239
 s_lshl_b32 s68, s41, 2
 s_lshl_b32 s3, s30, 1
 s_add_u32 s68, s68, s3
 s_add_u32 s68, s68, s29
 v_mfma_f32_32x32x16_bf16 a[128:143], a[28:31], v[180:183], a[128:143]
 s_lshl_b32 s69, s68, 3
 s_add_u32 s69, s69, s40
 s_lshl_b32 s70, s69, 11
 s_lshl_b32 s71, s69, 7
 v_mfma_f32_32x32x16_bf16 a[144:159], a[28:31], a[188:191], a[144:159]
 v_bfe_u32 v230, v255, 2, 3
 v_lshl_add_u32 v239, v230, 24, v239
 v_and_b32_e64 v230, 3, v255
 v_lshl_add_u32 v239, v230, 4, v239
 v_mfma_f32_32x32x16_bf16 v[32:47], a[120:123], v[200:203], 0
 v_mfma_f32_32x32x16_bf16 v[32:47], a[124:127], v[204:207], v[32:47]
 v_cvt_pk_bf16_f32 v218, v48, v49
 v_mfma_f32_32x32x16_bf16 v[64:79], a[0:3], v[160:163], v[64:79]
 v_cvt_pk_bf16_f32 v219, v50, v51
 v_cvt_pk_bf16_f32 v222, v52, v53
 v_cvt_pk_bf16_f32 v223, v54, v55
 v_cvt_pk_bf16_f32 v220, v56, v57
 v_mfma_f32_32x32x16_bf16 v[80:95], a[0:3], a[176:179], v[80:95]
 v_cvt_pk_bf16_f32 v221, v58, v59
 v_cvt_pk_bf16_f32 v224, v60, v61
 v_cvt_pk_bf16_f32 v225, v62, v63
 v_permlane16_swap_b32_e64 v218, v220
 v_mfma_f32_32x32x16_bf16 v[64:79], a[4:7], v[164:167], v[64:79]
 v_permlane16_swap_b32 v219, v221
 v_permlane16_swap_b32 v222, v224
 v_permlane16_swap_b32_e64 v223, v225
 v_mfma_f32_32x32x16_bf16 v[48:63], a[120:123], v[218:221], 0
 s_nop 0
 s_nop 0
 v_mfma_f32_32x32x16_bf16 v[48:63], a[124:127], v[222:225], v[48:63]
 ds_write_b128 v226, a[128:131]
 v_mfma_f32_32x32x16_bf16 v[80:95], a[4:7], a[180:183], v[80:95]
 ds_write_b128 v226, a[132:135] offset:1024
 v_mfma_f32_32x32x16_bf16 v[64:79], a[16:19], v[176:179], v[64:79]
 ds_write_b128 v226, a[136:139] offset:2048
 ds_write_b128 v226, a[140:143] offset:3072
 v_mfma_f32_32x32x16_bf16 v[80:95], a[16:19], a[184:187], v[80:95]
 ds_write_b128 v228, a[144:147] offset:4096
 ds_write_b128 v228, a[148:151] offset:4112
 v_mfma_f32_32x32x16_bf16 v[64:79], a[20:23], v[180:183], v[64:79]
 ds_write_b128 v228, a[152:155] offset:4128
 v_mfma_f32_32x32x16_bf16 v[80:95], a[20:23], a[188:191], v[80:95]
 ds_write_b128 v228, a[156:159] offset:4144
 s_waitcnt lgkmcnt(0)
 s_barrier
 ds_read_b128 v[96:99], v227
 ds_read_b128 v[100:103], v227 offset:1024
 ds_read_b128 v[104:107], v227 offset:2048
 ds_read_b128 v[108:111], v227 offset:3072
 ds_read_b128 v[112:115], v229 offset:4096
 ds_read_b128 v[116:119], v229 offset:4112
 ds_read_b128 v[120:123], v229 offset:4128
 ds_read_b128 v[124:127], v229 offset:4144
 s_lshl_b32 s3, s68, 7
 v_lshlrev_b32 v236, 20, v255
 v_add_u32 v236, s3, v236
 v_mov_b32 v237, s3
 v_mov_b32 v252, 1
 s_waitcnt lgkmcnt(7)
 v_pk_add_f32 v[64:65], v[64:65], v[96:97]
 v_pk_add_f32 v[66:67], v[66:67], v[98:99]
 v_cvt_pk_bf16_f32 v64, v64, v65
 v_cvt_pk_bf16_f32 v65, v66, v67
 s_waitcnt lgkmcnt(6)
 s_nop 0
 v_pk_add_f32 v[68:69], v[68:69], v[100:101]
 v_pk_add_f32 v[70:71], v[70:71], v[102:103]
 v_cvt_pk_bf16_f32 v66, v68, v69
 v_cvt_pk_bf16_f32 v67, v70, v71
 buffer_store_dwordx4 v[64:67], v238, s[20:23], s70 offen sc1
 s_waitcnt lgkmcnt(5)
 s_nop 0
 v_pk_add_f32 v[72:73], v[72:73], v[104:105]
 v_pk_add_f32 v[74:75], v[74:75], v[106:107]
 v_cvt_pk_bf16_f32 v68, v72, v73
 v_cvt_pk_bf16_f32 v69, v74, v75
 s_waitcnt lgkmcnt(4)
 s_nop 0
 v_pk_add_f32 v[76:77], v[76:77], v[108:109]
 v_pk_add_f32 v[78:79], v[78:79], v[110:111]
 v_cvt_pk_bf16_f32 v70, v76, v77
 v_cvt_pk_bf16_f32 v71, v78, v79
 buffer_store_dwordx4 v[68:71], v238, s[20:23], s70 offen offset:1024 sc1
 s_waitcnt lgkmcnt(3)
 v_pk_add_f32 v[80:81], v[80:81], v[112:113]
 v_pk_add_f32 v[82:83], v[82:83], v[114:115]
 s_waitcnt lgkmcnt(2)
 v_pk_add_f32 v[84:85], v[84:85], v[116:117]
 v_pk_add_f32 v[86:87], v[86:87], v[118:119]
 v_cmp_eq_u32 vcc, 1, v230
 s_nop 1
 v_cndmask_b32 v80, v80, v84, vcc
 v_cndmask_b32 v81, v81, v85, vcc
 v_cndmask_b32 v82, v82, v86, vcc
 v_cndmask_b32_e64 v83, v83, v87, vcc
 s_waitcnt lgkmcnt(1)
 v_pk_add_f32 v[88:89], v[88:89], v[120:121]
 v_pk_add_f32 v[90:91], v[90:91], v[122:123]
 v_cmp_eq_u32 vcc, 2, v230
 s_nop 1
 v_cndmask_b32 v80, v80, v88, vcc
 v_cndmask_b32 v81, v81, v89, vcc
 v_cndmask_b32 v82, v82, v90, vcc
 v_cndmask_b32_e64 v83, v83, v91, vcc
 s_waitcnt lgkmcnt(0)
 v_pk_add_f32 v[92:93], v[92:93], v[124:125]
 v_pk_add_f32 v[94:95], v[94:95], v[126:127]
 v_cmp_eq_u32 vcc, 3, v230
 s_nop 1
 v_cndmask_b32 v80, v80, v92, vcc
 v_cndmask_b32 v81, v81, v93, vcc
 v_cndmask_b32 v82, v82, v94, vcc
 v_cndmask_b32 v83, v83, v95, vcc
 buffer_store_dwordx4 v[80:83], v239, s[92:95], s71 offen sc1
 v_max3_f32 v224, v0, v1, v2
 v_max3_f32 v230, v16, v17, v18
 v_max3_f32 v225, -v0, -v1, -v2
 v_max3_f32 v231, -v16, -v17, -v18
 v_max3_f32 v224, v224, v3, v4
 v_max3_f32 v230, v230, v19, v20
 v_max3_f32 v225, v225, -v3, -v4
 v_max3_f32 v231, v231, -v19, -v20
 v_max3_f32 v224, v224, v5, v6
 v_max3_f32 v230, v230, v21, v22
 v_max3_f32 v225, v225, -v5, -v6
 v_max3_f32 v231, v231, -v21, -v22
 v_max3_f32 v224, v224, v7, v8
 v_max3_f32 v230, v230, v23, v24
 v_max3_f32 v225, v225, -v7, -v8
 v_max3_f32 v231, v231, -v23, -v24
 v_max3_f32 v224, v224, v9, v10
 v_max3_f32 v230, v230, v25, v26
 v_max3_f32 v225, v225, -v9, -v10
 v_max3_f32 v231, v231, -v25, -v26
 v_max3_f32 v224, v224, v11, v12
 v_max3_f32 v230, v230, v27, v28
 v_max3_f32 v225, v225, -v11, -v12
 v_max3_f32 v231, v231, -v27, -v28
 v_max3_f32 v224, v224, v13, v14
 v_max3_f32 v230, v230, v29, v30
 v_max3_f32 v225, v225, -v13, -v14
 v_max3_f32 v231, v231, -v29, -v30
 v_max_f32 v224, v224, v15
 v_max_f32 v230, v230, v31
 v_max_f32_e64 v225, v225, -v15
 v_max_f32_e64 v231, v231, -v31
 v_mul_f32 v228, 0x3fb8aa3b, v248
 v_mul_f32 v234, 0x3fb8aa3b, v249
 v_permlane32_swap_b32 v224, v225
 v_permlane32_swap_b32 v230, v231
 v_max_f32 v224, v224, v225
 v_max_f32 v230, v230, v231
 v_mul_f32 v224, v228, v224
 v_mul_f32 v230, v234, v230
 v_mov_b32 v226, v224
 v_mov_b32 v232, v230
 s_nop 0
 v_permlane32_swap_b32 v224, v226
 v_permlane32_swap_b32_e64 v230, v232
 v_pk_fma_f32 v[192:193], v[0:1], v[228:229], v[224:225] op_sel_hi:[1,0,0] neg_lo:[0,0,1] neg_hi:[0,0,1]
 v_pk_fma_f32 v[208:209], v[16:17], v[234:235], v[230:231] op_sel_hi:[1,0,0] neg_lo:[0,0,1] neg_hi:[0,0,1]
 v_pk_fma_f32 v[194:195], v[2:3], v[228:229], v[224:225] op_sel_hi:[1,0,0] neg_lo:[0,0,1] neg_hi:[0,0,1]
 v_pk_fma_f32 v[210:211], v[18:19], v[234:235], v[230:231] op_sel_hi:[1,0,0] neg_lo:[0,0,1] neg_hi:[0,0,1]
 v_pk_fma_f32 v[196:197], v[4:5], v[228:229], v[224:225] op_sel_hi:[1,0,0] neg_lo:[0,0,1] neg_hi:[0,0,1]
 v_pk_fma_f32 v[212:213], v[20:21], v[234:235], v[230:231] op_sel_hi:[1,0,0] neg_lo:[0,0,1] neg_hi:[0,0,1]
 v_pk_fma_f32 v[198:199], v[6:7], v[228:229], v[224:225] op_sel_hi:[1,0,0] neg_lo:[0,0,1] neg_hi:[0,0,1]
 v_pk_fma_f32 v[214:215], v[22:23], v[234:235], v[230:231] op_sel_hi:[1,0,0] neg_lo:[0,0,1] neg_hi:[0,0,1]
 v_pk_fma_f32 v[200:201], v[8:9], v[228:229], v[224:225] op_sel_hi:[1,0,0] neg_lo:[0,0,1] neg_hi:[0,0,1]
 v_pk_fma_f32 v[216:217], v[24:25], v[234:235], v[230:231] op_sel_hi:[1,0,0] neg_lo:[0,0,1] neg_hi:[0,0,1]
 v_pk_fma_f32 v[202:203], v[10:11], v[228:229], v[224:225] op_sel_hi:[1,0,0] neg_lo:[0,0,1] neg_hi:[0,0,1]
 v_pk_fma_f32 v[218:219], v[26:27], v[234:235], v[230:231] op_sel_hi:[1,0,0] neg_lo:[0,0,1] neg_hi:[0,0,1]
 v_pk_fma_f32 v[204:205], v[12:13], v[228:229], v[224:225] op_sel_hi:[1,0,0] neg_lo:[0,0,1] neg_hi:[0,0,1]
 v_pk_fma_f32 v[220:221], v[28:29], v[234:235], v[230:231] op_sel_hi:[1,0,0] neg_lo:[0,0,1] neg_hi:[0,0,1]
 v_pk_fma_f32 v[206:207], v[14:15], v[228:229], v[224:225] op_sel_hi:[1,0,0] neg_lo:[0,0,1] neg_hi:[0,0,1]
 v_pk_fma_f32 v[222:223], v[30:31], v[234:235], v[230:231] op_sel_hi:[1,0,0] neg_lo:[0,0,1] neg_hi:[0,0,1]
 v_pk_fma_f32 v[0:1], v[0:1], v[228:229], v[226:227] op_sel_hi:[1,0,0] neg_lo:[1,0,1] neg_hi:[1,0,1]
 v_pk_fma_f32 v[16:17], v[16:17], v[234:235], v[232:233] op_sel_hi:[1,0,0] neg_lo:[1,0,1] neg_hi:[1,0,1]
 v_pk_fma_f32 v[2:3], v[2:3], v[228:229], v[226:227] op_sel_hi:[1,0,0] neg_lo:[1,0,1] neg_hi:[1,0,1]
 v_pk_fma_f32 v[18:19], v[18:19], v[234:235], v[232:233] op_sel_hi:[1,0,0] neg_lo:[1,0,1] neg_hi:[1,0,1]
 v_pk_fma_f32 v[4:5], v[4:5], v[228:229], v[226:227] op_sel_hi:[1,0,0] neg_lo:[1,0,1] neg_hi:[1,0,1]
 v_pk_fma_f32 v[20:21], v[20:21], v[234:235], v[232:233] op_sel_hi:[1,0,0] neg_lo:[1,0,1] neg_hi:[1,0,1]
 v_pk_fma_f32 v[6:7], v[6:7], v[228:229], v[226:227] op_sel_hi:[1,0,0] neg_lo:[1,0,1] neg_hi:[1,0,1]
 v_pk_fma_f32 v[22:23], v[22:23], v[234:235], v[232:233] op_sel_hi:[1,0,0] neg_lo:[1,0,1] neg_hi:[1,0,1]
 v_pk_fma_f32 v[8:9], v[8:9], v[228:229], v[226:227] op_sel_hi:[1,0,0] neg_lo:[1,0,1] neg_hi:[1,0,1]
 v_pk_fma_f32 v[24:25], v[24:25], v[234:235], v[232:233] op_sel_hi:[1,0,0] neg_lo:[1,0,1] neg_hi:[1,0,1]
 v_pk_fma_f32 v[10:11], v[10:11], v[228:229], v[226:227] op_sel_hi:[1,0,0] neg_lo:[1,0,1] neg_hi:[1,0,1]
 v_pk_fma_f32 v[26:27], v[26:27], v[234:235], v[232:233] op_sel_hi:[1,0,0] neg_lo:[1,0,1] neg_hi:[1,0,1]
 v_pk_fma_f32 v[12:13], v[12:13], v[228:229], v[226:227] op_sel_hi:[1,0,0] neg_lo:[1,0,1] neg_hi:[1,0,1]
 v_pk_fma_f32 v[28:29], v[28:29], v[234:235], v[232:233] op_sel_hi:[1,0,0] neg_lo:[1,0,1] neg_hi:[1,0,1]
 v_pk_fma_f32 v[14:15], v[14:15], v[228:229], v[226:227] op_sel_hi:[1,0,0] neg_lo:[1,0,1] neg_hi:[1,0,1]
 v_pk_fma_f32 v[30:31], v[30:31], v[234:235], v[232:233] op_sel_hi:[1,0,0] neg_lo:[1,0,1] neg_hi:[1,0,1]
 v_exp_f32 v192, v192
 v_exp_f32 v208, v208
 v_exp_f32 v193, v193
 v_exp_f32 v209, v209
 v_exp_f32 v194, v194
 v_exp_f32 v210, v210
 v_exp_f32 v195, v195
 v_exp_f32 v211, v211
 v_exp_f32 v196, v196
 v_exp_f32 v212, v212
 v_exp_f32 v197, v197
 v_exp_f32 v213, v213
 v_exp_f32 v198, v198
 v_exp_f32 v214, v214
 v_exp_f32 v199, v199
 v_exp_f32 v215, v215
 v_exp_f32 v200, v200
 v_exp_f32 v216, v216
 v_exp_f32 v201, v201
 v_exp_f32 v217, v217
 v_exp_f32 v202, v202
 v_exp_f32_e64 v218, v218
 s_waitcnt vmcnt(0)
 buffer_atomic_add v252, v236, s[76:79], 0 offen sc1
 v_exp_f32_e64 v203, v203
 s_add_u32 s4, s37, 65536
 s_and_b32 m0, s4, 0x1ffff
 s_add_u32 s35, s33, 524288
 buffer_load_dwordx4 v244, s[12:15], s35 offen lds
 v_exp_f32 v219, v219
 v_exp_f32 v204, v204
 v_exp_f32 v220, v220
 v_exp_f32 v205, v205
 v_exp_f32 v221, v221
 v_exp_f32 v206, v206
 v_exp_f32 v222, v222
 v_exp_f32 v207, v207
 v_exp_f32 v223, v223
 v_exp_f32 v0, v0
 v_exp_f32 v16, v16
 v_exp_f32 v1, v1
 v_exp_f32 v17, v17
 v_exp_f32 v2, v2
 v_exp_f32 v18, v18
 v_exp_f32 v3, v3
 v_exp_f32 v19, v19
 v_exp_f32 v4, v4
 v_exp_f32_e64 v20, v20
 buffer_load_dwordx4 v245, s[12:15], s35 offen offset:1024 lds
 v_exp_f32 v5, v5
 v_exp_f32 v21, v21
 v_exp_f32 v6, v6
 v_exp_f32 v22, v22
 v_exp_f32 v7, v7
 v_exp_f32 v23, v23
 v_exp_f32 v8, v8
 v_exp_f32 v24, v24
 v_exp_f32 v9, v9
 v_exp_f32 v25, v25
 v_exp_f32 v10, v10
 v_exp_f32 v26, v26
 v_exp_f32 v11, v11
 v_exp_f32 v27, v27
 v_exp_f32 v12, v12
 v_exp_f32 v28, v28
 v_exp_f32 v13, v13
 v_exp_f32 v29, v29
 v_exp_f32 v14, v14
 v_exp_f32 v30, v30
 buffer_load_dwordx4 v246, s[12:15], s35 offen offset:2048 lds
 v_exp_f32 v15, v15
 v_exp_f32 v31, v31
 v_pk_add_f32 v[224:225], v[192:193], v[194:195]
 v_pk_add_f32 v[230:231], v[208:209], v[210:211]
 v_pk_add_f32 v[226:227], v[0:1], v[2:3]
 v_pk_add_f32 v[232:233], v[16:17], v[18:19]
 v_pk_add_f32 v[224:225], v[224:225], v[196:197]
 v_pk_add_f32 v[230:231], v[230:231], v[212:213]
 v_pk_add_f32 v[226:227], v[226:227], v[4:5]
 v_pk_add_f32 v[232:233], v[232:233], v[20:21]
 v_pk_add_f32 v[224:225], v[224:225], v[198:199]
 v_pk_add_f32 v[230:231], v[230:231], v[214:215]
 v_pk_add_f32 v[226:227], v[226:227], v[6:7]
 v_pk_add_f32 v[232:233], v[232:233], v[22:23]
 v_pk_add_f32 v[224:225], v[224:225], v[200:201]
 v_pk_add_f32 v[230:231], v[230:231], v[216:217]
 v_pk_add_f32 v[226:227], v[226:227], v[8:9]
 v_pk_add_f32 v[232:233], v[232:233], v[24:25]
 v_pk_add_f32 v[224:225], v[224:225], v[202:203]
 buffer_load_dwordx4 v247, s[12:15], s35 offen offset:3072 lds
 v_pk_add_f32 v[230:231], v[230:231], v[218:219]
 v_pk_add_f32 v[226:227], v[226:227], v[10:11]
 v_pk_add_f32 v[232:233], v[232:233], v[26:27]
 v_pk_add_f32 v[224:225], v[224:225], v[204:205]
 v_pk_add_f32 v[230:231], v[230:231], v[220:221]
 v_pk_add_f32 v[226:227], v[226:227], v[12:13]
 v_pk_add_f32 v[232:233], v[232:233], v[28:29]
 v_pk_add_f32 v[224:225], v[224:225], v[206:207]
 v_pk_add_f32 v[230:231], v[230:231], v[222:223]
 v_pk_add_f32 v[226:227], v[226:227], v[14:15]
 v_pk_add_f32 v[232:233], v[232:233], v[30:31]
 v_add_f32 v224, v224, v225
 v_add_f32 v230, v230, v231
 v_add_f32 v226, v226, v227
 v_add_f32 v232, v232, v233
 s_nop 0
 v_permlane32_swap_b32 v224, v226
 v_permlane32_swap_b32 v230, v232
 v_add_f32 v224, v224, v226
 v_add_f32 v230, v230, v232
 v_rcp_f32 v224, v224
 s_add_u32 s4, s37, 81920
 s_and_b32 m0, s4, 0x1ffff
 s_add_u32 s35, s33, 655360
 buffer_load_dwordx4 v244, s[12:15], s35 offen lds
 v_rcp_f32 v230, v230
 v_mov_b32 v226, v224
 v_mov_b32 v232, v230
 s_nop 0
 v_permlane32_swap_b32 v224, v226
 v_permlane32_swap_b32 v230, v232
 v_pk_mul_f32 v[8:9], v[8:9], v[226:227] op_sel_hi:[1,0]
 v_pk_mul_f32 v[24:25], v[24:25], v[232:233] op_sel_hi:[1,0]
 v_pk_mul_f32 v[10:11], v[10:11], v[226:227] op_sel_hi:[1,0]
 v_pk_mul_f32 v[26:27], v[26:27], v[232:233] op_sel_hi:[1,0]
 v_pk_mul_f32 v[12:13], v[12:13], v[226:227] op_sel_hi:[1,0]
 v_pk_mul_f32 v[28:29], v[28:29], v[232:233] op_sel_hi:[1,0]
 v_pk_mul_f32 v[14:15], v[14:15], v[226:227] op_sel_hi:[1,0]
 v_pk_mul_f32 v[30:31], v[30:31], v[232:233] op_sel_hi:[1,0]
 v_cvt_pk_bf16_f32 v15, v14, v15
 v_cvt_pk_bf16_f32 v31, v30, v31
 v_cvt_pk_bf16_f32 v14, v12, v13
 v_cvt_pk_bf16_f32 v30, v28, v29
 v_cvt_pk_bf16_f32 v13, v10, v11
 v_cvt_pk_bf16_f32 v29, v26, v27
 buffer_load_dword v252, v237, s[76:79], 0 offen sc1
 v_cvt_pk_bf16_f32 v12, v8, v9
 buffer_load_dwordx4 v245, s[12:15], s35 offen offset:1024 lds
 v_cvt_pk_bf16_f32 v28, v24, v25
 v_pk_mul_f32 v[0:1], v[0:1], v[226:227] op_sel_hi:[1,0]
 v_pk_mul_f32 v[16:17], v[16:17], v[232:233] op_sel_hi:[1,0]
 v_pk_mul_f32 v[2:3], v[2:3], v[226:227] op_sel_hi:[1,0]
 v_pk_mul_f32 v[18:19], v[18:19], v[232:233] op_sel_hi:[1,0]
 v_pk_mul_f32 v[4:5], v[4:5], v[226:227] op_sel_hi:[1,0]
 v_pk_mul_f32 v[20:21], v[20:21], v[232:233] op_sel_hi:[1,0]
 v_pk_mul_f32 v[6:7], v[6:7], v[226:227] op_sel_hi:[1,0]
 v_pk_mul_f32 v[22:23], v[22:23], v[232:233] op_sel_hi:[1,0]
 v_cvt_pk_bf16_f32 v11, v6, v7
 v_cvt_pk_bf16_f32 v27, v22, v23
 v_cvt_pk_bf16_f32 v10, v4, v5
 v_cvt_pk_bf16_f32 v26, v20, v21
 v_cvt_pk_bf16_f32 v9, v2, v3
 buffer_load_dwordx4 v246, s[12:15], s35 offen offset:2048 lds
 v_cvt_pk_bf16_f32 v25, v18, v19
 v_cvt_pk_bf16_f32 v8, v0, v1
 v_cvt_pk_bf16_f32 v24, v16, v17
 v_pk_mul_f32 v[192:193], v[192:193], v[224:225] op_sel_hi:[1,0]
 v_pk_mul_f32 v[208:209], v[208:209], v[230:231] op_sel_hi:[1,0]
 v_pk_mul_f32 v[194:195], v[194:195], v[224:225] op_sel_hi:[1,0]
 v_pk_mul_f32 v[210:211], v[210:211], v[230:231] op_sel_hi:[1,0]
 v_pk_mul_f32 v[196:197], v[196:197], v[224:225] op_sel_hi:[1,0]
 v_pk_mul_f32 v[212:213], v[212:213], v[230:231] op_sel_hi:[1,0]
 v_pk_mul_f32 v[198:199], v[198:199], v[224:225] op_sel_hi:[1,0]
 v_pk_mul_f32 v[214:215], v[214:215], v[230:231] op_sel_hi:[1,0]
 v_cvt_pk_bf16_f32 v0, v192, v193
 v_cvt_pk_bf16_f32 v16, v208, v209
 v_cvt_pk_bf16_f32 v1, v194, v195
 buffer_load_dwordx4 v247, s[12:15], s35 offen offset:3072 lds
 v_cvt_pk_bf16_f32 v17, v210, v211
 v_cvt_pk_bf16_f32 v2, v196, v197
 v_cvt_pk_bf16_f32 v18, v212, v213
 v_cvt_pk_bf16_f32 v3, v198, v199
 v_cvt_pk_bf16_f32 v19, v214, v215
 v_pk_mul_f32 v[200:201], v[200:201], v[224:225] op_sel_hi:[1,0]
 v_pk_mul_f32 v[216:217], v[216:217], v[230:231] op_sel_hi:[1,0]
 v_pk_mul_f32 v[202:203], v[202:203], v[224:225] op_sel_hi:[1,0]
 v_pk_mul_f32 v[218:219], v[218:219], v[230:231] op_sel_hi:[1,0]
 v_pk_mul_f32 v[204:205], v[204:205], v[224:225] op_sel_hi:[1,0]
 v_pk_mul_f32 v[220:221], v[220:221], v[230:231] op_sel_hi:[1,0]
 v_pk_mul_f32 v[206:207], v[206:207], v[224:225] op_sel_hi:[1,0]
 v_pk_mul_f32 v[222:223], v[222:223], v[230:231] op_sel_hi:[1,0]
 v_cvt_pk_bf16_f32 v4, v200, v201
 s_add_u32 s4, s37, 98304
 s_and_b32 m0, s4, 0x1ffff
 s_add_u32 s35, s33, 786432
 buffer_load_dwordx4 v244, s[12:15], s35 offen lds
 v_cvt_pk_bf16_f32 v20, v216, v217
 v_cvt_pk_bf16_f32 v5, v202, v203
 v_cvt_pk_bf16_f32 v21, v218, v219
 v_cvt_pk_bf16_f32 v6, v204, v205
 v_cvt_pk_bf16_f32 v22, v220, v221
 v_cvt_pk_bf16_f32 v7, v206, v207
 v_cvt_pk_bf16_f32 v23, v222, v223
 v_max3_f32 v224, v32, v33, v34
 v_max3_f32 v230, v48, v49, v50
 v_max3_f32 v225, -v32, -v33, -v34
 v_max3_f32 v231, -v48, -v49, -v50
 v_max3_f32 v224, v224, v35, v36
 v_max3_f32 v230, v230, v51, v52
 v_max3_f32 v225, v225, -v35, -v36
 buffer_load_dwordx4 v245, s[12:15], s35 offen offset:1024 lds
 v_max3_f32 v231, v231, -v51, -v52
 v_max3_f32 v224, v224, v37, v38
 v_max3_f32 v230, v230, v53, v54
 v_max3_f32 v225, v225, -v37, -v38
 v_max3_f32 v231, v231, -v53, -v54
 v_max3_f32 v224, v224, v39, v40
 v_max3_f32 v230, v230, v55, v56
 v_max3_f32 v225, v225, -v39, -v40
 v_max3_f32 v231, v231, -v55, -v56
 v_max3_f32 v224, v224, v41, v42
 v_max3_f32 v230, v230, v57, v58
 v_max3_f32 v225, v225, -v41, -v42
 v_max3_f32 v231, v231, -v57, -v58
 v_max3_f32 v224, v224, v43, v44
 v_max3_f32 v230, v230, v59, v60
 v_max3_f32 v225, v225, -v43, -v44
 v_max3_f32 v231, v231, -v59, -v60
 v_max3_f32 v224, v224, v45, v46
 v_max3_f32 v230, v230, v61, v62
 v_max3_f32 v225, v225, -v45, -v46
 v_max3_f32 v231, v231, -v61, -v62
 v_max_f32 v224, v224, v47
 v_max_f32 v230, v230, v63
 v_max_f32_e64 v225, v225, -v47
 v_max_f32_e64 v231, v231, -v63
 v_mul_f32 v228, 0x3fb8aa3b, v250
 v_mul_f32 v234, 0x3fb8aa3b, v251
 v_permlane32_swap_b32 v224, v225
 v_permlane32_swap_b32 v230, v231
 v_max_f32 v224, v224, v225
 v_max_f32 v230, v230, v231
 v_mul_f32 v224, v228, v224
 s_waitcnt vmcnt(0)
 v_readfirstlane_b32 s3, v252
 s_nop 0
 s_cmp_lt_u32 s3, 8
 s_cbranch_scc1 L1q_pp
L1q_ppr:
 v_mul_f32 v230, v234, v230
 s_lshl_b32 s70, s68, 14
 v_mov_b32 v226, v224
 v_mov_b32 v232, v230
 s_nop 0
 v_permlane32_swap_b32 v224, v226
 v_permlane32_swap_b32_e64 v230, v232
 v_pk_fma_f32 v[192:193], v[32:33], v[228:229], v[224:225] op_sel_hi:[1,0,0] neg_lo:[0,0,1] neg_hi:[0,0,1]
 v_pk_fma_f32 v[208:209], v[48:49], v[234:235], v[230:231] op_sel_hi:[1,0,0] neg_lo:[0,0,1] neg_hi:[0,0,1]
 s_lshl_b32 s71, s68, 10
 s_nop 0
 v_pk_fma_f32 v[194:195], v[34:35], v[228:229], v[224:225] op_sel_hi:[1,0,0] neg_lo:[0,0,1] neg_hi:[0,0,1]
 v_pk_fma_f32 v[210:211], v[50:51], v[234:235], v[230:231] op_sel_hi:[1,0,0] neg_lo:[0,0,1] neg_hi:[0,0,1]
 v_pk_fma_f32 v[196:197], v[36:37], v[228:229], v[224:225] op_sel_hi:[1,0,0] neg_lo:[0,0,1] neg_hi:[0,0,1]
 v_pk_fma_f32 v[212:213], v[52:53], v[234:235], v[230:231] op_sel_hi:[1,0,0] neg_lo:[0,0,1] neg_hi:[0,0,1]
 v_pk_fma_f32 v[198:199], v[38:39], v[228:229], v[224:225] op_sel_hi:[1,0,0] neg_lo:[0,0,1] neg_hi:[0,0,1]
 v_pk_fma_f32 v[214:215], v[54:55], v[234:235], v[230:231] op_sel_hi:[1,0,0] neg_lo:[0,0,1] neg_hi:[0,0,1]
 v_pk_fma_f32 v[200:201], v[40:41], v[228:229], v[224:225] op_sel_hi:[1,0,0] neg_lo:[0,0,1] neg_hi:[0,0,1]
 buffer_load_dwordx4 v[240:243], v238, s[92:95], s71 offen sc1
 v_pk_fma_f32 v[216:217], v[56:57], v[234:235], v[230:231] op_sel_hi:[1,0,0] neg_lo:[0,0,1] neg_hi:[0,0,1]
 v_pk_fma_f32 v[202:203], v[42:43], v[228:229], v[224:225] op_sel_hi:[1,0,0] neg_lo:[0,0,1] neg_hi:[0,0,1]
 v_pk_fma_f32 v[218:219], v[58:59], v[234:235], v[230:231] op_sel_hi:[1,0,0] neg_lo:[0,0,1] neg_hi:[0,0,1]
 v_pk_fma_f32 v[204:205], v[44:45], v[228:229], v[224:225] op_sel_hi:[1,0,0] neg_lo:[0,0,1] neg_hi:[0,0,1]
 v_pk_fma_f32 v[220:221], v[60:61], v[234:235], v[230:231] op_sel_hi:[1,0,0] neg_lo:[0,0,1] neg_hi:[0,0,1]
 v_pk_fma_f32 v[206:207], v[46:47], v[228:229], v[224:225] op_sel_hi:[1,0,0] neg_lo:[0,0,1] neg_hi:[0,0,1]
 buffer_load_dwordx4 v[128:131], v238, s[20:23], s70 offen sc1
 v_pk_fma_f32 v[222:223], v[62:63], v[234:235], v[230:231] op_sel_hi:[1,0,0] neg_lo:[0,0,1] neg_hi:[0,0,1]
 v_pk_fma_f32 v[32:33], v[32:33], v[228:229], v[226:227] op_sel_hi:[1,0,0] neg_lo:[1,0,1] neg_hi:[1,0,1]
 v_pk_fma_f32 v[48:49], v[48:49], v[234:235], v[232:233] op_sel_hi:[1,0,0] neg_lo:[1,0,1] neg_hi:[1,0,1]
 v_pk_fma_f32 v[34:35], v[34:35], v[228:229], v[226:227] op_sel_hi:[1,0,0] neg_lo:[1,0,1] neg_hi:[1,0,1]
 v_pk_fma_f32 v[50:51], v[50:51], v[234:235], v[232:233] op_sel_hi:[1,0,0] neg_lo:[1,0,1] neg_hi:[1,0,1]
 v_pk_fma_f32 v[36:37], v[36:37], v[228:229], v[226:227] op_sel_hi:[1,0,0] neg_lo:[1,0,1] neg_hi:[1,0,1]
 v_pk_fma_f32 v[52:53], v[52:53], v[234:235], v[232:233] op_sel_hi:[1,0,0] neg_lo:[1,0,1] neg_hi:[1,0,1]
 buffer_load_dwordx4 v[132:135], v238, s[20:23], s70 offen offset:1024 sc1
 v_pk_fma_f32 v[38:39], v[38:39], v[228:229], v[226:227] op_sel_hi:[1,0,0] neg_lo:[1,0,1] neg_hi:[1,0,1]
 v_pk_fma_f32 v[54:55], v[54:55], v[234:235], v[232:233] op_sel_hi:[1,0,0] neg_lo:[1,0,1] neg_hi:[1,0,1]
 v_pk_fma_f32 v[40:41], v[40:41], v[228:229], v[226:227] op_sel_hi:[1,0,0] neg_lo:[1,0,1] neg_hi:[1,0,1]
 v_pk_fma_f32 v[56:57], v[56:57], v[234:235], v[232:233] op_sel_hi:[1,0,0] neg_lo:[1,0,1] neg_hi:[1,0,1]
 v_pk_fma_f32 v[42:43], v[42:43], v[228:229], v[226:227] op_sel_hi:[1,0,0] neg_lo:[1,0,1] neg_hi:[1,0,1]
 v_pk_fma_f32 v[58:59], v[58:59], v[234:235], v[232:233] op_sel_hi:[1,0,0] neg_lo:[1,0,1] neg_hi:[1,0,1]
 buffer_load_dwordx4 v[136:139], v238, s[20:23], s70 offen offset:2048 sc1
 v_pk_fma_f32 v[44:45], v[44:45], v[228:229], v[226:227] op_sel_hi:[1,0,0] neg_lo:[1,0,1] neg_hi:[1,0,1]
 v_pk_fma_f32 v[60:61], v[60:61], v[234:235], v[232:233] op_sel_hi:[1,0,0] neg_lo:[1,0,1] neg_hi:[1,0,1]
 v_pk_fma_f32 v[46:47], v[46:47], v[228:229], v[226:227] op_sel_hi:[1,0,0] neg_lo:[1,0,1] neg_hi:[1,0,1]
 v_pk_fma_f32 v[62:63], v[62:63], v[234:235], v[232:233] op_sel_hi:[1,0,0] neg_lo:[1,0,1] neg_hi:[1,0,1]
 v_exp_f32 v192, v192
 v_exp_f32 v208, v208
 v_exp_f32_e64 v193, v193
 buffer_load_dwordx4 v[140:143], v238, s[20:23], s70 offen offset:3072 sc1
 v_exp_f32 v209, v209
 v_exp_f32 v194, v194
 v_exp_f32 v210, v210
 v_exp_f32 v195, v195
 v_exp_f32 v211, v211
 v_exp_f32 v196, v196
 s_add_u32 s70, s70, 4096
 v_exp_f32 v212, v212
 v_exp_f32 v197, v197
 v_exp_f32 v213, v213
 v_exp_f32 v198, v198
 v_exp_f32 v214, v214
 v_exp_f32 v199, v199
 v_exp_f32_e64 v215, v215
 buffer_load_dwordx4 v[144:147], v238, s[20:23], s70 offen sc1
 v_exp_f32 v200, v200
 v_exp_f32 v216, v216
 v_exp_f32 v201, v201
 v_exp_f32 v217, v217
 v_exp_f32 v202, v202
 v_exp_f32 v218, v218
 buffer_load_dwordx4 v[148:151], v238, s[20:23], s70 offen offset:1024 sc1
 v_exp_f32 v203, v203
 v_exp_f32 v219, v219
 v_exp_f32 v204, v204
 v_exp_f32 v220, v220
 v_exp_f32 v205, v205
 v_exp_f32 v221, v221
 v_exp_f32_e64 v206, v206
 buffer_load_dwordx4 v[152:155], v238, s[20:23], s70 offen offset:2048 sc1
 v_exp_f32 v222, v222
 v_exp_f32 v207, v207
 v_exp_f32 v223, v223
 v_exp_f32 v32, v32
 v_exp_f32 v48, v48
 v_exp_f32 v33, v33
 v_exp_f32_e64 v49, v49
 buffer_load_dwordx4 v[156:159], v238, s[20:23], s70 offen offset:3072 sc1
 v_exp_f32 v34, v34
 v_exp_f32 v50, v50
 v_exp_f32 v35, v35
 v_exp_f32 v51, v51
 v_exp_f32 v36, v36
 v_exp_f32 v52, v52
 s_add_u32 s70, s70, 4096
 v_exp_f32 v37, v37
 v_exp_f32 v53, v53
 v_exp_f32 v38, v38
 v_exp_f32 v54, v54
 v_exp_f32 v39, v39
 v_exp_f32 v55, v55
 v_exp_f32_e64 v40, v40
 buffer_load_dwordx4 v[160:163], v238, s[20:23], s70 offen sc1
 v_exp_f32 v56, v56
 v_exp_f32 v41, v41
 v_exp_f32 v57, v57
 v_exp_f32 v42, v42
 v_exp_f32 v58, v58
 v_exp_f32 v43, v43
 buffer_load_dwordx4 v[164:167], v238, s[20:23], s70 offen offset:1024 sc1
 v_exp_f32 v59, v59
 v_exp_f32 v44, v44
 v_exp_f32 v60, v60
 v_exp_f32 v45, v45
 v_exp_f32 v61, v61
 v_exp_f32 v46, v46
 v_exp_f32_e64 v62, v62
 buffer_load_dwordx4 v[168:171], v238, s[20:23], s70 offen offset:2048 sc1
 v_exp_f32 v47, v47
 v_exp_f32 v63, v63
 v_pk_add_f32 v[224:225], v[192:193], v[194:195]
 v_pk_add_f32 v[230:231], v[208:209], v[210:211]
 v_pk_add_f32 v[226:227], v[32:33], v[34:35]
 v_pk_add_f32 v[232:233], v[48:49], v[50:51]
 buffer_load_dwordx4 v[172:175], v238, s[20:23], s70 offen offset:3072 sc1
 v_pk_add_f32 v[224:225], v[224:225], v[196:197]
 v_pk_add_f32 v[230:231], v[230:231], v[212:213]
 v_pk_add_f32 v[226:227], v[226:227], v[36:37]
 v_pk_add_f32 v[232:233], v[232:233], v[52:53]
 v_pk_add_f32 v[224:225], v[224:225], v[198:199]
 v_pk_add_f32 v[230:231], v[230:231], v[214:215]
 v_pk_add_f32 v[226:227], v[226:227], v[38:39]
 s_add_u32 s70, s70, 4096
 v_pk_add_f32 v[232:233], v[232:233], v[54:55]
 v_pk_add_f32 v[224:225], v[224:225], v[200:201]
 v_pk_add_f32 v[230:231], v[230:231], v[216:217]
 v_pk_add_f32 v[226:227], v[226:227], v[40:41]
 v_pk_add_f32 v[232:233], v[232:233], v[56:57]
 v_pk_add_f32 v[224:225], v[224:225], v[202:203]
 buffer_load_dwordx4 v[176:179], v238, s[20:23], s70 offen sc1
 v_pk_add_f32 v[230:231], v[230:231], v[218:219]
 v_pk_add_f32 v[226:227], v[226:227], v[42:43]
 v_pk_add_f32 v[232:233], v[232:233], v[58:59]
 v_pk_add_f32 v[224:225], v[224:225], v[204:205]
 v_pk_add_f32 v[230:231], v[230:231], v[220:221]
 v_pk_add_f32 v[226:227], v[226:227], v[44:45]
 v_pk_add_f32 v[232:233], v[232:233], v[60:61]
 buffer_load_dwordx4 v[180:183], v238, s[20:23], s70 offen offset:1024 sc1
 v_pk_add_f32 v[224:225], v[224:225], v[206:207]
 v_pk_add_f32 v[230:231], v[230:231], v[222:223]
 v_pk_add_f32 v[226:227], v[226:227], v[46:47]
 v_pk_add_f32 v[232:233], v[232:233], v[62:63]
 v_add_f32 v224, v224, v225
 v_add_f32 v230, v230, v231
 buffer_load_dwordx4 v[184:187], v238, s[20:23], s70 offen offset:2048 sc1
 v_add_f32 v226, v226, v227
 v_add_f32 v232, v232, v233
 s_nop 0
 v_permlane32_swap_b32 v224, v226
 v_permlane32_swap_b32 v230, v232
 v_add_f32 v224, v224, v226
 v_add_f32 v230, v230, v232
 v_rcp_f32 v224, v224
 buffer_load_dwordx4 v[188:191], v238, s[20:23], s70 offen offset:3072 sc1
 v_rcp_f32 v230, v230
 v_mov_b32 v226, v224
 v_mov_b32 v232, v230
 s_nop 0
 v_permlane32_swap_b32 v224, v226
 v_permlane32_swap_b32 v230, v232
 v_pk_mul_f32 v[40:41], v[40:41], v[226:227] op_sel_hi:[1,0]
 v_pk_mul_f32 v[56:57], v[56:57], v[232:233] op_sel_hi:[1,0]
 v_pk_mul_f32 v[42:43], v[42:43], v[226:227] op_sel_hi:[1,0]
 v_pk_mul_f32 v[58:59], v[58:59], v[232:233] op_sel_hi:[1,0]
 v_pk_mul_f32 v[44:45], v[44:45], v[226:227] op_sel_hi:[1,0]
 v_pk_mul_f32 v[60:61], v[60:61], v[232:233] op_sel_hi:[1,0]
 v_pk_mul_f32 v[46:47], v[46:47], v[226:227] op_sel_hi:[1,0]
 v_pk_mul_f32 v[62:63], v[62:63], v[232:233] op_sel_hi:[1,0]
 v_cvt_pk_bf16_f32 v47, v46, v47
 v_cvt_pk_bf16_f32 v63, v62, v63
 v_cvt_pk_bf16_f32 v46, v44, v45
 v_cvt_pk_bf16_f32 v62, v60, v61
 v_cvt_pk_bf16_f32 v45, v42, v43
 v_cvt_pk_bf16_f32 v61, v58, v59
 v_cvt_pk_bf16_f32 v44, v40, v41
 v_cvt_pk_bf16_f32 v60, v56, v57
 v_pk_mul_f32 v[32:33], v[32:33], v[226:227] op_sel_hi:[1,0]
 v_pk_mul_f32 v[48:49], v[48:49], v[232:233] op_sel_hi:[1,0]
 v_pk_mul_f32 v[34:35], v[34:35], v[226:227] op_sel_hi:[1,0]
 v_pk_mul_f32 v[50:51], v[50:51], v[232:233] op_sel_hi:[1,0]
 v_pk_mul_f32 v[36:37], v[36:37], v[226:227] op_sel_hi:[1,0]
 v_pk_mul_f32 v[52:53], v[52:53], v[232:233] op_sel_hi:[1,0]
 v_pk_mul_f32 v[38:39], v[38:39], v[226:227] op_sel_hi:[1,0]
 v_pk_mul_f32 v[54:55], v[54:55], v[232:233] op_sel_hi:[1,0]
 v_cvt_pk_bf16_f32 v43, v38, v39
 v_cvt_pk_bf16_f32 v59, v54, v55
 v_cvt_pk_bf16_f32 v42, v36, v37
 v_cvt_pk_bf16_f32 v58, v52, v53
 v_cvt_pk_bf16_f32 v41, v34, v35
 v_cvt_pk_bf16_f32 v57, v50, v51
 v_cvt_pk_bf16_f32 v40, v32, v33
 v_cvt_pk_bf16_f32 v56, v48, v49
 v_pk_mul_f32 v[192:193], v[192:193], v[224:225] op_sel_hi:[1,0]
 v_pk_mul_f32 v[208:209], v[208:209], v[230:231] op_sel_hi:[1,0]
 v_pk_mul_f32 v[194:195], v[194:195], v[224:225] op_sel_hi:[1,0]
 v_pk_mul_f32 v[210:211], v[210:211], v[230:231] op_sel_hi:[1,0]
 v_pk_mul_f32 v[196:197], v[196:197], v[224:225] op_sel_hi:[1,0]
 v_pk_mul_f32 v[212:213], v[212:213], v[230:231] op_sel_hi:[1,0]
 v_pk_mul_f32 v[198:199], v[198:199], v[224:225] op_sel_hi:[1,0]
 v_pk_mul_f32 v[214:215], v[214:215], v[230:231] op_sel_hi:[1,0]
 v_cvt_pk_bf16_f32 v32, v192, v193
 v_cvt_pk_bf16_f32 v48, v208, v209
 v_cvt_pk_bf16_f32 v33, v194, v195
 v_cvt_pk_bf16_f32 v49, v210, v211
 v_cvt_pk_bf16_f32 v34, v196, v197
 v_cvt_pk_bf16_f32 v50, v212, v213
 v_cvt_pk_bf16_f32 v35, v198, v199
 v_cvt_pk_bf16_f32 v51, v214, v215
 v_pk_mul_f32 v[200:201], v[200:201], v[224:225] op_sel_hi:[1,0]
 v_pk_mul_f32 v[216:217], v[216:217], v[230:231] op_sel_hi:[1,0]
 v_pk_mul_f32 v[202:203], v[202:203], v[224:225] op_sel_hi:[1,0]
 v_pk_mul_f32 v[218:219], v[218:219], v[230:231] op_sel_hi:[1,0]
 v_pk_mul_f32 v[204:205], v[204:205], v[224:225] op_sel_hi:[1,0]
 v_pk_mul_f32 v[220:221], v[220:221], v[230:231] op_sel_hi:[1,0]
 v_pk_mul_f32 v[206:207], v[206:207], v[224:225] op_sel_hi:[1,0]
 v_pk_mul_f32 v[222:223], v[222:223], v[230:231] op_sel_hi:[1,0]
 v_cvt_pk_bf16_f32 v36, v200, v201
 v_cvt_pk_bf16_f32 v52, v216, v217
 v_cvt_pk_bf16_f32 v37, v202, v203
 v_cvt_pk_bf16_f32 v53, v218, v219
 v_cvt_pk_bf16_f32 v38, v204, v205
 v_cvt_pk_bf16_f32 v54, v220, v221
 v_cvt_pk_bf16_f32 v39, v206, v207
 v_cvt_pk_bf16_f32 v55, v222, v223
 s_mul_i32 s3, s30, 4352
 s_add_u32 s3, s3, 148480
 s_lshl_b32 s69, s29, 11
 s_add_u32 s69, s69, s3
 v_add_u32 v224, s69, v238
 v_add_u32 v225, s3, v238
 s_lshl_b32 s69, s29, 6
 s_add_u32 s69, s69, s3
 s_add_u32 s69, s69, 4096
 v_and_b32 v226, 7, v255
 v_lshlrev_b32 v226, 3, v226
 v_add_u32 v226, s69, v226
 v_lshrrev_b32 v227, 5, v255
 v_lshlrev_b32_e64 v227, 5, v227
 s_add_u32 s3, s3, 4096
 v_add_u32_e64 v227, s3, v227
 s_mov_b32 s46, 0x3f80
 s_mov_b32 s47, 0x3f800000
 s_waitcnt vmcnt(16)
 v_add_f32_dpp v240, v240, v240 row_ror:8 row_mask:0xf bank_mask:0xf
 v_add_f32_dpp v241, v241, v241 row_ror:8 row_mask:0xf bank_mask:0xf
 v_add_f32_dpp v242, v242, v242 row_ror:8 row_mask:0xf bank_mask:0xf
 v_add_f32_dpp v243, v243, v243 row_ror:8 row_mask:0xf bank_mask:0xf
 v_mov_b32 v192, v240
 v_mov_b32 v193, v241
 v_mov_b32 v194, v242
 v_mov_b32 v195, v243
 v_permlane16_swap_b32 v240, v192
 v_permlane16_swap_b32 v241, v193
 v_permlane16_swap_b32 v242, v194
 v_permlane16_swap_b32 v243, v195
 v_add_f32 v240, v240, v192
 v_add_f32 v241, v241, v193
 v_add_f32 v242, v242, v194
 v_add_f32 v243, v243, v195
 v_mov_b32 v192, v240
 v_mov_b32 v193, v241
 v_mov_b32 v194, v242
 v_mov_b32 v195, v243
 v_permlane32_swap_b32 v240, v192
 v_permlane32_swap_b32 v241, v193
 v_permlane32_swap_b32 v242, v194
 v_permlane32_swap_b32 v243, v195
 v_add_f32 v240, v240, v192
 v_add_f32 v241, v241, v193
 v_add_f32 v242, v242, v194
 v_add_f32 v243, v243, v195
 v_cvt_pk_bf16_f32 v240, v240, v241
 v_cvt_pk_bf16_f32 v241, v242, v243
 ds_write_b64 v226, v[240:241]
 s_waitcnt vmcnt(14)
 v_lshlrev_b32 v64, 16, v128
 v_and_b32 v65, 0xffff0000, v128
 v_lshlrev_b32_e64 v66, 16, v129
 v_and_b32 v67, 0xffff0000, v129
 v_lshlrev_b32_e64 v68, 16, v130
 v_and_b32 v69, 0xffff0000, v130
 v_lshlrev_b32_e64 v70, 16, v131
 v_and_b32 v71, 0xffff0000, v131
 v_lshlrev_b32_e64 v72, 16, v132
 v_and_b32 v73, 0xffff0000, v132
 v_lshlrev_b32_e64 v74, 16, v133
 v_and_b32 v75, 0xffff0000, v133
 v_lshlrev_b32_e64 v76, 16, v134
 v_and_b32 v77, 0xffff0000, v134
 v_lshlrev_b32_e64 v78, 16, v135
 v_and_b32 v79, 0xffff0000, v135
 s_waitcnt vmcnt(12)
 v_dot2c_f32_bf16 v64, s46, v136
 v_dot2c_f32_bf16 v65, s47, v136
 v_dot2c_f32_bf16 v66, s46, v137
 v_dot2c_f32_bf16 v67, s47, v137
 v_dot2c_f32_bf16 v68, s46, v138
 v_dot2c_f32_bf16 v69, s47, v138
 v_dot2c_f32_bf16 v70, s46, v139
 v_dot2c_f32_bf16 v71, s47, v139
 v_dot2c_f32_bf16 v72, s46, v140
 v_dot2c_f32_bf16 v73, s47, v140
 v_dot2c_f32_bf16 v74, s46, v141
 v_dot2c_f32_bf16 v75, s47, v141
 v_dot2c_f32_bf16 v76, s46, v142
 v_dot2c_f32_bf16 v77, s47, v142
 v_dot2c_f32_bf16 v78, s46, v143
 v_dot2c_f32_bf16 v79, s47, v143
 s_waitcnt vmcnt(10)
 v_dot2c_f32_bf16 v64, s46, v144
 v_dot2c_f32_bf16 v65, s47, v144
 v_dot2c_f32_bf16 v66, s46, v145
 v_dot2c_f32_bf16 v67, s47, v145
 v_dot2c_f32_bf16 v68, s46, v146
 v_dot2c_f32_bf16 v69, s47, v146
 v_dot2c_f32_bf16 v70, s46, v147
 v_dot2c_f32_bf16 v71, s47, v147
 v_dot2c_f32_bf16 v72, s46, v148
 v_dot2c_f32_bf16 v73, s47, v148
 v_dot2c_f32_bf16 v74, s46, v149
 v_dot2c_f32_bf16 v75, s47, v149
 v_dot2c_f32_bf16 v76, s46, v150
 v_dot2c_f32_bf16 v77, s47, v150
 v_dot2c_f32_bf16 v78, s46, v151
 v_dot2c_f32_bf16 v79, s47, v151
 s_waitcnt vmcnt(8)
 v_dot2c_f32_bf16 v64, s46, v152
 v_dot2c_f32_bf16 v65, s47, v152
 v_dot2c_f32_bf16 v66, s46, v153
 v_dot2c_f32_bf16 v67, s47, v153
 v_dot2c_f32_bf16 v68, s46, v154
 v_dot2c_f32_bf16 v69, s47, v154
 v_dot2c_f32_bf16 v70, s46, v155
 v_dot2c_f32_bf16 v71, s47, v155
 v_dot2c_f32_bf16 v72, s46, v156
 v_dot2c_f32_bf16 v73, s47, v156
 v_dot2c_f32_bf16 v74, s46, v157
 v_dot2c_f32_bf16 v75, s47, v157
 v_dot2c_f32_bf16 v76, s46, v158
 v_dot2c_f32_bf16 v77, s47, v158
 v_dot2c_f32_bf16 v78, s46, v159
 v_dot2c_f32_bf16 v79, s47, v159
 s_waitcnt vmcnt(6)
 v_dot2c_f32_bf16 v64, s46, v160
 v_dot2c_f32_bf16 v65, s47, v160
 v_dot2c_f32_bf16 v66, s46, v161
 v_dot2c_f32_bf16 v67, s47, v161
 v_dot2c_f32_bf16 v68, s46, v162
 v_dot2c_f32_bf16 v69, s47, v162
 v_dot2c_f32_bf16 v70, s46, v163
 v_dot2c_f32_bf16 v71, s47, v163
 v_dot2c_f32_bf16 v72, s46, v164
 v_dot2c_f32_bf16 v73, s47, v164
 v_dot2c_f32_bf16 v74, s46, v165
 v_dot2c_f32_bf16 v75, s47, v165
 v_dot2c_f32_bf16 v76, s46, v166
 v_dot2c_f32_bf16 v77, s47, v166
 v_dot2c_f32_bf16 v78, s46, v167
 v_dot2c_f32_bf16 v79, s47, v167
 s_waitcnt vmcnt(4)
 v_dot2c_f32_bf16 v64, s46, v168
 v_dot2c_f32_bf16 v65, s47, v168
 v_dot2c_f32_bf16 v66, s46, v169
 v_dot2c_f32_bf16 v67, s47, v169
 v_dot2c_f32_bf16 v68, s46, v170
 v_dot2c_f32_bf16 v69, s47, v170
 v_dot2c_f32_bf16 v70, s46, v171
 v_dot2c_f32_bf16 v71, s47, v171
 v_dot2c_f32_bf16 v72, s46, v172
 v_dot2c_f32_bf16 v73, s47, v172
 v_dot2c_f32_bf16 v74, s46, v173
 v_dot2c_f32_bf16 v75, s47, v173
 v_dot2c_f32_bf16 v76, s46, v174
 v_dot2c_f32_bf16 v77, s47, v174
 v_dot2c_f32_bf16 v78, s46, v175
 v_dot2c_f32_bf16 v79, s47, v175
 s_waitcnt vmcnt(2)
 v_dot2c_f32_bf16 v64, s46, v176
 v_dot2c_f32_bf16 v65, s47, v176
 v_dot2c_f32_bf16 v66, s46, v177
 v_dot2c_f32_bf16 v67, s47, v177
 v_dot2c_f32_bf16 v68, s46, v178
 v_dot2c_f32_bf16 v69, s47, v178
 v_dot2c_f32_bf16 v70, s46, v179
 v_dot2c_f32_bf16 v71, s47, v179
 v_dot2c_f32_bf16 v72, s46, v180
 v_dot2c_f32_bf16 v73, s47, v180
 v_dot2c_f32_bf16 v74, s46, v181
 v_dot2c_f32_bf16 v75, s47, v181
 v_dot2c_f32_bf16 v76, s46, v182
 v_dot2c_f32_bf16 v77, s47, v182
 v_dot2c_f32_bf16 v78, s46, v183
 v_dot2c_f32_bf16 v79, s47, v183
 s_waitcnt vmcnt(0)
 v_dot2c_f32_bf16 v64, s46, v184
 v_dot2c_f32_bf16 v65, s47, v184
 v_dot2c_f32_bf16 v66, s46, v185
 v_dot2c_f32_bf16 v67, s47, v185
 v_dot2c_f32_bf16 v68, s46, v186
 v_dot2c_f32_bf16 v69, s47, v186
 v_dot2c_f32_bf16 v70, s46, v187
 v_dot2c_f32_bf16 v71, s47, v187
 v_dot2c_f32_bf16 v72, s46, v188
 v_dot2c_f32_bf16 v73, s47, v188
 v_dot2c_f32_bf16 v74, s46, v189
 v_dot2c_f32_bf16 v75, s47, v189
 v_dot2c_f32_bf16 v76, s46, v190
 v_dot2c_f32_bf16 v77, s47, v190
 v_dot2c_f32_bf16 v78, s46, v191
 v_dot2c_f32_bf16 v79, s47, v191
 s_lshl_b32 s3, s40, 2
 s_add_u32 s3, s3, s39
 s_lshl_b32 s3, s3, 7
 s_add_u32 s3, s3, 8192
 v_mov_b32_e64 v242, s3
 v_cvt_pk_bf16_f32 v192, v64, v65
 v_cvt_pk_bf16_f32 v193, v66, v67
 v_cvt_pk_bf16_f32 v194, v68, v69
 v_cvt_pk_bf16_f32 v195, v70, v71
 v_cvt_pk_bf16_f32 v196, v72, v73
 v_cvt_pk_bf16_f32 v197, v74, v75
 v_cvt_pk_bf16_f32 v198, v76, v77
 v_cvt_pk_bf16_f32 v199, v78, v79
 ds_write_b128 v224, v[192:195]
 ds_write_b128 v224, v[196:199] offset:1024
 buffer_load_dword v243, v242, s[76:79], 0 offen sc1
 s_waitcnt lgkmcnt(0)
 s_barrier
 ds_read_b128 a[0:3], v225
 ds_read_b128 v[208:211], v227
 ds_read_b128 a[4:7], v225 offset:1024
 ds_read_b128 v[212:215], v227 offset:16
 ds_read_b128 a[8:11], v225 offset:2048
 ds_read_b128 v[216:219], v227 offset:64
 ds_read_b128 a[12:15], v225 offset:3072
 ds_read_b128 v[220:223], v227 offset:80
 s_waitcnt lgkmcnt(0)
 s_lshl_b32 s4, s41, 1
 v_mfma_f32_32x32x16_bf16 v[64:79], a[0:3], v[0:3], 0
 s_add_u32 s4, s4, s30
 s_mul_i32 s6, s4, 37
 s_lshr_b32 s6, s6, 8
 s_mul_i32 s3, s6, 7
 v_mfma_f32_32x32x16_bf16 v[64:79], a[4:7], v[4:7], v[64:79]
 s_sub_u32 s4, s4, s3
 s_lshl_b32 s4, s4, 3
 s_add_u32 s4, s4, 4
 s_add_u32 s6, s6, 16
 s_lshl_b32 s69, s6, 13
 v_mfma_f32_32x32x16_bf16 v[64:79], a[8:11], v[8:11], v[64:79]
 s_lshl_b32 s3, s40, 4
 s_lshl_b32 s6, s29, 3
 s_add_u32 s3, s3, s6
 s_mul_i32 s3, s3, 172032
 v_mfma_f32_32x32x16_bf16 v[64:79], a[12:15], v[12:15], v[64:79]
 s_add_u32 s69, s69, s3
 v_lshrrev_b32 v230, 5, v255
 v_bfe_u32 v231, v255, 3, 1
 v_lshl_add_u32 v230, v230, 1, v231
 v_add_u32_e64 v228, s4, v230
 v_mfma_f32_32x32x16_bf16 v[96:111], a[0:3], v[16:19], 0
 v_mul_u32_u24 v231, 37, v228
 v_lshrrev_b32 v231, 8, v231
 v_add3_u32 v228, v228, v231, -4
 v_lshlrev_b32 v228, 7, v228
 s_add_u32 s4, s4, 4
 v_mfma_f32_32x32x16_bf16 v[96:111], a[4:7], v[20:23], v[96:111]
 v_add_u32 v229, s4, v230
 v_mul_u32_u24 v231, 37, v229
 v_lshrrev_b32_e64 v231, 8, v231
 v_add3_u32 v229, v229, v231, -4
 v_mfma_f32_32x32x16_bf16 v[96:111], a[8:11], v[24:27], v[96:111]
 v_lshlrev_b32_e64 v229, 7, v229
 v_bfe_u32 v230, v255, 4, 1
 s_mov_b32 s3, 172032
 v_mul_u32_u24 v230, s3, v230
 v_and_b32 v231, 7, v255
 v_mfma_f32_32x32x16_bf16 v[96:111], a[12:15], v[28:31], v[96:111]
 v_lshl_add_u32 v230, v231, 4, v230
 v_add_u32 v228, v228, v230
 v_add_u32 v229, v229, v230
 s_mov_b32 s70, 0x358637bd
 v_mov_b32 v80, 0
 v_mov_b32 v112, 0
 v_mov_b32 v81, 0
 v_mov_b32 v113, 0
 v_dot2c_f32_bf16 v80, v0, v208
 v_dot2c_f32_bf16 v112, v16, v208
 v_dot2c_f32_bf16 v81, v1, v209
 v_dot2c_f32_bf16 v113, v17, v209
 v_dot2c_f32_bf16 v80, v2, v210
 v_dot2c_f32_bf16 v112, v18, v210
 v_dot2c_f32_bf16 v81, v3, v211
 v_dot2c_f32_bf16 v113, v19, v211
 v_dot2c_f32_bf16 v80, v4, v212
 v_dot2c_f32_bf16 v112, v20, v212
 v_dot2c_f32_bf16 v81, v5, v213
 v_dot2c_f32_bf16 v113, v21, v213
 v_dot2c_f32_bf16 v80, v6, v214
 v_dot2c_f32_bf16 v112, v22, v214
 v_dot2c_f32_bf16 v81, v7, v215
 v_dot2c_f32_bf16 v113, v23, v215
 v_dot2c_f32_bf16 v80, v8, v216
 v_dot2c_f32_bf16 v112, v24, v216
 v_dot2c_f32_bf16 v81, v9, v217
 v_dot2c_f32_bf16 v113, v25, v217
 v_dot2c_f32_bf16 v80, v10, v218
 v_dot2c_f32_bf16 v112, v26, v218
 v_dot2c_f32_bf16 v81, v11, v219
 v_dot2c_f32_bf16 v113, v27, v219
 v_dot2c_f32_bf16 v80, v12, v220
 v_dot2c_f32_bf16 v112, v28, v220
 v_dot2c_f32_bf16 v81, v13, v221
 v_dot2c_f32_bf16 v113, v29, v221
 v_dot2c_f32_bf16 v80, v14, v222
 v_dot2c_f32_bf16 v112, v30, v222
 v_dot2c_f32_bf16 v81, v15, v223
 v_dot2c_f32_bf16 v113, v31, v223
 s_nop 1
 v_add_f32 v80, v80, v81
 v_add_f32 v112, v112, v113
 v_mov_b32 v81, v80
 v_mov_b32 v113, v112
 s_nop 0
 v_permlane32_swap_b32 v80, v81
 v_permlane32_swap_b32 v112, v113
 v_add_f32 v80, v80, v81
 v_add_f32 v112, v112, v113
 v_add_f32 v80, s70, v80
 v_add_f32 v112, s70, v112
 v_rcp_f32 v80, v80
 v_rcp_f32 v112, v112
 v_mul_f32 v80, 0xbf317218, v80
 v_mul_f32 v112, 0xbf317218, v112
 v_mov_b32 v144, 0
 v_mov_b32 v176, 0
 v_mov_b32 v145, 0
 v_mov_b32 v177, 0
 v_dot2c_f32_bf16 v144, v32, v208
 v_dot2c_f32_bf16 v176, v48, v208
 v_dot2c_f32_bf16 v145, v33, v209
 v_dot2c_f32_bf16 v177, v49, v209
 v_dot2c_f32_bf16 v144, v34, v210
 v_dot2c_f32_bf16 v176, v50, v210
 v_dot2c_f32_bf16 v145, v35, v211
 v_dot2c_f32_bf16 v177, v51, v211
 v_dot2c_f32_bf16 v144, v36, v212
 v_dot2c_f32_bf16 v176, v52, v212
 v_dot2c_f32_bf16 v145, v37, v213
 v_dot2c_f32_bf16 v177, v53, v213
 v_dot2c_f32_bf16 v144, v38, v214
 v_dot2c_f32_bf16 v176, v54, v214
 v_dot2c_f32_bf16 v145, v39, v215
 v_dot2c_f32_bf16 v177, v55, v215
 v_dot2c_f32_bf16 v144, v40, v216
 v_dot2c_f32_bf16 v176, v56, v216
 v_dot2c_f32_bf16 v145, v41, v217
 v_dot2c_f32_bf16 v177, v57, v217
 v_dot2c_f32_bf16 v144, v42, v218
 v_dot2c_f32_bf16 v176, v58, v218
 v_dot2c_f32_bf16 v145, v43, v219
 v_dot2c_f32_bf16 v177, v59, v219
 v_dot2c_f32_bf16 v144, v44, v220
 v_dot2c_f32_bf16 v176, v60, v220
 v_dot2c_f32_bf16 v145, v45, v221
 v_dot2c_f32_bf16 v177, v61, v221
 v_dot2c_f32_bf16 v144, v46, v222
 v_dot2c_f32_bf16 v176, v62, v222
 v_dot2c_f32_bf16 v145, v47, v223
 v_dot2c_f32_bf16 v177, v63, v223
 s_nop 1
 v_add_f32 v144, v144, v145
 v_add_f32 v176, v176, v177
 v_mov_b32 v145, v144
 v_mov_b32 v177, v176
 s_nop 0
 v_permlane32_swap_b32 v144, v145
 v_permlane32_swap_b32 v176, v177
 v_add_f32 v144, v144, v145
 v_add_f32 v176, v176, v177
 v_add_f32 v144, s70, v144
 v_add_f32 v176, s70, v176
 v_rcp_f32 v144, v144
 v_rcp_f32 v176, v176
 v_mul_f32 v144, 0xbf317218, v144
 v_mul_f32 v176, 0xbf317218, v176
 v_mul_f32_e64 v64, v80, v64
 v_mfma_f32_32x32x16_bf16 v[128:143], a[0:3], v[32:35], 0
 v_mul_f32 v65, v80, v65
 v_mul_f32 v66, v80, v66
 v_mul_f32_e64 v67, v80, v67
 v_mfma_f32_32x32x16_bf16 v[128:143], a[4:7], v[36:39], v[128:143]
 v_mul_f32 v68, v80, v68
 v_mul_f32 v69, v80, v69
 v_mul_f32_e64 v70, v80, v70
 v_mfma_f32_32x32x16_bf16 v[128:143], a[8:11], v[40:43], v[128:143]
 v_mul_f32 v71, v80, v71
 v_mul_f32 v72, v80, v72
 v_mul_f32_e64 v73, v80, v73
 v_mfma_f32_32x32x16_bf16 v[128:143], a[12:15], v[44:47], v[128:143]
 v_mul_f32 v74, v80, v74
 v_mul_f32 v75, v80, v75
 v_mul_f32_e64 v76, v80, v76
 v_mfma_f32_32x32x16_bf16 v[160:175], a[0:3], v[48:51], 0
 v_mul_f32 v77, v80, v77
 v_mul_f32 v78, v80, v78
 v_mul_f32_e64 v79, v80, v79
 v_mfma_f32_32x32x16_bf16 v[160:175], a[4:7], v[52:55], v[160:175]
 v_cvt_pk_bf16_f32 v64, v64, v65
 v_cvt_pk_bf16_f32 v65, v66, v67
 v_cvt_pk_bf16_f32 v66, v68, v69
 v_mfma_f32_32x32x16_bf16 v[160:175], a[8:11], v[56:59], v[160:175]
 v_cvt_pk_bf16_f32 v67, v70, v71
 v_cvt_pk_bf16_f32 v68, v72, v73
 v_cvt_pk_bf16_f32 v69, v74, v75
 v_mfma_f32_32x32x16_bf16 v[160:175], a[12:15], v[60:63], v[160:175]
 v_cvt_pk_bf16_f32 v70, v76, v77
 v_cvt_pk_bf16_f32 v71, v78, v79
 buffer_store_dwordx4 v[64:67], v228, s[16:19], s69 offen sc1
 buffer_store_dwordx4 v[68:71], v229, s[16:19], s69 offen sc1
 s_add_u32 s69, s69, 344064
 v_pk_mul_f32 v[96:97], v[96:97], v[112:113] op_sel_hi:[1,0]
 v_pk_mul_f32 v[98:99], v[98:99], v[112:113] op_sel_hi:[1,0]
 v_pk_mul_f32 v[100:101], v[100:101], v[112:113] op_sel_hi:[1,0]
 v_pk_mul_f32 v[102:103], v[102:103], v[112:113] op_sel_hi:[1,0]
 v_pk_mul_f32 v[104:105], v[104:105], v[112:113] op_sel_hi:[1,0]
 v_pk_mul_f32 v[106:107], v[106:107], v[112:113] op_sel_hi:[1,0]
 v_pk_mul_f32 v[108:109], v[108:109], v[112:113] op_sel_hi:[1,0]
 v_pk_mul_f32 v[110:111], v[110:111], v[112:113] op_sel_hi:[1,0]
 v_cvt_pk_bf16_f32 v96, v96, v97
 v_cvt_pk_bf16_f32 v97, v98, v99
 v_cvt_pk_bf16_f32 v98, v100, v101
 v_cvt_pk_bf16_f32 v99, v102, v103
 v_cvt_pk_bf16_f32 v100, v104, v105
 v_cvt_pk_bf16_f32 v101, v106, v107
 v_cvt_pk_bf16_f32 v102, v108, v109
 v_cvt_pk_bf16_f32 v103, v110, v111
 buffer_store_dwordx4 v[96:99], v228, s[16:19], s69 offen sc1
 buffer_store_dwordx4 v[100:103], v229, s[16:19], s69 offen sc1
 s_add_u32 s69, s69, 344064
 v_pk_mul_f32 v[128:129], v[128:129], v[144:145] op_sel_hi:[1,0]
 v_pk_mul_f32 v[130:131], v[130:131], v[144:145] op_sel_hi:[1,0]
 v_pk_mul_f32 v[132:133], v[132:133], v[144:145] op_sel_hi:[1,0]
 v_pk_mul_f32 v[134:135], v[134:135], v[144:145] op_sel_hi:[1,0]
 v_pk_mul_f32 v[136:137], v[136:137], v[144:145] op_sel_hi:[1,0]
 v_pk_mul_f32 v[138:139], v[138:139], v[144:145] op_sel_hi:[1,0]
 v_pk_mul_f32 v[140:141], v[140:141], v[144:145] op_sel_hi:[1,0]
 v_pk_mul_f32 v[142:143], v[142:143], v[144:145] op_sel_hi:[1,0]
 v_cvt_pk_bf16_f32 v128, v128, v129
 v_cvt_pk_bf16_f32 v129, v130, v131
 v_cvt_pk_bf16_f32 v130, v132, v133
 v_cvt_pk_bf16_f32 v131, v134, v135
 v_cvt_pk_bf16_f32 v132, v136, v137
 v_cvt_pk_bf16_f32 v133, v138, v139
 v_cvt_pk_bf16_f32 v134, v140, v141
 v_cvt_pk_bf16_f32 v135, v142, v143
 buffer_store_dwordx4 v[128:131], v228, s[16:19], s69 offen sc1
 buffer_store_dwordx4 v[132:135], v229, s[16:19], s69 offen sc1
 s_add_u32 s69, s69, 344064
 v_pk_mul_f32 v[160:161], v[160:161], v[176:177] op_sel_hi:[1,0]
 v_pk_mul_f32 v[162:163], v[162:163], v[176:177] op_sel_hi:[1,0]
 v_pk_mul_f32 v[164:165], v[164:165], v[176:177] op_sel_hi:[1,0]
 v_pk_mul_f32 v[166:167], v[166:167], v[176:177] op_sel_hi:[1,0]
 v_pk_mul_f32 v[168:169], v[168:169], v[176:177] op_sel_hi:[1,0]
 v_pk_mul_f32 v[170:171], v[170:171], v[176:177] op_sel_hi:[1,0]
 v_pk_mul_f32 v[172:173], v[172:173], v[176:177] op_sel_hi:[1,0]
 v_pk_mul_f32 v[174:175], v[174:175], v[176:177] op_sel_hi:[1,0]
 v_cvt_pk_bf16_f32 v160, v160, v161
 v_cvt_pk_bf16_f32 v161, v162, v163
 v_cvt_pk_bf16_f32 v162, v164, v165
 v_cvt_pk_bf16_f32 v163, v166, v167
 v_cvt_pk_bf16_f32 v164, v168, v169
 v_cvt_pk_bf16_f32 v165, v170, v171
 v_cvt_pk_bf16_f32 v166, v172, v173
 v_cvt_pk_bf16_f32 v167, v174, v175
 buffer_store_dwordx4 v[160:163], v228, s[16:19], s69 offen sc1
 buffer_store_dwordx4 v[164:167], v229, s[16:19], s69 offen sc1
 s_add_u32 s69, s69, 344064
 s_waitcnt vmcnt(8)
L_P2:
 v_bfe_u32 v252, v255, 2, 3
 v_lshlrev_b32 v224, 7, v252
 v_lshrrev_b32_e64 v252, 1, v252
 v_lshl_add_u32 v224, v252, 5, v224
 v_and_b32_e64 v252, 3, v255
 v_lshl_add_u32 v224, v252, 3, v224
 v_lshrrev_b32_e64 v252, 5, v255
 v_lshl_add_u32 v216, v252, 11, v224
 v_lshl_add_u32 v224, v252, 12, v224
 v_xor_b32 v225, 32, v224
 v_xor_b32 v226, 64, v224
 v_xor_b32 v227, 96, v224
 v_xor_b32 v228, 65536, v224
 v_xor_b32 v229, 65568, v224
 v_xor_b32 v230, 65600, v224
 v_xor_b32 v231, 65632, v224
 s_mov_b32 s8, s66
 s_mov_b32 s9, s67
 s_mov_b32 s10, 0x1500000
 s_mov_b32 s11, 0x20000
 v_lshlrev_b32 v232, 4, v255
 v_lshrrev_b32 v252, 3, v255
 v_mul_u32_u24_e64 v252, 37, v252
 v_add_u32 v208, 148, v252
 v_lshrrev_b32_e64 v208, 8, v208
 v_lshl_add_u32 v208, v208, 7, v232
 v_add_u32 v209, 2489, v252
 v_lshrrev_b32_e64 v209, 8, v209
 v_lshl_add_u32 v209, v209, 7, v232
 v_add_u32 v210, 4830, v252
 v_lshrrev_b32_e64 v210, 8, v210
 v_lshl_add_u32 v210, v210, 7, v232
 v_add_u32 v211, 7171, v252
 v_lshrrev_b32_e64 v211, 8, v211
 v_lshl_add_u32 v211, v211, 7, v232
 v_add_u32 v212, 9512, v252
 v_lshrrev_b32_e64 v212, 8, v212
 v_lshl_add_u32 v212, v212, 7, v232
 v_add_u32 v213, 11853, v252
 v_lshrrev_b32_e64 v213, 8, v213
 v_lshl_add_u32 v213, v213, 7, v232
 v_add_u32 v214, 14194, v252
 v_lshrrev_b32_e64 v214, 8, v214
 v_lshl_add_u32 v214, v214, 7, v232
 s_lshl_b32 s3, s40, 4
 s_lshl_b32 s4, s28, 2
 s_add_u32 s3, s3, s4
 s_and_b32 s4, s39, 2
 s_add_u32 s6, s3, s4
 s_xor_b32 s4, s4, 2
 s_add_u32 s3, s3, s4
 s_lshl_b32 s4, s39, 15
 s_mul_i32 s44, s6, 172032
 s_mul_i32 s3, s3, 172032
 s_add_u32 s31, s44, s4
 s_add_u32 s36, s3, s4
 s_add_u32 s32, s31, 172032
 s_add_u32 s38, s36, 172032
 s_add_u32 m0, s34, 98304
 s_add_u32 s33, s33, 786432
 s_lshl_b32 s3, s40, 2
 s_add_u32 s3, s3, s39
 s_lshl_b32 s3, s3, 7
 s_add_u32 s3, s3, 8192
 v_mov_b32 v242, s3
 v_readfirstlane_b32 s3, v243
 s_nop 0
 s_cmp_lt_u32 s3, 4
 s_cbranch_scc1 L2_hq
L2_hq_r:
 buffer_load_dwordx4 a[64:67], v208, s[8:11], s31 offen sc1
 buffer_load_dwordx4 a[68:71], v208, s[8:11], s32 offen sc1
 buffer_load_dwordx4 a[72:75], v208, s[8:11], s36 offen sc1
 buffer_load_dwordx4 a[76:79], v208, s[8:11], s38 offen sc1
 buffer_load_dwordx4 a[80:83], v209, s[8:11], s31 offen sc1
 buffer_load_dwordx4 a[84:87], v209, s[8:11], s32 offen sc1
 buffer_load_dwordx4 a[88:91], v209, s[8:11], s36 offen sc1
 buffer_load_dwordx4 a[92:95], v209, s[8:11], s38 offen sc1
 buffer_load_dwordx4 a[96:99], v210, s[8:11], s31 offen sc1
 buffer_load_dwordx4 a[100:103], v210, s[8:11], s32 offen sc1
 buffer_load_dwordx4 a[104:107], v210, s[8:11], s36 offen sc1
 buffer_load_dwordx4 a[108:111], v210, s[8:11], s38 offen sc1
 ds_read_b64_tr_b16 a[0:1], v224
 ds_read_b64_tr_b16 a[2:3], v224 offset:2048
 ds_read_b64_tr_b16 a[4:5], v225
 ds_read_b64_tr_b16 a[6:7], v225 offset:2048
 ds_read_b64_tr_b16 a[8:9], v226
 ds_read_b64_tr_b16 a[10:11], v226 offset:2048
 ds_read_b64_tr_b16 a[12:13], v227
 ds_read_b64_tr_b16 a[14:15], v227 offset:2048
 ds_read_b64_tr_b16 a[16:17], v224 offset:1024
 ds_read_b64_tr_b16 a[18:19], v224 offset:3072
 ds_read_b64_tr_b16 a[20:21], v225 offset:1024
 ds_read_b64_tr_b16 a[22:23], v225 offset:3072
 ds_read_b64_tr_b16 a[24:25], v226 offset:1024
 ds_read_b64_tr_b16 a[26:27], v226 offset:3072
 ds_read_b64_tr_b16 a[28:29], v227 offset:1024
 ds_read_b64_tr_b16 a[30:31], v227 offset:3072
 s_lshl_b32 s3, s40, 7
 s_add_u32 s3, s3, 12288
 v_mov_b32 v242, s3
 v_add_u32 v240, s28, v255
 v_lshlrev_b32_e64 v240, 20, v240
 s_lshl_b32 s4, s81, 28
 v_add3_u32 v240, v240, v242, s4
 v_mov_b32 v241, 1
 v_lshlrev_b32 v239, 20, v255
 s_add_u32 s44, s44, 131072
 s_mov_b32 s42, 0x3f80
 s_mov_b32 s43, 0x3f800000
 s_mov_b32 s20, s48
 s_mov_b32 s21, s49
 s_mov_b32 s22, 0x400000
 s_mov_b32 s23, 0x20000
 s_mov_b32 s24, s62
 s_mov_b32 s25, s63
 s_nop 0
 s_mov_b32 s26, 0x400000
 s_mov_b32 s27, 0x20000
 s_add_u32 s16, s66, 0x1c00000
 s_addc_u32 s17, s67, 0
 s_mov_b32 s18, 0x1000000
 s_mov_b32 s19, 0x20000
 s_lshl_b32 s3, s40, 3
 s_add_u32 s3, s3, s83
 s_lshl_b32 s6, s3, 18
 s_lshl_b32 s4, s28, 12
 s_add_u32 s6, s6, s4
 s_lshl_b32 s7, s3, 9
 s_lshl_b32 s4, s28, 2
 s_add_u32 s7, s7, s4
 s_add_u32 s7, s7, 32768
 s_lshl_b32 s4, s39, 16
 s_add_u32 s90, s6, s4
 s_lshl_b32 s4, s39, 7
 s_add_u32 s91, s7, s4
 s_xor_b32 s3, s39, 3
 s_lshl_b32 s4, s3, 16
 s_add_u32 s4, s4, s6
 s_add_u32 s68, s4, 0
 s_lshl_b32 s4, s3, 7
 s_add_u32 s74, s4, s7
 s_xor_b32 s3, s39, 1
 s_lshl_b32 s4, s3, 16
 s_add_u32 s4, s4, s6
 s_add_u32 s69, s4, 16384
 s_lshl_b32 s4, s3, 7
 s_add_u32 s75, s4, s7
 s_xor_b32 s3, s39, 2
 s_lshl_b32 s4, s3, 16
 s_add_u32 s4, s4, s6
 s_add_u32 s70, s4, 32768
 s_lshl_b32 s4, s3, 7
 s_add_u32 s89, s4, s7
 v_xor_b32 v217, 32, v216
 v_xor_b32_e64 v218, 64, v216
 v_xor_b32 v219, 96, v216
 v_xor_b32 v220, 65536, v216
 v_xor_b32 v221, 65568, v216
 v_xor_b32 v222, 65600, v216
 v_xor_b32 v223, 65632, v216
 v_lshrrev_b32 v252, 3, v255
 v_lshlrev_b32 v233, 11, v252
 v_and_b32_e64 v215, 7, v255
 v_lshl_add_u32 v233, v215, 4, v233
 s_lshl_b32 s3, s83, 8
 s_and_b32 s4, s39, 1
 s_lshl_b32 s4, s4, 7
 s_add_u32 s3, s3, s4
 s_lshl_b32 s4, s40, 19
 s_add_u32 s3, s3, s4
 s_lshl_b32 s4, s28, 17
 s_add_u32 s3, s3, s4
 s_and_b32 s4, s39, 2
 s_lshl_b32 s4, s4, 15
 s_add_u32 s3, s3, s4
 v_add_u32 v233, s3, v233
 s_mov_b32 s71, 16384
 s_mov_b32 s72, 32768
 s_mov_b32 s73, 49152
 v_xor_b32 v234, v252, v215
 v_lshlrev_b32 v238, 7, v252
 v_lshl_add_u32 v238, v234, 4, v238
 s_lshl_b32 s3, s28, 12
 s_add_u32 s3, s3, 98304
 v_add_u32 v238, s3, v238
 v_lshrrev_b32 v252, 5, v255
 v_xor_b32 v252, v252, v215
 v_and_b32 v215, 15, v255
 v_lshlrev_b32 v234, 7, v215
 v_lshl_add_u32 v234, v252, 4, v234
 v_bfe_u32 v252, v255, 4, 1
 v_lshl_add_u32 v234, v252, 3, v234
 v_add_u32 v234, s3, v234
 v_xor_b32 v235, 32, v234
 v_xor_b32_e64 v236, 64, v234
 v_xor_b32 v237, 96, v234
 s_waitcnt lgkmcnt(0)
 s_waitcnt vmcnt(8) lgkmcnt(8)
 v_mfma_f32_16x16x32_bf16 v[0:3], a[0:3], a[64:67], 0
 ds_read_b64_tr_b16 a[32:33], v224 offset:8192
 v_mfma_f32_16x16x32_bf16 v[16:19], a[0:3], a[68:71], 0
 buffer_load_dwordx4 a[112:115], v211, s[8:11], s31 offen sc1
 v_mfma_f32_16x16x32_bf16 v[64:67], a[0:3], a[72:75], 0
 ds_read_b64_tr_b16 a[34:35], v224 offset:10240
 v_mfma_f32_16x16x32_bf16 v[80:83], a[0:3], a[76:79], 0
 buffer_load_dwordx4 a[116:119], v211, s[8:11], s32 offen sc1
 v_mfma_f32_16x16x32_bf16 v[84:87], a[4:7], a[76:79], 0
 ds_read_b64_tr_b16 a[36:37], v225 offset:8192
 v_mfma_f32_16x16x32_bf16 v[68:71], a[4:7], a[72:75], 0
 v_mfma_f32_16x16x32_bf16 v[20:23], a[4:7], a[68:71], 0
 ds_read_b64_tr_b16 a[38:39], v225 offset:10240
 v_mfma_f32_16x16x32_bf16 v[4:7], a[4:7], a[64:67], 0
 buffer_load_dwordx4 a[120:123], v211, s[8:11], s36 offen sc1
 v_mfma_f32_16x16x32_bf16 v[8:11], a[8:11], a[64:67], 0
 ds_read_b64_tr_b16 a[40:41], v226 offset:8192
 v_mfma_f32_16x16x32_bf16 v[24:27], a[8:11], a[68:71], 0
 v_mfma_f32_16x16x32_bf16 v[72:75], a[8:11], a[72:75], 0
 ds_read_b64_tr_b16 a[42:43], v226 offset:10240
 v_mfma_f32_16x16x32_bf16 v[88:91], a[8:11], a[76:79], 0
 buffer_load_dwordx4 a[124:127], v211, s[8:11], s38 offen sc1
 v_mfma_f32_16x16x32_bf16 v[92:95], a[12:15], a[76:79], 0
 ds_read_b64_tr_b16 a[44:45], v227 offset:8192
 v_mfma_f32_16x16x32_bf16 v[76:79], a[12:15], a[72:75], 0
 v_mfma_f32_16x16x32_bf16 v[28:31], a[12:15], a[68:71], 0
 ds_read_b64_tr_b16 a[46:47], v227 offset:10240
 v_mfma_f32_16x16x32_bf16 v[12:15], a[12:15], a[64:67], 0
 s_waitcnt lgkmcnt(8)
 buffer_load_dwordx4 a[128:131], v212, s[8:11], s31 offen sc1
 v_mfma_f32_16x16x32_bf16 v[32:35], a[16:19], a[64:67], 0
 ds_read_b64_tr_b16 a[48:49], v224 offset:9216
 v_mfma_f32_16x16x32_bf16 v[48:51], a[16:19], a[68:71], 0
 v_mfma_f32_16x16x32_bf16 v[96:99], a[16:19], a[72:75], 0
 ds_read_b64_tr_b16 a[50:51], v224 offset:11264
 v_mfma_f32_16x16x32_bf16 v[112:115], a[16:19], a[76:79], 0
 buffer_load_dwordx4 a[132:135], v212, s[8:11], s32 offen sc1
 v_mfma_f32_16x16x32_bf16 v[116:119], a[20:23], a[76:79], 0
 ds_read_b64_tr_b16 a[52:53], v225 offset:9216
 v_mfma_f32_16x16x32_bf16 v[100:103], a[20:23], a[72:75], 0
 v_mfma_f32_16x16x32_bf16 v[52:55], a[20:23], a[68:71], 0
 ds_read_b64_tr_b16 a[54:55], v225 offset:11264
 v_mfma_f32_16x16x32_bf16 v[36:39], a[20:23], a[64:67], 0
 buffer_load_dwordx4 v246, s[12:15], s33 offen offset:2048 lds
 v_mfma_f32_16x16x32_bf16 v[40:43], a[24:27], a[64:67], 0
 ds_read_b64_tr_b16 a[56:57], v226 offset:9216
 v_mfma_f32_16x16x32_bf16 v[56:59], a[24:27], a[68:71], 0
 v_mfma_f32_16x16x32_bf16 v[104:107], a[24:27], a[72:75], 0
 ds_read_b64_tr_b16 a[58:59], v226 offset:11264
 v_mfma_f32_16x16x32_bf16 v[120:123], a[24:27], a[76:79], 0
 buffer_load_dwordx4 v247, s[12:15], s33 offen offset:3072 lds
 s_add_u32 s33, s33, 131072
 v_mfma_f32_16x16x32_bf16 v[124:127], a[28:31], a[76:79], 0
 ds_read_b64_tr_b16 a[60:61], v227 offset:9216
 v_mfma_f32_16x16x32_bf16 v[108:111], a[28:31], a[72:75], 0
 v_mfma_f32_16x16x32_bf16 v[60:63], a[28:31], a[68:71], 0
 ds_read_b64_tr_b16 a[62:63], v227 offset:11264
 v_mfma_f32_16x16x32_bf16 v[44:47], a[28:31], a[64:67], 0
 s_waitcnt vmcnt(12) lgkmcnt(8)
 s_barrier
 v_mfma_f32_16x16x32_bf16 v[0:3], a[32:35], a[80:83], v[0:3]
 ds_read_b64_tr_b16 a[0:1], v224 offset:16384
 v_mfma_f32_16x16x32_bf16 v[16:19], a[32:35], a[84:87], v[16:19]
 buffer_atomic_add v241, v240, s[76:79], 0 offen sc1
 v_mfma_f32_16x16x32_bf16 v[64:67], a[32:35], a[88:91], v[64:67]
 ds_read_b64_tr_b16 a[2:3], v224 offset:18432
 v_mfma_f32_16x16x32_bf16 v[80:83], a[32:35], a[92:95], v[80:83]
 buffer_load_dwordx4 a[136:139], v212, s[8:11], s36 offen sc1
 v_mfma_f32_16x16x32_bf16 v[84:87], a[36:39], a[92:95], v[84:87]
 ds_read_b64_tr_b16 a[4:5], v225 offset:16384
 v_mfma_f32_16x16x32_bf16 v[68:71], a[36:39], a[88:91], v[68:71]
 v_mfma_f32_16x16x32_bf16 v[20:23], a[36:39], a[84:87], v[20:23]
 ds_read_b64_tr_b16 a[6:7], v225 offset:18432
 v_mfma_f32_16x16x32_bf16 v[4:7], a[36:39], a[80:83], v[4:7]
 buffer_load_dwordx4 a[140:143], v212, s[8:11], s38 offen sc1
 v_mfma_f32_16x16x32_bf16 v[8:11], a[40:43], a[80:83], v[8:11]
 ds_read_b64_tr_b16 a[8:9], v226 offset:16384
 v_mfma_f32_16x16x32_bf16 v[24:27], a[40:43], a[84:87], v[24:27]
 buffer_load_dwordx4 a[144:147], v213, s[8:11], s31 offen sc1
 v_mfma_f32_16x16x32_bf16 v[72:75], a[40:43], a[88:91], v[72:75]
 ds_read_b64_tr_b16 a[10:11], v226 offset:18432
 v_mfma_f32_16x16x32_bf16 v[88:91], a[40:43], a[92:95], v[88:91]
 v_mfma_f32_16x16x32_bf16 v[92:95], a[44:47], a[92:95], v[92:95]
 ds_read_b64_tr_b16 a[12:13], v227 offset:16384
 v_mfma_f32_16x16x32_bf16 v[76:79], a[44:47], a[88:91], v[76:79]
 buffer_load_dwordx4 a[148:151], v213, s[8:11], s32 offen sc1
 v_mfma_f32_16x16x32_bf16 v[28:31], a[44:47], a[84:87], v[28:31]
 ds_read_b64_tr_b16 a[14:15], v227 offset:18432
 v_mfma_f32_16x16x32_bf16 v[12:15], a[44:47], a[80:83], v[12:15]
 s_waitcnt lgkmcnt(8)
 buffer_load_dwordx4 a[152:155], v213, s[8:11], s36 offen sc1
 v_mfma_f32_16x16x32_bf16 v[32:35], a[48:51], a[80:83], v[32:35]
 ds_read_b64_tr_b16 a[16:17], v224 offset:17408
 v_mfma_f32_16x16x32_bf16 v[48:51], a[48:51], a[84:87], v[48:51]
 v_mfma_f32_16x16x32_bf16 v[96:99], a[48:51], a[88:91], v[96:99]
 ds_read_b64_tr_b16 a[18:19], v224 offset:19456
 v_mfma_f32_16x16x32_bf16 v[112:115], a[48:51], a[92:95], v[112:115]
 buffer_load_dwordx4 a[156:159], v213, s[8:11], s38 offen sc1
 v_mfma_f32_16x16x32_bf16 v[116:119], a[52:55], a[92:95], v[116:119]
 ds_read_b64_tr_b16 a[20:21], v225 offset:17408
 v_mfma_f32_16x16x32_bf16 v[100:103], a[52:55], a[88:91], v[100:103]
 s_add_u32 m0, s34, 114688
 v_mfma_f32_16x16x32_bf16 v[52:55], a[52:55], a[84:87], v[52:55]
 ds_read_b64_tr_b16 a[22:23], v225 offset:19456
 v_mfma_f32_16x16x32_bf16 v[36:39], a[52:55], a[80:83], v[36:39]
 v_mfma_f32_16x16x32_bf16 v[40:43], a[56:59], a[80:83], v[40:43]
 ds_read_b64_tr_b16 a[24:25], v226 offset:17408
 v_mfma_f32_16x16x32_bf16 v[56:59], a[56:59], a[84:87], v[56:59]
 buffer_load_dwordx4 v244, s[12:15], s33 offen lds
 v_mfma_f32_16x16x32_bf16 v[104:107], a[56:59], a[88:91], v[104:107]
 ds_read_b64_tr_b16 a[26:27], v226 offset:19456
 v_mfma_f32_16x16x32_bf16 v[120:123], a[56:59], a[92:95], v[120:123]
 buffer_load_dwordx4 v245, s[12:15], s33 offen offset:1024 lds
 v_mfma_f32_16x16x32_bf16 v[124:127], a[60:63], a[92:95], v[124:127]
 ds_read_b64_tr_b16 a[28:29], v227 offset:17408
 v_mfma_f32_16x16x32_bf16 v[108:111], a[60:63], a[88:91], v[108:111]
 v_mfma_f32_16x16x32_bf16 v[60:63], a[60:63], a[84:87], v[60:63]
 ds_read_b64_tr_b16 a[30:31], v227 offset:19456
 v_mfma_f32_16x16x32_bf16 v[44:47], a[60:63], a[80:83], v[44:47]
 s_waitcnt vmcnt(17) lgkmcnt(8)
 v_mfma_f32_16x16x32_bf16 v[0:3], a[0:3], a[96:99], v[0:3]
 ds_read_b64_tr_b16 a[32:33], v224 offset:24576
 v_mfma_f32_16x16x32_bf16 v[16:19], a[0:3], a[100:103], v[16:19]
 buffer_load_dwordx4 a[160:163], v214, s[8:11], s31 offen sc1
 v_mfma_f32_16x16x32_bf16 v[64:67], a[0:3], a[104:107], v[64:67]
 ds_read_b64_tr_b16 a[34:35], v224 offset:26624
 v_mfma_f32_16x16x32_bf16 v[80:83], a[0:3], a[108:111], v[80:83]
 buffer_load_dwordx4 a[164:167], v214, s[8:11], s32 offen sc1
 s_add_u32 s31, s31, 8192
 s_add_u32 s32, s32, 8192
 v_mfma_f32_16x16x32_bf16 v[84:87], a[4:7], a[108:111], v[84:87]
 ds_read_b64_tr_b16 a[36:37], v225 offset:24576
 v_mfma_f32_16x16x32_bf16 v[68:71], a[4:7], a[104:107], v[68:71]
 v_mfma_f32_16x16x32_bf16 v[20:23], a[4:7], a[100:103], v[20:23]
 ds_read_b64_tr_b16 a[38:39], v225 offset:26624
 v_mfma_f32_16x16x32_bf16 v[4:7], a[4:7], a[96:99], v[4:7]
 buffer_load_dwordx4 a[168:171], v214, s[8:11], s36 offen sc1
 v_mfma_f32_16x16x32_bf16 v[8:11], a[8:11], a[96:99], v[8:11]
 ds_read_b64_tr_b16 a[40:41], v226 offset:24576
 v_mfma_f32_16x16x32_bf16 v[24:27], a[8:11], a[100:103], v[24:27]
 v_mfma_f32_16x16x32_bf16 v[72:75], a[8:11], a[104:107], v[72:75]
 ds_read_b64_tr_b16 a[42:43], v226 offset:26624
 v_mfma_f32_16x16x32_bf16 v[88:91], a[8:11], a[108:111], v[88:91]
 buffer_load_dwordx4 a[172:175], v214, s[8:11], s38 offen sc1
 s_add_u32 s36, s36, 8192
 s_add_u32 s38, s38, 8192
 v_mfma_f32_16x16x32_bf16 v[92:95], a[12:15], a[108:111], v[92:95]
 ds_read_b64_tr_b16 a[44:45], v227 offset:24576
 v_mfma_f32_16x16x32_bf16 v[76:79], a[12:15], a[104:107], v[76:79]
 v_mfma_f32_16x16x32_bf16 v[28:31], a[12:15], a[100:103], v[28:31]
 ds_read_b64_tr_b16 a[46:47], v227 offset:26624
 v_mfma_f32_16x16x32_bf16 v[12:15], a[12:15], a[96:99], v[12:15]
 s_waitcnt lgkmcnt(8)
 buffer_load_dwordx4 a[176:179], v208, s[8:11], s31 offen sc1
 v_mfma_f32_16x16x32_bf16 v[32:35], a[16:19], a[96:99], v[32:35]
 ds_read_b64_tr_b16 a[48:49], v224 offset:25600
 v_mfma_f32_16x16x32_bf16 v[48:51], a[16:19], a[100:103], v[48:51]
 v_mfma_f32_16x16x32_bf16 v[96:99], a[16:19], a[104:107], v[96:99]
 ds_read_b64_tr_b16 a[50:51], v224 offset:27648
 v_mfma_f32_16x16x32_bf16 v[112:115], a[16:19], a[108:111], v[112:115]
 buffer_load_dwordx4 a[180:183], v208, s[8:11], s32 offen sc1
 v_mfma_f32_16x16x32_bf16 v[116:119], a[20:23], a[108:111], v[116:119]
 ds_read_b64_tr_b16 a[52:53], v225 offset:25600
 v_mfma_f32_16x16x32_bf16 v[100:103], a[20:23], a[104:107], v[100:103]
 v_mfma_f32_16x16x32_bf16 v[52:55], a[20:23], a[100:103], v[52:55]
 ds_read_b64_tr_b16 a[54:55], v225 offset:27648
 v_mfma_f32_16x16x32_bf16 v[36:39], a[20:23], a[96:99], v[36:39]
 buffer_load_dwordx4 v246, s[12:15], s33 offen offset:2048 lds
 v_mfma_f32_16x16x32_bf16 v[40:43], a[24:27], a[96:99], v[40:43]
 ds_read_b64_tr_b16 a[56:57], v226 offset:25600
 v_mfma_f32_16x16x32_bf16 v[56:59], a[24:27], a[100:103], v[56:59]
 v_mfma_f32_16x16x32_bf16 v[104:107], a[24:27], a[104:107], v[104:107]
 ds_read_b64_tr_b16 a[58:59], v226 offset:27648
 v_mfma_f32_16x16x32_bf16 v[120:123], a[24:27], a[108:111], v[120:123]
 buffer_load_dwordx4 v247, s[12:15], s33 offen offset:3072 lds
 s_add_u32 s33, s33, 131072
 v_mfma_f32_16x16x32_bf16 v[124:127], a[28:31], a[108:111], v[124:127]
 ds_read_b64_tr_b16 a[60:61], v227 offset:25600
 v_mfma_f32_16x16x32_bf16 v[108:111], a[28:31], a[104:107], v[108:111]
 v_mfma_f32_16x16x32_bf16 v[60:63], a[28:31], a[100:103], v[60:63]
 ds_read_b64_tr_b16 a[62:63], v227 offset:27648
 v_mfma_f32_16x16x32_bf16 v[44:47], a[28:31], a[96:99], v[44:47]
 s_waitcnt vmcnt(21) lgkmcnt(8)
 s_barrier
 v_mfma_f32_16x16x32_bf16 v[0:3], a[32:35], a[112:115], v[0:3]
 ds_read_b64_tr_b16 a[0:1], v224 offset:32768
 v_mfma_f32_16x16x32_bf16 v[16:19], a[32:35], a[116:119], v[16:19]
 buffer_load_dwordx4 a[184:187], v208, s[8:11], s36 offen sc1
 v_mfma_f32_16x16x32_bf16 v[64:67], a[32:35], a[120:123], v[64:67]
 ds_read_b64_tr_b16 a[2:3], v224 offset:34816
 v_mfma_f32_16x16x32_bf16 v[80:83], a[32:35], a[124:127], v[80:83]
 buffer_load_dwordx4 a[188:191], v208, s[8:11], s38 offen sc1
 v_mfma_f32_16x16x32_bf16 v[84:87], a[36:39], a[124:127], v[84:87]
 ds_read_b64_tr_b16 a[4:5], v225 offset:32768
 v_mfma_f32_16x16x32_bf16 v[68:71], a[36:39], a[120:123], v[68:71]
 v_mfma_f32_16x16x32_bf16 v[20:23], a[36:39], a[116:119], v[20:23]
 ds_read_b64_tr_b16 a[6:7], v225 offset:34816
 v_mfma_f32_16x16x32_bf16 v[4:7], a[36:39], a[112:115], v[4:7]
 buffer_load_dwordx4 a[192:195], v209, s[8:11], s31 offen sc1
 v_mfma_f32_16x16x32_bf16 v[8:11], a[40:43], a[112:115], v[8:11]
 ds_read_b64_tr_b16 a[8:9], v226 offset:32768
 v_mfma_f32_16x16x32_bf16 v[24:27], a[40:43], a[116:119], v[24:27]
 v_mfma_f32_16x16x32_bf16 v[72:75], a[40:43], a[120:123], v[72:75]
 ds_read_b64_tr_b16 a[10:11], v226 offset:34816
 v_mfma_f32_16x16x32_bf16 v[88:91], a[40:43], a[124:127], v[88:91]
 buffer_load_dwordx4 a[196:199], v209, s[8:11], s32 offen sc1
 v_mfma_f32_16x16x32_bf16 v[92:95], a[44:47], a[124:127], v[92:95]
 ds_read_b64_tr_b16 a[12:13], v227 offset:32768
 v_mfma_f32_16x16x32_bf16 v[76:79], a[44:47], a[120:123], v[76:79]
 buffer_load_dwordx4 a[200:203], v209, s[8:11], s36 offen sc1
 v_mfma_f32_16x16x32_bf16 v[28:31], a[44:47], a[116:119], v[28:31]
 ds_read_b64_tr_b16 a[14:15], v227 offset:34816
 v_mfma_f32_16x16x32_bf16 v[12:15], a[44:47], a[112:115], v[12:15]
 s_waitcnt lgkmcnt(8)
 v_mfma_f32_16x16x32_bf16 v[32:35], a[48:51], a[112:115], v[32:35]
 ds_read_b64_tr_b16 a[16:17], v224 offset:33792
 v_mfma_f32_16x16x32_bf16 v[48:51], a[48:51], a[116:119], v[48:51]
 buffer_load_dwordx4 a[204:207], v209, s[8:11], s38 offen sc1
 v_mfma_f32_16x16x32_bf16 v[96:99], a[48:51], a[120:123], v[96:99]
 ds_read_b64_tr_b16 a[18:19], v224 offset:35840
 v_mfma_f32_16x16x32_bf16 v[112:115], a[48:51], a[124:127], v[112:115]
 v_mfma_f32_16x16x32_bf16 v[116:119], a[52:55], a[124:127], v[116:119]
 ds_read_b64_tr_b16 a[20:21], v225 offset:33792
 v_mfma_f32_16x16x32_bf16 v[100:103], a[52:55], a[120:123], v[100:103]
 s_add_u32 m0, s34, 0
 v_mfma_f32_16x16x32_bf16 v[52:55], a[52:55], a[116:119], v[52:55]
 ds_read_b64_tr_b16 a[22:23], v225 offset:35840
 v_mfma_f32_16x16x32_bf16 v[36:39], a[52:55], a[112:115], v[36:39]
 buffer_load_dwordx4 v244, s[12:15], s33 offen lds
 v_mfma_f32_16x16x32_bf16 v[40:43], a[56:59], a[112:115], v[40:43]
 ds_read_b64_tr_b16 a[24:25], v226 offset:33792
 v_mfma_f32_16x16x32_bf16 v[56:59], a[56:59], a[116:119], v[56:59]
 v_mfma_f32_16x16x32_bf16 v[104:107], a[56:59], a[120:123], v[104:107]
 ds_read_b64_tr_b16 a[26:27], v226 offset:35840
 v_mfma_f32_16x16x32_bf16 v[120:123], a[56:59], a[124:127], v[120:123]
 buffer_load_dwordx4 v245, s[12:15], s33 offen offset:1024 lds
 v_mfma_f32_16x16x32_bf16 v[124:127], a[60:63], a[124:127], v[124:127]
 ds_read_b64_tr_b16 a[28:29], v227 offset:33792
 v_mfma_f32_16x16x32_bf16 v[108:111], a[60:63], a[120:123], v[108:111]
 v_mfma_f32_16x16x32_bf16 v[60:63], a[60:63], a[116:119], v[60:63]
 ds_read_b64_tr_b16 a[30:31], v227 offset:35840
 v_mfma_f32_16x16x32_bf16 v[44:47], a[60:63], a[112:115], v[44:47]
 s_waitcnt vmcnt(22) lgkmcnt(8)
 v_mfma_f32_16x16x32_bf16 v[0:3], a[0:3], a[128:131], v[0:3]
 ds_read_b64_tr_b16 a[32:33], v224 offset:40960
 v_mfma_f32_16x16x32_bf16 v[16:19], a[0:3], a[132:135], v[16:19]
 buffer_load_dwordx4 a[208:211], v210, s[8:11], s31 offen sc1
 v_mfma_f32_16x16x32_bf16 v[64:67], a[0:3], a[136:139], v[64:67]
 ds_read_b64_tr_b16 a[34:35], v224 offset:43008
 v_mfma_f32_16x16x32_bf16 v[80:83], a[0:3], a[140:143], v[80:83]
 v_mfma_f32_16x16x32_bf16 v[84:87], a[4:7], a[140:143], v[84:87]
 ds_read_b64_tr_b16 a[36:37], v225 offset:40960
 v_mfma_f32_16x16x32_bf16 v[68:71], a[4:7], a[136:139], v[68:71]
 buffer_load_dwordx4 a[212:215], v210, s[8:11], s32 offen sc1
 v_mfma_f32_16x16x32_bf16 v[20:23], a[4:7], a[132:135], v[20:23]
 ds_read_b64_tr_b16 a[38:39], v225 offset:43008
 v_mfma_f32_16x16x32_bf16 v[4:7], a[4:7], a[128:131], v[4:7]
 v_mfma_f32_16x16x32_bf16 v[8:11], a[8:11], a[128:131], v[8:11]
 ds_read_b64_tr_b16 a[40:41], v226 offset:40960
 v_mfma_f32_16x16x32_bf16 v[24:27], a[8:11], a[132:135], v[24:27]
 v_mfma_f32_16x16x32_bf16 v[72:75], a[8:11], a[136:139], v[72:75]
 ds_read_b64_tr_b16 a[42:43], v226 offset:43008
 v_mfma_f32_16x16x32_bf16 v[88:91], a[8:11], a[140:143], v[88:91]
 buffer_load_dwordx4 a[216:219], v210, s[8:11], s36 offen sc1
 v_mfma_f32_16x16x32_bf16 v[92:95], a[12:15], a[140:143], v[92:95]
 ds_read_b64_tr_b16 a[44:45], v227 offset:40960
 v_mfma_f32_16x16x32_bf16 v[76:79], a[12:15], a[136:139], v[76:79]
 v_mfma_f32_16x16x32_bf16 v[28:31], a[12:15], a[132:135], v[28:31]
 ds_read_b64_tr_b16 a[46:47], v227 offset:43008
 v_mfma_f32_16x16x32_bf16 v[12:15], a[12:15], a[128:131], v[12:15]
 s_waitcnt lgkmcnt(8)
 buffer_load_dwordx4 a[220:223], v210, s[8:11], s38 offen sc1
 v_mfma_f32_16x16x32_bf16 v[32:35], a[16:19], a[128:131], v[32:35]
 ds_read_b64_tr_b16 a[48:49], v224 offset:41984
 v_mfma_f32_16x16x32_bf16 v[48:51], a[16:19], a[132:135], v[48:51]
 v_mfma_f32_16x16x32_bf16 v[96:99], a[16:19], a[136:139], v[96:99]
 ds_read_b64_tr_b16 a[50:51], v224 offset:44032
 v_mfma_f32_16x16x32_bf16 v[112:115], a[16:19], a[140:143], v[112:115]
 v_mfma_f32_16x16x32_bf16 v[116:119], a[20:23], a[140:143], v[116:119]
 ds_read_b64_tr_b16 a[52:53], v225 offset:41984
 v_mfma_f32_16x16x32_bf16 v[100:103], a[20:23], a[136:139], v[100:103]
 buffer_load_dwordx4 v246, s[12:15], s33 offen offset:2048 lds
 v_mfma_f32_16x16x32_bf16 v[52:55], a[20:23], a[132:135], v[52:55]
 ds_read_b64_tr_b16 a[54:55], v225 offset:44032
 v_mfma_f32_16x16x32_bf16 v[36:39], a[20:23], a[128:131], v[36:39]
 v_mfma_f32_16x16x32_bf16 v[40:43], a[24:27], a[128:131], v[40:43]
 ds_read_b64_tr_b16 a[56:57], v226 offset:41984
 v_mfma_f32_16x16x32_bf16 v[56:59], a[24:27], a[132:135], v[56:59]
 buffer_load_dwordx4 v247, s[12:15], s33 offen offset:3072 lds
 s_add_u32 s33, s33, 131072
 v_mfma_f32_16x16x32_bf16 v[104:107], a[24:27], a[136:139], v[104:107]
 ds_read_b64_tr_b16 a[58:59], v226 offset:44032
 v_mfma_f32_16x16x32_bf16 v[120:123], a[24:27], a[140:143], v[120:123]
 v_mfma_f32_16x16x32_bf16 v[124:127], a[28:31], a[140:143], v[124:127]
 ds_read_b64_tr_b16 a[60:61], v227 offset:41984
 v_mfma_f32_16x16x32_bf16 v[108:111], a[28:31], a[136:139], v[108:111]
 v_mfma_f32_16x16x32_bf16 v[60:63], a[28:31], a[132:135], v[60:63]
 ds_read_b64_tr_b16 a[62:63], v227 offset:44032
 v_mfma_f32_16x16x32_bf16 v[44:47], a[28:31], a[128:131], v[44:47]
 s_waitcnt vmcnt(24) lgkmcnt(8)
 s_barrier
 v_mfma_f32_16x16x32_bf16 v[0:3], a[32:35], a[144:147], v[0:3]
 ds_read_b64_tr_b16 a[0:1], v224 offset:49152
 v_mfma_f32_16x16x32_bf16 v[16:19], a[32:35], a[148:151], v[16:19]
 buffer_load_dwordx4 a[224:227], v211, s[8:11], s31 offen sc1
 v_mfma_f32_16x16x32_bf16 v[64:67], a[32:35], a[152:155], v[64:67]
 ds_read_b64_tr_b16 a[2:3], v224 offset:51200
 v_mfma_f32_16x16x32_bf16 v[80:83], a[32:35], a[156:159], v[80:83]
 v_mfma_f32_16x16x32_bf16 v[84:87], a[36:39], a[156:159], v[84:87]
 ds_read_b64_tr_b16 a[4:5], v225 offset:49152
 v_mfma_f32_16x16x32_bf16 v[68:71], a[36:39], a[152:155], v[68:71]
 buffer_load_dwordx4 a[228:231], v211, s[8:11], s32 offen sc1
 v_mfma_f32_16x16x32_bf16 v[20:23], a[36:39], a[148:151], v[20:23]
 ds_read_b64_tr_b16 a[6:7], v225 offset:51200
 v_mfma_f32_16x16x32_bf16 v[4:7], a[36:39], a[144:147], v[4:7]
 v_mfma_f32_16x16x32_bf16 v[8:11], a[40:43], a[144:147], v[8:11]
 ds_read_b64_tr_b16 a[8:9], v226 offset:49152
 v_mfma_f32_16x16x32_bf16 v[24:27], a[40:43], a[148:151], v[24:27]
 buffer_load_dwordx4 a[232:235], v211, s[8:11], s36 offen sc1
 v_mfma_f32_16x16x32_bf16 v[72:75], a[40:43], a[152:155], v[72:75]
 ds_read_b64_tr_b16 a[10:11], v226 offset:51200
 v_mfma_f32_16x16x32_bf16 v[88:91], a[40:43], a[156:159], v[88:91]
 v_mfma_f32_16x16x32_bf16 v[92:95], a[44:47], a[156:159], v[92:95]
 ds_read_b64_tr_b16 a[12:13], v227 offset:49152
 v_mfma_f32_16x16x32_bf16 v[76:79], a[44:47], a[152:155], v[76:79]
 buffer_load_dwordx4 a[236:239], v211, s[8:11], s38 offen sc1
 v_mfma_f32_16x16x32_bf16 v[28:31], a[44:47], a[148:151], v[28:31]
 ds_read_b64_tr_b16 a[14:15], v227 offset:51200
 v_mfma_f32_16x16x32_bf16 v[12:15], a[44:47], a[144:147], v[12:15]
 s_waitcnt lgkmcnt(8)
 v_mfma_f32_16x16x32_bf16 v[32:35], a[48:51], a[144:147], v[32:35]
 ds_read_b64_tr_b16 a[16:17], v224 offset:50176
 v_mfma_f32_16x16x32_bf16 v[48:51], a[48:51], a[148:151], v[48:51]
 s_add_u32 m0, s34, 16384
 v_mfma_f32_16x16x32_bf16 v[96:99], a[48:51], a[152:155], v[96:99]
 ds_read_b64_tr_b16 a[18:19], v224 offset:52224
 v_mfma_f32_16x16x32_bf16 v[112:115], a[48:51], a[156:159], v[112:115]
 v_mfma_f32_16x16x32_bf16 v[116:119], a[52:55], a[156:159], v[116:119]
 ds_read_b64_tr_b16 a[20:21], v225 offset:50176
 v_mfma_f32_16x16x32_bf16 v[100:103], a[52:55], a[152:155], v[100:103]
 buffer_load_dwordx4 v244, s[12:15], s33 offen lds
 v_mfma_f32_16x16x32_bf16 v[52:55], a[52:55], a[148:151], v[52:55]
 ds_read_b64_tr_b16 a[22:23], v225 offset:52224
 v_mfma_f32_16x16x32_bf16 v[36:39], a[52:55], a[144:147], v[36:39]
 v_mfma_f32_16x16x32_bf16 v[40:43], a[56:59], a[144:147], v[40:43]
 ds_read_b64_tr_b16 a[24:25], v226 offset:50176
 v_mfma_f32_16x16x32_bf16 v[56:59], a[56:59], a[148:151], v[56:59]
 buffer_load_dwordx4 v245, s[12:15], s33 offen offset:1024 lds
 v_mfma_f32_16x16x32_bf16 v[104:107], a[56:59], a[152:155], v[104:107]
 ds_read_b64_tr_b16 a[26:27], v226 offset:52224
 v_mfma_f32_16x16x32_bf16 v[120:123], a[56:59], a[156:159], v[120:123]
 v_mfma_f32_16x16x32_bf16 v[124:127], a[60:63], a[156:159], v[124:127]
 ds_read_b64_tr_b16 a[28:29], v227 offset:50176
 v_mfma_f32_16x16x32_bf16 v[108:111], a[60:63], a[152:155], v[108:111]
 v_mfma_f32_16x16x32_bf16 v[60:63], a[60:63], a[148:151], v[60:63]
 ds_read_b64_tr_b16 a[30:31], v227 offset:52224
 v_mfma_f32_16x16x32_bf16 v[44:47], a[60:63], a[144:147], v[44:47]
 s_waitcnt vmcnt(24) lgkmcnt(8)
 v_mfma_f32_16x16x32_bf16 v[0:3], a[0:3], a[160:163], v[0:3]
 ds_read_b64_tr_b16 a[32:33], v224 offset:57344
 v_mfma_f32_16x16x32_bf16 v[16:19], a[0:3], a[164:167], v[16:19]
 buffer_load_dwordx4 a[240:243], v212, s[8:11], s31 offen sc1
 v_mfma_f32_16x16x32_bf16 v[64:67], a[0:3], a[168:171], v[64:67]
 ds_read_b64_tr_b16 a[34:35], v224 offset:59392
 v_mfma_f32_16x16x32_bf16 v[80:83], a[0:3], a[172:175], v[80:83]
 v_mfma_f32_16x16x32_bf16 v[84:87], a[4:7], a[172:175], v[84:87]
 ds_read_b64_tr_b16 a[36:37], v225 offset:57344
 v_mfma_f32_16x16x32_bf16 v[68:71], a[4:7], a[168:171], v[68:71]
 buffer_load_dwordx4 a[244:247], v212, s[8:11], s32 offen sc1
 v_mfma_f32_16x16x32_bf16 v[20:23], a[4:7], a[164:167], v[20:23]
 ds_read_b64_tr_b16 a[38:39], v225 offset:59392
 v_mfma_f32_16x16x32_bf16 v[4:7], a[4:7], a[160:163], v[4:7]
 v_mfma_f32_16x16x32_bf16 v[8:11], a[8:11], a[160:163], v[8:11]
 ds_read_b64_tr_b16 a[40:41], v226 offset:57344
 v_mfma_f32_16x16x32_bf16 v[24:27], a[8:11], a[164:167], v[24:27]
 v_mfma_f32_16x16x32_bf16 v[72:75], a[8:11], a[168:171], v[72:75]
 ds_read_b64_tr_b16 a[42:43], v226 offset:59392
 v_mfma_f32_16x16x32_bf16 v[88:91], a[8:11], a[172:175], v[88:91]
 buffer_load_dwordx4 a[248:251], v212, s[8:11], s36 offen sc1
 v_mfma_f32_16x16x32_bf16 v[92:95], a[12:15], a[172:175], v[92:95]
 ds_read_b64_tr_b16 a[44:45], v227 offset:57344
 v_mfma_f32_16x16x32_bf16 v[76:79], a[12:15], a[168:171], v[76:79]
 v_mfma_f32_16x16x32_bf16 v[28:31], a[12:15], a[164:167], v[28:31]
 ds_read_b64_tr_b16 a[46:47], v227 offset:59392
 v_mfma_f32_16x16x32_bf16 v[12:15], a[12:15], a[160:163], v[12:15]
 s_waitcnt lgkmcnt(8)
 buffer_load_dwordx4 a[252:255], v212, s[8:11], s38 offen sc1
 v_mfma_f32_16x16x32_bf16 v[32:35], a[16:19], a[160:163], v[32:35]
 ds_read_b64_tr_b16 a[48:49], v224 offset:58368
 v_mfma_f32_16x16x32_bf16 v[48:51], a[16:19], a[164:167], v[48:51]
 v_mfma_f32_16x16x32_bf16 v[96:99], a[16:19], a[168:171], v[96:99]
 ds_read_b64_tr_b16 a[50:51], v224 offset:60416
 v_mfma_f32_16x16x32_bf16 v[112:115], a[16:19], a[172:175], v[112:115]
 v_mfma_f32_16x16x32_bf16 v[116:119], a[20:23], a[172:175], v[116:119]
 ds_read_b64_tr_b16 a[52:53], v225 offset:58368
 v_mfma_f32_16x16x32_bf16 v[100:103], a[20:23], a[168:171], v[100:103]
 buffer_load_dwordx4 v246, s[12:15], s33 offen offset:2048 lds
 v_mfma_f32_16x16x32_bf16 v[52:55], a[20:23], a[164:167], v[52:55]
 ds_read_b64_tr_b16 a[54:55], v225 offset:60416
 v_mfma_f32_16x16x32_bf16 v[36:39], a[20:23], a[160:163], v[36:39]
 v_mfma_f32_16x16x32_bf16 v[40:43], a[24:27], a[160:163], v[40:43]
 ds_read_b64_tr_b16 a[56:57], v226 offset:58368
 v_mfma_f32_16x16x32_bf16 v[56:59], a[24:27], a[164:167], v[56:59]
 buffer_load_dwordx4 v247, s[12:15], s33 offen offset:3072 lds
 s_add_u32 s33, s33, 131072
 v_mfma_f32_16x16x32_bf16 v[104:107], a[24:27], a[168:171], v[104:107]
 ds_read_b64_tr_b16 a[58:59], v226 offset:60416
 v_mfma_f32_16x16x32_bf16 v[120:123], a[24:27], a[172:175], v[120:123]
 v_mfma_f32_16x16x32_bf16 v[124:127], a[28:31], a[172:175], v[124:127]
 ds_read_b64_tr_b16 a[60:61], v227 offset:58368
 v_mfma_f32_16x16x32_bf16 v[108:111], a[28:31], a[168:171], v[108:111]
 v_mfma_f32_16x16x32_bf16 v[60:63], a[28:31], a[164:167], v[60:63]
 ds_read_b64_tr_b16 a[62:63], v227 offset:60416
 v_mfma_f32_16x16x32_bf16 v[44:47], a[28:31], a[160:163], v[44:47]
 s_waitcnt vmcnt(24) lgkmcnt(8)
 s_barrier
 v_mfma_f32_16x16x32_bf16 v[0:3], a[32:35], a[176:179], v[0:3]
 ds_read_b64_tr_b16 a[0:1], v228
 v_mfma_f32_16x16x32_bf16 v[16:19], a[32:35], a[180:183], v[16:19]
 buffer_load_dwordx4 a[64:67], v213, s[8:11], s31 offen sc1
 v_mfma_f32_16x16x32_bf16 v[64:67], a[32:35], a[184:187], v[64:67]
 ds_read_b64_tr_b16 a[2:3], v228 offset:2048
 v_mfma_f32_16x16x32_bf16 v[80:83], a[32:35], a[188:191], v[80:83]
 v_min_u32 v215, 15, v255
 v_mfma_f32_16x16x32_bf16 v[84:87], a[36:39], a[188:191], v[84:87]
 ds_read_b64_tr_b16 a[4:5], v229
 v_mfma_f32_16x16x32_bf16 v[68:71], a[36:39], a[184:187], v[68:71]
 buffer_load_dwordx4 a[68:71], v213, s[8:11], s32 offen sc1
 v_mfma_f32_16x16x32_bf16 v[20:23], a[36:39], a[180:183], v[20:23]
 ds_read_b64_tr_b16 a[6:7], v229 offset:2048
 v_mfma_f32_16x16x32_bf16 v[4:7], a[36:39], a[176:179], v[4:7]
 s_bfe_u32 s6, s2, 0x20006
 s_lshl_b32 s6, s6, 2
 v_mfma_f32_16x16x32_bf16 v[8:11], a[40:43], a[176:179], v[8:11]
 ds_read_b64_tr_b16 a[8:9], v230
 v_mfma_f32_16x16x32_bf16 v[24:27], a[40:43], a[180:183], v[24:27]
 buffer_load_dwordx4 a[72:75], v213, s[8:11], s36 offen sc1
 v_mfma_f32_16x16x32_bf16 v[72:75], a[40:43], a[184:187], v[72:75]
 ds_read_b64_tr_b16 a[10:11], v230 offset:2048
 v_mfma_f32_16x16x32_bf16 v[88:91], a[40:43], a[188:191], v[88:91]
 s_add_u32 s6, s6, s28
 s_lshl_b32 s6, s6, 4
 v_mfma_f32_16x16x32_bf16 v[92:95], a[44:47], a[188:191], v[92:95]
 ds_read_b64_tr_b16 a[12:13], v231
 v_mfma_f32_16x16x32_bf16 v[76:79], a[44:47], a[184:187], v[76:79]
 buffer_load_dwordx4 a[76:79], v213, s[8:11], s38 offen sc1
 v_mfma_f32_16x16x32_bf16 v[28:31], a[44:47], a[180:183], v[28:31]
 ds_read_b64_tr_b16 a[14:15], v231 offset:2048
 v_mfma_f32_16x16x32_bf16 v[12:15], a[44:47], a[176:179], v[12:15]
 s_waitcnt lgkmcnt(8)
 v_add_lshl_u32 v215, v215, s6, 7
 v_mfma_f32_16x16x32_bf16 v[32:35], a[48:51], a[176:179], v[32:35]
 ds_read_b64_tr_b16 a[16:17], v228 offset:1024
 v_mfma_f32_16x16x32_bf16 v[48:51], a[48:51], a[180:183], v[48:51]
 s_add_u32 m0, s34, 32768
 v_mfma_f32_16x16x32_bf16 v[96:99], a[48:51], a[184:187], v[96:99]
 ds_read_b64_tr_b16 a[18:19], v228 offset:3072
 v_mfma_f32_16x16x32_bf16 v[112:115], a[48:51], a[188:191], v[112:115]
 v_min_u32 v215, L_end-L_ct3-2048, v215
 v_mfma_f32_16x16x32_bf16 v[116:119], a[52:55], a[188:191], v[116:119]
 ds_read_b64_tr_b16 a[20:21], v229 offset:1024
 v_mfma_f32_16x16x32_bf16 v[100:103], a[52:55], a[184:187], v[100:103]
 buffer_load_dwordx4 v244, s[12:15], s33 offen lds
 v_mfma_f32_16x16x32_bf16 v[52:55], a[52:55], a[180:183], v[52:55]
 ds_read_b64_tr_b16 a[22:23], v229 offset:3072
 v_mfma_f32_16x16x32_bf16 v[36:39], a[52:55], a[176:179], v[36:39]
 s_getpc_b64 s[6:7]
L_ct3:
 s_add_u32 s6, s6, 2048
 s_addc_u32 s7, s7, 0
 v_mfma_f32_16x16x32_bf16 v[40:43], a[56:59], a[176:179], v[40:43]
 ds_read_b64_tr_b16 a[24:25], v230 offset:1024
 v_mfma_f32_16x16x32_bf16 v[56:59], a[56:59], a[180:183], v[56:59]
 buffer_load_dwordx4 v245, s[12:15], s33 offen offset:1024 lds
 v_mfma_f32_16x16x32_bf16 v[104:107], a[56:59], a[184:187], v[104:107]
 ds_read_b64_tr_b16 a[26:27], v230 offset:3072
 v_mfma_f32_16x16x32_bf16 v[120:123], a[56:59], a[188:191], v[120:123]
 global_load_dword v252, v215, s[6:7]
 v_mfma_f32_16x16x32_bf16 v[124:127], a[60:63], a[188:191], v[124:127]
 ds_read_b64_tr_b16 a[28:29], v231 offset:1024
 v_mfma_f32_16x16x32_bf16 v[108:111], a[60:63], a[184:187], v[108:111]
 v_mfma_f32_16x16x32_bf16 v[60:63], a[60:63], a[180:183], v[60:63]
 ds_read_b64_tr_b16 a[30:31], v231 offset:3072
 v_mfma_f32_16x16x32_bf16 v[44:47], a[60:63], a[176:179], v[44:47]
 s_waitcnt vmcnt(27) lgkmcnt(8)
 v_mfma_f32_16x16x32_bf16 v[0:3], a[0:3], a[192:195], v[0:3]
 ds_read_b64_tr_b16 a[32:33], v228 offset:8192
 v_mfma_f32_16x16x32_bf16 v[16:19], a[0:3], a[196:199], v[16:19]
 buffer_load_dwordx4 a[80:83], v214, s[8:11], s31 offen sc1
 v_mfma_f32_16x16x32_bf16 v[64:67], a[0:3], a[200:203], v[64:67]
 ds_read_b64_tr_b16 a[34:35], v228 offset:10240
 v_mfma_f32_16x16x32_bf16 v[80:83], a[0:3], a[204:207], v[80:83]
 v_mfma_f32_16x16x32_bf16 v[84:87], a[4:7], a[204:207], v[84:87]
 ds_read_b64_tr_b16 a[36:37], v229 offset:8192
 v_mfma_f32_16x16x32_bf16 v[68:71], a[4:7], a[200:203], v[68:71]
 buffer_load_dwordx4 a[84:87], v214, s[8:11], s32 offen sc1
 s_add_u32 s31, s31, 8192
 s_add_u32 s32, s32, 8192
 v_mfma_f32_16x16x32_bf16 v[20:23], a[4:7], a[196:199], v[20:23]
 ds_read_b64_tr_b16 a[38:39], v229 offset:10240
 v_mfma_f32_16x16x32_bf16 v[4:7], a[4:7], a[192:195], v[4:7]
 v_mfma_f32_16x16x32_bf16 v[8:11], a[8:11], a[192:195], v[8:11]
 ds_read_b64_tr_b16 a[40:41], v230 offset:8192
 v_mfma_f32_16x16x32_bf16 v[24:27], a[8:11], a[196:199], v[24:27]
 v_mfma_f32_16x16x32_bf16 v[72:75], a[8:11], a[200:203], v[72:75]
 ds_read_b64_tr_b16 a[42:43], v230 offset:10240
 v_mfma_f32_16x16x32_bf16 v[88:91], a[8:11], a[204:207], v[88:91]
 buffer_load_dwordx4 a[88:91], v214, s[8:11], s36 offen sc1
 v_mfma_f32_16x16x32_bf16 v[92:95], a[12:15], a[204:207], v[92:95]
 ds_read_b64_tr_b16 a[44:45], v231 offset:8192
 v_mfma_f32_16x16x32_bf16 v[76:79], a[12:15], a[200:203], v[76:79]
 v_mfma_f32_16x16x32_bf16 v[28:31], a[12:15], a[196:199], v[28:31]
 ds_read_b64_tr_b16 a[46:47], v231 offset:10240
 v_mfma_f32_16x16x32_bf16 v[12:15], a[12:15], a[192:195], v[12:15]
 s_waitcnt lgkmcnt(8)
 buffer_load_dwordx4 a[92:95], v214, s[8:11], s38 offen sc1
 s_add_u32 s36, s36, 8192
 s_add_u32 s38, s38, 8192
 v_mfma_f32_16x16x32_bf16 v[32:35], a[16:19], a[192:195], v[32:35]
 ds_read_b64_tr_b16 a[48:49], v228 offset:9216
 v_mfma_f32_16x16x32_bf16 v[48:51], a[16:19], a[196:199], v[48:51]
 v_mfma_f32_16x16x32_bf16 v[96:99], a[16:19], a[200:203], v[96:99]
 ds_read_b64_tr_b16 a[50:51], v228 offset:11264
 v_mfma_f32_16x16x32_bf16 v[112:115], a[16:19], a[204:207], v[112:115]
 v_mfma_f32_16x16x32_bf16 v[116:119], a[20:23], a[204:207], v[116:119]
 ds_read_b64_tr_b16 a[52:53], v229 offset:9216
 v_mfma_f32_16x16x32_bf16 v[100:103], a[20:23], a[200:203], v[100:103]
 buffer_load_dwordx4 v246, s[12:15], s33 offen offset:2048 lds
 v_mfma_f32_16x16x32_bf16 v[52:55], a[20:23], a[196:199], v[52:55]
 ds_read_b64_tr_b16 a[54:55], v229 offset:11264
 v_mfma_f32_16x16x32_bf16 v[36:39], a[20:23], a[192:195], v[36:39]
 v_mfma_f32_16x16x32_bf16 v[40:43], a[24:27], a[192:195], v[40:43]
 ds_read_b64_tr_b16 a[56:57], v230 offset:9216
 v_mfma_f32_16x16x32_bf16 v[56:59], a[24:27], a[196:199], v[56:59]
 buffer_load_dwordx4 v247, s[12:15], s33 offen offset:3072 lds
 s_add_u32 s33, s33, 131072
 v_mfma_f32_16x16x32_bf16 v[104:107], a[24:27], a[200:203], v[104:107]
 ds_read_b64_tr_b16 a[58:59], v230 offset:11264
 v_mfma_f32_16x16x32_bf16 v[120:123], a[24:27], a[204:207], v[120:123]
 v_mfma_f32_16x16x32_bf16 v[124:127], a[28:31], a[204:207], v[124:127]
 ds_read_b64_tr_b16 a[60:61], v231 offset:9216
 v_mfma_f32_16x16x32_bf16 v[108:111], a[28:31], a[200:203], v[108:111]
 v_mfma_f32_16x16x32_bf16 v[60:63], a[28:31], a[196:199], v[60:63]
 ds_read_b64_tr_b16 a[62:63], v231 offset:11264
 v_mfma_f32_16x16x32_bf16 v[44:47], a[28:31], a[192:195], v[44:47]
 s_waitcnt vmcnt(27) lgkmcnt(8)
 s_barrier
 v_mfma_f32_16x16x32_bf16 v[0:3], a[32:35], a[208:211], v[0:3]
 ds_read_b64_tr_b16 a[0:1], v228 offset:16384
 v_mfma_f32_16x16x32_bf16 v[16:19], a[32:35], a[212:215], v[16:19]
 buffer_load_dwordx4 a[96:99], v208, s[8:11], s31 offen sc1
 v_mfma_f32_16x16x32_bf16 v[64:67], a[32:35], a[216:219], v[64:67]
 ds_read_b64_tr_b16 a[2:3], v228 offset:18432
 v_mfma_f32_16x16x32_bf16 v[80:83], a[32:35], a[220:223], v[80:83]
 v_and_b32_e64 v215, 3, v255
 v_mfma_f32_16x16x32_bf16 v[84:87], a[36:39], a[220:223], v[84:87]
 ds_read_b64_tr_b16 a[4:5], v229 offset:16384
 v_mfma_f32_16x16x32_bf16 v[68:71], a[36:39], a[216:219], v[68:71]
 buffer_load_dwordx4 a[100:103], v208, s[8:11], s32 offen sc1
 v_lshlrev_b32_e64 v215, 13, v215
 v_mfma_f32_16x16x32_bf16 v[20:23], a[36:39], a[212:215], v[20:23]
 ds_read_b64_tr_b16 a[6:7], v229 offset:18432
 v_mfma_f32_16x16x32_bf16 v[4:7], a[36:39], a[208:211], v[4:7]
 v_mfma_f32_16x16x32_bf16 v[8:11], a[40:43], a[208:211], v[8:11]
 ds_read_b64_tr_b16 a[8:9], v230 offset:16384
 v_mfma_f32_16x16x32_bf16 v[24:27], a[40:43], a[212:215], v[24:27]
 buffer_load_dwordx4 a[104:107], v208, s[8:11], s36 offen sc1
 v_lshrrev_b32_e64 v252, 2, v255
 v_mfma_f32_16x16x32_bf16 v[72:75], a[40:43], a[216:219], v[72:75]
 ds_read_b64_tr_b16 a[10:11], v230 offset:18432
 v_mfma_f32_16x16x32_bf16 v[88:91], a[40:43], a[220:223], v[88:91]
 v_mfma_f32_16x16x32_bf16 v[92:95], a[44:47], a[220:223], v[92:95]
 ds_read_b64_tr_b16 a[12:13], v231 offset:16384
 v_mfma_f32_16x16x32_bf16 v[76:79], a[44:47], a[216:219], v[76:79]
 buffer_load_dwordx4 a[108:111], v208, s[8:11], s38 offen sc1
 s_mov_b32 s6, 172032
 v_mfma_f32_16x16x32_bf16 v[28:31], a[44:47], a[212:215], v[28:31]
 ds_read_b64_tr_b16 a[14:15], v231 offset:18432
 v_mfma_f32_16x16x32_bf16 v[12:15], a[44:47], a[208:211], v[12:15]
 s_waitcnt lgkmcnt(8)
 v_mfma_f32_16x16x32_bf16 v[32:35], a[48:51], a[208:211], v[32:35]
 ds_read_b64_tr_b16 a[16:17], v228 offset:17408
 v_mfma_f32_16x16x32_bf16 v[48:51], a[48:51], a[212:215], v[48:51]
 s_add_u32 m0, s34, 49152
 v_mad_u32_u24 v215, v252, s6, v215
 v_mfma_f32_16x16x32_bf16 v[96:99], a[48:51], a[216:219], v[96:99]
 ds_read_b64_tr_b16 a[18:19], v228 offset:19456
 v_mfma_f32_16x16x32_bf16 v[112:115], a[48:51], a[220:223], v[112:115]
 v_lshrrev_b32 v252, 3, v255
 v_mfma_f32_16x16x32_bf16 v[116:119], a[52:55], a[220:223], v[116:119]
 ds_read_b64_tr_b16 a[20:21], v229 offset:17408
 v_mfma_f32_16x16x32_bf16 v[100:103], a[52:55], a[216:219], v[100:103]
 buffer_load_dwordx4 v244, s[12:15], s33 offen lds
 v_mfma_f32_16x16x32_bf16 v[52:55], a[52:55], a[212:215], v[52:55]
 ds_read_b64_tr_b16 a[22:23], v229 offset:19456
 v_mfma_f32_16x16x32_bf16 v[36:39], a[52:55], a[208:211], v[36:39]
 v_lshl_add_u32 v215, v252, 28, v215
 v_mfma_f32_16x16x32_bf16 v[40:43], a[56:59], a[208:211], v[40:43]
 ds_read_b64_tr_b16 a[24:25], v230 offset:17408
 v_mfma_f32_16x16x32_bf16 v[56:59], a[56:59], a[212:215], v[56:59]
 buffer_load_dwordx4 v245, s[12:15], s33 offen offset:1024 lds
 v_mfma_f32_16x16x32_bf16 v[104:107], a[56:59], a[216:219], v[104:107]
 ds_read_b64_tr_b16 a[26:27], v230 offset:19456
 v_mfma_f32_16x16x32_bf16 v[120:123], a[56:59], a[220:223], v[120:123]
 buffer_load_dword v252, v215, s[8:11], s44 offen offset:384
 v_mfma_f32_16x16x32_bf16 v[124:127], a[60:63], a[220:223], v[124:127]
 ds_read_b64_tr_b16 a[28:29], v231 offset:17408
 v_mfma_f32_16x16x32_bf16 v[108:111], a[60:63], a[216:219], v[108:111]
 v_mfma_f32_16x16x32_bf16 v[60:63], a[60:63], a[212:215], v[60:63]
 ds_read_b64_tr_b16 a[30:31], v231 offset:19456
 v_mfma_f32_16x16x32_bf16 v[44:47], a[60:63], a[208:211], v[44:47]
 s_waitcnt vmcnt(28) lgkmcnt(8)
 v_mfma_f32_16x16x32_bf16 v[0:3], a[0:3], a[224:227], v[0:3]
 ds_read_b64_tr_b16 a[32:33], v228 offset:24576
 v_mfma_f32_16x16x32_bf16 v[16:19], a[0:3], a[228:231], v[16:19]
 buffer_load_dwordx4 a[112:115], v209, s[8:11], s31 offen sc1
 v_mfma_f32_16x16x32_bf16 v[64:67], a[0:3], a[232:235], v[64:67]
 ds_read_b64_tr_b16 a[34:35], v228 offset:26624
 v_mfma_f32_16x16x32_bf16 v[80:83], a[0:3], a[236:239], v[80:83]
 v_mfma_f32_16x16x32_bf16 v[84:87], a[4:7], a[236:239], v[84:87]
 ds_read_b64_tr_b16 a[36:37], v229 offset:24576
 v_mfma_f32_16x16x32_bf16 v[68:71], a[4:7], a[232:235], v[68:71]
 buffer_load_dwordx4 a[116:119], v209, s[8:11], s32 offen sc1
 v_mfma_f32_16x16x32_bf16 v[20:23], a[4:7], a[228:231], v[20:23]
 ds_read_b64_tr_b16 a[38:39], v229 offset:26624
 v_mfma_f32_16x16x32_bf16 v[4:7], a[4:7], a[224:227], v[4:7]
 v_mfma_f32_16x16x32_bf16 v[8:11], a[8:11], a[224:227], v[8:11]
 ds_read_b64_tr_b16 a[40:41], v230 offset:24576
 v_mfma_f32_16x16x32_bf16 v[24:27], a[8:11], a[228:231], v[24:27]
 v_mfma_f32_16x16x32_bf16 v[72:75], a[8:11], a[232:235], v[72:75]
 ds_read_b64_tr_b16 a[42:43], v230 offset:26624
 v_mfma_f32_16x16x32_bf16 v[88:91], a[8:11], a[236:239], v[88:91]
 buffer_load_dwordx4 a[120:123], v209, s[8:11], s36 offen sc1
 v_mfma_f32_16x16x32_bf16 v[92:95], a[12:15], a[236:239], v[92:95]
 ds_read_b64_tr_b16 a[44:45], v231 offset:24576
 v_mfma_f32_16x16x32_bf16 v[76:79], a[12:15], a[232:235], v[76:79]
 v_mfma_f32_16x16x32_bf16 v[28:31], a[12:15], a[228:231], v[28:31]
 ds_read_b64_tr_b16 a[46:47], v231 offset:26624
 v_mfma_f32_16x16x32_bf16 v[12:15], a[12:15], a[224:227], v[12:15]
 s_waitcnt lgkmcnt(8)
 buffer_load_dwordx4 a[124:127], v209, s[8:11], s38 offen sc1
 v_mfma_f32_16x16x32_bf16 v[32:35], a[16:19], a[224:227], v[32:35]
 ds_read_b64_tr_b16 a[48:49], v228 offset:25600
 v_mfma_f32_16x16x32_bf16 v[48:51], a[16:19], a[228:231], v[48:51]
 v_mfma_f32_16x16x32_bf16 v[96:99], a[16:19], a[232:235], v[96:99]
 ds_read_b64_tr_b16 a[50:51], v228 offset:27648
 v_mfma_f32_16x16x32_bf16 v[112:115], a[16:19], a[236:239], v[112:115]
 v_mfma_f32_16x16x32_bf16 v[116:119], a[20:23], a[236:239], v[116:119]
 ds_read_b64_tr_b16 a[52:53], v229 offset:25600
 v_mfma_f32_16x16x32_bf16 v[100:103], a[20:23], a[232:235], v[100:103]
 buffer_load_dwordx4 v246, s[12:15], s33 offen offset:2048 lds
 v_mfma_f32_16x16x32_bf16 v[52:55], a[20:23], a[228:231], v[52:55]
 ds_read_b64_tr_b16 a[54:55], v229 offset:27648
 v_mfma_f32_16x16x32_bf16 v[36:39], a[20:23], a[224:227], v[36:39]
 v_mfma_f32_16x16x32_bf16 v[40:43], a[24:27], a[224:227], v[40:43]
 ds_read_b64_tr_b16 a[56:57], v230 offset:25600
 v_mfma_f32_16x16x32_bf16 v[56:59], a[24:27], a[228:231], v[56:59]
 buffer_load_dwordx4 v247, s[12:15], s33 offen offset:3072 lds
 s_add_u32 s33, s33, 131072
 v_mfma_f32_16x16x32_bf16 v[104:107], a[24:27], a[232:235], v[104:107]
 ds_read_b64_tr_b16 a[58:59], v230 offset:27648
 v_mfma_f32_16x16x32_bf16 v[120:123], a[24:27], a[236:239], v[120:123]
 v_mfma_f32_16x16x32_bf16 v[124:127], a[28:31], a[236:239], v[124:127]
 ds_read_b64_tr_b16 a[60:61], v231 offset:25600
 v_mfma_f32_16x16x32_bf16 v[108:111], a[28:31], a[232:235], v[108:111]
 v_mfma_f32_16x16x32_bf16 v[60:63], a[28:31], a[228:231], v[60:63]
 ds_read_b64_tr_b16 a[62:63], v231 offset:27648
 v_mfma_f32_16x16x32_bf16 v[44:47], a[28:31], a[224:227], v[44:47]
 s_waitcnt vmcnt(28) lgkmcnt(8)
 s_barrier
 v_mfma_f32_16x16x32_bf16 v[0:3], a[32:35], a[240:243], v[0:3]
 ds_read_b64_tr_b16 a[0:1], v228 offset:32768
 v_mfma_f32_16x16x32_bf16 v[16:19], a[32:35], a[244:247], v[16:19]
 buffer_load_dwordx4 a[128:131], v210, s[8:11], s31 offen sc1
 v_mfma_f32_16x16x32_bf16 v[64:67], a[32:35], a[248:251], v[64:67]
 ds_read_b64_tr_b16 a[2:3], v228 offset:34816
 v_mfma_f32_16x16x32_bf16 v[80:83], a[32:35], a[252:255], v[80:83]
 v_readfirstlane_b32 s6, v233
 v_mfma_f32_16x16x32_bf16 v[84:87], a[36:39], a[252:255], v[84:87]
 ds_read_b64_tr_b16 a[4:5], v229 offset:32768
 v_mfma_f32_16x16x32_bf16 v[68:71], a[36:39], a[248:251], v[68:71]
 buffer_load_dwordx4 a[132:135], v210, s[8:11], s32 offen sc1
 v_mfma_f32_16x16x32_bf16 v[20:23], a[36:39], a[244:247], v[20:23]
 ds_read_b64_tr_b16 a[6:7], v229 offset:34816
 v_mfma_f32_16x16x32_bf16 v[4:7], a[36:39], a[240:243], v[4:7]
 v_lshlrev_b32 v215, 26, v255
 v_mfma_f32_16x16x32_bf16 v[8:11], a[40:43], a[240:243], v[8:11]
 ds_read_b64_tr_b16 a[8:9], v230 offset:32768
 v_mfma_f32_16x16x32_bf16 v[24:27], a[40:43], a[244:247], v[24:27]
 buffer_load_dwordx4 a[136:139], v210, s[8:11], s36 offen sc1
 v_mfma_f32_16x16x32_bf16 v[72:75], a[40:43], a[248:251], v[72:75]
 ds_read_b64_tr_b16 a[10:11], v230 offset:34816
 v_mfma_f32_16x16x32_bf16 v[88:91], a[40:43], a[252:255], v[88:91]
 buffer_load_dword v252, v215, s[16:19], s68 offen sc1
 v_mfma_f32_16x16x32_bf16 v[92:95], a[44:47], a[252:255], v[92:95]
 ds_read_b64_tr_b16 a[12:13], v231 offset:32768
 v_mfma_f32_16x16x32_bf16 v[76:79], a[44:47], a[248:251], v[76:79]
 buffer_load_dwordx4 a[140:143], v210, s[8:11], s38 offen sc1
 v_mfma_f32_16x16x32_bf16 v[28:31], a[44:47], a[244:247], v[28:31]
 ds_read_b64_tr_b16 a[14:15], v231 offset:34816
 v_mfma_f32_16x16x32_bf16 v[12:15], a[44:47], a[240:243], v[12:15]
 s_waitcnt lgkmcnt(8)
 v_mfma_f32_16x16x32_bf16 v[32:35], a[48:51], a[240:243], v[32:35]
 ds_read_b64_tr_b16 a[16:17], v228 offset:33792
 v_mfma_f32_16x16x32_bf16 v[48:51], a[48:51], a[244:247], v[48:51]
 s_add_u32 m0, s34, 65536
 buffer_load_dword v252, v215, s[16:19], s69 offen sc1
 v_mfma_f32_16x16x32_bf16 v[96:99], a[48:51], a[248:251], v[96:99]
 ds_read_b64_tr_b16 a[18:19], v228 offset:35840
 v_mfma_f32_16x16x32_bf16 v[112:115], a[48:51], a[252:255], v[112:115]
 v_mfma_f32_16x16x32_bf16 v[116:119], a[52:55], a[252:255], v[116:119]
 ds_read_b64_tr_b16 a[20:21], v229 offset:33792
 v_mfma_f32_16x16x32_bf16 v[100:103], a[52:55], a[248:251], v[100:103]
 buffer_load_dwordx4 v244, s[12:15], s33 offen lds
 buffer_load_dword v252, v215, s[16:19], s70 offen sc1
 v_mfma_f32_16x16x32_bf16 v[52:55], a[52:55], a[244:247], v[52:55]
 ds_read_b64_tr_b16 a[22:23], v229 offset:35840
 v_mfma_f32_16x16x32_bf16 v[36:39], a[52:55], a[240:243], v[36:39]
 v_mfma_f32_16x16x32_bf16 v[40:43], a[56:59], a[240:243], v[40:43]
 ds_read_b64_tr_b16 a[24:25], v230 offset:33792
 v_mfma_f32_16x16x32_bf16 v[56:59], a[56:59], a[244:247], v[56:59]
 buffer_load_dwordx4 v245, s[12:15], s33 offen offset:1024 lds
 buffer_load_dword v252, v215, s[24:27], s6 offen sc1
 v_mfma_f32_16x16x32_bf16 v[104:107], a[56:59], a[248:251], v[104:107]
 ds_read_b64_tr_b16 a[26:27], v230 offset:35840
 v_mfma_f32_16x16x32_bf16 v[120:123], a[56:59], a[252:255], v[120:123]
 v_mfma_f32_16x16x32_bf16 v[124:127], a[60:63], a[252:255], v[124:127]
 ds_read_b64_tr_b16 a[28:29], v231 offset:33792
 v_mfma_f32_16x16x32_bf16 v[108:111], a[60:63], a[248:251], v[108:111]
 v_mfma_f32_16x16x32_bf16 v[60:63], a[60:63], a[244:247], v[60:63]
 ds_read_b64_tr_b16 a[30:31], v231 offset:35840
 v_mfma_f32_16x16x32_bf16 v[44:47], a[60:63], a[240:243], v[44:47]
 s_waitcnt vmcnt(32) lgkmcnt(8)
 v_mfma_f32_16x16x32_bf16 v[0:3], a[0:3], a[64:67], v[0:3]
 ds_read_b64_tr_b16 a[32:33], v228 offset:40960
 v_mfma_f32_16x16x32_bf16 v[16:19], a[0:3], a[68:71], v[16:19]
 buffer_load_dwordx4 a[144:147], v211, s[8:11], s31 offen sc1
 v_mfma_f32_16x16x32_bf16 v[64:67], a[0:3], a[72:75], v[64:67]
 ds_read_b64_tr_b16 a[34:35], v228 offset:43008
 v_mfma_f32_16x16x32_bf16 v[80:83], a[0:3], a[76:79], v[80:83]
 v_mfma_f32_16x16x32_bf16 v[84:87], a[4:7], a[76:79], v[84:87]
 ds_read_b64_tr_b16 a[36:37], v229 offset:40960
 v_mfma_f32_16x16x32_bf16 v[68:71], a[4:7], a[72:75], v[68:71]
 buffer_load_dwordx4 a[148:151], v211, s[8:11], s32 offen sc1
 v_mfma_f32_16x16x32_bf16 v[20:23], a[4:7], a[68:71], v[20:23]
 ds_read_b64_tr_b16 a[38:39], v229 offset:43008
 v_mfma_f32_16x16x32_bf16 v[4:7], a[4:7], a[64:67], v[4:7]
 v_mfma_f32_16x16x32_bf16 v[8:11], a[8:11], a[64:67], v[8:11]
 ds_read_b64_tr_b16 a[40:41], v230 offset:40960
 v_mfma_f32_16x16x32_bf16 v[24:27], a[8:11], a[68:71], v[24:27]
 v_mfma_f32_16x16x32_bf16 v[72:75], a[8:11], a[72:75], v[72:75]
 ds_read_b64_tr_b16 a[42:43], v230 offset:43008
 v_mfma_f32_16x16x32_bf16 v[88:91], a[8:11], a[76:79], v[88:91]
 buffer_load_dwordx4 a[152:155], v211, s[8:11], s36 offen sc1
 v_mfma_f32_16x16x32_bf16 v[92:95], a[12:15], a[76:79], v[92:95]
 ds_read_b64_tr_b16 a[44:45], v231 offset:40960
 v_mfma_f32_16x16x32_bf16 v[76:79], a[12:15], a[72:75], v[76:79]
 v_mfma_f32_16x16x32_bf16 v[28:31], a[12:15], a[68:71], v[28:31]
 ds_read_b64_tr_b16 a[46:47], v231 offset:43008
 v_mfma_f32_16x16x32_bf16 v[12:15], a[12:15], a[64:67], v[12:15]
 s_waitcnt lgkmcnt(8)
 buffer_load_dwordx4 a[156:159], v211, s[8:11], s38 offen sc1
 v_mfma_f32_16x16x32_bf16 v[32:35], a[16:19], a[64:67], v[32:35]
 ds_read_b64_tr_b16 a[48:49], v228 offset:41984
 v_mfma_f32_16x16x32_bf16 v[48:51], a[16:19], a[68:71], v[48:51]
 v_mfma_f32_16x16x32_bf16 v[96:99], a[16:19], a[72:75], v[96:99]
 ds_read_b64_tr_b16 a[50:51], v228 offset:44032
 v_mfma_f32_16x16x32_bf16 v[112:115], a[16:19], a[76:79], v[112:115]
 v_mfma_f32_16x16x32_bf16 v[116:119], a[20:23], a[76:79], v[116:119]
 ds_read_b64_tr_b16 a[52:53], v229 offset:41984
 v_mfma_f32_16x16x32_bf16 v[100:103], a[20:23], a[72:75], v[100:103]
 buffer_load_dwordx4 v246, s[12:15], s33 offen offset:2048 lds
 v_mfma_f32_16x16x32_bf16 v[52:55], a[20:23], a[68:71], v[52:55]
 ds_read_b64_tr_b16 a[54:55], v229 offset:44032
 v_mfma_f32_16x16x32_bf16 v[36:39], a[20:23], a[64:67], v[36:39]
 v_mfma_f32_16x16x32_bf16 v[40:43], a[24:27], a[64:67], v[40:43]
 ds_read_b64_tr_b16 a[56:57], v230 offset:41984
 v_mfma_f32_16x16x32_bf16 v[56:59], a[24:27], a[68:71], v[56:59]
 buffer_load_dwordx4 v247, s[12:15], s33 offen offset:3072 lds
 s_add_u32 s33, s33, 131072
 v_mfma_f32_16x16x32_bf16 v[104:107], a[24:27], a[72:75], v[104:107]
 ds_read_b64_tr_b16 a[58:59], v230 offset:44032
 v_mfma_f32_16x16x32_bf16 v[120:123], a[24:27], a[76:79], v[120:123]
 v_mfma_f32_16x16x32_bf16 v[124:127], a[28:31], a[76:79], v[124:127]
 ds_read_b64_tr_b16 a[60:61], v231 offset:41984
 v_mfma_f32_16x16x32_bf16 v[108:111], a[28:31], a[72:75], v[108:111]
 v_mfma_f32_16x16x32_bf16 v[60:63], a[28:31], a[68:71], v[60:63]
 ds_read_b64_tr_b16 a[62:63], v231 offset:44032
 v_mfma_f32_16x16x32_bf16 v[44:47], a[28:31], a[64:67], v[44:47]
 s_waitcnt vmcnt(31) lgkmcnt(8)
 s_barrier
 v_mfma_f32_16x16x32_bf16 v[0:3], a[32:35], a[80:83], v[0:3]
 ds_read_b64_tr_b16 a[0:1], v228 offset:49152
 v_mfma_f32_16x16x32_bf16 v[16:19], a[32:35], a[84:87], v[16:19]
 buffer_load_dwordx4 a[160:163], v212, s[8:11], s31 offen sc1
 v_mfma_f32_16x16x32_bf16 v[64:67], a[32:35], a[88:91], v[64:67]
 ds_read_b64_tr_b16 a[2:3], v228 offset:51200
 v_mfma_f32_16x16x32_bf16 v[80:83], a[32:35], a[92:95], v[80:83]
 v_mfma_f32_16x16x32_bf16 v[84:87], a[36:39], a[92:95], v[84:87]
 ds_read_b64_tr_b16 a[4:5], v229 offset:49152
 v_mfma_f32_16x16x32_bf16 v[68:71], a[36:39], a[88:91], v[68:71]
 buffer_load_dwordx4 a[164:167], v212, s[8:11], s32 offen sc1
 v_mfma_f32_16x16x32_bf16 v[20:23], a[36:39], a[84:87], v[20:23]
 ds_read_b64_tr_b16 a[6:7], v229 offset:51200
 v_mfma_f32_16x16x32_bf16 v[4:7], a[36:39], a[80:83], v[4:7]
 v_mfma_f32_16x16x32_bf16 v[8:11], a[40:43], a[80:83], v[8:11]
 ds_read_b64_tr_b16 a[8:9], v230 offset:49152
 v_mfma_f32_16x16x32_bf16 v[24:27], a[40:43], a[84:87], v[24:27]
 buffer_load_dwordx4 a[168:171], v212, s[8:11], s36 offen sc1
 v_mfma_f32_16x16x32_bf16 v[72:75], a[40:43], a[88:91], v[72:75]
 ds_read_b64_tr_b16 a[10:11], v230 offset:51200
 v_mfma_f32_16x16x32_bf16 v[88:91], a[40:43], a[92:95], v[88:91]
 v_mfma_f32_16x16x32_bf16 v[92:95], a[44:47], a[92:95], v[92:95]
 ds_read_b64_tr_b16 a[12:13], v231 offset:49152
 v_mfma_f32_16x16x32_bf16 v[76:79], a[44:47], a[88:91], v[76:79]
 buffer_load_dwordx4 a[172:175], v212, s[8:11], s38 offen sc1
 v_mfma_f32_16x16x32_bf16 v[28:31], a[44:47], a[84:87], v[28:31]
 ds_read_b64_tr_b16 a[14:15], v231 offset:51200
 v_mfma_f32_16x16x32_bf16 v[12:15], a[44:47], a[80:83], v[12:15]
 s_waitcnt lgkmcnt(8)
 v_mfma_f32_16x16x32_bf16 v[32:35], a[48:51], a[80:83], v[32:35]
 ds_read_b64_tr_b16 a[16:17], v228 offset:50176
 v_mfma_f32_16x16x32_bf16 v[48:51], a[48:51], a[84:87], v[48:51]
 s_add_u32 m0, s34, 81920
 v_mfma_f32_16x16x32_bf16 v[96:99], a[48:51], a[88:91], v[96:99]
 ds_read_b64_tr_b16 a[18:19], v228 offset:52224
 v_mfma_f32_16x16x32_bf16 v[112:115], a[48:51], a[92:95], v[112:115]
 v_mfma_f32_16x16x32_bf16 v[116:119], a[52:55], a[92:95], v[116:119]
 ds_read_b64_tr_b16 a[20:21], v229 offset:50176
 v_mfma_f32_16x16x32_bf16 v[100:103], a[52:55], a[88:91], v[100:103]
 buffer_load_dwordx4 v244, s[12:15], s33 offen lds
 v_mfma_f32_16x16x32_bf16 v[52:55], a[52:55], a[84:87], v[52:55]
 ds_read_b64_tr_b16 a[22:23], v229 offset:52224
 v_mfma_f32_16x16x32_bf16 v[36:39], a[52:55], a[80:83], v[36:39]
 v_mfma_f32_16x16x32_bf16 v[40:43], a[56:59], a[80:83], v[40:43]
 ds_read_b64_tr_b16 a[24:25], v230 offset:50176
 v_mfma_f32_16x16x32_bf16 v[56:59], a[56:59], a[84:87], v[56:59]
 buffer_load_dwordx4 v245, s[12:15], s33 offen offset:1024 lds
 v_mfma_f32_16x16x32_bf16 v[104:107], a[56:59], a[88:91], v[104:107]
 ds_read_b64_tr_b16 a[26:27], v230 offset:52224
 v_mfma_f32_16x16x32_bf16 v[120:123], a[56:59], a[92:95], v[120:123]
 v_mfma_f32_16x16x32_bf16 v[124:127], a[60:63], a[92:95], v[124:127]
 ds_read_b64_tr_b16 a[28:29], v231 offset:50176
 v_mfma_f32_16x16x32_bf16 v[108:111], a[60:63], a[88:91], v[108:111]
 v_mfma_f32_16x16x32_bf16 v[60:63], a[60:63], a[84:87], v[60:63]
 ds_read_b64_tr_b16 a[30:31], v231 offset:52224
 v_mfma_f32_16x16x32_bf16 v[44:47], a[60:63], a[80:83], v[44:47]
 s_waitcnt vmcnt(31) lgkmcnt(8)
 v_mfma_f32_16x16x32_bf16 v[0:3], a[0:3], a[96:99], v[0:3]
 ds_read_b64_tr_b16 a[32:33], v228 offset:57344
 v_mfma_f32_16x16x32_bf16 v[16:19], a[0:3], a[100:103], v[16:19]
 buffer_load_dwordx4 a[176:179], v213, s[8:11], s31 offen sc1
 v_mfma_f32_16x16x32_bf16 v[64:67], a[0:3], a[104:107], v[64:67]
 ds_read_b64_tr_b16 a[34:35], v228 offset:59392
 v_mfma_f32_16x16x32_bf16 v[80:83], a[0:3], a[108:111], v[80:83]
 v_mfma_f32_16x16x32_bf16 v[84:87], a[4:7], a[108:111], v[84:87]
 ds_read_b64_tr_b16 a[36:37], v229 offset:57344
 v_mfma_f32_16x16x32_bf16 v[68:71], a[4:7], a[104:107], v[68:71]
 buffer_load_dwordx4 a[180:183], v213, s[8:11], s32 offen sc1
 v_mfma_f32_16x16x32_bf16 v[20:23], a[4:7], a[100:103], v[20:23]
 ds_read_b64_tr_b16 a[38:39], v229 offset:59392
 v_mfma_f32_16x16x32_bf16 v[4:7], a[4:7], a[96:99], v[4:7]
 v_mfma_f32_16x16x32_bf16 v[8:11], a[8:11], a[96:99], v[8:11]
 ds_read_b64_tr_b16 a[40:41], v230 offset:57344
 v_mfma_f32_16x16x32_bf16 v[24:27], a[8:11], a[100:103], v[24:27]
 v_mfma_f32_16x16x32_bf16 v[72:75], a[8:11], a[104:107], v[72:75]
 ds_read_b64_tr_b16 a[42:43], v230 offset:59392
 v_mfma_f32_16x16x32_bf16 v[88:91], a[8:11], a[108:111], v[88:91]
 buffer_load_dwordx4 a[184:187], v213, s[8:11], s36 offen sc1
 v_mfma_f32_16x16x32_bf16 v[92:95], a[12:15], a[108:111], v[92:95]
 ds_read_b64_tr_b16 a[44:45], v231 offset:57344
 v_mfma_f32_16x16x32_bf16 v[76:79], a[12:15], a[104:107], v[76:79]
 v_mfma_f32_16x16x32_bf16 v[28:31], a[12:15], a[100:103], v[28:31]
 ds_read_b64_tr_b16 a[46:47], v231 offset:59392
 v_mfma_f32_16x16x32_bf16 v[12:15], a[12:15], a[96:99], v[12:15]
 s_waitcnt lgkmcnt(8)
 buffer_load_dwordx4 a[188:191], v213, s[8:11], s38 offen sc1
 v_mfma_f32_16x16x32_bf16 v[32:35], a[16:19], a[96:99], v[32:35]
 ds_read_b64_tr_b16 a[48:49], v228 offset:58368
 v_mfma_f32_16x16x32_bf16 v[48:51], a[16:19], a[100:103], v[48:51]
 v_mfma_f32_16x16x32_bf16 v[96:99], a[16:19], a[104:107], v[96:99]
 ds_read_b64_tr_b16 a[50:51], v228 offset:60416
 v_mfma_f32_16x16x32_bf16 v[112:115], a[16:19], a[108:111], v[112:115]
 v_mfma_f32_16x16x32_bf16 v[116:119], a[20:23], a[108:111], v[116:119]
 ds_read_b64_tr_b16 a[52:53], v229 offset:58368
 v_mfma_f32_16x16x32_bf16 v[100:103], a[20:23], a[104:107], v[100:103]
 buffer_load_dwordx4 v246, s[12:15], s33 offen offset:2048 lds
 v_mfma_f32_16x16x32_bf16 v[52:55], a[20:23], a[100:103], v[52:55]
 ds_read_b64_tr_b16 a[54:55], v229 offset:60416
 v_mfma_f32_16x16x32_bf16 v[36:39], a[20:23], a[96:99], v[36:39]
 v_mfma_f32_16x16x32_bf16 v[40:43], a[24:27], a[96:99], v[40:43]
 ds_read_b64_tr_b16 a[56:57], v230 offset:58368
 v_mfma_f32_16x16x32_bf16 v[56:59], a[24:27], a[100:103], v[56:59]
 buffer_load_dwordx4 v247, s[12:15], s33 offen offset:3072 lds
 v_mfma_f32_16x16x32_bf16 v[104:107], a[24:27], a[104:107], v[104:107]
 ds_read_b64_tr_b16 a[58:59], v230 offset:60416
 v_mfma_f32_16x16x32_bf16 v[120:123], a[24:27], a[108:111], v[120:123]
 v_mfma_f32_16x16x32_bf16 v[124:127], a[28:31], a[108:111], v[124:127]
 ds_read_b64_tr_b16 a[60:61], v231 offset:58368
 v_mfma_f32_16x16x32_bf16 v[108:111], a[28:31], a[104:107], v[108:111]
 v_mfma_f32_16x16x32_bf16 v[60:63], a[28:31], a[100:103], v[60:63]
 ds_read_b64_tr_b16 a[62:63], v231 offset:60416
 v_mfma_f32_16x16x32_bf16 v[44:47], a[28:31], a[96:99], v[44:47]
 s_waitcnt vmcnt(30) lgkmcnt(8)
 s_barrier
 v_mfma_f32_16x16x32_bf16 v[0:3], a[32:35], a[112:115], v[0:3]
 ds_read_b64_tr_b16 a[0:1], v224
 v_mfma_f32_16x16x32_bf16 v[16:19], a[32:35], a[116:119], v[16:19]
 buffer_load_dwordx4 a[200:203], v214, s[8:11], s36 offen sc1
 v_mfma_f32_16x16x32_bf16 v[64:67], a[32:35], a[120:123], v[64:67]
 ds_read_b64_tr_b16 a[2:3], v224 offset:2048
 v_mfma_f32_16x16x32_bf16 v[80:83], a[32:35], a[124:127], v[80:83]
 buffer_load_dwordx4 a[204:207], v214, s[8:11], s38 offen sc1
 s_add_u32 s36, s36, 8192
 s_add_u32 s38, s38, 8192
 v_mfma_f32_16x16x32_bf16 v[84:87], a[36:39], a[124:127], v[84:87]
 ds_read_b64_tr_b16 a[4:5], v225
 v_mfma_f32_16x16x32_bf16 v[68:71], a[36:39], a[120:123], v[68:71]
 buffer_load_dwordx4 a[216:219], v208, s[8:11], s36 offen sc1
 v_mfma_f32_16x16x32_bf16 v[20:23], a[36:39], a[116:119], v[20:23]
 ds_read_b64_tr_b16 a[6:7], v225 offset:2048
 v_mfma_f32_16x16x32_bf16 v[4:7], a[36:39], a[112:115], v[4:7]
 buffer_load_dwordx4 a[220:223], v208, s[8:11], s38 offen sc1
 v_mfma_f32_16x16x32_bf16 v[8:11], a[40:43], a[112:115], v[8:11]
 ds_read_b64_tr_b16 a[8:9], v226
 v_mfma_f32_16x16x32_bf16 v[24:27], a[40:43], a[116:119], v[24:27]
 v_mfma_f32_16x16x32_bf16 v[72:75], a[40:43], a[120:123], v[72:75]
 ds_read_b64_tr_b16 a[10:11], v226 offset:2048
 v_mfma_f32_16x16x32_bf16 v[88:91], a[40:43], a[124:127], v[88:91]
 s_sub_u32 s12, s54, 4096
 s_subb_u32 s13, s55, 0
 v_mfma_f32_16x16x32_bf16 v[92:95], a[44:47], a[124:127], v[92:95]
 ds_read_b64_tr_b16 a[12:13], v227
 v_mfma_f32_16x16x32_bf16 v[76:79], a[44:47], a[120:123], v[76:79]
 s_mov_b32 s14, 0x201000
 s_mov_b32 s33, 0
 v_mfma_f32_16x16x32_bf16 v[28:31], a[44:47], a[116:119], v[28:31]
 ds_read_b64_tr_b16 a[14:15], v227 offset:2048
 v_mfma_f32_16x16x32_bf16 v[12:15], a[44:47], a[112:115], v[12:15]
 s_waitcnt lgkmcnt(8)
 s_lshl_b32 s3, s28, 15
 v_add_u32_e64 v244, s3, v244
 v_mfma_f32_16x16x32_bf16 v[32:35], a[48:51], a[112:115], v[32:35]
 ds_read_b64_tr_b16 a[16:17], v224 offset:1024
 v_mfma_f32_16x16x32_bf16 v[48:51], a[48:51], a[116:119], v[48:51]
 v_add_u32 v245, 15360, v244
 v_mfma_f32_16x16x32_bf16 v[96:99], a[48:51], a[120:123], v[96:99]
 ds_read_b64_tr_b16 a[18:19], v224 offset:3072
 v_mfma_f32_16x16x32_bf16 v[112:115], a[48:51], a[124:127], v[112:115]
 v_mfma_f32_16x16x32_bf16 v[116:119], a[52:55], a[124:127], v[116:119]
 ds_read_b64_tr_b16 a[20:21], v225 offset:1024
 v_mfma_f32_16x16x32_bf16 v[100:103], a[52:55], a[120:123], v[100:103]
 v_add_u32 v246, 30720, v244
 v_add_u32 v247, 46080, v244
 v_mfma_f32_16x16x32_bf16 v[52:55], a[52:55], a[116:119], v[52:55]
 ds_read_b64_tr_b16 a[22:23], v225 offset:3072
 v_mfma_f32_16x16x32_bf16 v[36:39], a[52:55], a[112:115], v[36:39]
 s_add_u32 m0, s34, 98304
 v_mfma_f32_16x16x32_bf16 v[40:43], a[56:59], a[112:115], v[40:43]
 ds_read_b64_tr_b16 a[24:25], v226 offset:1024
 v_mfma_f32_16x16x32_bf16 v[56:59], a[56:59], a[116:119], v[56:59]
 buffer_load_dwordx4 v244, s[12:15], s33 offen lds
 v_mfma_f32_16x16x32_bf16 v[104:107], a[56:59], a[120:123], v[104:107]
 ds_read_b64_tr_b16 a[26:27], v226 offset:3072
 v_mfma_f32_16x16x32_bf16 v[120:123], a[56:59], a[124:127], v[120:123]
 buffer_load_dwordx4 v245, s[12:15], s33 offen offset:1024 lds
 v_mfma_f32_16x16x32_bf16 v[124:127], a[60:63], a[124:127], v[124:127]
 ds_read_b64_tr_b16 a[28:29], v227 offset:1024
 v_mfma_f32_16x16x32_bf16 v[108:111], a[60:63], a[120:123], v[108:111]
 v_mfma_f32_16x16x32_bf16 v[60:63], a[60:63], a[116:119], v[60:63]
 ds_read_b64_tr_b16 a[30:31], v227 offset:3072
 v_mfma_f32_16x16x32_bf16 v[44:47], a[60:63], a[112:115], v[44:47]
 s_waitcnt vmcnt(29) lgkmcnt(8)
 v_mfma_f32_16x16x32_bf16 v[0:3], a[0:3], a[128:131], v[0:3]
 ds_read_b64_tr_b16 a[32:33], v224 offset:8192
 v_mfma_f32_16x16x32_bf16 v[16:19], a[0:3], a[132:135], v[16:19]
 buffer_load_dwordx4 a[232:235], v209, s[8:11], s36 offen sc1
 v_mfma_f32_16x16x32_bf16 v[64:67], a[0:3], a[136:139], v[64:67]
 ds_read_b64_tr_b16 a[34:35], v224 offset:10240
 v_mfma_f32_16x16x32_bf16 v[80:83], a[0:3], a[140:143], v[80:83]
 buffer_load_dwordx4 a[236:239], v209, s[8:11], s38 offen sc1
 v_min_u32 v215, 15, v255
 v_mfma_f32_16x16x32_bf16 v[84:87], a[4:7], a[140:143], v[84:87]
 ds_read_b64_tr_b16 a[36:37], v225 offset:8192
 v_mfma_f32_16x16x32_bf16 v[68:71], a[4:7], a[136:139], v[68:71]
 v_mfma_f32_16x16x32_bf16 v[20:23], a[4:7], a[132:135], v[20:23]
 ds_read_b64_tr_b16 a[38:39], v225 offset:10240
 v_mfma_f32_16x16x32_bf16 v[4:7], a[4:7], a[128:131], v[4:7]
 buffer_load_dwordx4 a[248:251], v210, s[8:11], s36 offen sc1
 s_bfe_u32 s6, s2, 0x20006
 s_lshl_b32 s6, s6, 2
 v_mfma_f32_16x16x32_bf16 v[8:11], a[8:11], a[128:131], v[8:11]
 ds_read_b64_tr_b16 a[40:41], v226 offset:8192
 v_mfma_f32_16x16x32_bf16 v[24:27], a[8:11], a[132:135], v[24:27]
 v_mfma_f32_16x16x32_bf16 v[72:75], a[8:11], a[136:139], v[72:75]
 ds_read_b64_tr_b16 a[42:43], v226 offset:10240
 v_mfma_f32_16x16x32_bf16 v[88:91], a[8:11], a[140:143], v[88:91]
 buffer_load_dwordx4 a[252:255], v210, s[8:11], s38 offen sc1
 s_add_u32 s6, s6, s28
 s_lshl_b32 s6, s6, 4
 v_mfma_f32_16x16x32_bf16 v[92:95], a[12:15], a[140:143], v[92:95]
 ds_read_b64_tr_b16 a[44:45], v227 offset:8192
 v_mfma_f32_16x16x32_bf16 v[76:79], a[12:15], a[136:139], v[76:79]
 v_mfma_f32_16x16x32_bf16 v[28:31], a[12:15], a[132:135], v[28:31]
 ds_read_b64_tr_b16 a[46:47], v227 offset:10240
 v_mfma_f32_16x16x32_bf16 v[12:15], a[12:15], a[128:131], v[12:15]
 s_waitcnt lgkmcnt(8)
 buffer_load_dwordx4 a[72:75], v211, s[8:11], s36 offen sc1
 v_add_lshl_u32 v215, v215, s6, 7
 v_mfma_f32_16x16x32_bf16 v[32:35], a[16:19], a[128:131], v[32:35]
 ds_read_b64_tr_b16 a[48:49], v224 offset:9216
 v_mfma_f32_16x16x32_bf16 v[48:51], a[16:19], a[132:135], v[48:51]
 v_mfma_f32_16x16x32_bf16 v[96:99], a[16:19], a[136:139], v[96:99]
 ds_read_b64_tr_b16 a[50:51], v224 offset:11264
 v_mfma_f32_16x16x32_bf16 v[112:115], a[16:19], a[140:143], v[112:115]
 buffer_load_dwordx4 a[76:79], v211, s[8:11], s38 offen sc1
 v_min_u32 v215, L_end-L_ct4-2048, v215
 v_mfma_f32_16x16x32_bf16 v[116:119], a[20:23], a[140:143], v[116:119]
 ds_read_b64_tr_b16 a[52:53], v225 offset:9216
 v_mfma_f32_16x16x32_bf16 v[100:103], a[20:23], a[136:139], v[100:103]
 v_mfma_f32_16x16x32_bf16 v[52:55], a[20:23], a[132:135], v[52:55]
 ds_read_b64_tr_b16 a[54:55], v225 offset:11264
 v_mfma_f32_16x16x32_bf16 v[36:39], a[20:23], a[128:131], v[36:39]
 buffer_load_dwordx4 v246, s[12:15], s33 offen offset:2048 lds
 s_getpc_b64 s[6:7]
L_ct4:
 s_add_u32 s6, s6, 2048
 s_addc_u32 s7, s7, 0
 v_mfma_f32_16x16x32_bf16 v[40:43], a[24:27], a[128:131], v[40:43]
 ds_read_b64_tr_b16 a[56:57], v226 offset:9216
 v_mfma_f32_16x16x32_bf16 v[56:59], a[24:27], a[132:135], v[56:59]
 v_mfma_f32_16x16x32_bf16 v[104:107], a[24:27], a[136:139], v[104:107]
 ds_read_b64_tr_b16 a[58:59], v226 offset:11264
 v_mfma_f32_16x16x32_bf16 v[120:123], a[24:27], a[140:143], v[120:123]
 buffer_load_dwordx4 v247, s[12:15], s33 offen offset:3072 lds
 s_add_u32 s33, s33, 262144
 global_load_dword v252, v215, s[6:7]
 v_mfma_f32_16x16x32_bf16 v[124:127], a[28:31], a[140:143], v[124:127]
 ds_read_b64_tr_b16 a[60:61], v227 offset:9216
 v_mfma_f32_16x16x32_bf16 v[108:111], a[28:31], a[136:139], v[108:111]
 v_mfma_f32_16x16x32_bf16 v[60:63], a[28:31], a[132:135], v[60:63]
 ds_read_b64_tr_b16 a[62:63], v227 offset:11264
 v_mfma_f32_16x16x32_bf16 v[44:47], a[28:31], a[128:131], v[44:47]
 s_waitcnt vmcnt(29) lgkmcnt(8)
 s_barrier
 v_mfma_f32_16x16x32_bf16 v[0:3], a[32:35], a[144:147], v[0:3]
 ds_read_b64_tr_b16 a[0:1], v224 offset:16384
 v_mfma_f32_16x16x32_bf16 v[16:19], a[32:35], a[148:151], v[16:19]
 buffer_load_dwordx4 a[88:91], v212, s[8:11], s36 offen sc1
 v_mfma_f32_16x16x32_bf16 v[64:67], a[32:35], a[152:155], v[64:67]
 ds_read_b64_tr_b16 a[2:3], v224 offset:18432
 v_mfma_f32_16x16x32_bf16 v[80:83], a[32:35], a[156:159], v[80:83]
 buffer_load_dwordx4 a[92:95], v212, s[8:11], s38 offen sc1
 v_mfma_f32_16x16x32_bf16 v[84:87], a[36:39], a[156:159], v[84:87]
 ds_read_b64_tr_b16 a[4:5], v225 offset:16384
 v_mfma_f32_16x16x32_bf16 v[68:71], a[36:39], a[152:155], v[68:71]
 v_mfma_f32_16x16x32_bf16 v[20:23], a[36:39], a[148:151], v[20:23]
 ds_read_b64_tr_b16 a[6:7], v225 offset:18432
 v_mfma_f32_16x16x32_bf16 v[4:7], a[36:39], a[144:147], v[4:7]
 buffer_load_dwordx4 a[104:107], v213, s[8:11], s36 offen sc1
 v_mfma_f32_16x16x32_bf16 v[8:11], a[40:43], a[144:147], v[8:11]
 ds_read_b64_tr_b16 a[8:9], v226 offset:16384
 v_mfma_f32_16x16x32_bf16 v[24:27], a[40:43], a[148:151], v[24:27]
 v_mfma_f32_16x16x32_bf16 v[72:75], a[40:43], a[152:155], v[72:75]
 ds_read_b64_tr_b16 a[10:11], v226 offset:18432
 v_mfma_f32_16x16x32_bf16 v[88:91], a[40:43], a[156:159], v[88:91]
 buffer_load_dwordx4 a[108:111], v213, s[8:11], s38 offen sc1
 v_mfma_f32_16x16x32_bf16 v[92:95], a[44:47], a[156:159], v[92:95]
 ds_read_b64_tr_b16 a[12:13], v227 offset:16384
 v_mfma_f32_16x16x32_bf16 v[76:79], a[44:47], a[152:155], v[76:79]
 buffer_load_dwordx4 a[120:123], v214, s[8:11], s36 offen sc1
 v_mfma_f32_16x16x32_bf16 v[28:31], a[44:47], a[148:151], v[28:31]
 ds_read_b64_tr_b16 a[14:15], v227 offset:18432
 v_mfma_f32_16x16x32_bf16 v[12:15], a[44:47], a[144:147], v[12:15]
 s_waitcnt lgkmcnt(8)
 v_mfma_f32_16x16x32_bf16 v[32:35], a[48:51], a[144:147], v[32:35]
 ds_read_b64_tr_b16 a[16:17], v224 offset:17408
 v_mfma_f32_16x16x32_bf16 v[48:51], a[48:51], a[148:151], v[48:51]
 buffer_load_dwordx4 a[124:127], v214, s[8:11], s38 offen sc1
 v_mfma_f32_16x16x32_bf16 v[96:99], a[48:51], a[152:155], v[96:99]
 ds_read_b64_tr_b16 a[18:19], v224 offset:19456
 v_mfma_f32_16x16x32_bf16 v[112:115], a[48:51], a[156:159], v[112:115]
 v_mfma_f32_16x16x32_bf16 v[116:119], a[52:55], a[156:159], v[116:119]
 ds_read_b64_tr_b16 a[20:21], v225 offset:17408
 v_mfma_f32_16x16x32_bf16 v[100:103], a[52:55], a[152:155], v[100:103]
 s_add_u32 m0, s34, 114688
 v_mfma_f32_16x16x32_bf16 v[52:55], a[52:55], a[148:151], v[52:55]
 ds_read_b64_tr_b16 a[22:23], v225 offset:19456
 v_mfma_f32_16x16x32_bf16 v[36:39], a[52:55], a[144:147], v[36:39]
 buffer_load_dwordx4 v244, s[12:15], s33 offen lds
 v_mfma_f32_16x16x32_bf16 v[40:43], a[56:59], a[144:147], v[40:43]
 ds_read_b64_tr_b16 a[24:25], v226 offset:17408
 v_mfma_f32_16x16x32_bf16 v[56:59], a[56:59], a[148:151], v[56:59]
 v_mfma_f32_16x16x32_bf16 v[104:107], a[56:59], a[152:155], v[104:107]
 ds_read_b64_tr_b16 a[26:27], v226 offset:19456
 v_mfma_f32_16x16x32_bf16 v[120:123], a[56:59], a[156:159], v[120:123]
 buffer_load_dwordx4 v245, s[12:15], s33 offen offset:1024 lds
 v_mfma_f32_16x16x32_bf16 v[124:127], a[60:63], a[156:159], v[124:127]
 ds_read_b64_tr_b16 a[28:29], v227 offset:17408
 v_mfma_f32_16x16x32_bf16 v[108:111], a[60:63], a[152:155], v[108:111]
 v_mfma_f32_16x16x32_bf16 v[60:63], a[60:63], a[148:151], v[60:63]
 ds_read_b64_tr_b16 a[30:31], v227 offset:19456
 v_mfma_f32_16x16x32_bf16 v[44:47], a[60:63], a[144:147], v[44:47]
 s_waitcnt vmcnt(31) lgkmcnt(8)
 v_mfma_f32_16x16x32_bf16 v[0:3], a[0:3], a[160:163], v[0:3]
 ds_read_b64_tr_b16 a[32:33], v224 offset:24576
 v_mfma_f32_16x16x32_bf16 v[16:19], a[0:3], a[164:167], v[16:19]
 buffer_load_dwordx4 a[192:195], v214, s[8:11], s31 offen sc1
 v_mfma_f32_16x16x32_bf16 v[64:67], a[0:3], a[168:171], v[64:67]
 ds_read_b64_tr_b16 a[34:35], v224 offset:26624
 v_mfma_f32_16x16x32_bf16 v[80:83], a[0:3], a[172:175], v[80:83]
 buffer_load_dwordx4 a[196:199], v214, s[8:11], s32 offen sc1
 s_add_u32 s31, s31, 8192
 s_add_u32 s32, s32, 8192
 v_mfma_f32_16x16x32_bf16 v[84:87], a[4:7], a[172:175], v[84:87]
 ds_read_b64_tr_b16 a[36:37], v225 offset:24576
 v_mfma_f32_16x16x32_bf16 v[68:71], a[4:7], a[168:171], v[68:71]
 v_mfma_f32_16x16x32_bf16 v[20:23], a[4:7], a[164:167], v[20:23]
 ds_read_b64_tr_b16 a[38:39], v225 offset:26624
 v_mfma_f32_16x16x32_bf16 v[4:7], a[4:7], a[160:163], v[4:7]
 buffer_load_dwordx4 a[208:211], v208, s[8:11], s31 offen sc1
 v_mfma_f32_16x16x32_bf16 v[8:11], a[8:11], a[160:163], v[8:11]
 ds_read_b64_tr_b16 a[40:41], v226 offset:24576
 v_mfma_f32_16x16x32_bf16 v[24:27], a[8:11], a[164:167], v[24:27]
 v_mfma_f32_16x16x32_bf16 v[72:75], a[8:11], a[168:171], v[72:75]
 ds_read_b64_tr_b16 a[42:43], v226 offset:26624
 v_mfma_f32_16x16x32_bf16 v[88:91], a[8:11], a[172:175], v[88:91]
 buffer_load_dwordx4 a[212:215], v208, s[8:11], s32 offen sc1
 v_mfma_f32_16x16x32_bf16 v[92:95], a[12:15], a[172:175], v[92:95]
 ds_read_b64_tr_b16 a[44:45], v227 offset:24576
 v_mfma_f32_16x16x32_bf16 v[76:79], a[12:15], a[168:171], v[76:79]
 v_mfma_f32_16x16x32_bf16 v[28:31], a[12:15], a[164:167], v[28:31]
 ds_read_b64_tr_b16 a[46:47], v227 offset:26624
 v_mfma_f32_16x16x32_bf16 v[12:15], a[12:15], a[160:163], v[12:15]
 s_waitcnt lgkmcnt(8)
 buffer_load_dwordx4 a[224:227], v209, s[8:11], s31 offen sc1
 v_mfma_f32_16x16x32_bf16 v[32:35], a[16:19], a[160:163], v[32:35]
 ds_read_b64_tr_b16 a[48:49], v224 offset:25600
 v_mfma_f32_16x16x32_bf16 v[48:51], a[16:19], a[164:167], v[48:51]
 v_mfma_f32_16x16x32_bf16 v[96:99], a[16:19], a[168:171], v[96:99]
 ds_read_b64_tr_b16 a[50:51], v224 offset:27648
 v_mfma_f32_16x16x32_bf16 v[112:115], a[16:19], a[172:175], v[112:115]
 buffer_load_dwordx4 a[228:231], v209, s[8:11], s32 offen sc1
 v_mfma_f32_16x16x32_bf16 v[116:119], a[20:23], a[172:175], v[116:119]
 ds_read_b64_tr_b16 a[52:53], v225 offset:25600
 v_mfma_f32_16x16x32_bf16 v[100:103], a[20:23], a[168:171], v[100:103]
 v_mfma_f32_16x16x32_bf16 v[52:55], a[20:23], a[164:167], v[52:55]
 ds_read_b64_tr_b16 a[54:55], v225 offset:27648
 v_mfma_f32_16x16x32_bf16 v[36:39], a[20:23], a[160:163], v[36:39]
 buffer_load_dwordx4 v246, s[12:15], s33 offen offset:2048 lds
 v_mfma_f32_16x16x32_bf16 v[40:43], a[24:27], a[160:163], v[40:43]
 ds_read_b64_tr_b16 a[56:57], v226 offset:25600
 v_mfma_f32_16x16x32_bf16 v[56:59], a[24:27], a[164:167], v[56:59]
 v_mfma_f32_16x16x32_bf16 v[104:107], a[24:27], a[168:171], v[104:107]
 ds_read_b64_tr_b16 a[58:59], v226 offset:27648
 v_mfma_f32_16x16x32_bf16 v[120:123], a[24:27], a[172:175], v[120:123]
 buffer_load_dwordx4 v247, s[12:15], s33 offen offset:3072 lds
 s_add_u32 s33, s33, 262144
 v_mfma_f32_16x16x32_bf16 v[124:127], a[28:31], a[172:175], v[124:127]
 ds_read_b64_tr_b16 a[60:61], v227 offset:25600
 v_mfma_f32_16x16x32_bf16 v[108:111], a[28:31], a[168:171], v[108:111]
 v_mfma_f32_16x16x32_bf16 v[60:63], a[28:31], a[164:167], v[60:63]
 ds_read_b64_tr_b16 a[62:63], v227 offset:27648
 v_mfma_f32_16x16x32_bf16 v[44:47], a[28:31], a[160:163], v[44:47]
 s_waitcnt vmcnt(31) lgkmcnt(8)
 s_barrier
 v_mfma_f32_16x16x32_bf16 v[0:3], a[32:35], a[176:179], v[0:3]
 ds_read_b64_tr_b16 a[0:1], v224 offset:33792
 v_mfma_f32_16x16x32_bf16 v[16:19], a[32:35], a[180:183], v[16:19]
 buffer_load_dwordx4 a[240:243], v210, s[8:11], s31 offen sc1
 v_mfma_f32_16x16x32_bf16 v[64:67], a[32:35], a[184:187], v[64:67]
 ds_read_b64_tr_b16 a[2:3], v224 offset:35840
 v_mfma_f32_16x16x32_bf16 v[80:83], a[32:35], a[188:191], v[80:83]
 buffer_load_dwordx4 a[244:247], v210, s[8:11], s32 offen sc1
 v_mfma_f32_16x16x32_bf16 v[84:87], a[36:39], a[188:191], v[84:87]
 ds_read_b64_tr_b16 a[4:5], v225 offset:33792
 v_mfma_f32_16x16x32_bf16 v[68:71], a[36:39], a[184:187], v[68:71]
 v_mfma_f32_16x16x32_bf16 v[20:23], a[36:39], a[180:183], v[20:23]
 ds_read_b64_tr_b16 a[6:7], v225 offset:35840
 v_mfma_f32_16x16x32_bf16 v[4:7], a[36:39], a[176:179], v[4:7]
 buffer_load_dwordx4 a[64:67], v211, s[8:11], s31 offen sc1
 v_mfma_f32_16x16x32_bf16 v[8:11], a[40:43], a[176:179], v[8:11]
 ds_read_b64_tr_b16 a[8:9], v226 offset:33792
 v_mfma_f32_16x16x32_bf16 v[24:27], a[40:43], a[180:183], v[24:27]
 v_mfma_f32_16x16x32_bf16 v[72:75], a[40:43], a[184:187], v[72:75]
 ds_read_b64_tr_b16 a[10:11], v226 offset:35840
 v_mfma_f32_16x16x32_bf16 v[88:91], a[40:43], a[188:191], v[88:91]
 buffer_load_dwordx4 a[68:71], v211, s[8:11], s32 offen sc1
 v_mfma_f32_16x16x32_bf16 v[92:95], a[44:47], a[188:191], v[92:95]
 ds_read_b64_tr_b16 a[12:13], v227 offset:33792
 v_mfma_f32_16x16x32_bf16 v[76:79], a[44:47], a[184:187], v[76:79]
 buffer_load_dwordx4 a[80:83], v212, s[8:11], s31 offen sc1
 v_mfma_f32_16x16x32_bf16 v[28:31], a[44:47], a[180:183], v[28:31]
 ds_read_b64_tr_b16 a[14:15], v227 offset:35840
 v_mfma_f32_16x16x32_bf16 v[12:15], a[44:47], a[176:179], v[12:15]
 s_waitcnt lgkmcnt(8)
 v_mfma_f32_16x16x32_bf16 v[32:35], a[48:51], a[176:179], v[32:35]
 ds_read_b64_tr_b16 a[16:17], v224 offset:41984
 v_mfma_f32_16x16x32_bf16 v[48:51], a[48:51], a[180:183], v[48:51]
 buffer_load_dwordx4 a[84:87], v212, s[8:11], s32 offen sc1
 v_mfma_f32_16x16x32_bf16 v[96:99], a[48:51], a[184:187], v[96:99]
 ds_read_b64_tr_b16 a[18:19], v224 offset:44032
 v_mfma_f32_16x16x32_bf16 v[112:115], a[48:51], a[188:191], v[112:115]
 v_mfma_f32_16x16x32_bf16 v[116:119], a[52:55], a[188:191], v[116:119]
 ds_read_b64_tr_b16 a[20:21], v225 offset:41984
 v_mfma_f32_16x16x32_bf16 v[100:103], a[52:55], a[184:187], v[100:103]
 s_add_u32 m0, s34, 0
 v_mfma_f32_16x16x32_bf16 v[52:55], a[52:55], a[180:183], v[52:55]
 ds_read_b64_tr_b16 a[22:23], v225 offset:44032
 v_mfma_f32_16x16x32_bf16 v[36:39], a[52:55], a[176:179], v[36:39]
 buffer_load_dwordx4 v244, s[12:15], s33 offen lds
 v_mfma_f32_16x16x32_bf16 v[40:43], a[56:59], a[176:179], v[40:43]
 ds_read_b64_tr_b16 a[24:25], v226 offset:41984
 v_mfma_f32_16x16x32_bf16 v[56:59], a[56:59], a[180:183], v[56:59]
 v_mfma_f32_16x16x32_bf16 v[104:107], a[56:59], a[184:187], v[104:107]
 ds_read_b64_tr_b16 a[26:27], v226 offset:44032
 v_mfma_f32_16x16x32_bf16 v[120:123], a[56:59], a[188:191], v[120:123]
 buffer_load_dwordx4 v245, s[12:15], s33 offen offset:1024 lds
 v_mfma_f32_16x16x32_bf16 v[124:127], a[60:63], a[188:191], v[124:127]
 ds_read_b64_tr_b16 a[28:29], v227 offset:41984
 v_mfma_f32_16x16x32_bf16 v[108:111], a[60:63], a[184:187], v[108:111]
 v_mfma_f32_16x16x32_bf16 v[60:63], a[60:63], a[180:183], v[60:63]
 ds_read_b64_tr_b16 a[30:31], v227 offset:44032
 v_mfma_f32_16x16x32_bf16 v[44:47], a[60:63], a[176:179], v[44:47]
 s_waitcnt vmcnt(35) lgkmcnt(8)
 v_mfma_f32_16x16x32_bf16 v[96:99], a[0:3], a[200:203], v[96:99]
 ds_read_b64_tr_b16 a[32:33], v224 offset:50176
 v_mfma_f32_16x16x32_bf16 v[112:115], a[0:3], a[204:207], v[112:115]
 ds_read_b64_tr_b16 a[34:35], v224 offset:52224
 buffer_load_dwordx4 a[96:99], v213, s[8:11], s31 offen sc1
 v_mfma_f32_16x16x32_bf16 v[116:119], a[4:7], a[204:207], v[116:119]
 ds_read_b64_tr_b16 a[36:37], v225 offset:50176
 v_mfma_f32_16x16x32_bf16 v[100:103], a[4:7], a[200:203], v[100:103]
 ds_read_b64_tr_b16 a[38:39], v225 offset:52224
 v_mfma_f32_16x16x32_bf16 v[104:107], a[8:11], a[200:203], v[104:107]
 ds_read_b64_tr_b16 a[40:41], v226 offset:50176
 buffer_load_dwordx4 a[100:103], v213, s[8:11], s32 offen sc1
 v_mfma_f32_16x16x32_bf16 v[120:123], a[8:11], a[204:207], v[120:123]
 ds_read_b64_tr_b16 a[42:43], v226 offset:52224
 v_mfma_f32_16x16x32_bf16 v[124:127], a[12:15], a[204:207], v[124:127]
 ds_read_b64_tr_b16 a[44:45], v227 offset:50176
 v_mfma_f32_16x16x32_bf16 v[108:111], a[12:15], a[200:203], v[108:111]
 ds_read_b64_tr_b16 a[46:47], v227 offset:52224
 s_waitcnt lgkmcnt(8)
 v_mfma_f32_16x16x32_bf16 v[96:99], a[16:19], a[216:219], v[96:99]
 ds_read_b64_tr_b16 a[48:49], v224 offset:58368
 buffer_load_dwordx4 v246, s[12:15], s33 offen offset:2048 lds
 v_mfma_f32_16x16x32_bf16 v[112:115], a[16:19], a[220:223], v[112:115]
 ds_read_b64_tr_b16 a[50:51], v224 offset:60416
 v_mfma_f32_16x16x32_bf16 v[116:119], a[20:23], a[220:223], v[116:119]
 ds_read_b64_tr_b16 a[52:53], v225 offset:58368
 v_mfma_f32_16x16x32_bf16 v[100:103], a[20:23], a[216:219], v[100:103]
 ds_read_b64_tr_b16 a[54:55], v225 offset:60416
 v_mfma_f32_16x16x32_bf16 v[104:107], a[24:27], a[216:219], v[104:107]
 ds_read_b64_tr_b16 a[56:57], v226 offset:58368
 buffer_load_dwordx4 v247, s[12:15], s33 offen offset:3072 lds
 s_add_u32 s33, s33, 262144
 v_mfma_f32_16x16x32_bf16 v[120:123], a[24:27], a[220:223], v[120:123]
 ds_read_b64_tr_b16 a[58:59], v226 offset:60416
 v_mfma_f32_16x16x32_bf16 v[124:127], a[28:31], a[220:223], v[124:127]
 ds_read_b64_tr_b16 a[60:61], v227 offset:58368
 v_mfma_f32_16x16x32_bf16 v[108:111], a[28:31], a[216:219], v[108:111]
 ds_read_b64_tr_b16 a[62:63], v227 offset:60416
 s_waitcnt vmcnt(33) lgkmcnt(8)
 s_barrier
 v_mfma_f32_16x16x32_bf16 v[96:99], a[32:35], a[232:235], v[96:99]
 ds_read_b64_tr_b16 a[0:1], v228 offset:1024
 v_mfma_f32_16x16x32_bf16 v[112:115], a[32:35], a[236:239], v[112:115]
 ds_read_b64_tr_b16 a[2:3], v228 offset:3072
 buffer_load_dwordx4 a[112:115], v214, s[8:11], s31 offen sc1
 v_mfma_f32_16x16x32_bf16 v[116:119], a[36:39], a[236:239], v[116:119]
 ds_read_b64_tr_b16 a[4:5], v229 offset:1024
 v_mfma_f32_16x16x32_bf16 v[100:103], a[36:39], a[232:235], v[100:103]
 ds_read_b64_tr_b16 a[6:7], v229 offset:3072
 v_mfma_f32_16x16x32_bf16 v[104:107], a[40:43], a[232:235], v[104:107]
 ds_read_b64_tr_b16 a[8:9], v230 offset:1024
 buffer_load_dwordx4 a[116:119], v214, s[8:11], s32 offen sc1
 s_mov_b32 s31, s44
 s_add_u32 s32, s44, 172032
 v_mfma_f32_16x16x32_bf16 v[120:123], a[40:43], a[236:239], v[120:123]
 ds_read_b64_tr_b16 a[10:11], v230 offset:3072
 v_mfma_f32_16x16x32_bf16 v[124:127], a[44:47], a[236:239], v[124:127]
 ds_read_b64_tr_b16 a[12:13], v231 offset:1024
 v_mfma_f32_16x16x32_bf16 v[108:111], a[44:47], a[232:235], v[108:111]
 ds_read_b64_tr_b16 a[14:15], v231 offset:3072
 s_waitcnt lgkmcnt(8)
 v_mfma_f32_16x16x32_bf16 v[96:99], a[48:51], a[248:251], v[96:99]
 ds_read_b64_tr_b16 a[16:17], v228 offset:9216
 s_add_u32 m0, s34, 16384
 v_mfma_f32_16x16x32_bf16 v[112:115], a[48:51], a[252:255], v[112:115]
 ds_read_b64_tr_b16 a[18:19], v228 offset:11264
 v_mfma_f32_16x16x32_bf16 v[116:119], a[52:55], a[252:255], v[116:119]
 ds_read_b64_tr_b16 a[20:21], v229 offset:9216
 v_mfma_f32_16x16x32_bf16 v[100:103], a[52:55], a[248:251], v[100:103]
 ds_read_b64_tr_b16 a[22:23], v229 offset:11264
 v_mfma_f32_16x16x32_bf16 v[104:107], a[56:59], a[248:251], v[104:107]
 ds_read_b64_tr_b16 a[24:25], v230 offset:9216
 buffer_load_dwordx4 v244, s[12:15], s33 offen lds
 v_mfma_f32_16x16x32_bf16 v[120:123], a[56:59], a[252:255], v[120:123]
 ds_read_b64_tr_b16 a[26:27], v230 offset:11264
 v_mfma_f32_16x16x32_bf16 v[124:127], a[60:63], a[252:255], v[124:127]
 ds_read_b64_tr_b16 a[28:29], v231 offset:9216
 v_mfma_f32_16x16x32_bf16 v[108:111], a[60:63], a[248:251], v[108:111]
 ds_read_b64_tr_b16 a[30:31], v231 offset:11264
 s_waitcnt vmcnt(29) lgkmcnt(8)
 v_mfma_f32_16x16x32_bf16 v[96:99], a[0:3], a[72:75], v[96:99]
 ds_read_b64_tr_b16 a[32:33], v228 offset:17408
 v_mfma_f32_16x16x32_bf16 v[112:115], a[0:3], a[76:79], v[112:115]
 ds_read_b64_tr_b16 a[34:35], v228 offset:19456
 buffer_load_dwordx4 v245, s[12:15], s33 offen offset:1024 lds
 v_mfma_f32_16x16x32_bf16 v[116:119], a[4:7], a[76:79], v[116:119]
 ds_read_b64_tr_b16 a[36:37], v229 offset:17408
 v_mfma_f32_16x16x32_bf16 v[100:103], a[4:7], a[72:75], v[100:103]
 ds_read_b64_tr_b16 a[38:39], v229 offset:19456
 v_mfma_f32_16x16x32_bf16 v[104:107], a[8:11], a[72:75], v[104:107]
 ds_read_b64_tr_b16 a[40:41], v230 offset:17408
 v_mfma_f32_16x16x32_bf16 v[120:123], a[8:11], a[76:79], v[120:123]
 ds_read_b64_tr_b16 a[42:43], v230 offset:19456
 v_mfma_f32_16x16x32_bf16 v[124:127], a[12:15], a[76:79], v[124:127]
 ds_read_b64_tr_b16 a[44:45], v231 offset:17408
 v_mfma_f32_16x16x32_bf16 v[108:111], a[12:15], a[72:75], v[108:111]
 ds_read_b64_tr_b16 a[46:47], v231 offset:19456
 s_waitcnt lgkmcnt(8)
 v_mfma_f32_16x16x32_bf16 v[96:99], a[16:19], a[88:91], v[96:99]
 ds_read_b64_tr_b16 a[48:49], v228 offset:25600
 v_mfma_f32_16x16x32_bf16 v[112:115], a[16:19], a[92:95], v[112:115]
 ds_read_b64_tr_b16 a[50:51], v228 offset:27648
 v_mfma_f32_16x16x32_bf16 v[116:119], a[20:23], a[92:95], v[116:119]
 ds_read_b64_tr_b16 a[52:53], v229 offset:25600
 v_mfma_f32_16x16x32_bf16 v[100:103], a[20:23], a[88:91], v[100:103]
 ds_read_b64_tr_b16 a[54:55], v229 offset:27648
 v_mfma_f32_16x16x32_bf16 v[104:107], a[24:27], a[88:91], v[104:107]
 ds_read_b64_tr_b16 a[56:57], v230 offset:25600
 v_mfma_f32_16x16x32_bf16 v[120:123], a[24:27], a[92:95], v[120:123]
 ds_read_b64_tr_b16 a[58:59], v230 offset:27648
 v_mfma_f32_16x16x32_bf16 v[124:127], a[28:31], a[92:95], v[124:127]
 ds_read_b64_tr_b16 a[60:61], v231 offset:25600
 v_mfma_f32_16x16x32_bf16 v[108:111], a[28:31], a[88:91], v[108:111]
 ds_read_b64_tr_b16 a[62:63], v231 offset:27648
 s_waitcnt vmcnt(26) lgkmcnt(8)
 v_mfma_f32_16x16x32_bf16 v[96:99], a[32:35], a[104:107], v[96:99]
 ds_read_b64_tr_b16 a[0:1], v224 offset:33792
 v_mfma_f32_16x16x32_bf16 v[112:115], a[32:35], a[108:111], v[112:115]
 ds_read_b64_tr_b16 a[2:3], v224 offset:35840
 buffer_load_dwordx4 v246, s[12:15], s33 offen offset:2048 lds
 v_mfma_f32_16x16x32_bf16 v[116:119], a[36:39], a[108:111], v[116:119]
 ds_read_b64_tr_b16 a[4:5], v225 offset:33792
 v_mfma_f32_16x16x32_bf16 v[100:103], a[36:39], a[104:107], v[100:103]
 ds_read_b64_tr_b16 a[6:7], v225 offset:35840
 v_mfma_f32_16x16x32_bf16 v[104:107], a[40:43], a[104:107], v[104:107]
 ds_read_b64_tr_b16 a[8:9], v226 offset:33792
 v_mfma_f32_16x16x32_bf16 v[120:123], a[40:43], a[108:111], v[120:123]
 ds_read_b64_tr_b16 a[10:11], v226 offset:35840
 v_mfma_f32_16x16x32_bf16 v[124:127], a[44:47], a[108:111], v[124:127]
 ds_read_b64_tr_b16 a[12:13], v227 offset:33792
 v_mfma_f32_16x16x32_bf16 v[108:111], a[44:47], a[104:107], v[108:111]
 ds_read_b64_tr_b16 a[14:15], v227 offset:35840
 s_waitcnt lgkmcnt(8)
 v_mfma_f32_16x16x32_bf16 v[96:99], a[48:51], a[120:123], v[96:99]
 ds_read_b64_tr_b16 a[16:17], v224 offset:41984
 v_mfma_f32_16x16x32_bf16 v[112:115], a[48:51], a[124:127], v[112:115]
 ds_read_b64_tr_b16 a[18:19], v224 offset:44032
 v_mfma_f32_16x16x32_bf16 v[116:119], a[52:55], a[124:127], v[116:119]
 ds_read_b64_tr_b16 a[20:21], v225 offset:41984
 v_mfma_f32_16x16x32_bf16 v[100:103], a[52:55], a[120:123], v[100:103]
 ds_read_b64_tr_b16 a[22:23], v225 offset:44032
 v_mfma_f32_16x16x32_bf16 v[104:107], a[56:59], a[120:123], v[104:107]
 ds_read_b64_tr_b16 a[24:25], v226 offset:41984
 v_mfma_f32_16x16x32_bf16 v[120:123], a[56:59], a[124:127], v[120:123]
 ds_read_b64_tr_b16 a[26:27], v226 offset:44032
 v_mfma_f32_16x16x32_bf16 v[124:127], a[60:63], a[124:127], v[124:127]
 ds_read_b64_tr_b16 a[28:29], v227 offset:41984
 v_mfma_f32_16x16x32_bf16 v[108:111], a[60:63], a[120:123], v[108:111]
 ds_read_b64_tr_b16 a[30:31], v227 offset:44032
 s_waitcnt vmcnt(21) lgkmcnt(8)
 v_mfma_f32_16x16x32_bf16 v[32:35], a[0:3], a[192:195], v[32:35]
 ds_read_b64_tr_b16 a[32:33], v224 offset:50176
 v_mfma_f32_16x16x32_bf16 v[48:51], a[0:3], a[196:199], v[48:51]
 ds_read_b64_tr_b16 a[34:35], v224 offset:52224
 buffer_load_dwordx4 v247, s[12:15], s33 offen offset:3072 lds
 s_add_u32 s33, s33, 262144
 v_mfma_f32_16x16x32_bf16 v[52:55], a[4:7], a[196:199], v[52:55]
 ds_read_b64_tr_b16 a[36:37], v225 offset:50176
 v_mfma_f32_16x16x32_bf16 v[36:39], a[4:7], a[192:195], v[36:39]
 ds_read_b64_tr_b16 a[38:39], v225 offset:52224
 v_mfma_f32_16x16x32_bf16 v[40:43], a[8:11], a[192:195], v[40:43]
 ds_read_b64_tr_b16 a[40:41], v226 offset:50176
 v_cvt_pk_bf16_f32 v96, v96, v97
 v_mfma_f32_16x16x32_bf16 v[56:59], a[8:11], a[196:199], v[56:59]
 ds_read_b64_tr_b16 a[42:43], v226 offset:52224
 v_mfma_f32_16x16x32_bf16 v[60:63], a[12:15], a[196:199], v[60:63]
 ds_read_b64_tr_b16 a[44:45], v227 offset:50176
 v_cvt_pk_bf16_f32 v97, v98, v99
 v_mfma_f32_16x16x32_bf16 v[44:47], a[12:15], a[192:195], v[44:47]
 ds_read_b64_tr_b16 a[46:47], v227 offset:52224
 s_waitcnt lgkmcnt(8)
 v_mfma_f32_16x16x32_bf16 v[32:35], a[16:19], a[208:211], v[32:35]
 ds_read_b64_tr_b16 a[48:49], v224 offset:58368
 v_cvt_pk_bf16_f32 v98, v100, v101
 v_mfma_f32_16x16x32_bf16 v[48:51], a[16:19], a[212:215], v[48:51]
 ds_read_b64_tr_b16 a[50:51], v224 offset:60416
 v_mfma_f32_16x16x32_bf16 v[52:55], a[20:23], a[212:215], v[52:55]
 ds_read_b64_tr_b16 a[52:53], v225 offset:58368
 v_mfma_f32_16x16x32_bf16 v[36:39], a[20:23], a[208:211], v[36:39]
 ds_read_b64_tr_b16 a[54:55], v225 offset:60416
 v_cvt_pk_bf16_f32 v99, v102, v103
 v_mfma_f32_16x16x32_bf16 v[40:43], a[24:27], a[208:211], v[40:43]
 ds_read_b64_tr_b16 a[56:57], v226 offset:58368
 v_mfma_f32_16x16x32_bf16 v[56:59], a[24:27], a[212:215], v[56:59]
 ds_read_b64_tr_b16 a[58:59], v226 offset:60416
 buffer_store_dwordx4 v[96:99], v232, s[16:19], s68 offen sc1
 v_mfma_f32_16x16x32_bf16 v[60:63], a[28:31], a[212:215], v[60:63]
 ds_read_b64_tr_b16 a[60:61], v227 offset:58368
 v_mfma_f32_16x16x32_bf16 v[44:47], a[28:31], a[208:211], v[44:47]
 ds_read_b64_tr_b16 a[62:63], v227 offset:60416
 s_waitcnt vmcnt(17) lgkmcnt(8)
 v_mfma_f32_16x16x32_bf16 v[32:35], a[32:35], a[224:227], v[32:35]
 ds_read_b64_tr_b16 a[0:1], v228 offset:1024
 v_mfma_f32_16x16x32_bf16 v[48:51], a[32:35], a[228:231], v[48:51]
 ds_read_b64_tr_b16 a[2:3], v228 offset:3072
 s_add_u32 m0, s34, 131072
 v_mfma_f32_16x16x32_bf16 v[52:55], a[36:39], a[228:231], v[52:55]
 ds_read_b64_tr_b16 a[4:5], v229 offset:1024
 v_mfma_f32_16x16x32_bf16 v[36:39], a[36:39], a[224:227], v[36:39]
 ds_read_b64_tr_b16 a[6:7], v229 offset:3072
 v_mfma_f32_16x16x32_bf16 v[40:43], a[40:43], a[224:227], v[40:43]
 ds_read_b64_tr_b16 a[8:9], v230 offset:1024
 v_cvt_pk_bf16_f32 v104, v104, v105
 v_mfma_f32_16x16x32_bf16 v[56:59], a[40:43], a[228:231], v[56:59]
 ds_read_b64_tr_b16 a[10:11], v230 offset:3072
 v_mfma_f32_16x16x32_bf16 v[60:63], a[44:47], a[228:231], v[60:63]
 ds_read_b64_tr_b16 a[12:13], v231 offset:1024
 v_cvt_pk_bf16_f32 v105, v106, v107
 v_mfma_f32_16x16x32_bf16 v[44:47], a[44:47], a[224:227], v[44:47]
 ds_read_b64_tr_b16 a[14:15], v231 offset:3072
 s_waitcnt lgkmcnt(8)
 v_mfma_f32_16x16x32_bf16 v[32:35], a[48:51], a[240:243], v[32:35]
 ds_read_b64_tr_b16 a[16:17], v228 offset:9216
 buffer_load_dwordx4 v244, s[12:15], s33 offen lds
 v_cvt_pk_bf16_f32 v106, v108, v109
 v_mfma_f32_16x16x32_bf16 v[48:51], a[48:51], a[244:247], v[48:51]
 ds_read_b64_tr_b16 a[18:19], v228 offset:11264
 v_mfma_f32_16x16x32_bf16 v[52:55], a[52:55], a[244:247], v[52:55]
 ds_read_b64_tr_b16 a[20:21], v229 offset:9216
 v_mfma_f32_16x16x32_bf16 v[36:39], a[52:55], a[240:243], v[36:39]
 ds_read_b64_tr_b16 a[22:23], v229 offset:11264
 v_cvt_pk_bf16_f32 v107, v110, v111
 v_mfma_f32_16x16x32_bf16 v[40:43], a[56:59], a[240:243], v[40:43]
 ds_read_b64_tr_b16 a[24:25], v230 offset:9216
 v_mfma_f32_16x16x32_bf16 v[56:59], a[56:59], a[244:247], v[56:59]
 ds_read_b64_tr_b16 a[26:27], v230 offset:11264
 buffer_store_dwordx4 v[104:107], v232, s[16:19], s68 offen offset:1024 sc1
 v_mfma_f32_16x16x32_bf16 v[60:63], a[60:63], a[244:247], v[60:63]
 ds_read_b64_tr_b16 a[28:29], v231 offset:9216
 v_mfma_f32_16x16x32_bf16 v[44:47], a[60:63], a[240:243], v[44:47]
 ds_read_b64_tr_b16 a[30:31], v231 offset:11264
 s_waitcnt vmcnt(15) lgkmcnt(8)
 v_mfma_f32_16x16x32_bf16 v[32:35], a[0:3], a[64:67], v[32:35]
 ds_read_b64_tr_b16 a[32:33], v228 offset:17408
 v_mfma_f32_16x16x32_bf16 v[48:51], a[0:3], a[68:71], v[48:51]
 ds_read_b64_tr_b16 a[34:35], v228 offset:19456
 buffer_load_dword v243, v242, s[76:79], 0 offen sc1
 v_mfma_f32_16x16x32_bf16 v[52:55], a[4:7], a[68:71], v[52:55]
 ds_read_b64_tr_b16 a[36:37], v229 offset:17408
 v_mfma_f32_16x16x32_bf16 v[36:39], a[4:7], a[64:67], v[36:39]
 ds_read_b64_tr_b16 a[38:39], v229 offset:19456
 v_mfma_f32_16x16x32_bf16 v[40:43], a[8:11], a[64:67], v[40:43]
 ds_read_b64_tr_b16 a[40:41], v230 offset:17408
 v_cvt_pk_bf16_f32 v112, v112, v113
 v_mfma_f32_16x16x32_bf16 v[56:59], a[8:11], a[68:71], v[56:59]
 ds_read_b64_tr_b16 a[42:43], v230 offset:19456
 v_mfma_f32_16x16x32_bf16 v[60:63], a[12:15], a[68:71], v[60:63]
 ds_read_b64_tr_b16 a[44:45], v231 offset:17408
 v_cvt_pk_bf16_f32 v113, v114, v115
 v_mfma_f32_16x16x32_bf16 v[44:47], a[12:15], a[64:67], v[44:47]
 ds_read_b64_tr_b16 a[46:47], v231 offset:19456
 s_waitcnt lgkmcnt(8)
 v_mfma_f32_16x16x32_bf16 v[32:35], a[16:19], a[80:83], v[32:35]
 ds_read_b64_tr_b16 a[48:49], v228 offset:25600
 buffer_load_dwordx4 v245, s[12:15], s33 offen offset:1024 lds
 v_cvt_pk_bf16_f32 v114, v116, v117
 v_mfma_f32_16x16x32_bf16 v[48:51], a[16:19], a[84:87], v[48:51]
 ds_read_b64_tr_b16 a[50:51], v228 offset:27648
 v_mfma_f32_16x16x32_bf16 v[52:55], a[20:23], a[84:87], v[52:55]
 ds_read_b64_tr_b16 a[52:53], v229 offset:25600
 v_mfma_f32_16x16x32_bf16 v[36:39], a[20:23], a[80:83], v[36:39]
 ds_read_b64_tr_b16 a[54:55], v229 offset:27648
 v_cvt_pk_bf16_f32 v115, v118, v119
 v_mfma_f32_16x16x32_bf16 v[40:43], a[24:27], a[80:83], v[40:43]
 ds_read_b64_tr_b16 a[56:57], v230 offset:25600
 v_mfma_f32_16x16x32_bf16 v[56:59], a[24:27], a[84:87], v[56:59]
 ds_read_b64_tr_b16 a[58:59], v230 offset:27648
 buffer_store_dwordx4 v[112:115], v232, s[16:19], s68 offen offset:2048 sc1
 v_mfma_f32_16x16x32_bf16 v[60:63], a[28:31], a[84:87], v[60:63]
 ds_read_b64_tr_b16 a[60:61], v231 offset:25600
 v_mfma_f32_16x16x32_bf16 v[44:47], a[28:31], a[80:83], v[44:47]
 ds_read_b64_tr_b16 a[62:63], v231 offset:27648
 s_waitcnt vmcnt(10) lgkmcnt(8)
 v_mfma_f32_16x16x32_bf16 v[32:35], a[32:35], a[96:99], v[32:35]
 ds_read_b64_tr_b16 a[0:1], v224 offset:32768
 v_mfma_f32_16x16x32_bf16 v[48:51], a[32:35], a[100:103], v[48:51]
 ds_read_b64_tr_b16 a[2:3], v224 offset:34816
 buffer_load_dwordx4 v246, s[12:15], s33 offen offset:2048 lds
 v_mfma_f32_16x16x32_bf16 v[52:55], a[36:39], a[100:103], v[52:55]
 ds_read_b64_tr_b16 a[4:5], v225 offset:32768
 v_mfma_f32_16x16x32_bf16 v[36:39], a[36:39], a[96:99], v[36:39]
 ds_read_b64_tr_b16 a[6:7], v225 offset:34816
 v_mfma_f32_16x16x32_bf16 v[40:43], a[40:43], a[96:99], v[40:43]
 ds_read_b64_tr_b16 a[8:9], v226 offset:32768
 v_cvt_pk_bf16_f32 v120, v120, v121
 v_mfma_f32_16x16x32_bf16 v[56:59], a[40:43], a[100:103], v[56:59]
 ds_read_b64_tr_b16 a[10:11], v226 offset:34816
 v_mfma_f32_16x16x32_bf16 v[60:63], a[44:47], a[100:103], v[60:63]
 ds_read_b64_tr_b16 a[12:13], v227 offset:32768
 v_cvt_pk_bf16_f32 v121, v122, v123
 v_mfma_f32_16x16x32_bf16 v[44:47], a[44:47], a[96:99], v[44:47]
 ds_read_b64_tr_b16 a[14:15], v227 offset:34816
 s_waitcnt lgkmcnt(8)
 v_mfma_f32_16x16x32_bf16 v[32:35], a[48:51], a[112:115], v[32:35]
 ds_read_b64_tr_b16 a[16:17], v224 offset:40960
 v_cvt_pk_bf16_f32 v122, v124, v125
 v_mfma_f32_16x16x32_bf16 v[48:51], a[48:51], a[116:119], v[48:51]
 ds_read_b64_tr_b16 a[18:19], v224 offset:43008
 v_mfma_f32_16x16x32_bf16 v[52:55], a[52:55], a[116:119], v[52:55]
 ds_read_b64_tr_b16 a[20:21], v225 offset:40960
 v_mfma_f32_16x16x32_bf16 v[36:39], a[52:55], a[112:115], v[36:39]
 ds_read_b64_tr_b16 a[22:23], v225 offset:43008
 v_cvt_pk_bf16_f32 v123, v126, v127
 v_mfma_f32_16x16x32_bf16 v[40:43], a[56:59], a[112:115], v[40:43]
 ds_read_b64_tr_b16 a[24:25], v226 offset:40960
 v_mfma_f32_16x16x32_bf16 v[56:59], a[56:59], a[116:119], v[56:59]
 ds_read_b64_tr_b16 a[26:27], v226 offset:43008
 buffer_store_dwordx4 v[120:123], v232, s[16:19], s68 offen offset:3072 sc1
 v_mfma_f32_16x16x32_bf16 v[60:63], a[60:63], a[116:119], v[60:63]
 ds_read_b64_tr_b16 a[28:29], v227 offset:40960
 v_mfma_f32_16x16x32_bf16 v[44:47], a[60:63], a[112:115], v[44:47]
 ds_read_b64_tr_b16 a[30:31], v227 offset:43008
 s_waitcnt vmcnt(53) lgkmcnt(8)
 v_mfma_f32_16x16x32_bf16 v[64:67], a[0:3], a[200:203], v[64:67]
 ds_read_b64_tr_b16 a[32:33], v224 offset:49152
 v_mfma_f32_16x16x32_bf16 v[80:83], a[0:3], a[204:207], v[80:83]
 ds_read_b64_tr_b16 a[34:35], v224 offset:51200
 buffer_load_dwordx4 v247, s[12:15], s33 offen offset:3072 lds
 s_add_u32 s33, s33, 262144
 v_mfma_f32_16x16x32_bf16 v[84:87], a[4:7], a[204:207], v[84:87]
 ds_read_b64_tr_b16 a[36:37], v225 offset:49152
 v_mfma_f32_16x16x32_bf16 v[68:71], a[4:7], a[200:203], v[68:71]
 ds_read_b64_tr_b16 a[38:39], v225 offset:51200
 v_mfma_f32_16x16x32_bf16 v[72:75], a[8:11], a[200:203], v[72:75]
 ds_read_b64_tr_b16 a[40:41], v226 offset:49152
 v_cvt_pk_bf16_f32 v32, v32, v33
 v_mfma_f32_16x16x32_bf16 v[88:91], a[8:11], a[204:207], v[88:91]
 ds_read_b64_tr_b16 a[42:43], v226 offset:51200
 v_mfma_f32_16x16x32_bf16 v[92:95], a[12:15], a[204:207], v[92:95]
 ds_read_b64_tr_b16 a[44:45], v227 offset:49152
 v_cvt_pk_bf16_f32 v33, v34, v35
 v_mfma_f32_16x16x32_bf16 v[76:79], a[12:15], a[200:203], v[76:79]
 ds_read_b64_tr_b16 a[46:47], v227 offset:51200
 s_waitcnt lgkmcnt(8)
 v_mfma_f32_16x16x32_bf16 v[64:67], a[16:19], a[216:219], v[64:67]
 ds_read_b64_tr_b16 a[48:49], v224 offset:57344
 v_cvt_pk_bf16_f32 v34, v36, v37
 v_mfma_f32_16x16x32_bf16 v[80:83], a[16:19], a[220:223], v[80:83]
 ds_read_b64_tr_b16 a[50:51], v224 offset:59392
 v_mfma_f32_16x16x32_bf16 v[84:87], a[20:23], a[220:223], v[84:87]
 ds_read_b64_tr_b16 a[52:53], v225 offset:57344
 v_mfma_f32_16x16x32_bf16 v[68:71], a[20:23], a[216:219], v[68:71]
 ds_read_b64_tr_b16 a[54:55], v225 offset:59392
 v_cvt_pk_bf16_f32 v35, v38, v39
 v_mfma_f32_16x16x32_bf16 v[72:75], a[24:27], a[216:219], v[72:75]
 ds_read_b64_tr_b16 a[56:57], v226 offset:57344
 v_mfma_f32_16x16x32_bf16 v[88:91], a[24:27], a[220:223], v[88:91]
 ds_read_b64_tr_b16 a[58:59], v226 offset:59392
 buffer_store_dwordx4 v[32:35], v232, s[16:19], s69 offen sc1
 v_mfma_f32_16x16x32_bf16 v[92:95], a[28:31], a[220:223], v[92:95]
 ds_read_b64_tr_b16 a[60:61], v227 offset:57344
 v_mfma_f32_16x16x32_bf16 v[76:79], a[28:31], a[216:219], v[76:79]
 ds_read_b64_tr_b16 a[62:63], v227 offset:59392
 s_waitcnt vmcnt(49) lgkmcnt(8)
 v_mfma_f32_16x16x32_bf16 v[64:67], a[32:35], a[232:235], v[64:67]
 ds_read_b64_tr_b16 a[0:1], v228
 v_mfma_f32_16x16x32_bf16 v[80:83], a[32:35], a[236:239], v[80:83]
 ds_read_b64_tr_b16 a[2:3], v228 offset:2048
 s_add_u32 m0, s34, 147456
 v_mfma_f32_16x16x32_bf16 v[84:87], a[36:39], a[236:239], v[84:87]
 ds_read_b64_tr_b16 a[4:5], v229
 v_mfma_f32_16x16x32_bf16 v[68:71], a[36:39], a[232:235], v[68:71]
 ds_read_b64_tr_b16 a[6:7], v229 offset:2048
 v_mfma_f32_16x16x32_bf16 v[72:75], a[40:43], a[232:235], v[72:75]
 ds_read_b64_tr_b16 a[8:9], v230
 v_cvt_pk_bf16_f32 v40, v40, v41
 v_mfma_f32_16x16x32_bf16 v[88:91], a[40:43], a[236:239], v[88:91]
 ds_read_b64_tr_b16 a[10:11], v230 offset:2048
 v_mfma_f32_16x16x32_bf16 v[92:95], a[44:47], a[236:239], v[92:95]
 ds_read_b64_tr_b16 a[12:13], v231
 v_cvt_pk_bf16_f32 v41, v42, v43
 v_mfma_f32_16x16x32_bf16 v[76:79], a[44:47], a[232:235], v[76:79]
 ds_read_b64_tr_b16 a[14:15], v231 offset:2048
 s_waitcnt lgkmcnt(8)
 v_mfma_f32_16x16x32_bf16 v[64:67], a[48:51], a[248:251], v[64:67]
 ds_read_b64_tr_b16 a[16:17], v228 offset:8192
 buffer_load_dwordx4 v244, s[12:15], s33 offen lds
 v_cvt_pk_bf16_f32 v42, v44, v45
 v_mfma_f32_16x16x32_bf16 v[80:83], a[48:51], a[252:255], v[80:83]
 ds_read_b64_tr_b16 a[18:19], v228 offset:10240
 v_mfma_f32_16x16x32_bf16 v[84:87], a[52:55], a[252:255], v[84:87]
 ds_read_b64_tr_b16 a[20:21], v229 offset:8192
 v_mfma_f32_16x16x32_bf16 v[68:71], a[52:55], a[248:251], v[68:71]
 ds_read_b64_tr_b16 a[22:23], v229 offset:10240
 v_cvt_pk_bf16_f32 v43, v46, v47
 v_mfma_f32_16x16x32_bf16 v[72:75], a[56:59], a[248:251], v[72:75]
 ds_read_b64_tr_b16 a[24:25], v230 offset:8192
 v_mfma_f32_16x16x32_bf16 v[88:91], a[56:59], a[252:255], v[88:91]
 ds_read_b64_tr_b16 a[26:27], v230 offset:10240
 buffer_store_dwordx4 v[40:43], v232, s[16:19], s69 offen offset:1024 sc1
 v_mfma_f32_16x16x32_bf16 v[92:95], a[60:63], a[252:255], v[92:95]
 ds_read_b64_tr_b16 a[28:29], v231 offset:8192
 v_mfma_f32_16x16x32_bf16 v[76:79], a[60:63], a[248:251], v[76:79]
 ds_read_b64_tr_b16 a[30:31], v231 offset:10240
 s_waitcnt vmcnt(8) lgkmcnt(8)
 v_readfirstlane_b32 s3, v243
 v_mfma_f32_16x16x32_bf16 v[64:67], a[0:3], a[72:75], v[64:67]
 s_cmp_lt_u32 s3, 16
 s_cbranch_scc1 L2_chk
L2_chk_r:
 ds_read_b64_tr_b16 a[32:33], v228 offset:16384
 v_mfma_f32_16x16x32_bf16 v[80:83], a[0:3], a[76:79], v[80:83]
 ds_read_b64_tr_b16 a[34:35], v228 offset:18432
 buffer_load_dwordx4 a[128:131], v208, s[8:11], s31 offen sc1
 v_mfma_f32_16x16x32_bf16 v[84:87], a[4:7], a[76:79], v[84:87]
 ds_read_b64_tr_b16 a[36:37], v229 offset:16384
 v_mfma_f32_16x16x32_bf16 v[68:71], a[4:7], a[72:75], v[68:71]
 ds_read_b64_tr_b16 a[38:39], v229 offset:18432
 v_mfma_f32_16x16x32_bf16 v[72:75], a[8:11], a[72:75], v[72:75]
 ds_read_b64_tr_b16 a[40:41], v230 offset:16384
 v_cvt_pk_bf16_f32 v48, v48, v49
 v_mfma_f32_16x16x32_bf16 v[88:91], a[8:11], a[76:79], v[88:91]
 ds_read_b64_tr_b16 a[42:43], v230 offset:18432
 v_mfma_f32_16x16x32_bf16 v[92:95], a[12:15], a[76:79], v[92:95]
 ds_read_b64_tr_b16 a[44:45], v231 offset:16384
 buffer_load_dwordx4 a[132:135], v208, s[8:11], s32 offen sc1
 v_cvt_pk_bf16_f32 v49, v50, v51
 v_mfma_f32_16x16x32_bf16 v[76:79], a[12:15], a[72:75], v[76:79]
 ds_read_b64_tr_b16 a[46:47], v231 offset:18432
 s_waitcnt lgkmcnt(8)
 v_mfma_f32_16x16x32_bf16 v[64:67], a[16:19], a[88:91], v[64:67]
 ds_read_b64_tr_b16 a[48:49], v228 offset:24576
 v_cvt_pk_bf16_f32 v50, v52, v53
 v_mfma_f32_16x16x32_bf16 v[80:83], a[16:19], a[92:95], v[80:83]
 ds_read_b64_tr_b16 a[50:51], v228 offset:26624
 v_mfma_f32_16x16x32_bf16 v[84:87], a[20:23], a[92:95], v[84:87]
 ds_read_b64_tr_b16 a[52:53], v229 offset:24576
 v_cvt_pk_bf16_f32 v51, v54, v55
 v_mfma_f32_16x16x32_bf16 v[68:71], a[20:23], a[88:91], v[68:71]
 ds_read_b64_tr_b16 a[54:55], v229 offset:26624
 buffer_load_dwordx4 v245, s[12:15], s33 offen offset:1024 lds
 v_mfma_f32_16x16x32_bf16 v[72:75], a[24:27], a[88:91], v[72:75]
 ds_read_b64_tr_b16 a[56:57], v230 offset:24576
 buffer_store_dwordx4 v[48:51], v232, s[16:19], s69 offen offset:2048 sc1
 v_mfma_f32_16x16x32_bf16 v[88:91], a[24:27], a[92:95], v[88:91]
 ds_read_b64_tr_b16 a[58:59], v230 offset:26624
 v_mfma_f32_16x16x32_bf16 v[92:95], a[28:31], a[92:95], v[92:95]
 ds_read_b64_tr_b16 a[60:61], v231 offset:24576
 v_mov_b32_e64 v242, s91
 v_mfma_f32_16x16x32_bf16 v[76:79], a[28:31], a[88:91], v[76:79]
 ds_read_b64_tr_b16 a[62:63], v231 offset:26624
 s_waitcnt vmcnt(8) lgkmcnt(8)
 v_mfma_f32_16x16x32_bf16 v[64:67], a[32:35], a[104:107], v[64:67]
 ds_read_b64_tr_b16 a[0:1], v224 offset:32768
 v_mfma_f32_16x16x32_bf16 v[80:83], a[32:35], a[108:111], v[80:83]
 ds_read_b64_tr_b16 a[2:3], v224 offset:34816
 buffer_atomic_add v241, v239, s[76:79], s74 offen sc1
 v_mfma_f32_16x16x32_bf16 v[84:87], a[36:39], a[108:111], v[84:87]
 ds_read_b64_tr_b16 a[4:5], v225 offset:32768
 v_mfma_f32_16x16x32_bf16 v[68:71], a[36:39], a[104:107], v[68:71]
 ds_read_b64_tr_b16 a[6:7], v225 offset:34816
 buffer_load_dwordx4 a[136:139], v209, s[8:11], s31 offen sc1
 v_mfma_f32_16x16x32_bf16 v[72:75], a[40:43], a[104:107], v[72:75]
 ds_read_b64_tr_b16 a[8:9], v226 offset:32768
 v_cvt_pk_bf16_f32 v56, v56, v57
 v_mfma_f32_16x16x32_bf16 v[88:91], a[40:43], a[108:111], v[88:91]
 ds_read_b64_tr_b16 a[10:11], v226 offset:34816
 v_mfma_f32_16x16x32_bf16 v[92:95], a[44:47], a[108:111], v[92:95]
 ds_read_b64_tr_b16 a[12:13], v227 offset:32768
 buffer_load_dwordx4 a[140:143], v209, s[8:11], s32 offen sc1
 v_cvt_pk_bf16_f32 v57, v58, v59
 v_mfma_f32_16x16x32_bf16 v[76:79], a[44:47], a[104:107], v[76:79]
 ds_read_b64_tr_b16 a[14:15], v227 offset:34816
 s_waitcnt lgkmcnt(8)
 v_mfma_f32_16x16x32_bf16 v[64:67], a[48:51], a[120:123], v[64:67]
 ds_read_b64_tr_b16 a[16:17], v224 offset:40960
 buffer_load_dwordx4 a[144:147], v210, s[8:11], s31 offen sc1
 v_cvt_pk_bf16_f32 v58, v60, v61
 v_mfma_f32_16x16x32_bf16 v[80:83], a[48:51], a[124:127], v[80:83]
 ds_read_b64_tr_b16 a[18:19], v224 offset:43008
 v_mfma_f32_16x16x32_bf16 v[84:87], a[52:55], a[124:127], v[84:87]
 ds_read_b64_tr_b16 a[20:21], v225 offset:40960
 v_mfma_f32_16x16x32_bf16 v[68:71], a[52:55], a[120:123], v[68:71]
 ds_read_b64_tr_b16 a[22:23], v225 offset:43008
 buffer_load_dwordx4 a[148:151], v210, s[8:11], s32 offen sc1
 v_cvt_pk_bf16_f32 v59, v62, v63
 v_mfma_f32_16x16x32_bf16 v[72:75], a[56:59], a[120:123], v[72:75]
 ds_read_b64_tr_b16 a[24:25], v226 offset:40960
 v_mfma_f32_16x16x32_bf16 v[88:91], a[56:59], a[124:127], v[88:91]
 ds_read_b64_tr_b16 a[26:27], v226 offset:43008
 buffer_load_dwordx4 v246, s[12:15], s33 offen offset:2048 lds
 buffer_store_dwordx4 v[56:59], v232, s[16:19], s69 offen offset:3072 sc1
 v_mfma_f32_16x16x32_bf16 v[92:95], a[60:63], a[124:127], v[92:95]
 ds_read_b64_tr_b16 a[28:29], v227 offset:40960
 v_mfma_f32_16x16x32_bf16 v[76:79], a[60:63], a[120:123], v[76:79]
 ds_read_b64_tr_b16 a[30:31], v227 offset:43008
 s_waitcnt vmcnt(45) lgkmcnt(8)
 v_mfma_f32_16x16x32_bf16 v[0:3], a[0:3], a[192:195], v[0:3]
 ds_read_b64_tr_b16 a[32:33], v224 offset:49152
 v_mfma_f32_16x16x32_bf16 v[16:19], a[0:3], a[196:199], v[16:19]
 ds_read_b64_tr_b16 a[34:35], v224 offset:51200
 buffer_load_dwordx4 a[152:155], v211, s[8:11], s31 offen sc1
 v_mfma_f32_16x16x32_bf16 v[20:23], a[4:7], a[196:199], v[20:23]
 ds_read_b64_tr_b16 a[36:37], v225 offset:49152
 v_mfma_f32_16x16x32_bf16 v[4:7], a[4:7], a[192:195], v[4:7]
 ds_read_b64_tr_b16 a[38:39], v225 offset:51200
 v_mfma_f32_16x16x32_bf16 v[8:11], a[8:11], a[192:195], v[8:11]
 ds_read_b64_tr_b16 a[40:41], v226 offset:49152
 v_cvt_pk_bf16_f32 v64, v64, v65
 v_mfma_f32_16x16x32_bf16 v[24:27], a[8:11], a[196:199], v[24:27]
 ds_read_b64_tr_b16 a[42:43], v226 offset:51200
 v_mfma_f32_16x16x32_bf16 v[28:31], a[12:15], a[196:199], v[28:31]
 ds_read_b64_tr_b16 a[44:45], v227 offset:49152
 buffer_load_dwordx4 a[156:159], v211, s[8:11], s32 offen sc1
 v_cvt_pk_bf16_f32 v65, v66, v67
 v_mfma_f32_16x16x32_bf16 v[12:15], a[12:15], a[192:195], v[12:15]
 ds_read_b64_tr_b16 a[46:47], v227 offset:51200
 s_waitcnt lgkmcnt(8)
 v_mfma_f32_16x16x32_bf16 v[0:3], a[16:19], a[208:211], v[0:3]
 ds_read_b64_tr_b16 a[48:49], v224 offset:57344
 v_cvt_pk_bf16_f32 v66, v68, v69
 v_mfma_f32_16x16x32_bf16 v[16:19], a[16:19], a[212:215], v[16:19]
 ds_read_b64_tr_b16 a[50:51], v224 offset:59392
 v_mfma_f32_16x16x32_bf16 v[20:23], a[20:23], a[212:215], v[20:23]
 ds_read_b64_tr_b16 a[52:53], v225 offset:57344
 v_mfma_f32_16x16x32_bf16 v[4:7], a[20:23], a[208:211], v[4:7]
 ds_read_b64_tr_b16 a[54:55], v225 offset:59392
 buffer_load_dwordx4 v247, s[12:15], s33 offen offset:3072 lds
 s_add_u32 s33, s33, 262144
 v_cvt_pk_bf16_f32 v67, v70, v71
 v_mfma_f32_16x16x32_bf16 v[8:11], a[24:27], a[208:211], v[8:11]
 ds_read_b64_tr_b16 a[56:57], v226 offset:57344
 v_mfma_f32_16x16x32_bf16 v[24:27], a[24:27], a[212:215], v[24:27]
 ds_read_b64_tr_b16 a[58:59], v226 offset:59392
 buffer_store_dwordx4 v[64:67], v232, s[16:19], s70 offen sc1
 v_mfma_f32_16x16x32_bf16 v[28:31], a[28:31], a[212:215], v[28:31]
 ds_read_b64_tr_b16 a[60:61], v227 offset:57344
 v_mfma_f32_16x16x32_bf16 v[12:15], a[28:31], a[208:211], v[12:15]
 ds_read_b64_tr_b16 a[62:63], v227 offset:59392
 s_waitcnt vmcnt(43) lgkmcnt(8)
 v_mfma_f32_16x16x32_bf16 v[0:3], a[32:35], a[224:227], v[0:3]
 ds_read_b64_tr_b16 a[0:1], v228
 v_mfma_f32_16x16x32_bf16 v[16:19], a[32:35], a[228:231], v[16:19]
 ds_read_b64_tr_b16 a[2:3], v228 offset:2048
 buffer_load_dwordx4 a[160:163], v212, s[8:11], s31 offen sc1
 v_mfma_f32_16x16x32_bf16 v[20:23], a[36:39], a[228:231], v[20:23]
 ds_read_b64_tr_b16 a[4:5], v229
 v_mfma_f32_16x16x32_bf16 v[4:7], a[36:39], a[224:227], v[4:7]
 ds_read_b64_tr_b16 a[6:7], v229 offset:2048
 v_mfma_f32_16x16x32_bf16 v[8:11], a[40:43], a[224:227], v[8:11]
 ds_read_b64_tr_b16 a[8:9], v230
 buffer_load_dwordx4 a[164:167], v212, s[8:11], s32 offen sc1
 v_cvt_pk_bf16_f32 v72, v72, v73
 v_mfma_f32_16x16x32_bf16 v[24:27], a[40:43], a[228:231], v[24:27]
 ds_read_b64_tr_b16 a[10:11], v230 offset:2048
 v_mfma_f32_16x16x32_bf16 v[28:31], a[44:47], a[228:231], v[28:31]
 ds_read_b64_tr_b16 a[12:13], v231
 v_cvt_pk_bf16_f32 v73, v74, v75
 v_mfma_f32_16x16x32_bf16 v[12:15], a[44:47], a[224:227], v[12:15]
 ds_read_b64_tr_b16 a[14:15], v231 offset:2048
 s_waitcnt lgkmcnt(8)
 v_mfma_f32_16x16x32_bf16 v[0:3], a[48:51], a[240:243], v[0:3]
 ds_read_b64_tr_b16 a[16:17], v228 offset:8192
 buffer_load_dwordx4 a[168:171], v213, s[8:11], s31 offen sc1
 v_cvt_pk_bf16_f32 v74, v76, v77
 v_mfma_f32_16x16x32_bf16 v[16:19], a[48:51], a[244:247], v[16:19]
 ds_read_b64_tr_b16 a[18:19], v228 offset:10240
 v_mfma_f32_16x16x32_bf16 v[20:23], a[52:55], a[244:247], v[20:23]
 ds_read_b64_tr_b16 a[20:21], v229 offset:8192
 v_mfma_f32_16x16x32_bf16 v[4:7], a[52:55], a[240:243], v[4:7]
 ds_read_b64_tr_b16 a[22:23], v229 offset:10240
 v_cvt_pk_bf16_f32 v75, v78, v79
 v_mfma_f32_16x16x32_bf16 v[8:11], a[56:59], a[240:243], v[8:11]
 ds_read_b64_tr_b16 a[24:25], v230 offset:8192
 buffer_load_dwordx4 a[172:175], v213, s[8:11], s32 offen sc1
 v_mfma_f32_16x16x32_bf16 v[24:27], a[56:59], a[244:247], v[24:27]
 ds_read_b64_tr_b16 a[26:27], v230 offset:10240
 buffer_store_dwordx4 v[72:75], v232, s[16:19], s70 offen offset:1024 sc1
 v_mfma_f32_16x16x32_bf16 v[28:31], a[60:63], a[244:247], v[28:31]
 ds_read_b64_tr_b16 a[28:29], v231 offset:8192
 v_mfma_f32_16x16x32_bf16 v[12:15], a[60:63], a[240:243], v[12:15]
 ds_read_b64_tr_b16 a[30:31], v231 offset:10240
 s_waitcnt vmcnt(44) lgkmcnt(8)
 v_mfma_f32_16x16x32_bf16 v[0:3], a[0:3], a[64:67], v[0:3]
 ds_read_b64_tr_b16 a[32:33], v228 offset:16384
 v_mfma_f32_16x16x32_bf16 v[16:19], a[0:3], a[68:71], v[16:19]
 ds_read_b64_tr_b16 a[34:35], v228 offset:18432
 buffer_load_dwordx4 a[176:179], v214, s[8:11], s31 offen sc1
 v_mfma_f32_16x16x32_bf16 v[20:23], a[4:7], a[68:71], v[20:23]
 ds_read_b64_tr_b16 a[36:37], v229 offset:16384
 v_mfma_f32_16x16x32_bf16 v[4:7], a[4:7], a[64:67], v[4:7]
 ds_read_b64_tr_b16 a[38:39], v229 offset:18432
 v_mfma_f32_16x16x32_bf16 v[8:11], a[8:11], a[64:67], v[8:11]
 ds_read_b64_tr_b16 a[40:41], v230 offset:16384
 v_cvt_pk_bf16_f32 v80, v80, v81
 v_mfma_f32_16x16x32_bf16 v[24:27], a[8:11], a[68:71], v[24:27]
 ds_read_b64_tr_b16 a[42:43], v230 offset:18432
 v_mfma_f32_16x16x32_bf16 v[28:31], a[12:15], a[68:71], v[28:31]
 ds_read_b64_tr_b16 a[44:45], v231 offset:16384
 v_cvt_pk_bf16_f32 v81, v82, v83
 v_mfma_f32_16x16x32_bf16 v[12:15], a[12:15], a[64:67], v[12:15]
 ds_read_b64_tr_b16 a[46:47], v231 offset:18432
 s_waitcnt lgkmcnt(8)
 v_mfma_f32_16x16x32_bf16 v[0:3], a[16:19], a[80:83], v[0:3]
 ds_read_b64_tr_b16 a[48:49], v228 offset:24576
 buffer_load_dwordx4 a[180:183], v214, s[8:11], s32 offen sc1
 s_add_u32 s31, s31, 8192
 s_add_u32 s32, s32, 8192
 v_cvt_pk_bf16_f32 v82, v84, v85
 v_mfma_f32_16x16x32_bf16 v[16:19], a[16:19], a[84:87], v[16:19]
 ds_read_b64_tr_b16 a[50:51], v228 offset:26624
 v_mfma_f32_16x16x32_bf16 v[20:23], a[20:23], a[84:87], v[20:23]
 ds_read_b64_tr_b16 a[52:53], v229 offset:24576
 v_mfma_f32_16x16x32_bf16 v[4:7], a[20:23], a[80:83], v[4:7]
 ds_read_b64_tr_b16 a[54:55], v229 offset:26624
 v_cvt_pk_bf16_f32 v83, v86, v87
 v_mfma_f32_16x16x32_bf16 v[8:11], a[24:27], a[80:83], v[8:11]
 ds_read_b64_tr_b16 a[56:57], v230 offset:24576
 v_mfma_f32_16x16x32_bf16 v[24:27], a[24:27], a[84:87], v[24:27]
 ds_read_b64_tr_b16 a[58:59], v230 offset:26624
 buffer_store_dwordx4 v[80:83], v232, s[16:19], s70 offen offset:2048 sc1
 v_mfma_f32_16x16x32_bf16 v[28:31], a[28:31], a[84:87], v[28:31]
 ds_read_b64_tr_b16 a[60:61], v231 offset:24576
 v_mfma_f32_16x16x32_bf16 v[12:15], a[28:31], a[80:83], v[12:15]
 ds_read_b64_tr_b16 a[62:63], v231 offset:26624
 s_waitcnt vmcnt(12) lgkmcnt(8)
 s_barrier
 v_mfma_f32_16x16x32_bf16 v[0:3], a[32:35], a[96:99], v[0:3]
 ds_read_b64_tr_b16 a[0:1], v220 offset:32768
 v_mfma_f32_16x16x32_bf16 v[16:19], a[32:35], a[100:103], v[16:19]
 ds_read_b64_tr_b16 a[2:3], v220 offset:33792
 buffer_atomic_add v241, v239, s[76:79], s75 offen sc1
 v_mfma_f32_16x16x32_bf16 v[20:23], a[36:39], a[100:103], v[20:23]
 ds_read_b64_tr_b16 a[4:5], v221 offset:32768
 v_mfma_f32_16x16x32_bf16 v[4:7], a[36:39], a[96:99], v[4:7]
 ds_read_b64_tr_b16 a[6:7], v221 offset:33792
 v_mfma_f32_16x16x32_bf16 v[8:11], a[40:43], a[96:99], v[8:11]
 ds_read_b64_tr_b16 a[8:9], v222 offset:32768
 buffer_load_dwordx4 a[184:187], v208, s[8:11], s31 offen sc1
 v_cvt_pk_bf16_f32 v88, v88, v89
 v_mfma_f32_16x16x32_bf16 v[24:27], a[40:43], a[100:103], v[24:27]
 ds_read_b64_tr_b16 a[10:11], v222 offset:33792
 v_mfma_f32_16x16x32_bf16 v[28:31], a[44:47], a[100:103], v[28:31]
 ds_read_b64_tr_b16 a[12:13], v223 offset:32768
 v_cvt_pk_bf16_f32 v89, v90, v91
 v_mfma_f32_16x16x32_bf16 v[12:15], a[44:47], a[96:99], v[12:15]
 ds_read_b64_tr_b16 a[14:15], v223 offset:33792
 s_waitcnt lgkmcnt(8)
 buffer_load_dwordx4 a[188:191], v208, s[8:11], s32 offen sc1
 v_mfma_f32_16x16x32_bf16 v[0:3], a[48:51], a[112:115], v[0:3]
 ds_read_b64_tr_b16 a[16:17], v220 offset:36864
 v_cvt_pk_bf16_f32 v90, v92, v93
 v_mfma_f32_16x16x32_bf16 v[16:19], a[48:51], a[116:119], v[16:19]
 ds_read_b64_tr_b16 a[18:19], v220 offset:37888
 v_mfma_f32_16x16x32_bf16 v[20:23], a[52:55], a[116:119], v[20:23]
 ds_read_b64_tr_b16 a[20:21], v221 offset:36864
 buffer_load_dwordx4 a[192:195], v209, s[8:11], s31 offen sc1
 v_mfma_f32_16x16x32_bf16 v[4:7], a[52:55], a[112:115], v[4:7]
 ds_read_b64_tr_b16 a[22:23], v221 offset:37888
 v_cvt_pk_bf16_f32 v91, v94, v95
 v_mfma_f32_16x16x32_bf16 v[8:11], a[56:59], a[112:115], v[8:11]
 ds_read_b64_tr_b16 a[24:25], v222 offset:36864
 v_mfma_f32_16x16x32_bf16 v[24:27], a[56:59], a[116:119], v[24:27]
 ds_read_b64_tr_b16 a[26:27], v222 offset:37888
 buffer_load_dwordx4 a[196:199], v209, s[8:11], s32 offen sc1
 buffer_store_dwordx4 v[88:91], v232, s[16:19], s70 offen offset:3072 sc1
 v_mfma_f32_16x16x32_bf16 v[28:31], a[60:63], a[116:119], v[28:31]
 ds_read_b64_tr_b16 a[28:29], v223 offset:36864
 v_mfma_f32_16x16x32_bf16 v[12:15], a[60:63], a[112:115], v[12:15]
 ds_read_b64_tr_b16 a[30:31], v223 offset:37888
 s_waitcnt vmcnt(27) lgkmcnt(8)
 v_mfma_f32_16x16x32_bf16 v[128:131], a[0:3], a[128:131], 0
 ds_read_b64_tr_b16 a[32:33], v220 offset:40960
 v_mfma_f32_16x16x32_bf16 v[144:147], a[0:3], a[132:135], 0
 ds_read_b64_tr_b16 a[34:35], v220 offset:41984
 buffer_load_dwordx4 a[200:203], v210, s[8:11], s31 offen sc1
 v_mfma_f32_16x16x32_bf16 v[148:151], a[4:7], a[132:135], 0
 ds_read_b64_tr_b16 a[36:37], v221 offset:40960
 v_mfma_f32_16x16x32_bf16 v[132:135], a[4:7], a[128:131], 0
 ds_read_b64_tr_b16 a[38:39], v221 offset:41984
 v_mfma_f32_16x16x32_bf16 v[136:139], a[8:11], a[128:131], 0
 ds_read_b64_tr_b16 a[40:41], v222 offset:40960
 buffer_load_dwordx4 a[204:207], v210, s[8:11], s32 offen sc1
 v_mfma_f32_16x16x32_bf16 v[152:155], a[8:11], a[132:135], 0
 ds_read_b64_tr_b16 a[42:43], v222 offset:41984
 v_mfma_f32_16x16x32_bf16 v[156:159], a[12:15], a[132:135], 0
 ds_read_b64_tr_b16 a[44:45], v223 offset:40960
 v_mfma_f32_16x16x32_bf16 v[140:143], a[12:15], a[128:131], 0
 ds_read_b64_tr_b16 a[46:47], v223 offset:41984
 s_waitcnt vmcnt(24) lgkmcnt(8)
 s_barrier
 v_mfma_f32_16x16x32_bf16 v[128:131], a[16:19], a[136:139], v[128:131]
 ds_read_b64_tr_b16 a[48:49], v220 offset:45056
 v_add_u32 v224, 0x20000, v216
 v_mfma_f32_16x16x32_bf16 v[144:147], a[16:19], a[140:143], v[144:147]
 ds_read_b64_tr_b16 a[50:51], v220 offset:46080
 buffer_load_dwordx4 a[208:211], v211, s[8:11], s31 offen sc1
 v_mfma_f32_16x16x32_bf16 v[148:151], a[20:23], a[140:143], v[148:151]
 ds_read_b64_tr_b16 a[52:53], v221 offset:45056
 v_add_u32 v225, 0x20000, v217
 v_mfma_f32_16x16x32_bf16 v[132:135], a[20:23], a[136:139], v[132:135]
 ds_read_b64_tr_b16 a[54:55], v221 offset:46080
 v_mfma_f32_16x16x32_bf16 v[136:139], a[24:27], a[136:139], v[136:139]
 ds_read_b64_tr_b16 a[56:57], v222 offset:45056
 buffer_load_dwordx4 a[212:215], v211, s[8:11], s32 offen sc1
 v_add_u32 v226, 0x20000, v218
 v_mfma_f32_16x16x32_bf16 v[152:155], a[24:27], a[140:143], v[152:155]
 ds_read_b64_tr_b16 a[58:59], v222 offset:46080
 v_mfma_f32_16x16x32_bf16 v[156:159], a[28:31], a[140:143], v[156:159]
 ds_read_b64_tr_b16 a[60:61], v223 offset:45056
 v_add_u32 v227, 0x20000, v219
 v_mfma_f32_16x16x32_bf16 v[140:143], a[28:31], a[136:139], v[140:143]
 ds_read_b64_tr_b16 a[62:63], v223 offset:46080
 s_waitcnt vmcnt(24) lgkmcnt(8)
 v_mfma_f32_16x16x32_bf16 v[128:131], a[32:35], a[144:147], v[128:131]
 ds_read_b64_tr_b16 a[0:1], v220 offset:49152
 v_mfma_f32_16x16x32_bf16 v[144:147], a[32:35], a[148:151], v[144:147]
 ds_read_b64_tr_b16 a[2:3], v220 offset:50176
 buffer_load_dwordx4 a[216:219], v212, s[8:11], s31 offen sc1
 v_mfma_f32_16x16x32_bf16 v[148:151], a[36:39], a[148:151], v[148:151]
 ds_read_b64_tr_b16 a[4:5], v221 offset:49152
 buffer_load_dwordx4 a[220:223], v212, s[8:11], s32 offen sc1
 v_mfma_f32_16x16x32_bf16 v[132:135], a[36:39], a[144:147], v[132:135]
 ds_read_b64_tr_b16 a[6:7], v221 offset:50176
 v_mfma_f32_16x16x32_bf16 v[136:139], a[40:43], a[144:147], v[136:139]
 ds_read_b64_tr_b16 a[8:9], v222 offset:49152
 s_add_u32 m0, s34, 65536
 v_mfma_f32_16x16x32_bf16 v[152:155], a[40:43], a[148:151], v[152:155]
 ds_read_b64_tr_b16 a[10:11], v222 offset:50176
 v_mfma_f32_16x16x32_bf16 v[156:159], a[44:47], a[148:151], v[156:159]
 ds_read_b64_tr_b16 a[12:13], v223 offset:49152
 buffer_load_dwordx4 v244, s[12:15], s33 offen lds
 v_mfma_f32_16x16x32_bf16 v[140:143], a[44:47], a[144:147], v[140:143]
 ds_read_b64_tr_b16 a[14:15], v223 offset:50176
 s_waitcnt vmcnt(23) lgkmcnt(8)
 v_mfma_f32_16x16x32_bf16 v[128:131], a[48:51], a[152:155], v[128:131]
 ds_read_b64_tr_b16 a[16:17], v220 offset:53248
 v_mfma_f32_16x16x32_bf16 v[144:147], a[48:51], a[156:159], v[144:147]
 ds_read_b64_tr_b16 a[18:19], v220 offset:54272
 buffer_load_dwordx4 a[224:227], v213, s[8:11], s31 offen sc1
 v_mfma_f32_16x16x32_bf16 v[148:151], a[52:55], a[156:159], v[148:151]
 ds_read_b64_tr_b16 a[20:21], v221 offset:53248
 v_mfma_f32_16x16x32_bf16 v[132:135], a[52:55], a[152:155], v[132:135]
 ds_read_b64_tr_b16 a[22:23], v221 offset:54272
 buffer_load_dwordx4 a[228:231], v213, s[8:11], s32 offen sc1
 v_mfma_f32_16x16x32_bf16 v[136:139], a[56:59], a[152:155], v[136:139]
 ds_read_b64_tr_b16 a[24:25], v222 offset:53248
 v_mfma_f32_16x16x32_bf16 v[152:155], a[56:59], a[156:159], v[152:155]
 ds_read_b64_tr_b16 a[26:27], v222 offset:54272
 buffer_load_dwordx4 v245, s[12:15], s33 offen offset:1024 lds
 v_mfma_f32_16x16x32_bf16 v[156:159], a[60:63], a[156:159], v[156:159]
 ds_read_b64_tr_b16 a[28:29], v223 offset:53248
 v_mfma_f32_16x16x32_bf16 v[140:143], a[60:63], a[152:155], v[140:143]
 ds_read_b64_tr_b16 a[30:31], v223 offset:54272
 s_waitcnt vmcnt(22) lgkmcnt(8)
 v_mfma_f32_16x16x32_bf16 v[128:131], a[0:3], a[160:163], v[128:131]
 ds_read_b64_tr_b16 a[32:33], v220 offset:57344
 v_mfma_f32_16x16x32_bf16 v[144:147], a[0:3], a[164:167], v[144:147]
 ds_read_b64_tr_b16 a[34:35], v220 offset:58368
 buffer_load_dwordx4 a[232:235], v214, s[8:11], s31 offen sc1
 v_mfma_f32_16x16x32_bf16 v[148:151], a[4:7], a[164:167], v[148:151]
 ds_read_b64_tr_b16 a[36:37], v221 offset:57344
 v_mfma_f32_16x16x32_bf16 v[132:135], a[4:7], a[160:163], v[132:135]
 ds_read_b64_tr_b16 a[38:39], v221 offset:58368
 buffer_load_dwordx4 a[236:239], v214, s[8:11], s32 offen sc1
 s_add_u32 s31, s31, 8192
 s_add_u32 s32, s32, 8192
 v_mfma_f32_16x16x32_bf16 v[136:139], a[8:11], a[160:163], v[136:139]
 ds_read_b64_tr_b16 a[40:41], v222 offset:57344
 v_mfma_f32_16x16x32_bf16 v[152:155], a[8:11], a[164:167], v[152:155]
 ds_read_b64_tr_b16 a[42:43], v222 offset:58368
 buffer_load_dwordx4 v246, s[12:15], s33 offen offset:2048 lds
 v_mfma_f32_16x16x32_bf16 v[156:159], a[12:15], a[164:167], v[156:159]
 ds_read_b64_tr_b16 a[44:45], v223 offset:57344
 v_mfma_f32_16x16x32_bf16 v[140:143], a[12:15], a[160:163], v[140:143]
 ds_read_b64_tr_b16 a[46:47], v223 offset:58368
 s_waitcnt vmcnt(23) lgkmcnt(8)
 v_mfma_f32_16x16x32_bf16 v[128:131], a[16:19], a[168:171], v[128:131]
 ds_read_b64_tr_b16 a[48:49], v220 offset:61440
 v_mfma_f32_16x16x32_bf16 v[144:147], a[16:19], a[172:175], v[144:147]
 ds_read_b64_tr_b16 a[50:51], v220 offset:62464
 buffer_load_dwordx4 a[240:243], v208, s[8:11], s31 offen sc1
 v_mfma_f32_16x16x32_bf16 v[148:151], a[20:23], a[172:175], v[148:151]
 ds_read_b64_tr_b16 a[52:53], v221 offset:61440
 v_mfma_f32_16x16x32_bf16 v[132:135], a[20:23], a[168:171], v[132:135]
 ds_read_b64_tr_b16 a[54:55], v221 offset:62464
 buffer_load_dwordx4 a[244:247], v208, s[8:11], s32 offen sc1
 v_mfma_f32_16x16x32_bf16 v[136:139], a[24:27], a[168:171], v[136:139]
 ds_read_b64_tr_b16 a[56:57], v222 offset:61440
 v_mfma_f32_16x16x32_bf16 v[152:155], a[24:27], a[172:175], v[152:155]
 ds_read_b64_tr_b16 a[58:59], v222 offset:62464
 buffer_load_dwordx4 v247, s[12:15], s33 offen offset:3072 lds
 s_add_u32 s33, s33, 262144
 v_mfma_f32_16x16x32_bf16 v[156:159], a[28:31], a[172:175], v[156:159]
 ds_read_b64_tr_b16 a[60:61], v223 offset:61440
 v_mfma_f32_16x16x32_bf16 v[140:143], a[28:31], a[168:171], v[140:143]
 ds_read_b64_tr_b16 a[62:63], v223 offset:62464
 s_waitcnt vmcnt(16) lgkmcnt(8)
 s_barrier
 v_mfma_f32_16x16x32_bf16 v[128:131], a[32:35], a[176:179], v[128:131]
 ds_read_b64_tr_b16 a[0:1], v216
 v_mfma_f32_16x16x32_bf16 v[144:147], a[32:35], a[180:183], v[144:147]
 ds_read_b64_tr_b16 a[2:3], v216 offset:1024
 buffer_atomic_add v241, v239, s[76:79], s89 offen sc1
 v_mfma_f32_16x16x32_bf16 v[148:151], a[36:39], a[180:183], v[148:151]
 ds_read_b64_tr_b16 a[4:5], v217
 buffer_load_dwordx4 a[248:251], v209, s[8:11], s31 offen sc1
 v_mfma_f32_16x16x32_bf16 v[132:135], a[36:39], a[176:179], v[132:135]
 ds_read_b64_tr_b16 a[6:7], v217 offset:1024
 buffer_load_dwordx4 a[252:255], v209, s[8:11], s32 offen sc1
 v_mfma_f32_16x16x32_bf16 v[136:139], a[40:43], a[176:179], v[136:139]
 ds_read_b64_tr_b16 a[8:9], v218
 v_mfma_f32_16x16x32_bf16 v[152:155], a[40:43], a[180:183], v[152:155]
 ds_read_b64_tr_b16 a[10:11], v218 offset:1024
 s_add_u32 m0, s34, 81920
 v_mfma_f32_16x16x32_bf16 v[156:159], a[44:47], a[180:183], v[156:159]
 ds_read_b64_tr_b16 a[12:13], v219
 buffer_load_dwordx4 v244, s[12:15], s33 offen lds
 v_mfma_f32_16x16x32_bf16 v[140:143], a[44:47], a[176:179], v[140:143]
 ds_read_b64_tr_b16 a[14:15], v219 offset:1024
 s_waitcnt vmcnt(23) lgkmcnt(8)
 v_mfma_f32_16x16x32_bf16 v[128:131], a[48:51], a[184:187], v[128:131]
 ds_read_b64_tr_b16 a[16:17], v216 offset:4096
 v_mfma_f32_16x16x32_bf16 v[144:147], a[48:51], a[188:191], v[144:147]
 ds_read_b64_tr_b16 a[18:19], v216 offset:5120
 buffer_load_dwordx4 a[64:67], v210, s[8:11], s31 offen sc1
 v_mfma_f32_16x16x32_bf16 v[148:151], a[52:55], a[188:191], v[148:151]
 ds_read_b64_tr_b16 a[20:21], v217 offset:4096
 v_mfma_f32_16x16x32_bf16 v[132:135], a[52:55], a[184:187], v[132:135]
 ds_read_b64_tr_b16 a[22:23], v217 offset:5120
 buffer_load_dwordx4 a[68:71], v210, s[8:11], s32 offen sc1
 v_mfma_f32_16x16x32_bf16 v[136:139], a[56:59], a[184:187], v[136:139]
 ds_read_b64_tr_b16 a[24:25], v218 offset:4096
 v_mfma_f32_16x16x32_bf16 v[152:155], a[56:59], a[188:191], v[152:155]
 ds_read_b64_tr_b16 a[26:27], v218 offset:5120
 buffer_load_dwordx4 v245, s[12:15], s33 offen offset:1024 lds
 v_mfma_f32_16x16x32_bf16 v[156:159], a[60:63], a[188:191], v[156:159]
 ds_read_b64_tr_b16 a[28:29], v219 offset:4096
 v_mfma_f32_16x16x32_bf16 v[140:143], a[60:63], a[184:187], v[140:143]
 ds_read_b64_tr_b16 a[30:31], v219 offset:5120
 s_waitcnt vmcnt(24) lgkmcnt(8)
 v_mfma_f32_16x16x32_bf16 v[128:131], a[0:3], a[192:195], v[128:131]
 ds_read_b64_tr_b16 a[32:33], v216 offset:8192
 v_mfma_f32_16x16x32_bf16 v[144:147], a[0:3], a[196:199], v[144:147]
 ds_read_b64_tr_b16 a[34:35], v216 offset:9216
 buffer_load_dwordx4 a[72:75], v211, s[8:11], s31 offen sc1
 v_mfma_f32_16x16x32_bf16 v[148:151], a[4:7], a[196:199], v[148:151]
 ds_read_b64_tr_b16 a[36:37], v217 offset:8192
 v_mfma_f32_16x16x32_bf16 v[132:135], a[4:7], a[192:195], v[132:135]
 ds_read_b64_tr_b16 a[38:39], v217 offset:9216
 buffer_load_dwordx4 a[76:79], v211, s[8:11], s32 offen sc1
 v_mfma_f32_16x16x32_bf16 v[136:139], a[8:11], a[192:195], v[136:139]
 ds_read_b64_tr_b16 a[40:41], v218 offset:8192
 v_mfma_f32_16x16x32_bf16 v[152:155], a[8:11], a[196:199], v[152:155]
 ds_read_b64_tr_b16 a[42:43], v218 offset:9216
 buffer_load_dwordx4 v246, s[12:15], s33 offen offset:2048 lds
 v_mfma_f32_16x16x32_bf16 v[156:159], a[12:15], a[196:199], v[156:159]
 ds_read_b64_tr_b16 a[44:45], v219 offset:8192
 v_mfma_f32_16x16x32_bf16 v[140:143], a[12:15], a[192:195], v[140:143]
 ds_read_b64_tr_b16 a[46:47], v219 offset:9216
 s_waitcnt vmcnt(24) lgkmcnt(8)
 v_mfma_f32_16x16x32_bf16 v[128:131], a[16:19], a[200:203], v[128:131]
 ds_read_b64_tr_b16 a[48:49], v216 offset:12288
 v_mfma_f32_16x16x32_bf16 v[144:147], a[16:19], a[204:207], v[144:147]
 ds_read_b64_tr_b16 a[50:51], v216 offset:13312
 buffer_load_dwordx4 a[80:83], v212, s[8:11], s31 offen sc1
 v_mfma_f32_16x16x32_bf16 v[148:151], a[20:23], a[204:207], v[148:151]
 ds_read_b64_tr_b16 a[52:53], v217 offset:12288
 v_mfma_f32_16x16x32_bf16 v[132:135], a[20:23], a[200:203], v[132:135]
 ds_read_b64_tr_b16 a[54:55], v217 offset:13312
 buffer_load_dwordx4 a[84:87], v212, s[8:11], s32 offen sc1
 v_mfma_f32_16x16x32_bf16 v[136:139], a[24:27], a[200:203], v[136:139]
 ds_read_b64_tr_b16 a[56:57], v218 offset:12288
 v_mfma_f32_16x16x32_bf16 v[152:155], a[24:27], a[204:207], v[152:155]
 ds_read_b64_tr_b16 a[58:59], v218 offset:13312
 buffer_load_dwordx4 v247, s[12:15], s33 offen offset:3072 lds
 v_mfma_f32_16x16x32_bf16 v[156:159], a[28:31], a[204:207], v[156:159]
 ds_read_b64_tr_b16 a[60:61], v219 offset:12288
 v_mfma_f32_16x16x32_bf16 v[140:143], a[28:31], a[200:203], v[140:143]
 ds_read_b64_tr_b16 a[62:63], v219 offset:13312
 s_waitcnt vmcnt(25) lgkmcnt(8)
 v_mfma_f32_16x16x32_bf16 v[128:131], a[32:35], a[208:211], v[128:131]
 ds_read_b64_tr_b16 a[0:1], v216 offset:16384
 v_mfma_f32_16x16x32_bf16 v[144:147], a[32:35], a[212:215], v[144:147]
 ds_read_b64_tr_b16 a[2:3], v216 offset:17408
 buffer_load_dwordx4 a[88:91], v213, s[8:11], s31 offen sc1
 v_mfma_f32_16x16x32_bf16 v[148:151], a[36:39], a[212:215], v[148:151]
 ds_read_b64_tr_b16 a[4:5], v217 offset:16384
 v_mfma_f32_16x16x32_bf16 v[132:135], a[36:39], a[208:211], v[132:135]
 ds_read_b64_tr_b16 a[6:7], v217 offset:17408
 v_mfma_f32_16x16x32_bf16 v[136:139], a[40:43], a[208:211], v[136:139]
 ds_read_b64_tr_b16 a[8:9], v218 offset:16384
 buffer_load_dwordx4 a[92:95], v213, s[8:11], s32 offen sc1
 v_mfma_f32_16x16x32_bf16 v[152:155], a[40:43], a[212:215], v[152:155]
 ds_read_b64_tr_b16 a[10:11], v218 offset:17408
 v_mfma_f32_16x16x32_bf16 v[156:159], a[44:47], a[212:215], v[156:159]
 ds_read_b64_tr_b16 a[12:13], v219 offset:16384
 v_mfma_f32_16x16x32_bf16 v[140:143], a[44:47], a[208:211], v[140:143]
 ds_read_b64_tr_b16 a[14:15], v219 offset:17408
 s_waitcnt vmcnt(25) lgkmcnt(8)
 v_mfma_f32_16x16x32_bf16 v[128:131], a[48:51], a[216:219], v[128:131]
 ds_read_b64_tr_b16 a[16:17], v216 offset:20480
 v_mfma_f32_16x16x32_bf16 v[144:147], a[48:51], a[220:223], v[144:147]
 ds_read_b64_tr_b16 a[18:19], v216 offset:21504
 buffer_load_dwordx4 a[96:99], v214, s[8:11], s31 offen sc1
 v_mfma_f32_16x16x32_bf16 v[148:151], a[52:55], a[220:223], v[148:151]
 ds_read_b64_tr_b16 a[20:21], v217 offset:20480
 v_mfma_f32_16x16x32_bf16 v[132:135], a[52:55], a[216:219], v[132:135]
 ds_read_b64_tr_b16 a[22:23], v217 offset:21504
 v_mfma_f32_16x16x32_bf16 v[136:139], a[56:59], a[216:219], v[136:139]
 ds_read_b64_tr_b16 a[24:25], v218 offset:20480
 buffer_load_dwordx4 a[100:103], v214, s[8:11], s32 offen sc1
 s_add_u32 s31, s31, 8192
 s_add_u32 s32, s32, 8192
 v_mfma_f32_16x16x32_bf16 v[152:155], a[56:59], a[220:223], v[152:155]
 ds_read_b64_tr_b16 a[26:27], v218 offset:21504
 v_mfma_f32_16x16x32_bf16 v[156:159], a[60:63], a[220:223], v[156:159]
 ds_read_b64_tr_b16 a[28:29], v219 offset:20480
 v_mfma_f32_16x16x32_bf16 v[140:143], a[60:63], a[216:219], v[140:143]
 ds_read_b64_tr_b16 a[30:31], v219 offset:21504
 s_waitcnt vmcnt(24) lgkmcnt(8)
 v_mfma_f32_16x16x32_bf16 v[128:131], a[0:3], a[224:227], v[128:131]
 ds_read_b64_tr_b16 a[32:33], v216 offset:24576
 v_mfma_f32_16x16x32_bf16 v[144:147], a[0:3], a[228:231], v[144:147]
 ds_read_b64_tr_b16 a[34:35], v216 offset:25600
 buffer_load_dwordx4 a[104:107], v208, s[8:11], s31 offen sc1
 v_mfma_f32_16x16x32_bf16 v[148:151], a[4:7], a[228:231], v[148:151]
 ds_read_b64_tr_b16 a[36:37], v217 offset:24576
 v_mfma_f32_16x16x32_bf16 v[132:135], a[4:7], a[224:227], v[132:135]
 ds_read_b64_tr_b16 a[38:39], v217 offset:25600
 buffer_load_dwordx4 a[108:111], v208, s[8:11], s32 offen sc1
 v_mfma_f32_16x16x32_bf16 v[136:139], a[8:11], a[224:227], v[136:139]
 ds_read_b64_tr_b16 a[40:41], v218 offset:24576
 v_mfma_f32_16x16x32_bf16 v[152:155], a[8:11], a[228:231], v[152:155]
 ds_read_b64_tr_b16 a[42:43], v218 offset:25600
 buffer_load_dwordx4 v[192:195], v233, s[20:23], 0 offen
 v_mfma_f32_16x16x32_bf16 v[156:159], a[12:15], a[228:231], v[156:159]
 ds_read_b64_tr_b16 a[44:45], v219 offset:24576
 v_mfma_f32_16x16x32_bf16 v[140:143], a[12:15], a[224:227], v[140:143]
 ds_read_b64_tr_b16 a[46:47], v219 offset:25600
 s_waitcnt vmcnt(24) lgkmcnt(8)
 v_mfma_f32_16x16x32_bf16 v[128:131], a[16:19], a[232:235], v[128:131]
 ds_read_b64_tr_b16 a[48:49], v216 offset:28672
 v_mfma_f32_16x16x32_bf16 v[144:147], a[16:19], a[236:239], v[144:147]
 ds_read_b64_tr_b16 a[50:51], v216 offset:29696
 buffer_load_dword v243, v242, s[76:79], 0 offen sc1
 v_mfma_f32_16x16x32_bf16 v[148:151], a[20:23], a[236:239], v[148:151]
 ds_read_b64_tr_b16 a[52:53], v217 offset:28672
 buffer_load_dwordx4 a[112:115], v209, s[8:11], s31 offen sc1
 v_mfma_f32_16x16x32_bf16 v[132:135], a[20:23], a[232:235], v[132:135]
 ds_read_b64_tr_b16 a[54:55], v217 offset:29696
 v_mfma_f32_16x16x32_bf16 v[136:139], a[24:27], a[232:235], v[136:139]
 ds_read_b64_tr_b16 a[56:57], v218 offset:28672
 buffer_load_dwordx4 a[116:119], v209, s[8:11], s32 offen sc1
 v_mfma_f32_16x16x32_bf16 v[152:155], a[24:27], a[236:239], v[152:155]
 ds_read_b64_tr_b16 a[58:59], v218 offset:29696
 v_mfma_f32_16x16x32_bf16 v[156:159], a[28:31], a[236:239], v[156:159]
 ds_read_b64_tr_b16 a[60:61], v219 offset:28672
 buffer_load_dwordx4 v[196:199], v233, s[20:23], s71 offen
 v_mfma_f32_16x16x32_bf16 v[140:143], a[28:31], a[232:235], v[140:143]
 ds_read_b64_tr_b16 a[62:63], v219 offset:29696
 s_waitcnt vmcnt(25) lgkmcnt(8)
 s_barrier
 v_mfma_f32_16x16x32_bf16 v[128:131], a[32:35], a[240:243], v[128:131]
 ds_read_b64_tr_b16 a[0:1], v224
 v_mfma_f32_16x16x32_bf16 v[144:147], a[32:35], a[244:247], v[144:147]
 ds_read_b64_tr_b16 a[2:3], v224 offset:1024
 buffer_load_dwordx4 a[120:123], v210, s[8:11], s31 offen sc1
 v_mfma_f32_16x16x32_bf16 v[148:151], a[36:39], a[244:247], v[148:151]
 ds_read_b64_tr_b16 a[4:5], v225
 v_mfma_f32_16x16x32_bf16 v[132:135], a[36:39], a[240:243], v[132:135]
 ds_read_b64_tr_b16 a[6:7], v225 offset:1024
 buffer_load_dwordx4 a[124:127], v210, s[8:11], s32 offen sc1
 v_mfma_f32_16x16x32_bf16 v[136:139], a[40:43], a[240:243], v[136:139]
 ds_read_b64_tr_b16 a[8:9], v226
 v_mfma_f32_16x16x32_bf16 v[152:155], a[40:43], a[244:247], v[152:155]
 ds_read_b64_tr_b16 a[10:11], v226 offset:1024
 buffer_load_dwordx4 v[200:203], v233, s[20:23], s72 offen
 v_mfma_f32_16x16x32_bf16 v[156:159], a[44:47], a[244:247], v[156:159]
 ds_read_b64_tr_b16 a[12:13], v227
 v_mfma_f32_16x16x32_bf16 v[140:143], a[44:47], a[240:243], v[140:143]
 ds_read_b64_tr_b16 a[14:15], v227 offset:1024
 s_waitcnt vmcnt(24) lgkmcnt(8)
 v_mfma_f32_16x16x32_bf16 v[128:131], a[48:51], a[248:251], v[128:131]
 ds_read_b64_tr_b16 a[16:17], v224 offset:4096
 v_mfma_f32_16x16x32_bf16 v[144:147], a[48:51], a[252:255], v[144:147]
 ds_read_b64_tr_b16 a[18:19], v224 offset:5120
 buffer_load_dwordx4 a[128:131], v211, s[8:11], s31 offen sc1
 v_mfma_f32_16x16x32_bf16 v[148:151], a[52:55], a[252:255], v[148:151]
 ds_read_b64_tr_b16 a[20:21], v225 offset:4096
 v_mfma_f32_16x16x32_bf16 v[132:135], a[52:55], a[248:251], v[132:135]
 ds_read_b64_tr_b16 a[22:23], v225 offset:5120
 buffer_load_dwordx4 a[132:135], v211, s[8:11], s32 offen sc1
 v_mfma_f32_16x16x32_bf16 v[136:139], a[56:59], a[248:251], v[136:139]
 ds_read_b64_tr_b16 a[24:25], v226 offset:4096
 v_mfma_f32_16x16x32_bf16 v[152:155], a[56:59], a[252:255], v[152:155]
 ds_read_b64_tr_b16 a[26:27], v226 offset:5120
 buffer_load_dwordx4 v[204:207], v233, s[20:23], s73 offen
 v_mfma_f32_16x16x32_bf16 v[156:159], a[60:63], a[252:255], v[156:159]
 ds_read_b64_tr_b16 a[28:29], v227 offset:4096
 v_mfma_f32_16x16x32_bf16 v[140:143], a[60:63], a[248:251], v[140:143]
 ds_read_b64_tr_b16 a[30:31], v227 offset:5120
 s_waitcnt vmcnt(24) lgkmcnt(8)
 v_mfma_f32_16x16x32_bf16 v[128:131], a[0:3], a[64:67], v[128:131]
 ds_read_b64_tr_b16 a[32:33], v224 offset:8192
 v_mfma_f32_16x16x32_bf16 v[144:147], a[0:3], a[68:71], v[144:147]
 ds_read_b64_tr_b16 a[34:35], v224 offset:9216
 buffer_load_dwordx4 a[136:139], v212, s[8:11], s31 offen sc1
 v_mfma_f32_16x16x32_bf16 v[148:151], a[4:7], a[68:71], v[148:151]
 ds_read_b64_tr_b16 a[36:37], v225 offset:8192
 v_mfma_f32_16x16x32_bf16 v[132:135], a[4:7], a[64:67], v[132:135]
 ds_read_b64_tr_b16 a[38:39], v225 offset:9216
 v_mfma_f32_16x16x32_bf16 v[136:139], a[8:11], a[64:67], v[136:139]
 ds_read_b64_tr_b16 a[40:41], v226 offset:8192
 buffer_load_dwordx4 a[140:143], v212, s[8:11], s32 offen sc1
 v_mfma_f32_16x16x32_bf16 v[152:155], a[8:11], a[68:71], v[152:155]
 ds_read_b64_tr_b16 a[42:43], v226 offset:9216
 v_mfma_f32_16x16x32_bf16 v[156:159], a[12:15], a[68:71], v[156:159]
 ds_read_b64_tr_b16 a[44:45], v227 offset:8192
 v_mfma_f32_16x16x32_bf16 v[140:143], a[12:15], a[64:67], v[140:143]
 ds_read_b64_tr_b16 a[46:47], v227 offset:9216
 s_waitcnt vmcnt(23) lgkmcnt(8)
 v_mfma_f32_16x16x32_bf16 v[128:131], a[16:19], a[72:75], v[128:131]
 ds_read_b64_tr_b16 a[48:49], v224 offset:12288
 v_mfma_f32_16x16x32_bf16 v[144:147], a[16:19], a[76:79], v[144:147]
 ds_read_b64_tr_b16 a[50:51], v224 offset:13312
 buffer_load_dwordx4 a[144:147], v213, s[8:11], s31 offen sc1
 v_mfma_f32_16x16x32_bf16 v[148:151], a[20:23], a[76:79], v[148:151]
 ds_read_b64_tr_b16 a[52:53], v225 offset:12288
 v_mfma_f32_16x16x32_bf16 v[132:135], a[20:23], a[72:75], v[132:135]
 ds_read_b64_tr_b16 a[54:55], v225 offset:13312
 v_mfma_f32_16x16x32_bf16 v[136:139], a[24:27], a[72:75], v[136:139]
 ds_read_b64_tr_b16 a[56:57], v226 offset:12288
 buffer_load_dwordx4 a[148:151], v213, s[8:11], s32 offen sc1
 v_mfma_f32_16x16x32_bf16 v[152:155], a[24:27], a[76:79], v[152:155]
 ds_read_b64_tr_b16 a[58:59], v226 offset:13312
 v_mfma_f32_16x16x32_bf16 v[156:159], a[28:31], a[76:79], v[156:159]
 ds_read_b64_tr_b16 a[60:61], v227 offset:12288
 v_mfma_f32_16x16x32_bf16 v[140:143], a[28:31], a[72:75], v[140:143]
 ds_read_b64_tr_b16 a[62:63], v227 offset:13312
 s_waitcnt vmcnt(13) lgkmcnt(8)
 v_readfirstlane_b32 s3, v243
 v_mfma_f32_16x16x32_bf16 v[128:131], a[32:35], a[80:83], v[128:131]
 ds_read_b64_tr_b16 a[0:1], v224 offset:16384
 s_cmp_lt_u32 s3, 3
 s_cbranch_scc1 L2_pp
L2_pp_r:
 v_mfma_f32_16x16x32_bf16 v[144:147], a[32:35], a[84:87], v[144:147]
 ds_read_b64_tr_b16 a[2:3], v224 offset:17408
 buffer_load_dwordx4 a[152:155], v214, s[8:11], s31 offen sc1
 v_mfma_f32_16x16x32_bf16 v[148:151], a[36:39], a[84:87], v[148:151]
 ds_read_b64_tr_b16 a[4:5], v225 offset:16384
 buffer_load_dwordx4 a[156:159], v214, s[8:11], s32 offen sc1
 s_add_u32 s31, s31, 8192
 s_add_u32 s32, s32, 8192
 v_mfma_f32_16x16x32_bf16 v[132:135], a[36:39], a[80:83], v[132:135]
 ds_read_b64_tr_b16 a[6:7], v225 offset:17408
 v_mfma_f32_16x16x32_bf16 v[136:139], a[40:43], a[80:83], v[136:139]
 ds_read_b64_tr_b16 a[8:9], v226 offset:16384
 s_add_u32 s6, s90, 0
 buffer_load_dwordx4 v[112:115], v232, s[16:19], s6 offen sc1
 v_mfma_f32_16x16x32_bf16 v[152:155], a[40:43], a[84:87], v[152:155]
 ds_read_b64_tr_b16 a[10:11], v226 offset:17408
 v_mfma_f32_16x16x32_bf16 v[156:159], a[44:47], a[84:87], v[156:159]
 ds_read_b64_tr_b16 a[12:13], v227 offset:16384
 buffer_load_dwordx4 v[116:119], v232, s[16:19], s6 offen offset:1024 sc1
 v_mfma_f32_16x16x32_bf16 v[140:143], a[44:47], a[80:83], v[140:143]
 ds_read_b64_tr_b16 a[14:15], v227 offset:17408
 s_waitcnt vmcnt(23) lgkmcnt(8)
 v_mfma_f32_16x16x32_bf16 v[128:131], a[48:51], a[88:91], v[128:131]
 ds_read_b64_tr_b16 a[16:17], v224 offset:20480
 v_mfma_f32_16x16x32_bf16 v[144:147], a[48:51], a[92:95], v[144:147]
 ds_read_b64_tr_b16 a[18:19], v224 offset:21504
 buffer_load_dwordx4 a[160:163], v208, s[8:11], s31 offen sc1
 v_mfma_f32_16x16x32_bf16 v[148:151], a[52:55], a[92:95], v[148:151]
 ds_read_b64_tr_b16 a[20:21], v225 offset:20480
 buffer_load_dwordx4 a[164:167], v208, s[8:11], s32 offen sc1
 v_mfma_f32_16x16x32_bf16 v[132:135], a[52:55], a[88:91], v[132:135]
 ds_read_b64_tr_b16 a[22:23], v225 offset:21504
 v_mfma_f32_16x16x32_bf16 v[136:139], a[56:59], a[88:91], v[136:139]
 ds_read_b64_tr_b16 a[24:25], v226 offset:20480
 buffer_load_dwordx4 v[120:123], v232, s[16:19], s6 offen offset:2048 sc1
 v_mfma_f32_16x16x32_bf16 v[152:155], a[56:59], a[92:95], v[152:155]
 ds_read_b64_tr_b16 a[26:27], v226 offset:21504
 v_mfma_f32_16x16x32_bf16 v[156:159], a[60:63], a[92:95], v[156:159]
 ds_read_b64_tr_b16 a[28:29], v227 offset:20480
 buffer_load_dwordx4 v[124:127], v232, s[16:19], s6 offen offset:3072 sc1
 v_mfma_f32_16x16x32_bf16 v[140:143], a[60:63], a[88:91], v[140:143]
 ds_read_b64_tr_b16 a[30:31], v227 offset:21504
 s_waitcnt vmcnt(25) lgkmcnt(8)
 v_mfma_f32_16x16x32_bf16 v[128:131], a[0:3], a[96:99], v[128:131]
 ds_read_b64_tr_b16 a[32:33], v224 offset:24576
 v_mfma_f32_16x16x32_bf16 v[144:147], a[0:3], a[100:103], v[144:147]
 ds_read_b64_tr_b16 a[34:35], v224 offset:25600
 buffer_load_dwordx4 a[168:171], v209, s[8:11], s31 offen sc1
 v_mfma_f32_16x16x32_bf16 v[148:151], a[4:7], a[100:103], v[148:151]
 ds_read_b64_tr_b16 a[36:37], v225 offset:24576
 buffer_load_dwordx4 a[172:175], v209, s[8:11], s32 offen sc1
 v_mfma_f32_16x16x32_bf16 v[132:135], a[4:7], a[96:99], v[132:135]
 ds_read_b64_tr_b16 a[38:39], v225 offset:25600
 v_mfma_f32_16x16x32_bf16 v[136:139], a[8:11], a[96:99], v[136:139]
 ds_read_b64_tr_b16 a[40:41], v226 offset:24576
 s_add_u32 s6, s90, 16384
 buffer_load_dwordx4 v[32:35], v232, s[16:19], s6 offen sc1
 v_mfma_f32_16x16x32_bf16 v[152:155], a[8:11], a[100:103], v[152:155]
 ds_read_b64_tr_b16 a[42:43], v226 offset:25600
 v_mfma_f32_16x16x32_bf16 v[156:159], a[12:15], a[100:103], v[156:159]
 ds_read_b64_tr_b16 a[44:45], v227 offset:24576
 buffer_load_dwordx4 v[36:39], v232, s[16:19], s6 offen offset:1024 sc1
 v_mfma_f32_16x16x32_bf16 v[140:143], a[12:15], a[96:99], v[140:143]
 ds_read_b64_tr_b16 a[46:47], v227 offset:25600
 s_waitcnt vmcnt(27) lgkmcnt(8)
 v_mfma_f32_16x16x32_bf16 v[128:131], a[16:19], a[104:107], v[128:131]
 ds_read_b64_tr_b16 a[48:49], v224 offset:28672
 v_mfma_f32_16x16x32_bf16 v[144:147], a[16:19], a[108:111], v[144:147]
 ds_read_b64_tr_b16 a[50:51], v224 offset:29696
 buffer_load_dwordx4 a[176:179], v210, s[8:11], s31 offen sc1
 v_mfma_f32_16x16x32_bf16 v[148:151], a[20:23], a[108:111], v[148:151]
 ds_read_b64_tr_b16 a[52:53], v225 offset:28672
 buffer_load_dwordx4 a[180:183], v210, s[8:11], s32 offen sc1
 v_mfma_f32_16x16x32_bf16 v[132:135], a[20:23], a[104:107], v[132:135]
 ds_read_b64_tr_b16 a[54:55], v225 offset:29696
 v_mfma_f32_16x16x32_bf16 v[136:139], a[24:27], a[104:107], v[136:139]
 ds_read_b64_tr_b16 a[56:57], v226 offset:28672
 buffer_load_dwordx4 v[40:43], v232, s[16:19], s6 offen offset:2048 sc1
 v_mfma_f32_16x16x32_bf16 v[152:155], a[24:27], a[108:111], v[152:155]
 ds_read_b64_tr_b16 a[58:59], v226 offset:29696
 v_mfma_f32_16x16x32_bf16 v[156:159], a[28:31], a[108:111], v[156:159]
 ds_read_b64_tr_b16 a[60:61], v227 offset:28672
 buffer_load_dwordx4 v[44:47], v232, s[16:19], s6 offen offset:3072 sc1
 v_mfma_f32_16x16x32_bf16 v[140:143], a[28:31], a[104:107], v[140:143]
 ds_read_b64_tr_b16 a[62:63], v227 offset:29696
 s_waitcnt vmcnt(27) lgkmcnt(8)
 s_barrier
 v_mfma_f32_16x16x32_bf16 v[128:131], a[32:35], a[112:115], v[128:131]
 ds_read_b64_tr_b16 a[0:1], v220
 v_mfma_f32_16x16x32_bf16 v[144:147], a[32:35], a[116:119], v[144:147]
 ds_read_b64_tr_b16 a[2:3], v220 offset:1024
 buffer_load_dwordx4 a[184:187], v211, s[8:11], s31 offen sc1
 v_mfma_f32_16x16x32_bf16 v[148:151], a[36:39], a[116:119], v[148:151]
 ds_read_b64_tr_b16 a[4:5], v221
 buffer_load_dwordx4 a[188:191], v211, s[8:11], s32 offen sc1
 v_mfma_f32_16x16x32_bf16 v[132:135], a[36:39], a[112:115], v[132:135]
 ds_read_b64_tr_b16 a[6:7], v221 offset:1024
 v_mfma_f32_16x16x32_bf16 v[136:139], a[40:43], a[112:115], v[136:139]
 ds_read_b64_tr_b16 a[8:9], v222
 s_add_u32 s6, s90, 32768
 buffer_load_dwordx4 v[64:67], v232, s[16:19], s6 offen sc1
 v_mfma_f32_16x16x32_bf16 v[152:155], a[40:43], a[116:119], v[152:155]
 ds_read_b64_tr_b16 a[10:11], v222 offset:1024
 v_mfma_f32_16x16x32_bf16 v[156:159], a[44:47], a[116:119], v[156:159]
 ds_read_b64_tr_b16 a[12:13], v223
 buffer_load_dwordx4 v[68:71], v232, s[16:19], s6 offen offset:1024 sc1
 v_mfma_f32_16x16x32_bf16 v[140:143], a[44:47], a[112:115], v[140:143]
 ds_read_b64_tr_b16 a[14:15], v223 offset:1024
 s_waitcnt vmcnt(28) lgkmcnt(8)
 v_mfma_f32_16x16x32_bf16 v[128:131], a[48:51], a[120:123], v[128:131]
 ds_read_b64_tr_b16 a[16:17], v220 offset:4096
 v_mfma_f32_16x16x32_bf16 v[144:147], a[48:51], a[124:127], v[144:147]
 ds_read_b64_tr_b16 a[18:19], v220 offset:5120
 buffer_load_dwordx4 v[72:75], v232, s[16:19], s6 offen offset:2048 sc1
 v_mfma_f32_16x16x32_bf16 v[148:151], a[52:55], a[124:127], v[148:151]
 ds_read_b64_tr_b16 a[20:21], v221 offset:4096
 v_mfma_f32_16x16x32_bf16 v[132:135], a[52:55], a[120:123], v[132:135]
 ds_read_b64_tr_b16 a[22:23], v221 offset:5120
 v_mfma_f32_16x16x32_bf16 v[136:139], a[56:59], a[120:123], v[136:139]
 ds_read_b64_tr_b16 a[24:25], v222 offset:4096
 buffer_load_dwordx4 v[76:79], v232, s[16:19], s6 offen offset:3072 sc1
 v_mfma_f32_16x16x32_bf16 v[152:155], a[56:59], a[124:127], v[152:155]
 ds_read_b64_tr_b16 a[26:27], v222 offset:5120
 v_mfma_f32_16x16x32_bf16 v[156:159], a[60:63], a[124:127], v[156:159]
 ds_read_b64_tr_b16 a[28:29], v223 offset:4096
 v_mfma_f32_16x16x32_bf16 v[140:143], a[60:63], a[120:123], v[140:143]
 ds_read_b64_tr_b16 a[30:31], v223 offset:5120
 s_waitcnt vmcnt(27) lgkmcnt(8)
 v_mfma_f32_16x16x32_bf16 v[128:131], a[0:3], a[128:131], v[128:131]
 ds_read_b64_tr_b16 a[32:33], v220 offset:8192
 v_mfma_f32_16x16x32_bf16 v[144:147], a[0:3], a[132:135], v[144:147]
 ds_read_b64_tr_b16 a[34:35], v220 offset:9216
 v_mfma_f32_16x16x32_bf16 v[148:151], a[4:7], a[132:135], v[148:151]
 ds_read_b64_tr_b16 a[36:37], v221 offset:8192
 v_mfma_f32_16x16x32_bf16 v[132:135], a[4:7], a[128:131], v[132:135]
 ds_read_b64_tr_b16 a[38:39], v221 offset:9216
 v_mfma_f32_16x16x32_bf16 v[136:139], a[8:11], a[128:131], v[136:139]
 ds_read_b64_tr_b16 a[40:41], v222 offset:8192
 v_mfma_f32_16x16x32_bf16 v[152:155], a[8:11], a[132:135], v[152:155]
 ds_read_b64_tr_b16 a[42:43], v222 offset:9216
 v_mfma_f32_16x16x32_bf16 v[156:159], a[12:15], a[132:135], v[156:159]
 ds_read_b64_tr_b16 a[44:45], v223 offset:8192
 v_mfma_f32_16x16x32_bf16 v[140:143], a[12:15], a[128:131], v[140:143]
 ds_read_b64_tr_b16 a[46:47], v223 offset:9216
 s_waitcnt vmcnt(24) lgkmcnt(8)
 v_mfma_f32_16x16x32_bf16 v[128:131], a[16:19], a[136:139], v[128:131]
 ds_read_b64_tr_b16 a[48:49], v220 offset:12288
 v_mfma_f32_16x16x32_bf16 v[144:147], a[16:19], a[140:143], v[144:147]
 ds_read_b64_tr_b16 a[50:51], v220 offset:13312
 v_mfma_f32_16x16x32_bf16 v[148:151], a[20:23], a[140:143], v[148:151]
 ds_read_b64_tr_b16 a[52:53], v221 offset:12288
 v_mfma_f32_16x16x32_bf16 v[132:135], a[20:23], a[136:139], v[132:135]
 ds_read_b64_tr_b16 a[54:55], v221 offset:13312
 v_mfma_f32_16x16x32_bf16 v[136:139], a[24:27], a[136:139], v[136:139]
 ds_read_b64_tr_b16 a[56:57], v222 offset:12288
 v_mfma_f32_16x16x32_bf16 v[152:155], a[24:27], a[140:143], v[152:155]
 ds_read_b64_tr_b16 a[58:59], v222 offset:13312
 v_mfma_f32_16x16x32_bf16 v[156:159], a[28:31], a[140:143], v[156:159]
 ds_read_b64_tr_b16 a[60:61], v223 offset:12288
 v_mfma_f32_16x16x32_bf16 v[140:143], a[28:31], a[136:139], v[140:143]
 ds_read_b64_tr_b16 a[62:63], v223 offset:13312
 s_waitcnt vmcnt(22) lgkmcnt(8)
 v_mfma_f32_16x16x32_bf16 v[128:131], a[32:35], a[144:147], v[128:131]
 ds_read_b64_tr_b16 a[0:1], v220 offset:16384
 v_mfma_f32_16x16x32_bf16 v[144:147], a[32:35], a[148:151], v[144:147]
 ds_read_b64_tr_b16 a[2:3], v220 offset:17408
 v_mfma_f32_16x16x32_bf16 v[148:151], a[36:39], a[148:151], v[148:151]
 ds_read_b64_tr_b16 a[4:5], v221 offset:16384
 v_mfma_f32_16x16x32_bf16 v[132:135], a[36:39], a[144:147], v[132:135]
 ds_read_b64_tr_b16 a[6:7], v221 offset:17408
 v_mfma_f32_16x16x32_bf16 v[136:139], a[40:43], a[144:147], v[136:139]
 ds_read_b64_tr_b16 a[8:9], v222 offset:16384
 v_mfma_f32_16x16x32_bf16 v[152:155], a[40:43], a[148:151], v[152:155]
 ds_read_b64_tr_b16 a[10:11], v222 offset:17408
 v_mfma_f32_16x16x32_bf16 v[156:159], a[44:47], a[148:151], v[156:159]
 ds_read_b64_tr_b16 a[12:13], v223 offset:16384
 v_mfma_f32_16x16x32_bf16 v[140:143], a[44:47], a[144:147], v[140:143]
 ds_read_b64_tr_b16 a[14:15], v223 offset:17408
 s_waitcnt vmcnt(20) lgkmcnt(8)
 v_mfma_f32_16x16x32_bf16 v[128:131], a[48:51], a[152:155], v[128:131]
 ds_read_b64_tr_b16 a[16:17], v220 offset:20480
 v_mfma_f32_16x16x32_bf16 v[144:147], a[48:51], a[156:159], v[144:147]
 ds_read_b64_tr_b16 a[18:19], v220 offset:21504
 v_mfma_f32_16x16x32_bf16 v[148:151], a[52:55], a[156:159], v[148:151]
 ds_read_b64_tr_b16 a[20:21], v221 offset:20480
 v_mfma_f32_16x16x32_bf16 v[132:135], a[52:55], a[152:155], v[132:135]
 ds_read_b64_tr_b16 a[22:23], v221 offset:21504
 v_mfma_f32_16x16x32_bf16 v[136:139], a[56:59], a[152:155], v[136:139]
 ds_read_b64_tr_b16 a[24:25], v222 offset:20480
 v_mfma_f32_16x16x32_bf16 v[152:155], a[56:59], a[156:159], v[152:155]
 ds_read_b64_tr_b16 a[26:27], v222 offset:21504
 v_mfma_f32_16x16x32_bf16 v[156:159], a[60:63], a[156:159], v[156:159]
 ds_read_b64_tr_b16 a[28:29], v223 offset:20480
 v_mfma_f32_16x16x32_bf16 v[140:143], a[60:63], a[152:155], v[140:143]
 ds_read_b64_tr_b16 a[30:31], v223 offset:21504
 s_waitcnt vmcnt(16) lgkmcnt(8)
 v_mfma_f32_16x16x32_bf16 v[128:131], a[0:3], a[160:163], v[128:131]
 ds_read_b64_tr_b16 a[32:33], v220 offset:24576
 v_lshlrev_b32_e64 v48, 16, v192
 v_mfma_f32_16x16x32_bf16 v[144:147], a[0:3], a[164:167], v[144:147]
 ds_read_b64_tr_b16 a[34:35], v220 offset:25600
 v_and_b32 v49, 0xffff0000, v192
 v_mfma_f32_16x16x32_bf16 v[148:151], a[4:7], a[164:167], v[148:151]
 ds_read_b64_tr_b16 a[36:37], v221 offset:24576
 v_lshlrev_b32_e64 v50, 16, v193
 v_mfma_f32_16x16x32_bf16 v[132:135], a[4:7], a[160:163], v[132:135]
 ds_read_b64_tr_b16 a[38:39], v221 offset:25600
 v_and_b32 v51, 0xffff0000, v193
 v_mfma_f32_16x16x32_bf16 v[136:139], a[8:11], a[160:163], v[136:139]
 ds_read_b64_tr_b16 a[40:41], v222 offset:24576
 v_lshlrev_b32_e64 v52, 16, v194
 v_mfma_f32_16x16x32_bf16 v[152:155], a[8:11], a[164:167], v[152:155]
 ds_read_b64_tr_b16 a[42:43], v222 offset:25600
 v_and_b32 v53, 0xffff0000, v194
 v_mfma_f32_16x16x32_bf16 v[156:159], a[12:15], a[164:167], v[156:159]
 ds_read_b64_tr_b16 a[44:45], v223 offset:24576
 v_lshlrev_b32_e64 v54, 16, v195
 v_mfma_f32_16x16x32_bf16 v[140:143], a[12:15], a[160:163], v[140:143]
 ds_read_b64_tr_b16 a[46:47], v223 offset:25600
 v_and_b32 v55, 0xffff0000, v195
 s_waitcnt vmcnt(12) lgkmcnt(8)
 v_mfma_f32_16x16x32_bf16 v[128:131], a[16:19], a[168:171], v[128:131]
 ds_read_b64_tr_b16 a[48:49], v220 offset:28672
 v_lshlrev_b32 v56, 16, v196
 v_mfma_f32_16x16x32_bf16 v[144:147], a[16:19], a[172:175], v[144:147]
 ds_read_b64_tr_b16 a[50:51], v220 offset:29696
 v_and_b32 v57, 0xffff0000, v196
 v_mfma_f32_16x16x32_bf16 v[148:151], a[20:23], a[172:175], v[148:151]
 ds_read_b64_tr_b16 a[52:53], v221 offset:28672
 v_lshlrev_b32_e64 v58, 16, v197
 v_mfma_f32_16x16x32_bf16 v[132:135], a[20:23], a[168:171], v[132:135]
 ds_read_b64_tr_b16 a[54:55], v221 offset:29696
 v_and_b32 v59, 0xffff0000, v197
 v_mfma_f32_16x16x32_bf16 v[136:139], a[24:27], a[168:171], v[136:139]
 ds_read_b64_tr_b16 a[56:57], v222 offset:28672
 v_lshlrev_b32_e64 v60, 16, v198
 v_mfma_f32_16x16x32_bf16 v[152:155], a[24:27], a[172:175], v[152:155]
 ds_read_b64_tr_b16 a[58:59], v222 offset:29696
 v_and_b32 v61, 0xffff0000, v198
 v_mfma_f32_16x16x32_bf16 v[156:159], a[28:31], a[172:175], v[156:159]
 ds_read_b64_tr_b16 a[60:61], v223 offset:28672
 v_lshlrev_b32_e64 v62, 16, v199
 v_mfma_f32_16x16x32_bf16 v[140:143], a[28:31], a[168:171], v[140:143]
 ds_read_b64_tr_b16 a[62:63], v223 offset:29696
 v_and_b32 v63, 0xffff0000, v199
 s_waitcnt vmcnt(8) lgkmcnt(8)
 v_mfma_f32_16x16x32_bf16 v[128:131], a[32:35], a[176:179], v[128:131]
 v_lshlrev_b32 v80, 16, v200
 v_mfma_f32_16x16x32_bf16 v[144:147], a[32:35], a[180:183], v[144:147]
 v_and_b32 v81, 0xffff0000, v200
 v_mfma_f32_16x16x32_bf16 v[148:151], a[36:39], a[180:183], v[148:151]
 v_lshlrev_b32_e64 v82, 16, v201
 v_mfma_f32_16x16x32_bf16 v[132:135], a[36:39], a[176:179], v[132:135]
 v_and_b32 v83, 0xffff0000, v201
 v_mfma_f32_16x16x32_bf16 v[136:139], a[40:43], a[176:179], v[136:139]
 v_lshlrev_b32_e64 v84, 16, v202
 v_mfma_f32_16x16x32_bf16 v[152:155], a[40:43], a[180:183], v[152:155]
 v_and_b32 v85, 0xffff0000, v202
 v_mfma_f32_16x16x32_bf16 v[156:159], a[44:47], a[180:183], v[156:159]
 v_lshlrev_b32_e64 v86, 16, v203
 v_mfma_f32_16x16x32_bf16 v[140:143], a[44:47], a[176:179], v[140:143]
 v_and_b32 v87, 0xffff0000, v203
 s_waitcnt vmcnt(4) lgkmcnt(0)
 v_mfma_f32_16x16x32_bf16 v[128:131], a[48:51], a[184:187], v[128:131]
 v_lshlrev_b32 v88, 16, v204
 v_mfma_f32_16x16x32_bf16 v[144:147], a[48:51], a[188:191], v[144:147]
 v_and_b32 v89, 0xffff0000, v204
 v_mfma_f32_16x16x32_bf16 v[148:151], a[52:55], a[188:191], v[148:151]
 v_lshlrev_b32_e64 v90, 16, v205
 v_mfma_f32_16x16x32_bf16 v[132:135], a[52:55], a[184:187], v[132:135]
 v_and_b32 v91, 0xffff0000, v205
 v_mfma_f32_16x16x32_bf16 v[136:139], a[56:59], a[184:187], v[136:139]
 v_lshlrev_b32_e64 v92, 16, v206
 v_mfma_f32_16x16x32_bf16 v[152:155], a[56:59], a[188:191], v[152:155]
 v_and_b32 v93, 0xffff0000, v206
 v_mfma_f32_16x16x32_bf16 v[156:159], a[60:63], a[188:191], v[156:159]
 v_lshlrev_b32_e64 v94, 16, v207
 v_mfma_f32_16x16x32_bf16 v[140:143], a[60:63], a[184:187], v[140:143]
 v_and_b32 v95, 0xffff0000, v207
 s_waitcnt vmcnt(0)
 v_dot2c_f32_bf16 v0, s42, v112
 v_dot2c_f32_bf16 v1, s43, v112
 v_dot2c_f32_bf16 v2, s42, v113
 v_dot2c_f32_bf16 v3, s43, v113
 v_dot2c_f32_bf16 v4, s42, v114
 v_dot2c_f32_bf16 v5, s43, v114
 v_dot2c_f32_bf16 v6, s42, v115
 v_dot2c_f32_bf16 v7, s43, v115
 v_dot2c_f32_bf16 v8, s42, v116
 v_dot2c_f32_bf16 v9, s43, v116
 v_dot2c_f32_bf16 v10, s42, v117
 v_dot2c_f32_bf16 v11, s43, v117
 v_dot2c_f32_bf16 v12, s42, v118
 v_dot2c_f32_bf16 v13, s43, v118
 v_dot2c_f32_bf16 v14, s42, v119
 v_dot2c_f32_bf16 v15, s43, v119
 v_dot2c_f32_bf16 v0, s42, v32
 v_dot2c_f32_bf16 v1, s43, v32
 v_dot2c_f32_bf16 v2, s42, v33
 v_dot2c_f32_bf16 v3, s43, v33
 v_dot2c_f32_bf16 v4, s42, v34
 v_dot2c_f32_bf16 v5, s43, v34
 v_dot2c_f32_bf16 v6, s42, v35
 v_dot2c_f32_bf16 v7, s43, v35
 v_dot2c_f32_bf16 v8, s42, v36
 v_dot2c_f32_bf16 v9, s43, v36
 v_dot2c_f32_bf16 v10, s42, v37
 v_dot2c_f32_bf16 v11, s43, v37
 v_dot2c_f32_bf16 v12, s42, v38
 v_dot2c_f32_bf16 v13, s43, v38
 v_dot2c_f32_bf16 v14, s42, v39
 v_dot2c_f32_bf16 v15, s43, v39
 v_dot2c_f32_bf16 v0, s42, v64
 v_dot2c_f32_bf16 v1, s43, v64
 v_dot2c_f32_bf16 v2, s42, v65
 v_dot2c_f32_bf16 v3, s43, v65
 v_dot2c_f32_bf16 v4, s42, v66
 v_dot2c_f32_bf16 v5, s43, v66
 v_dot2c_f32_bf16 v6, s42, v67
 v_dot2c_f32_bf16 v7, s43, v67
 v_dot2c_f32_bf16 v8, s42, v68
 v_dot2c_f32_bf16 v9, s43, v68
 v_dot2c_f32_bf16 v10, s42, v69
 v_dot2c_f32_bf16 v11, s43, v69
 v_dot2c_f32_bf16 v12, s42, v70
 v_dot2c_f32_bf16 v13, s43, v70
 v_dot2c_f32_bf16 v14, s42, v71
 v_dot2c_f32_bf16 v15, s43, v71
 v_exp_f32 v160, v0
 v_exp_f32 v161, v1
 v_exp_f32 v162, v2
 v_exp_f32 v163, v3
 v_exp_f32 v164, v4
 v_exp_f32 v165, v5
 v_exp_f32 v166, v6
 v_exp_f32 v167, v7
 v_exp_f32 v168, v8
 v_exp_f32 v169, v9
 v_exp_f32 v170, v10
 v_exp_f32 v171, v11
 v_exp_f32 v172, v12
 v_exp_f32 v173, v13
 v_exp_f32 v174, v14
 v_exp_f32_e64 v175, v15
 v_pk_mul_f32 v[0:1], v[0:1], v[128:129]
 v_pk_mul_f32 v[2:3], v[2:3], v[130:131]
 v_pk_mul_f32 v[4:5], v[4:5], v[132:133]
 v_pk_mul_f32 v[6:7], v[6:7], v[134:135]
 v_pk_mul_f32 v[8:9], v[8:9], v[136:137]
 v_pk_mul_f32 v[10:11], v[10:11], v[138:139]
 v_pk_mul_f32 v[12:13], v[12:13], v[140:141]
 v_pk_mul_f32 v[14:15], v[14:15], v[142:143]
 v_pk_add_f32 v[160:161], v[160:161], 1.0 op_sel_hi:[1,0]
 v_pk_add_f32 v[162:163], v[162:163], 1.0 op_sel_hi:[1,0]
 v_pk_add_f32 v[164:165], v[164:165], 1.0 op_sel_hi:[1,0]
 v_pk_add_f32 v[166:167], v[166:167], 1.0 op_sel_hi:[1,0]
 v_pk_add_f32 v[168:169], v[168:169], 1.0 op_sel_hi:[1,0]
 v_pk_add_f32 v[170:171], v[170:171], 1.0 op_sel_hi:[1,0]
 v_pk_add_f32 v[172:173], v[172:173], 1.0 op_sel_hi:[1,0]
 v_pk_add_f32 v[174:175], v[174:175], 1.0 op_sel_hi:[1,0]
 v_rcp_f32 v160, v160
 v_rcp_f32 v161, v161
 v_rcp_f32 v162, v162
 v_rcp_f32 v163, v163
 v_rcp_f32 v164, v164
 v_rcp_f32 v165, v165
 v_rcp_f32 v166, v166
 v_rcp_f32 v167, v167
 v_rcp_f32 v168, v168
 v_rcp_f32 v169, v169
 v_rcp_f32 v170, v170
 v_rcp_f32 v171, v171
 v_rcp_f32 v172, v172
 v_rcp_f32 v173, v173
 v_rcp_f32 v174, v174
 v_rcp_f32 v175, v175
 v_pk_mul_f32 v[160:161], v[160:161], v[0:1]
 v_pk_mul_f32 v[162:163], v[162:163], v[2:3]
 v_cvt_pk_bf16_f32 v160, v160, v161
 v_cvt_pk_bf16_f32 v161, v162, v163
 ds_write_b64 v234, v[160:161]
 v_pk_mul_f32 v[164:165], v[164:165], v[4:5]
 v_pk_mul_f32 v[166:167], v[166:167], v[6:7]
 v_cvt_pk_bf16_f32 v164, v164, v165
 v_cvt_pk_bf16_f32 v165, v166, v167
 ds_write_b64 v235, v[164:165]
 v_pk_mul_f32 v[168:169], v[168:169], v[8:9]
 v_pk_mul_f32 v[170:171], v[170:171], v[10:11]
 v_cvt_pk_bf16_f32 v168, v168, v169
 v_cvt_pk_bf16_f32 v169, v170, v171
 ds_write_b64 v236, v[168:169]
 v_pk_mul_f32 v[172:173], v[172:173], v[12:13]
 v_pk_mul_f32 v[174:175], v[174:175], v[14:15]
 v_cvt_pk_bf16_f32 v172, v172, v173
 v_cvt_pk_bf16_f32 v173, v174, v175
 ds_write_b64 v237, v[172:173]
 v_dot2c_f32_bf16 v16, s42, v120
 v_dot2c_f32_bf16 v17, s43, v120
 v_dot2c_f32_bf16 v18, s42, v121
 v_dot2c_f32_bf16 v19, s43, v121
 v_dot2c_f32_bf16 v20, s42, v122
 v_dot2c_f32_bf16 v21, s43, v122
 v_dot2c_f32_bf16 v22, s42, v123
 v_dot2c_f32_bf16 v23, s43, v123
 v_dot2c_f32_bf16 v24, s42, v124
 v_dot2c_f32_bf16 v25, s43, v124
 v_dot2c_f32_bf16 v26, s42, v125
 v_dot2c_f32_bf16 v27, s43, v125
 v_dot2c_f32_bf16 v28, s42, v126
 v_dot2c_f32_bf16 v29, s43, v126
 v_dot2c_f32_bf16 v30, s42, v127
 v_dot2c_f32_bf16 v31, s43, v127
 v_dot2c_f32_bf16 v16, s42, v40
 v_dot2c_f32_bf16 v17, s43, v40
 v_dot2c_f32_bf16 v18, s42, v41
 v_dot2c_f32_bf16 v19, s43, v41
 v_dot2c_f32_bf16 v20, s42, v42
 v_dot2c_f32_bf16 v21, s43, v42
 v_dot2c_f32_bf16 v22, s42, v43
 v_dot2c_f32_bf16 v23, s43, v43
 v_dot2c_f32_bf16 v24, s42, v44
 v_dot2c_f32_bf16 v25, s43, v44
 v_dot2c_f32_bf16 v26, s42, v45
 v_dot2c_f32_bf16 v27, s43, v45
 v_dot2c_f32_bf16 v28, s42, v46
 v_dot2c_f32_bf16 v29, s43, v46
 v_dot2c_f32_bf16 v30, s42, v47
 v_dot2c_f32_bf16 v31, s43, v47
 v_dot2c_f32_bf16 v16, s42, v72
 v_dot2c_f32_bf16 v17, s43, v72
 v_dot2c_f32_bf16 v18, s42, v73
 v_dot2c_f32_bf16 v19, s43, v73
 v_dot2c_f32_bf16 v20, s42, v74
 v_dot2c_f32_bf16 v21, s43, v74
 v_dot2c_f32_bf16 v22, s42, v75
 v_dot2c_f32_bf16 v23, s43, v75
 v_dot2c_f32_bf16 v24, s42, v76
 v_dot2c_f32_bf16 v25, s43, v76
 v_dot2c_f32_bf16 v26, s42, v77
 v_dot2c_f32_bf16 v27, s43, v77
 v_dot2c_f32_bf16 v28, s42, v78
 v_dot2c_f32_bf16 v29, s43, v78
 v_dot2c_f32_bf16 v30, s42, v79
 v_dot2c_f32_bf16 v31, s43, v79
 v_exp_f32 v176, v16
 v_exp_f32 v177, v17
 v_exp_f32 v178, v18
 v_exp_f32 v179, v19
 v_exp_f32 v180, v20
 v_exp_f32 v181, v21
 v_exp_f32 v182, v22
 v_exp_f32 v183, v23
 v_exp_f32 v184, v24
 v_exp_f32 v185, v25
 v_exp_f32 v186, v26
 v_exp_f32 v187, v27
 v_exp_f32 v188, v28
 v_exp_f32 v189, v29
 v_exp_f32 v190, v30
 v_exp_f32_e64 v191, v31
 s_waitcnt lgkmcnt(0)
 ds_read_b128 v[128:131], v238
 ds_read_b128 v[132:135], v238 offset:1024
 v_pk_mul_f32 v[16:17], v[16:17], v[144:145]
 v_pk_mul_f32 v[18:19], v[18:19], v[146:147]
 v_pk_mul_f32 v[20:21], v[20:21], v[148:149]
 v_pk_mul_f32 v[22:23], v[22:23], v[150:151]
 v_pk_mul_f32 v[24:25], v[24:25], v[152:153]
 v_pk_mul_f32 v[26:27], v[26:27], v[154:155]
 v_pk_mul_f32 v[28:29], v[28:29], v[156:157]
 v_pk_mul_f32 v[30:31], v[30:31], v[158:159]
 v_pk_add_f32 v[176:177], v[176:177], 1.0 op_sel_hi:[1,0]
 v_pk_add_f32 v[178:179], v[178:179], 1.0 op_sel_hi:[1,0]
 v_pk_add_f32 v[180:181], v[180:181], 1.0 op_sel_hi:[1,0]
 v_pk_add_f32 v[182:183], v[182:183], 1.0 op_sel_hi:[1,0]
 v_pk_add_f32 v[184:185], v[184:185], 1.0 op_sel_hi:[1,0]
 v_pk_add_f32 v[186:187], v[186:187], 1.0 op_sel_hi:[1,0]
 v_pk_add_f32 v[188:189], v[188:189], 1.0 op_sel_hi:[1,0]
 v_pk_add_f32 v[190:191], v[190:191], 1.0 op_sel_hi:[1,0]
 v_rcp_f32 v176, v176
 v_rcp_f32 v177, v177
 v_rcp_f32 v178, v178
 v_rcp_f32 v179, v179
 v_rcp_f32 v180, v180
 v_rcp_f32 v181, v181
 v_rcp_f32 v182, v182
 v_rcp_f32 v183, v183
 v_rcp_f32 v184, v184
 v_rcp_f32 v185, v185
 v_rcp_f32 v186, v186
 v_rcp_f32 v187, v187
 v_rcp_f32 v188, v188
 v_rcp_f32 v189, v189
 v_rcp_f32 v190, v190
 v_rcp_f32 v191, v191
 v_pk_mul_f32 v[176:177], v[176:177], v[16:17]
 v_pk_mul_f32 v[178:179], v[178:179], v[18:19]
 v_cvt_pk_bf16_f32 v176, v176, v177
 v_cvt_pk_bf16_f32 v177, v178, v179
 ds_write_b64 v234, v[176:177] offset:2048
 v_pk_mul_f32 v[180:181], v[180:181], v[20:21]
 v_pk_mul_f32 v[182:183], v[182:183], v[22:23]
 v_cvt_pk_bf16_f32 v180, v180, v181
 v_cvt_pk_bf16_f32 v181, v182, v183
 ds_write_b64 v235, v[180:181] offset:2048
 v_pk_mul_f32 v[184:185], v[184:185], v[24:25]
 v_pk_mul_f32 v[186:187], v[186:187], v[26:27]
 v_cvt_pk_bf16_f32 v184, v184, v185
 v_cvt_pk_bf16_f32 v185, v186, v187
 ds_write_b64 v236, v[184:185] offset:2048
 v_pk_mul_f32 v[188:189], v[188:189], v[28:29]
 v_pk_mul_f32 v[190:191], v[190:191], v[30:31]
 v_cvt_pk_bf16_f32 v188, v188, v189
 v_cvt_pk_bf16_f32 v189, v190, v191
 ds_write_b64 v237, v[188:189] offset:2048
 s_waitcnt lgkmcnt(4)
 v_lshlrev_b32 v160, 16, v128
 v_and_b32 v161, 0xffff0000, v128
 v_lshlrev_b32_e64 v162, 16, v129
 v_and_b32 v163, 0xffff0000, v129
 v_lshlrev_b32_e64 v164, 16, v130
 v_and_b32 v165, 0xffff0000, v130
 v_lshlrev_b32_e64 v166, 16, v131
 v_and_b32 v167, 0xffff0000, v131
 v_pk_add_f32 v[160:161], v[48:49], v[160:161]
 v_pk_add_f32 v[162:163], v[50:51], v[162:163]
 v_pk_add_f32 v[164:165], v[52:53], v[164:165]
 v_pk_add_f32 v[166:167], v[54:55], v[166:167]
 v_cvt_pk_bf16_f32 v192, v160, v161
 v_cvt_pk_bf16_f32 v193, v162, v163
 v_cvt_pk_bf16_f32 v194, v164, v165
 v_cvt_pk_bf16_f32 v195, v166, v167
 buffer_store_dwordx4 v[192:195], v233, s[24:27], 0 offen sc1
 s_waitcnt lgkmcnt(0)
 ds_read_b128 v[136:139], v238 offset:2048
 ds_read_b128 v[140:143], v238 offset:3072
 v_lshlrev_b32 v160, 16, v132
 v_and_b32 v161, 0xffff0000, v132
 v_lshlrev_b32_e64 v162, 16, v133
 v_and_b32 v163, 0xffff0000, v133
 v_lshlrev_b32_e64 v164, 16, v134
 v_and_b32 v165, 0xffff0000, v134
 v_lshlrev_b32_e64 v166, 16, v135
 v_and_b32 v167, 0xffff0000, v135
 v_pk_add_f32 v[160:161], v[56:57], v[160:161]
 v_pk_add_f32 v[162:163], v[58:59], v[162:163]
 v_pk_add_f32 v[164:165], v[60:61], v[164:165]
 v_pk_add_f32 v[166:167], v[62:63], v[166:167]
 v_cvt_pk_bf16_f32 v196, v160, v161
 v_cvt_pk_bf16_f32 v197, v162, v163
 v_cvt_pk_bf16_f32 v198, v164, v165
 v_cvt_pk_bf16_f32 v199, v166, v167
 buffer_store_dwordx4 v[196:199], v233, s[24:27], s71 offen sc1
 s_waitcnt lgkmcnt(1)
 v_lshlrev_b32 v160, 16, v136
 v_and_b32 v161, 0xffff0000, v136
 v_lshlrev_b32_e64 v162, 16, v137
 v_and_b32 v163, 0xffff0000, v137
 v_lshlrev_b32_e64 v164, 16, v138
 v_and_b32 v165, 0xffff0000, v138
 v_lshlrev_b32_e64 v166, 16, v139
 v_and_b32 v167, 0xffff0000, v139
 v_pk_add_f32 v[160:161], v[80:81], v[160:161]
 v_pk_add_f32 v[162:163], v[82:83], v[162:163]
 v_pk_add_f32 v[164:165], v[84:85], v[164:165]
 v_pk_add_f32 v[166:167], v[86:87], v[166:167]
 v_cvt_pk_bf16_f32 v200, v160, v161
 v_cvt_pk_bf16_f32 v201, v162, v163
 v_cvt_pk_bf16_f32 v202, v164, v165
 v_cvt_pk_bf16_f32 v203, v166, v167
 buffer_store_dwordx4 v[200:203], v233, s[24:27], s72 offen sc1
 s_waitcnt lgkmcnt(0)
 v_lshlrev_b32 v160, 16, v140
 v_and_b32 v161, 0xffff0000, v140
 v_lshlrev_b32_e64 v162, 16, v141
 v_and_b32 v163, 0xffff0000, v141
 v_lshlrev_b32_e64 v164, 16, v142
 v_and_b32 v165, 0xffff0000, v142
 v_lshlrev_b32_e64 v166, 16, v143
 v_and_b32 v167, 0xffff0000, v143
 v_pk_add_f32 v[160:161], v[88:89], v[160:161]
 v_pk_add_f32 v[162:163], v[90:91], v[162:163]
 v_pk_add_f32 v[164:165], v[92:93], v[164:165]
 v_pk_add_f32 v[166:167], v[94:95], v[166:167]
 v_cvt_pk_bf16_f32 v204, v160, v161
 v_cvt_pk_bf16_f32 v205, v162, v163
 v_cvt_pk_bf16_f32 v206, v164, v165
 v_cvt_pk_bf16_f32 v207, v166, v167
 buffer_store_dwordx4 v[204:207], v233, s[24:27], s73 offen sc1
 s_endpgm
L2_hq:
 s_mov_b32 s80, 0
L2_hpollq:
 buffer_load_dword v243, v242, s[76:79], 0 offen sc1
 s_waitcnt vmcnt(0)
 v_readfirstlane_b32 s3, v243
 s_add_u32 s80, s80, 1
 s_cmp_ge_u32 s80, 0x40000
 s_cbranch_scc1 L2_hpollq_ok
 s_cmp_lt_u32 s3, 4
 s_cbranch_scc1 L2_hpollq
L2_hpollq_ok:
 s_branch L2_hq_r
L2_chk:
 s_mov_b32 s80, 0
L2_opoll:
 buffer_load_dword v243, v242, s[76:79], 0 offen sc1
 s_waitcnt vmcnt(0)
 v_readfirstlane_b32 s3, v243
 s_add_u32 s80, s80, 1
 s_cmp_ge_u32 s80, 0x40000
 s_cbranch_scc1 L2_opoll_ok
 s_cmp_lt_u32 s3, 16
 s_cbranch_scc1 L2_opoll
L2_opoll_ok:
 s_branch L2_chk_r
L2_pp:
 s_mov_b32 s80, 0
L2_ppoll:
 buffer_load_dword v243, v242, s[76:79], 0 offen sc1
 s_waitcnt vmcnt(0)
 v_readfirstlane_b32 s3, v243
 s_add_u32 s80, s80, 1
 s_cmp_ge_u32 s80, 0x40000
 s_cbranch_scc1 L2_ppoll_ok
 s_cmp_lt_u32 s3, 3
 s_cbranch_scc1 L2_ppoll
L2_ppoll_ok:
 s_branch L2_pp_r
L1Q_d0:
 v_mfma_f32_16x16x32_bf16 a[156:159], a[32:35], a[128:131], 0
 v_mfma_f32_16x16x32_bf16 a[156:159], a[36:39], a[132:135], a[156:159]
 v_mfma_f32_16x16x32_bf16 a[156:159], a[40:43], a[136:139], a[156:159]
 v_mfma_f32_16x16x32_bf16 a[156:159], a[44:47], a[140:143], a[156:159]
 v_mfma_f32_16x16x32_bf16 a[156:159], a[48:51], a[144:147], a[156:159]
 v_mfma_f32_16x16x32_bf16 a[156:159], a[52:55], a[148:151], a[156:159]
 s_branch L1Q_d0_r
L1Q_d1:
 v_mfma_f32_16x16x32_bf16 a[156:159], a[92:95], a[128:131], a[156:159]
 v_mfma_f32_16x16x32_bf16 a[156:159], a[96:99], a[132:135], a[156:159]
 v_mfma_f32_16x16x32_bf16 a[156:159], a[100:103], a[136:139], a[156:159]
 v_mfma_f32_16x16x32_bf16 a[156:159], a[104:107], a[140:143], a[156:159]
 v_mfma_f32_16x16x32_bf16 a[156:159], a[108:111], a[144:147], a[156:159]
 v_mfma_f32_16x16x32_bf16 a[156:159], a[112:115], a[148:151], a[156:159]
 s_branch L1Q_d1_r
L1Q_d2:
 v_mfma_f32_16x16x32_bf16 a[156:159], a[32:35], a[128:131], a[156:159]
 v_mfma_f32_16x16x32_bf16 a[156:159], a[36:39], a[132:135], a[156:159]
 v_mfma_f32_16x16x32_bf16 a[156:159], a[40:43], a[136:139], a[156:159]
 v_mfma_f32_16x16x32_bf16 a[156:159], a[44:47], a[140:143], a[156:159]
 v_mfma_f32_16x16x32_bf16 a[156:159], a[48:51], a[144:147], a[156:159]
 v_mfma_f32_16x16x32_bf16 a[156:159], a[52:55], a[148:151], a[156:159]
 s_branch L1Q_d2_r
L1Q_d3:
 v_mfma_f32_16x16x32_bf16 a[156:159], a[92:95], a[128:131], a[156:159]
 v_mfma_f32_16x16x32_bf16 a[156:159], a[96:99], a[132:135], a[156:159]
 v_mfma_f32_16x16x32_bf16 a[156:159], a[100:103], a[136:139], a[156:159]
 v_mfma_f32_16x16x32_bf16 a[156:159], a[104:107], a[140:143], a[156:159]
 v_mfma_f32_16x16x32_bf16 a[156:159], a[108:111], a[144:147], a[156:159]
 v_mfma_f32_16x16x32_bf16 a[156:159], a[112:115], a[148:151], a[156:159]
 s_branch L1Q_d3_r
L1Q_d4:
 v_mfma_f32_16x16x32_bf16 a[156:159], a[32:35], a[128:131], 0
 v_mfma_f32_16x16x32_bf16 a[156:159], a[36:39], a[132:135], a[156:159]
 v_mfma_f32_16x16x32_bf16 a[156:159], a[40:43], a[136:139], a[156:159]
 v_mfma_f32_16x16x32_bf16 a[156:159], a[44:47], a[140:143], a[156:159]
 v_mfma_f32_16x16x32_bf16 a[156:159], a[48:51], a[144:147], a[156:159]
 v_mfma_f32_16x16x32_bf16 a[156:159], a[52:55], a[148:151], a[156:159]
 s_branch L1Q_d4_r
L1Q_d5:
 v_mfma_f32_16x16x32_bf16 a[156:159], a[92:95], a[128:131], a[156:159]
 v_mfma_f32_16x16x32_bf16 a[156:159], a[96:99], a[132:135], a[156:159]
 v_mfma_f32_16x16x32_bf16 a[156:159], a[100:103], a[136:139], a[156:159]
 v_mfma_f32_16x16x32_bf16 a[156:159], a[104:107], a[140:143], a[156:159]
 v_mfma_f32_16x16x32_bf16 a[156:159], a[108:111], a[144:147], a[156:159]
 v_mfma_f32_16x16x32_bf16 a[156:159], a[112:115], a[148:151], a[156:159]
 s_branch L1Q_d5_r
L1Q_d6:
 v_mfma_f32_16x16x32_bf16 a[156:159], a[32:35], a[128:131], a[156:159]
 v_mfma_f32_16x16x32_bf16 a[156:159], a[36:39], a[132:135], a[156:159]
 v_mfma_f32_16x16x32_bf16 a[156:159], a[40:43], a[136:139], a[156:159]
 v_mfma_f32_16x16x32_bf16 a[156:159], a[44:47], a[140:143], a[156:159]
 v_mfma_f32_16x16x32_bf16 a[156:159], a[48:51], a[144:147], a[156:159]
 v_mfma_f32_16x16x32_bf16 a[156:159], a[52:55], a[148:151], a[156:159]
 s_branch L1Q_d6_r
L1Q_d7:
 v_mfma_f32_16x16x32_bf16 a[156:159], a[92:95], a[128:131], a[156:159]
 v_mfma_f32_16x16x32_bf16 a[156:159], a[96:99], a[132:135], a[156:159]
 v_mfma_f32_16x16x32_bf16 a[156:159], a[100:103], a[136:139], a[156:159]
 v_mfma_f32_16x16x32_bf16 a[156:159], a[104:107], a[140:143], a[156:159]
 v_mfma_f32_16x16x32_bf16 a[156:159], a[108:111], a[144:147], a[156:159]
 v_mfma_f32_16x16x32_bf16 a[156:159], a[112:115], a[148:151], a[156:159]
 s_branch L1Q_d7_r
L1Q_d8:
 v_mfma_f32_16x16x32_bf16 a[156:159], a[32:35], a[128:131], 0
 v_mfma_f32_16x16x32_bf16 a[156:159], a[36:39], a[132:135], a[156:159]
 v_mfma_f32_16x16x32_bf16 a[156:159], a[40:43], a[136:139], a[156:159]
 v_mfma_f32_16x16x32_bf16 a[156:159], a[44:47], a[140:143], a[156:159]
 v_mfma_f32_16x16x32_bf16 a[156:159], a[48:51], a[144:147], a[156:159]
 v_mfma_f32_16x16x32_bf16 a[156:159], a[52:55], a[148:151], a[156:159]
 s_branch L1Q_d8_r
L1Q_d9:
 v_mfma_f32_16x16x32_bf16 a[156:159], a[92:95], a[128:131], a[156:159]
 v_mfma_f32_16x16x32_bf16 a[156:159], a[96:99], a[132:135], a[156:159]
 v_mfma_f32_16x16x32_bf16 a[156:159], a[100:103], a[136:139], a[156:159]
 v_mfma_f32_16x16x32_bf16 a[156:159], a[104:107], a[140:143], a[156:159]
 v_mfma_f32_16x16x32_bf16 a[156:159], a[108:111], a[144:147], a[156:159]
 v_mfma_f32_16x16x32_bf16 a[156:159], a[112:115], a[148:151], a[156:159]
 s_branch L1Q_d9_r
L1Q_d10:
 v_mfma_f32_16x16x32_bf16 a[156:159], a[32:35], a[128:131], a[156:159]
 v_mfma_f32_16x16x32_bf16 a[156:159], a[36:39], a[132:135], a[156:159]
 v_mfma_f32_16x16x32_bf16 a[156:159], a[40:43], a[136:139], a[156:159]
 v_mfma_f32_16x16x32_bf16 a[156:159], a[44:47], a[140:143], a[156:159]
 v_mfma_f32_16x16x32_bf16 a[156:159], a[48:51], a[144:147], a[156:159]
 v_mfma_f32_16x16x32_bf16 a[156:159], a[52:55], a[148:151], a[156:159]
 s_branch L1Q_d10_r
L1Q_d11:
 v_mfma_f32_16x16x32_bf16 a[156:159], a[92:95], a[128:131], a[156:159]
 v_mfma_f32_16x16x32_bf16 a[156:159], a[96:99], a[132:135], a[156:159]
 v_mfma_f32_16x16x32_bf16 a[156:159], a[100:103], a[136:139], a[156:159]
 v_mfma_f32_16x16x32_bf16 a[156:159], a[104:107], a[140:143], a[156:159]
 v_mfma_f32_16x16x32_bf16 a[156:159], a[108:111], a[144:147], a[156:159]
 v_mfma_f32_16x16x32_bf16 a[156:159], a[112:115], a[148:151], a[156:159]
 s_branch L1Q_d11_r
L1Q_d12:
 v_mfma_f32_16x16x32_bf16 a[156:159], a[32:35], a[128:131], 0
 v_mfma_f32_16x16x32_bf16 a[156:159], a[36:39], a[132:135], a[156:159]
 v_mfma_f32_16x16x32_bf16 a[156:159], a[40:43], a[136:139], a[156:159]
 v_mfma_f32_16x16x32_bf16 a[156:159], a[44:47], a[140:143], a[156:159]
 v_mfma_f32_16x16x32_bf16 a[156:159], a[48:51], a[144:147], a[156:159]
 v_mfma_f32_16x16x32_bf16 a[156:159], a[52:55], a[148:151], a[156:159]
 s_branch L1Q_d12_r
L1Q_d13:
 v_mfma_f32_16x16x32_bf16 a[156:159], a[92:95], a[128:131], a[156:159]
 v_mfma_f32_16x16x32_bf16 a[156:159], a[96:99], a[132:135], a[156:159]
 v_mfma_f32_16x16x32_bf16 a[156:159], a[100:103], a[136:139], a[156:159]
 v_mfma_f32_16x16x32_bf16 a[156:159], a[104:107], a[140:143], a[156:159]
 v_mfma_f32_16x16x32_bf16 a[156:159], a[108:111], a[144:147], a[156:159]
 v_mfma_f32_16x16x32_bf16 a[156:159], a[112:115], a[148:151], a[156:159]
 s_branch L1Q_d13_r
L1Q_d14:
 v_mfma_f32_16x16x32_bf16 a[156:159], a[32:35], a[128:131], a[156:159]
 v_mfma_f32_16x16x32_bf16 a[156:159], a[36:39], a[132:135], a[156:159]
 v_mfma_f32_16x16x32_bf16 a[156:159], a[40:43], a[136:139], a[156:159]
 v_mfma_f32_16x16x32_bf16 a[156:159], a[44:47], a[140:143], a[156:159]
 v_mfma_f32_16x16x32_bf16 a[156:159], a[48:51], a[144:147], a[156:159]
 v_mfma_f32_16x16x32_bf16 a[156:159], a[52:55], a[148:151], a[156:159]
 s_branch L1Q_d14_r
L1Q_d15:
 v_mfma_f32_16x16x32_bf16 a[156:159], a[92:95], a[128:131], a[156:159]
 v_mfma_f32_16x16x32_bf16 a[156:159], a[96:99], a[132:135], a[156:159]
 v_mfma_f32_16x16x32_bf16 a[156:159], a[100:103], a[136:139], a[156:159]
 v_mfma_f32_16x16x32_bf16 a[156:159], a[104:107], a[140:143], a[156:159]
 v_mfma_f32_16x16x32_bf16 a[156:159], a[108:111], a[144:147], a[156:159]
 v_mfma_f32_16x16x32_bf16 a[156:159], a[112:115], a[148:151], a[156:159]
 s_branch L1Q_d15_r
L1Q_sp0:
 s_mov_b32 s80, 0
L1Q_sp:
 buffer_load_dword v195, v196, s[96:99], 0 offen sc1
 s_waitcnt vmcnt(0)
 v_cmp_gt_u32 vcc, v197, v195
 s_add_u32 s80, s80, 1
 s_cmp_ge_u32 s80, 0x40000
 s_cbranch_scc1 L1Q_sok
 s_nop 2
 s_cbranch_vccz L1Q_sok
 s_sleep 8
 s_branch L1Q_sp
L1q_pp:
 s_mov_b32 s80, 0
L1q_poll:
 buffer_load_dword v252, v237, s[76:79], 0 offen sc1
 s_waitcnt vmcnt(0)
 v_readfirstlane_b32 s3, v252
 s_add_u32 s80, s80, 1
 s_cmp_ge_u32 s80, 0x40000
 s_cbranch_scc1 L1q_poll_ok
 s_cmp_lt_u32 s3, 8
 s_cbranch_scc1 L1q_poll
L1q_poll_ok:
 s_branch L1q_ppr
L1_ffn:
 v_lshrrev_b32_e64 v241, 4, v255
 v_mul_u32_u24 v238, 3072, v241
 v_and_b32_e64 v241, 1, v241
 v_bfe_u32 v242, v255, 3, 1
 v_lshl_or_b32 v241, v242, 2, v241
 s_lshl_b32 s3, s30, 2
 v_xor_b32 v241, s3, v241
 v_and_b32 v242, 2, v255
 v_xor_b32 v241, v241, v242
 v_lshl_add_u32 v238, v241, 4, v238
 v_and_b32_e64 v242, 1, v255
 v_lshl_add_u32 v238, v242, 3, v238
 v_bfe_u32 v242, v255, 2, 2
 v_lshl_add_u32 v238, v242, 7, v238
 v_add_u32 v238, 110592, v238
 v_xor_b32 v239, 16, v238
 v_lshrrev_b32 v241, 4, v255
 v_lshlrev_b32 v240, 9, v241
 v_and_b32 v241, 1, v241
 v_xor_b32_e64 v241, s30, v241
 v_lshl_add_u32 v240, v241, 5, v240
 v_bfe_u32 v241, v255, 2, 2
 v_lshl_add_u32 v240, v241, 6, v240
 v_and_b32_e64 v241, 3, v255
 v_lshl_add_u32 v240, v241, 3, v240
 v_add_u32 v240, 0x8000, v240
 s_lshl_b32 s68, s41, 13
 s_lshl_b32 s3, s40, 4
 s_lshl_b32 s70, s29, 3
 s_add_u32 s3, s3, s70
 s_mul_i32 s3, s3, 172032
 s_add_u32 s68, s68, s3
 s_mov_b32 s69, s68
 s_and_b32 s3, s41, 1
 s_add_u32 s70, s3, s30
 s_lshl_b32 s70, s70, 3
 s_add_u32 s70, s70, 4
 s_mul_i32 s3, s3, 48
 s_sub_u32 s71, 52, s3
 s_and_b32 s3, s83, 3
 s_lshl_b32 s4, s81, 2
 s_add_u32 s3, s3, s4
 s_lshl_b32 s3, s3, 2
 s_add_u32 s3, s3, s28
 s_lshl_b32 s3, s3, 14
 v_lshrrev_b32 v2, 0, v255
 v_lshlrev_b32 v247, 11, v2
 v_and_b32_e64 v2, 0, v255
 v_lshl_add_u32 v247, v2, 7, v247
 v_lshrrev_b32_e64 v2, 3, v255
 v_lshl_add_u32 v247, v2, 28, v247
 v_add_u32 v247, s3, v247
 s_and_b32 s3, s40, 3
 s_lshl_b32 s3, s3, 2
 s_add_u32 s3, s3, s28
 s_mul_i32 s3, s3, 28672
 v_lshrrev_b32_e64 v2, 2, v255
 v_mul_u32_u24 v252, 7168, v2
 v_and_b32_e64 v2, 3, v255
 v_lshl_add_u32 v252, v2, 7, v252
 s_mul_i32 s4, s41, 448
 s_and_b32 s4, s4, -128
 v_lshrrev_b32 v2, 4, v255
 s_add_u32 s3, s3, s4
 s_add_u32 s3, s3, 4096
 v_lshl_add_u32 v252, v2, 28, v252
 v_add_u32_e64 v252, s3, v252
 s_xor_b32 s6, s44, 1024
 s_add_u32 s6, s6, 256
 buffer_load_dword v251, v247, s[8:11], s6 offen
 s_add_u32 s6, s43, 917504
 buffer_load_dword v251, v252, s[12:15], s6 offen
 v_add_u32 v241, 73728, v236
 v_add_u32 v242, 73728, v237
 v_add_u32 v243, 73728, v240
 v_mov_b32 v28, 0
 v_mov_b32 v29, 0
 v_mov_b32 v30, 0
 v_mov_b32 v31, 0
 v_lshrrev_b32 v2, 4, v0
 v_lshlrev_b32 v2, 20, v2
 v_and_b32_e64 v3, 15, v0
 v_lshl_add_u32 v2, v3, 4, v2
 s_lshl_b32 s3, s2, 8
 buffer_store_dwordx4 v[28:31], v2, s[76:79], s3 offen sc1
 s_lshl_b32 s3, s81, 4
 s_add_u32 s3, s3, s41
 s_lshl_b32 s73, s3, 13
 s_add_u32 s73, s73, 73728
 s_lshl_b32 s75, s40, 10
 s_add_u32 s75, s75, s73
 s_lshl_b32 s72, s40, 14
 s_add_u32 s72, s72, 335872
 s_and_b32 s88, s40, 3
 s_lshl_b32 s3, s7, 9
 s_add_u32 s3, s3, s72
 s_lshl_b32 s74, s28, 7
 s_add_u32 s74, s74, s3
 s_mov_b32 s20, s12
 s_mov_b32 s21, s13
 s_mov_b32 s22, s14
 s_mov_b32 s23, 0x20000
 s_lshr_b32 s3, s40, 2
 s_mul_i32 s24, s3, 3670016
 s_add_u32 s24, s24, 921600
 s_add_u32 s3, s3, 2
 s_mul_i32 s26, s3, 524288
 s_lshl_b32 s3, s41, 2
 s_add_u32 s3, s3, s88
 s_lshl_b32 s3, s3, 2
 s_add_u32 s3, s3, s28
 s_mul_i32 s3, s3, 2048
 v_lshlrev_b32 v250, 7, v255
 v_lshrrev_b32_e64 v3, 4, v255
 v_lshl_add_u32 v250, v3, 26, v250
 v_add_u32 v250, s3, v250
 v_and_b32 v3, 15, v255
 v_mov_b32 v4, 0x3f803f80
 v_cmp_eq_u32 vcc, 0, v3
 s_nop 1
 v_cndmask_b32 v8, 0, v4, vcc
 v_cmp_eq_u32 vcc, 1, v3
 s_nop 1
 v_cndmask_b32 v9, 0, v4, vcc
 v_cmp_eq_u32 vcc, 2, v3
 s_nop 1
 v_cndmask_b32 v10, 0, v4, vcc
 v_cmp_eq_u32 vcc, 3, v3
 s_nop 1
 v_cndmask_b32 v11, 0, v4, vcc
 v_cmp_eq_u32 vcc, 4, v3
 s_nop 1
 v_cndmask_b32 v12, 0, v4, vcc
 v_cmp_eq_u32 vcc, 5, v3
 s_nop 1
 v_cndmask_b32 v13, 0, v4, vcc
 v_cmp_eq_u32 vcc, 6, v3
 s_nop 1
 v_cndmask_b32_e64 v14, 0, v4, vcc
 v_accvgpr_write_b32 a128, v8
 v_accvgpr_write_b32 a129, v8
 v_accvgpr_write_b32 a130, v8
 v_accvgpr_write_b32 a131, v8
 v_accvgpr_write_b32 a132, v9
 v_accvgpr_write_b32 a133, v9
 v_accvgpr_write_b32 a134, v9
 v_accvgpr_write_b32 a135, v9
 v_accvgpr_write_b32 a136, v10
 v_accvgpr_write_b32 a137, v10
 v_accvgpr_write_b32 a138, v10
 v_accvgpr_write_b32 a139, v10
 v_accvgpr_write_b32 a140, v11
 v_accvgpr_write_b32 a141, v11
 v_accvgpr_write_b32 a142, v11
 v_accvgpr_write_b32 a143, v11
 v_accvgpr_write_b32 a144, v12
 v_accvgpr_write_b32 a145, v12
 v_accvgpr_write_b32 a146, v12
 v_accvgpr_write_b32 a147, v12
 v_accvgpr_write_b32 a148, v13
 v_accvgpr_write_b32 a149, v13
 v_accvgpr_write_b32 a150, v13
 v_accvgpr_write_b32 a151, v13
 v_accvgpr_write_b32 a152, v14
 v_accvgpr_write_b32 a153, v14
 v_accvgpr_write_b32 a154, v14
 v_accvgpr_write_b32 a155, v14
 v_lshrrev_b32 v4, 1, v3
 v_lshlrev_b32 v192, 8, v4
 v_and_b32_e64 v4, 1, v3
 v_lshl_add_u32 v192, v4, 6, v192
 v_lshrrev_b32_e64 v4, 4, v255
 v_lshl_add_u32 v192, v4, 4, v192
 s_lshl_b32 s3, s30, 7
 s_lshl_b32 s4, s29, 24
 s_add_u32 s3, s3, s4
 v_add_u32 v192, s3, v192
 v_add_u32 v4, 8, v3
 v_lshrrev_b32 v4, 4, v4
 v_lshl_add_u32 v192, v4, 20, v192
 v_lshlrev_b32 v193, 12, v0
 s_lshl_b32 s3, s81, 4
 s_add_u32 s3, s3, s41
 s_add_u32 s3, s3, 32
 s_lshl_b32 s3, s3, 2
 v_add_u32 v195, s3, v193
 s_lshl_b32 s3, s40, 2
 v_add_u32 v193, s3, v193
 v_mov_b32_e64 v194, 1
 s_waitcnt vmcnt(10)
 s_barrier
 ds_read_b64_tr_b16 a[32:33], v238
 ds_read_b64_tr_b16 a[34:35], v238 offset:512
 ds_read_b128 a[0:3], v236
 ds_read_b128 a[4:7], v236 offset:2048
 ds_read_b128 a[8:11], v236 offset:4096
 ds_read_b128 a[12:15], v236 offset:6144
 ds_read_b128 a[16:19], v236 offset:8192
 ds_read_b128 a[20:23], v236 offset:10240
 ds_read_b128 a[24:27], v236 offset:12288
 ds_read_b128 a[28:31], v236 offset:14336
 ds_read_b64_tr_b16 a[36:37], v239
 ds_read_b64_tr_b16 a[38:39], v239 offset:512
 ds_read_b64_tr_b16 a[40:41], v238 offset:1024
 ds_read_b64_tr_b16 a[42:43], v238 offset:1536
 ds_read_b64_tr_b16 a[44:45], v239 offset:1024
 ds_read_b64_tr_b16 a[46:47], v239 offset:1536
 ds_read_b64_tr_b16 a[48:49], v238 offset:2048
 ds_read_b64_tr_b16 a[50:51], v238 offset:2560
 ds_read_b64_tr_b16 a[52:53], v239 offset:2048
 ds_read_b64_tr_b16 a[54:55], v239 offset:2560
 ds_read_b64_tr_b16 a[56:57], v240
 ds_read_b64_tr_b16 a[58:59], v240 offset:256
 s_waitcnt vmcnt(7) lgkmcnt(0)
 s_barrier
 v_mfma_f32_16x16x32_bf16 v[0:3], a[32:35], a[0:3], 0
 ds_read_b64_tr_b16 a[92:93], v238 offset:12288
 v_mfma_f32_16x16x32_bf16 v[24:27], a[32:35], a[4:7], 0
 ds_read_b64_tr_b16 a[94:95], v238 offset:12800
 v_mfma_f32_16x16x32_bf16 v[48:51], a[32:35], a[8:11], 0
 ds_read_b128 a[60:63], v237
 v_mfma_f32_16x16x32_bf16 v[72:75], a[32:35], a[12:15], 0
 ds_read_b128 a[64:67], v237 offset:2048
 v_mfma_f32_16x16x32_bf16 v[96:99], a[32:35], a[16:19], 0
 ds_read_b128 a[68:71], v237 offset:4096
 v_mfma_f32_16x16x32_bf16 v[120:123], a[32:35], a[20:23], 0
 ds_read_b128 a[72:75], v237 offset:6144
 v_mfma_f32_16x16x32_bf16 v[144:147], a[32:35], a[24:27], 0
 ds_read_b128 a[76:79], v237 offset:8192
 v_mfma_f32_16x16x32_bf16 v[168:171], a[32:35], a[28:31], 0
 ds_read_b128 a[80:83], v237 offset:10240
 v_mfma_f32_16x16x32_bf16 v[172:175], a[36:39], a[28:31], 0
 ds_read_b128 a[84:87], v237 offset:12288
 v_mfma_f32_16x16x32_bf16 v[148:151], a[36:39], a[24:27], 0
 ds_read_b128 a[88:91], v237 offset:14336
 v_mfma_f32_16x16x32_bf16 v[124:127], a[36:39], a[20:23], 0
 ds_read_b64_tr_b16 a[96:97], v239 offset:12288
 v_mfma_f32_16x16x32_bf16 v[100:103], a[36:39], a[16:19], 0
 ds_read_b64_tr_b16 a[98:99], v239 offset:12800
 v_mfma_f32_16x16x32_bf16 v[76:79], a[36:39], a[12:15], 0
 ds_read_b64_tr_b16 a[100:101], v238 offset:13312
 v_mfma_f32_16x16x32_bf16 v[52:55], a[36:39], a[8:11], 0
 ds_read_b64_tr_b16 a[102:103], v238 offset:13824
 v_mfma_f32_16x16x32_bf16 v[28:31], a[36:39], a[4:7], 0
 ds_read_b64_tr_b16 a[104:105], v239 offset:13312
 v_mfma_f32_16x16x32_bf16 v[4:7], a[36:39], a[0:3], 0
 ds_read_b64_tr_b16 a[106:107], v239 offset:13824
 v_mfma_f32_16x16x32_bf16 v[8:11], a[40:43], a[0:3], 0
 ds_read_b64_tr_b16 a[108:109], v238 offset:14336
 v_mfma_f32_16x16x32_bf16 v[32:35], a[40:43], a[4:7], 0
 ds_read_b64_tr_b16 a[110:111], v238 offset:14848
 v_mfma_f32_16x16x32_bf16 v[56:59], a[40:43], a[8:11], 0
 ds_read_b64_tr_b16 a[112:113], v239 offset:14336
 v_mfma_f32_16x16x32_bf16 v[80:83], a[40:43], a[12:15], 0
 ds_read_b64_tr_b16 a[114:115], v239 offset:14848
 v_mfma_f32_16x16x32_bf16 v[104:107], a[40:43], a[16:19], 0
 ds_read_b64_tr_b16 a[116:117], v240 offset:2048
 v_mfma_f32_16x16x32_bf16 v[128:131], a[40:43], a[20:23], 0
 ds_read_b64_tr_b16 a[118:119], v240 offset:2304
 v_mfma_f32_16x16x32_bf16 v[152:155], a[40:43], a[24:27], 0
 s_add_u32 m0, s37, 40960
 v_mfma_f32_16x16x32_bf16 v[176:179], a[40:43], a[28:31], 0
 buffer_load_dwordx4 v228, s[8:11], s31 offen lds
 v_mfma_f32_16x16x32_bf16 v[180:183], a[44:47], a[28:31], 0
 s_cmp_eq_u32 s88, 0
 s_cbranch_scc1 L1F_d0
L1F_d0_r:
 v_mfma_f32_16x16x32_bf16 v[156:159], a[44:47], a[24:27], 0
 buffer_load_dwordx4 v229, s[8:11], s31 offen offset:1024 lds
 v_mfma_f32_16x16x32_bf16 v[132:135], a[44:47], a[20:23], 0
 v_mfma_f32_16x16x32_bf16 v[108:111], a[44:47], a[16:19], 0
 buffer_load_dwordx4 v230, s[8:11], s31 offen offset:2048 lds
 v_mfma_f32_16x16x32_bf16 v[84:87], a[44:47], a[12:15], 0
 v_mfma_f32_16x16x32_bf16 v[60:63], a[44:47], a[8:11], 0
 buffer_load_dwordx4 v231, s[8:11], s31 offen offset:3072 lds
 v_mfma_f32_16x16x32_bf16 v[36:39], a[44:47], a[4:7], 0
 s_add_u32 m0, s42, 36864
 v_mfma_f32_16x16x32_bf16 v[12:15], a[44:47], a[0:3], 0
 v_mfma_f32_16x16x32_bf16 v[16:19], a[48:51], a[0:3], 0
 buffer_load_dwordx4 v235, s[12:15], s33 offen lds
 v_mfma_f32_16x16x32_bf16 v[40:43], a[48:51], a[4:7], 0
 v_mfma_f32_16x16x32_bf16 v[64:67], a[48:51], a[8:11], 0
 s_add_u32 s33, s33, 458752
 v_mfma_f32_16x16x32_bf16 v[88:91], a[48:51], a[12:15], 0
 v_mfma_f32_16x16x32_bf16 v[112:115], a[48:51], a[16:19], 0
 s_add_u32 s31, s31, 128
 v_mfma_f32_16x16x32_bf16 v[136:139], a[48:51], a[20:23], 0
 v_mfma_f32_16x16x32_bf16 v[160:163], a[48:51], a[24:27], 0
 s_add_u32 m0, s38, 24576
 v_mfma_f32_16x16x32_bf16 v[184:187], a[48:51], a[28:31], 0
 buffer_load_dwordx4 v232, s[12:15], s32 offen lds
 v_mfma_f32_16x16x32_bf16 v[188:191], a[52:55], a[28:31], 0
 v_mfma_f32_16x16x32_bf16 v[164:167], a[52:55], a[24:27], 0
 buffer_load_dwordx4 v233, s[12:15], s32 offen offset:1024 lds
 v_mfma_f32_16x16x32_bf16 v[140:143], a[52:55], a[20:23], 0
 v_mfma_f32_16x16x32_bf16 v[116:119], a[52:55], a[16:19], 0
 buffer_load_dwordx4 v234, s[12:15], s32 offen offset:2048 lds
 v_mfma_f32_16x16x32_bf16 v[92:95], a[52:55], a[12:15], 0
 v_mfma_f32_16x16x32_bf16 v[68:71], a[52:55], a[8:11], 0
 s_add_u32 s32, s32, 229376
 v_mfma_f32_16x16x32_bf16 v[44:47], a[52:55], a[4:7], 0
 v_mfma_f32_16x16x32_bf16 v[20:23], a[52:55], a[0:3], 0
 s_add_u32 m0, s38, 36864
 v_mfma_f32_16x16x32_bf16 a[160:163], a[56:59], a[0:3], 0
 buffer_load_dwordx4 v232, s[12:15], s32 offen lds
 v_mfma_f32_16x16x32_bf16 a[164:167], a[56:59], a[4:7], 0
 v_mfma_f32_16x16x32_bf16 a[168:171], a[56:59], a[8:11], 0
 buffer_load_dwordx4 v233, s[12:15], s32 offen offset:1024 lds
 v_mfma_f32_16x16x32_bf16 a[172:175], a[56:59], a[12:15], 0
 v_mfma_f32_16x16x32_bf16 a[176:179], a[56:59], a[16:19], 0
 buffer_load_dwordx4 v234, s[12:15], s32 offen offset:2048 lds
 v_mfma_f32_16x16x32_bf16 a[180:183], a[56:59], a[20:23], 0
 v_mfma_f32_16x16x32_bf16 a[184:187], a[56:59], a[24:27], 0
 s_add_u32 s32, s32, 229376
 v_mfma_f32_16x16x32_bf16 a[188:191], a[56:59], a[28:31], 0
 s_waitcnt vmcnt(3) lgkmcnt(0)
 s_barrier
 v_mfma_f32_16x16x32_bf16 v[0:3], a[92:95], a[60:63], v[0:3]
 ds_read_b64_tr_b16 a[32:33], v238 offset:24576
 v_mfma_f32_16x16x32_bf16 v[24:27], a[92:95], a[64:67], v[24:27]
 ds_read_b64_tr_b16 a[34:35], v238 offset:25088
 v_mfma_f32_16x16x32_bf16 v[48:51], a[92:95], a[68:71], v[48:51]
 ds_read_b128 a[0:3], v236 offset:36864
 v_mfma_f32_16x16x32_bf16 v[72:75], a[92:95], a[72:75], v[72:75]
 ds_read_b128 a[4:7], v236 offset:38912
 v_mfma_f32_16x16x32_bf16 v[96:99], a[92:95], a[76:79], v[96:99]
 ds_read_b128 a[8:11], v236 offset:40960
 v_mfma_f32_16x16x32_bf16 v[120:123], a[92:95], a[80:83], v[120:123]
 ds_read_b128 a[12:15], v236 offset:43008
 v_mfma_f32_16x16x32_bf16 v[144:147], a[92:95], a[84:87], v[144:147]
 ds_read_b128 a[16:19], v236 offset:45056
 v_mfma_f32_16x16x32_bf16 v[168:171], a[92:95], a[88:91], v[168:171]
 ds_read_b128 a[20:23], v236 offset:47104
 v_mfma_f32_16x16x32_bf16 v[172:175], a[96:99], a[88:91], v[172:175]
 ds_read_b128 a[24:27], v236 offset:49152
 v_mfma_f32_16x16x32_bf16 v[148:151], a[96:99], a[84:87], v[148:151]
 ds_read_b128 a[28:31], v236 offset:51200
 v_mfma_f32_16x16x32_bf16 v[124:127], a[96:99], a[80:83], v[124:127]
 ds_read_b64_tr_b16 a[36:37], v239 offset:24576
 v_mfma_f32_16x16x32_bf16 v[100:103], a[96:99], a[76:79], v[100:103]
 ds_read_b64_tr_b16 a[38:39], v239 offset:25088
 v_mfma_f32_16x16x32_bf16 v[76:79], a[96:99], a[72:75], v[76:79]
 ds_read_b64_tr_b16 a[40:41], v238 offset:25600
 v_mfma_f32_16x16x32_bf16 v[52:55], a[96:99], a[68:71], v[52:55]
 ds_read_b64_tr_b16 a[42:43], v238 offset:26112
 v_mfma_f32_16x16x32_bf16 v[28:31], a[96:99], a[64:67], v[28:31]
 ds_read_b64_tr_b16 a[44:45], v239 offset:25600
 v_mfma_f32_16x16x32_bf16 v[4:7], a[96:99], a[60:63], v[4:7]
 ds_read_b64_tr_b16 a[46:47], v239 offset:26112
 v_mfma_f32_16x16x32_bf16 v[8:11], a[100:103], a[60:63], v[8:11]
 ds_read_b64_tr_b16 a[48:49], v238 offset:26624
 v_mfma_f32_16x16x32_bf16 v[32:35], a[100:103], a[64:67], v[32:35]
 ds_read_b64_tr_b16 a[50:51], v238 offset:27136
 v_mfma_f32_16x16x32_bf16 v[56:59], a[100:103], a[68:71], v[56:59]
 ds_read_b64_tr_b16 a[52:53], v239 offset:26624
 v_mfma_f32_16x16x32_bf16 v[80:83], a[100:103], a[72:75], v[80:83]
 ds_read_b64_tr_b16 a[54:55], v239 offset:27136
 v_mfma_f32_16x16x32_bf16 v[104:107], a[100:103], a[76:79], v[104:107]
 ds_read_b64_tr_b16 a[56:57], v240 offset:36864
 v_mfma_f32_16x16x32_bf16 v[128:131], a[100:103], a[80:83], v[128:131]
 ds_read_b64_tr_b16 a[58:59], v240 offset:37120
 v_mfma_f32_16x16x32_bf16 v[152:155], a[100:103], a[84:87], v[152:155]
 s_add_u32 m0, s37, 73728
 v_mfma_f32_16x16x32_bf16 v[176:179], a[100:103], a[88:91], v[176:179]
 buffer_load_dwordx4 v224, s[8:11], s31 offen lds
 v_mfma_f32_16x16x32_bf16 v[180:183], a[104:107], a[88:91], v[180:183]
 buffer_load_dwordx4 v225, s[8:11], s31 offen offset:1024 lds
 v_mfma_f32_16x16x32_bf16 v[156:159], a[104:107], a[84:87], v[156:159]
 s_cmp_eq_u32 s88, 0
 s_cbranch_scc1 L1F_d1
L1F_d1_r:
 v_mfma_f32_16x16x32_bf16 v[132:135], a[104:107], a[80:83], v[132:135]
 buffer_load_dwordx4 v226, s[8:11], s31 offen offset:2048 lds
 v_mfma_f32_16x16x32_bf16 v[108:111], a[104:107], a[76:79], v[108:111]
 buffer_load_dwordx4 v227, s[8:11], s31 offen offset:3072 lds
 v_mfma_f32_16x16x32_bf16 v[84:87], a[104:107], a[72:75], v[84:87]
 v_mfma_f32_16x16x32_bf16 v[60:63], a[104:107], a[68:71], v[60:63]
 s_add_u32 m0, s37, 77824
 v_mfma_f32_16x16x32_bf16 v[36:39], a[104:107], a[64:67], v[36:39]
 buffer_load_dwordx4 v228, s[8:11], s31 offen lds
 v_mfma_f32_16x16x32_bf16 v[12:15], a[104:107], a[60:63], v[12:15]
 buffer_load_dwordx4 v229, s[8:11], s31 offen offset:1024 lds
 v_mfma_f32_16x16x32_bf16 v[16:19], a[108:111], a[60:63], v[16:19]
 v_mfma_f32_16x16x32_bf16 v[40:43], a[108:111], a[64:67], v[40:43]
 buffer_load_dwordx4 v230, s[8:11], s31 offen offset:2048 lds
 v_mfma_f32_16x16x32_bf16 v[64:67], a[108:111], a[68:71], v[64:67]
 buffer_load_dwordx4 v231, s[8:11], s31 offen offset:3072 lds
 v_mfma_f32_16x16x32_bf16 v[88:91], a[108:111], a[72:75], v[88:91]
 v_mfma_f32_16x16x32_bf16 v[112:115], a[108:111], a[76:79], v[112:115]
 s_add_u32 m0, s42, 73728
 v_mfma_f32_16x16x32_bf16 v[136:139], a[108:111], a[80:83], v[136:139]
 buffer_load_dwordx4 v235, s[12:15], s33 offen lds
 v_mfma_f32_16x16x32_bf16 v[160:163], a[108:111], a[84:87], v[160:163]
 v_mfma_f32_16x16x32_bf16 v[184:187], a[108:111], a[88:91], v[184:187]
 s_add_u32 s33, s33, 458752
 v_mfma_f32_16x16x32_bf16 v[188:191], a[112:115], a[88:91], v[188:191]
 s_add_u32 s31, s31, 128
 v_mfma_f32_16x16x32_bf16 v[164:167], a[112:115], a[84:87], v[164:167]
 s_add_u32 m0, s38, 0
 v_mfma_f32_16x16x32_bf16 v[140:143], a[112:115], a[80:83], v[140:143]
 v_mfma_f32_16x16x32_bf16 v[116:119], a[112:115], a[76:79], v[116:119]
 buffer_load_dwordx4 v232, s[12:15], s32 offen lds
 v_mfma_f32_16x16x32_bf16 v[92:95], a[112:115], a[72:75], v[92:95]
 buffer_load_dwordx4 v233, s[12:15], s32 offen offset:1024 lds
 v_mfma_f32_16x16x32_bf16 v[68:71], a[112:115], a[68:71], v[68:71]
 v_mfma_f32_16x16x32_bf16 v[44:47], a[112:115], a[64:67], v[44:47]
 buffer_load_dwordx4 v234, s[12:15], s32 offen offset:2048 lds
 v_mfma_f32_16x16x32_bf16 v[20:23], a[112:115], a[60:63], v[20:23]
 s_add_u32 s32, s32, 229376
 v_mfma_f32_16x16x32_bf16 a[160:163], a[116:119], a[60:63], a[160:163]
 s_xor_b32 s6, s44, 1024
 v_mfma_f32_16x16x32_bf16 a[164:167], a[116:119], a[64:67], a[164:167]
 v_mfma_f32_16x16x32_bf16 a[168:171], a[116:119], a[68:71], a[168:171]
 s_add_u32 s6, s6, 384
 v_mfma_f32_16x16x32_bf16 a[172:175], a[116:119], a[72:75], a[172:175]
 buffer_load_dword v251, v247, s[8:11], s6 offen
 v_mfma_f32_16x16x32_bf16 a[176:179], a[116:119], a[76:79], a[176:179]
 v_mfma_f32_16x16x32_bf16 a[180:183], a[116:119], a[80:83], a[180:183]
 s_add_u32 s6, s43, 1376256
 v_mfma_f32_16x16x32_bf16 a[184:187], a[116:119], a[84:87], a[184:187]
 buffer_load_dword v251, v252, s[12:15], s6 offen
 v_mfma_f32_16x16x32_bf16 a[188:191], a[116:119], a[88:91], a[188:191]
 s_waitcnt vmcnt(14) lgkmcnt(0)
 s_barrier
 v_mfma_f32_16x16x32_bf16 v[0:3], a[32:35], a[0:3], v[0:3]
 ds_read_b64_tr_b16 a[92:93], v238 offset:36864
 v_mfma_f32_16x16x32_bf16 v[24:27], a[32:35], a[4:7], v[24:27]
 ds_read_b64_tr_b16 a[94:95], v238 offset:37376
 v_mfma_f32_16x16x32_bf16 v[48:51], a[32:35], a[8:11], v[48:51]
 ds_read_b128 a[60:63], v237 offset:36864
 v_mfma_f32_16x16x32_bf16 v[72:75], a[32:35], a[12:15], v[72:75]
 ds_read_b128 a[64:67], v237 offset:38912
 v_mfma_f32_16x16x32_bf16 v[96:99], a[32:35], a[16:19], v[96:99]
 ds_read_b128 a[68:71], v237 offset:40960
 v_mfma_f32_16x16x32_bf16 v[120:123], a[32:35], a[20:23], v[120:123]
 ds_read_b128 a[72:75], v237 offset:43008
 v_mfma_f32_16x16x32_bf16 v[144:147], a[32:35], a[24:27], v[144:147]
 ds_read_b128 a[76:79], v237 offset:45056
 v_mfma_f32_16x16x32_bf16 v[168:171], a[32:35], a[28:31], v[168:171]
 ds_read_b128 a[80:83], v237 offset:47104
 v_mfma_f32_16x16x32_bf16 v[172:175], a[36:39], a[28:31], v[172:175]
 ds_read_b128 a[84:87], v237 offset:49152
 v_mfma_f32_16x16x32_bf16 v[148:151], a[36:39], a[24:27], v[148:151]
 ds_read_b128 a[88:91], v237 offset:51200
 v_mfma_f32_16x16x32_bf16 v[124:127], a[36:39], a[20:23], v[124:127]
 ds_read_b64_tr_b16 a[96:97], v239 offset:36864
 v_mfma_f32_16x16x32_bf16 v[100:103], a[36:39], a[16:19], v[100:103]
 ds_read_b64_tr_b16 a[98:99], v239 offset:37376
 v_mfma_f32_16x16x32_bf16 v[76:79], a[36:39], a[12:15], v[76:79]
 ds_read_b64_tr_b16 a[100:101], v238 offset:37888
 v_mfma_f32_16x16x32_bf16 v[52:55], a[36:39], a[8:11], v[52:55]
 ds_read_b64_tr_b16 a[102:103], v238 offset:38400
 v_mfma_f32_16x16x32_bf16 v[28:31], a[36:39], a[4:7], v[28:31]
 ds_read_b64_tr_b16 a[104:105], v239 offset:37888
 v_mfma_f32_16x16x32_bf16 v[4:7], a[36:39], a[0:3], v[4:7]
 ds_read_b64_tr_b16 a[106:107], v239 offset:38400
 v_mfma_f32_16x16x32_bf16 v[8:11], a[40:43], a[0:3], v[8:11]
 ds_read_b64_tr_b16 a[108:109], v238 offset:38912
 v_mfma_f32_16x16x32_bf16 v[32:35], a[40:43], a[4:7], v[32:35]
 ds_read_b64_tr_b16 a[110:111], v238 offset:39424
 v_mfma_f32_16x16x32_bf16 v[56:59], a[40:43], a[8:11], v[56:59]
 ds_read_b64_tr_b16 a[112:113], v239 offset:38912
 v_mfma_f32_16x16x32_bf16 v[80:83], a[40:43], a[12:15], v[80:83]
 ds_read_b64_tr_b16 a[114:115], v239 offset:39424
 v_mfma_f32_16x16x32_bf16 v[104:107], a[40:43], a[16:19], v[104:107]
 ds_read_b64_tr_b16 a[116:117], v240 offset:38912
 v_mfma_f32_16x16x32_bf16 v[128:131], a[40:43], a[20:23], v[128:131]
 ds_read_b64_tr_b16 a[118:119], v240 offset:39168
 v_mfma_f32_16x16x32_bf16 v[152:155], a[40:43], a[24:27], v[152:155]
 s_add_u32 m0, s38, 12288
 v_mfma_f32_16x16x32_bf16 v[176:179], a[40:43], a[28:31], v[176:179]
 s_cmp_eq_u32 s88, 0
 s_cbranch_scc1 L1F_d2
L1F_d2_r:
 v_mfma_f32_16x16x32_bf16 v[180:183], a[44:47], a[28:31], v[180:183]
 buffer_load_dwordx4 v232, s[12:15], s32 offen lds
 v_mfma_f32_16x16x32_bf16 v[156:159], a[44:47], a[24:27], v[156:159]
 v_mfma_f32_16x16x32_bf16 v[132:135], a[44:47], a[20:23], v[132:135]
 buffer_load_dwordx4 v233, s[12:15], s32 offen offset:1024 lds
 v_mfma_f32_16x16x32_bf16 v[108:111], a[44:47], a[16:19], v[108:111]
 v_mfma_f32_16x16x32_bf16 v[84:87], a[44:47], a[12:15], v[84:87]
 buffer_load_dwordx4 v234, s[12:15], s32 offen offset:2048 lds
 v_mfma_f32_16x16x32_bf16 v[60:63], a[44:47], a[8:11], v[60:63]
 v_mfma_f32_16x16x32_bf16 v[36:39], a[44:47], a[4:7], v[36:39]
 s_add_u32 s32, s32, 229376
 v_mfma_f32_16x16x32_bf16 v[12:15], a[44:47], a[0:3], v[12:15]
 v_mfma_f32_16x16x32_bf16 v[16:19], a[48:51], a[0:3], v[16:19]
 s_add_u32 m0, s37, 0
 v_mfma_f32_16x16x32_bf16 v[40:43], a[48:51], a[4:7], v[40:43]
 v_mfma_f32_16x16x32_bf16 v[64:67], a[48:51], a[8:11], v[64:67]
 buffer_load_dwordx4 v224, s[8:11], s31 offen lds
 v_mfma_f32_16x16x32_bf16 v[88:91], a[48:51], a[12:15], v[88:91]
 v_mfma_f32_16x16x32_bf16 v[112:115], a[48:51], a[16:19], v[112:115]
 buffer_load_dwordx4 v225, s[8:11], s31 offen offset:1024 lds
 v_mfma_f32_16x16x32_bf16 v[136:139], a[48:51], a[20:23], v[136:139]
 v_mfma_f32_16x16x32_bf16 v[160:163], a[48:51], a[24:27], v[160:163]
 buffer_load_dwordx4 v226, s[8:11], s31 offen offset:2048 lds
 v_mfma_f32_16x16x32_bf16 v[184:187], a[48:51], a[28:31], v[184:187]
 v_mfma_f32_16x16x32_bf16 v[188:191], a[52:55], a[28:31], v[188:191]
 buffer_load_dwordx4 v227, s[8:11], s31 offen offset:3072 lds
 v_mfma_f32_16x16x32_bf16 v[164:167], a[52:55], a[24:27], v[164:167]
 v_mfma_f32_16x16x32_bf16 v[140:143], a[52:55], a[20:23], v[140:143]
 s_add_u32 m0, s38, 24576
 v_mfma_f32_16x16x32_bf16 v[116:119], a[52:55], a[16:19], v[116:119]
 v_mfma_f32_16x16x32_bf16 v[92:95], a[52:55], a[12:15], v[92:95]
 buffer_load_dwordx4 v232, s[12:15], s32 offen lds
 v_mfma_f32_16x16x32_bf16 v[68:71], a[52:55], a[8:11], v[68:71]
 v_mfma_f32_16x16x32_bf16 v[44:47], a[52:55], a[4:7], v[44:47]
 buffer_load_dwordx4 v233, s[12:15], s32 offen offset:1024 lds
 v_mfma_f32_16x16x32_bf16 v[20:23], a[52:55], a[0:3], v[20:23]
 v_mfma_f32_16x16x32_bf16 a[160:163], a[56:59], a[0:3], a[160:163]
 buffer_load_dwordx4 v234, s[12:15], s32 offen offset:2048 lds
 v_mfma_f32_16x16x32_bf16 a[164:167], a[56:59], a[4:7], a[164:167]
 v_mfma_f32_16x16x32_bf16 a[168:171], a[56:59], a[8:11], a[168:171]
 s_add_u32 s32, s32, 229376
 v_mfma_f32_16x16x32_bf16 a[172:175], a[56:59], a[12:15], a[172:175]
 v_mfma_f32_16x16x32_bf16 a[176:179], a[56:59], a[16:19], a[176:179]
 buffer_load_dwordx4 v[200:203], v199, s[8:11], 0 offen
 v_mfma_f32_16x16x32_bf16 a[180:183], a[56:59], a[20:23], a[180:183]
 v_mfma_f32_16x16x32_bf16 a[184:187], a[56:59], a[24:27], a[184:187]
 buffer_load_dwordx4 v[204:207], v199, s[8:11], 0 offen offset:1024
 v_mfma_f32_16x16x32_bf16 a[188:191], a[56:59], a[28:31], a[188:191]
 s_waitcnt vmcnt(14) lgkmcnt(0)
 s_barrier
 v_mfma_f32_16x16x32_bf16 v[0:3], a[92:95], a[60:63], v[0:3]
 ds_read_b64_tr_b16 a[32:33], v238
 v_mfma_f32_16x16x32_bf16 v[24:27], a[92:95], a[64:67], v[24:27]
 ds_read_b64_tr_b16 a[34:35], v238 offset:512
 v_mfma_f32_16x16x32_bf16 v[48:51], a[92:95], a[68:71], v[48:51]
 ds_read_b128 a[0:3], v241
 v_mfma_f32_16x16x32_bf16 v[72:75], a[92:95], a[72:75], v[72:75]
 ds_read_b128 a[4:7], v241 offset:2048
 v_mfma_f32_16x16x32_bf16 v[96:99], a[92:95], a[76:79], v[96:99]
 ds_read_b128 a[8:11], v241 offset:4096
 v_mfma_f32_16x16x32_bf16 v[120:123], a[92:95], a[80:83], v[120:123]
 ds_read_b128 a[12:15], v241 offset:6144
 v_mfma_f32_16x16x32_bf16 v[144:147], a[92:95], a[84:87], v[144:147]
 ds_read_b128 a[16:19], v241 offset:8192
 v_mfma_f32_16x16x32_bf16 v[168:171], a[92:95], a[88:91], v[168:171]
 ds_read_b128 a[20:23], v241 offset:10240
 v_mfma_f32_16x16x32_bf16 v[172:175], a[96:99], a[88:91], v[172:175]
 ds_read_b128 a[24:27], v241 offset:12288
 v_mfma_f32_16x16x32_bf16 v[148:151], a[96:99], a[84:87], v[148:151]
 ds_read_b128 a[28:31], v241 offset:14336
 v_mfma_f32_16x16x32_bf16 v[124:127], a[96:99], a[80:83], v[124:127]
 ds_read_b64_tr_b16 a[36:37], v239
 v_mfma_f32_16x16x32_bf16 v[100:103], a[96:99], a[76:79], v[100:103]
 ds_read_b64_tr_b16 a[38:39], v239 offset:512
 v_mfma_f32_16x16x32_bf16 v[76:79], a[96:99], a[72:75], v[76:79]
 ds_read_b64_tr_b16 a[40:41], v238 offset:1024
 v_mfma_f32_16x16x32_bf16 v[52:55], a[96:99], a[68:71], v[52:55]
 ds_read_b64_tr_b16 a[42:43], v238 offset:1536
 v_mfma_f32_16x16x32_bf16 v[28:31], a[96:99], a[64:67], v[28:31]
 ds_read_b64_tr_b16 a[44:45], v239 offset:1024
 v_mfma_f32_16x16x32_bf16 v[4:7], a[96:99], a[60:63], v[4:7]
 ds_read_b64_tr_b16 a[46:47], v239 offset:1536
 v_mfma_f32_16x16x32_bf16 v[8:11], a[100:103], a[60:63], v[8:11]
 ds_read_b64_tr_b16 a[48:49], v238 offset:2048
 v_mfma_f32_16x16x32_bf16 v[32:35], a[100:103], a[64:67], v[32:35]
 ds_read_b64_tr_b16 a[50:51], v238 offset:2560
 v_mfma_f32_16x16x32_bf16 v[56:59], a[100:103], a[68:71], v[56:59]
 ds_read_b64_tr_b16 a[52:53], v239 offset:2048
 v_mfma_f32_16x16x32_bf16 v[80:83], a[100:103], a[72:75], v[80:83]
 ds_read_b64_tr_b16 a[54:55], v239 offset:2560
 v_mfma_f32_16x16x32_bf16 v[104:107], a[100:103], a[76:79], v[104:107]
 ds_read_b64_tr_b16 a[56:57], v243
 v_mfma_f32_16x16x32_bf16 v[128:131], a[100:103], a[80:83], v[128:131]
 ds_read_b64_tr_b16 a[58:59], v243 offset:256
 v_mfma_f32_16x16x32_bf16 v[152:155], a[100:103], a[84:87], v[152:155]
 s_add_u32 m0, s37, 4096
 v_mfma_f32_16x16x32_bf16 v[176:179], a[100:103], a[88:91], v[176:179]
 buffer_load_dwordx4 v228, s[8:11], s31 offen lds
 v_mfma_f32_16x16x32_bf16 v[180:183], a[104:107], a[88:91], v[180:183]
 buffer_load_dwordx4 v229, s[8:11], s31 offen offset:1024 lds
 v_mfma_f32_16x16x32_bf16 v[156:159], a[104:107], a[84:87], v[156:159]
 buffer_load_dwordx4 v230, s[8:11], s31 offen offset:2048 lds
 v_mfma_f32_16x16x32_bf16 v[132:135], a[104:107], a[80:83], v[132:135]
 s_cmp_eq_u32 s88, 0
 s_cbranch_scc1 L1F_d3
L1F_d3_r:
 v_mfma_f32_16x16x32_bf16 v[108:111], a[104:107], a[76:79], v[108:111]
 buffer_load_dwordx4 v231, s[8:11], s31 offen offset:3072 lds
 v_mfma_f32_16x16x32_bf16 v[84:87], a[104:107], a[72:75], v[84:87]
 s_add_u32 m0, s42, 0
 v_mfma_f32_16x16x32_bf16 v[60:63], a[104:107], a[68:71], v[60:63]
 buffer_load_dwordx4 v235, s[12:15], s33 offen lds
 v_mfma_f32_16x16x32_bf16 v[36:39], a[104:107], a[64:67], v[36:39]
 v_mfma_f32_16x16x32_bf16 v[12:15], a[104:107], a[60:63], v[12:15]
 s_add_u32 s33, s33, 458752
 v_mfma_f32_16x16x32_bf16 v[16:19], a[108:111], a[60:63], v[16:19]
 s_add_u32 s31, s31, 128
 v_mfma_f32_16x16x32_bf16 v[40:43], a[108:111], a[64:67], v[40:43]
 s_add_u32 m0, s38, 36864
 v_mfma_f32_16x16x32_bf16 v[64:67], a[108:111], a[68:71], v[64:67]
 v_mfma_f32_16x16x32_bf16 v[88:91], a[108:111], a[72:75], v[88:91]
 buffer_load_dwordx4 v232, s[12:15], s32 offen lds
 v_mfma_f32_16x16x32_bf16 v[112:115], a[108:111], a[76:79], v[112:115]
 buffer_load_dwordx4 v233, s[12:15], s32 offen offset:1024 lds
 v_mfma_f32_16x16x32_bf16 v[136:139], a[108:111], a[80:83], v[136:139]
 buffer_load_dwordx4 v234, s[12:15], s32 offen offset:2048 lds
 v_mfma_f32_16x16x32_bf16 v[160:163], a[108:111], a[84:87], v[160:163]
 v_mfma_f32_16x16x32_bf16 v[184:187], a[108:111], a[88:91], v[184:187]
 s_add_u32 s32, s32, 229376
 v_mfma_f32_16x16x32_bf16 v[188:191], a[112:115], a[88:91], v[188:191]
 s_add_u32 m0, s37, 36864
 v_mfma_f32_16x16x32_bf16 v[164:167], a[112:115], a[84:87], v[164:167]
 buffer_load_dwordx4 v224, s[8:11], s31 offen lds
 v_mfma_f32_16x16x32_bf16 v[140:143], a[112:115], a[80:83], v[140:143]
 buffer_load_dwordx4 v225, s[8:11], s31 offen offset:1024 lds
 v_mfma_f32_16x16x32_bf16 v[116:119], a[112:115], a[76:79], v[116:119]
 v_mfma_f32_16x16x32_bf16 v[92:95], a[112:115], a[72:75], v[92:95]
 buffer_load_dwordx4 v226, s[8:11], s31 offen offset:2048 lds
 v_mfma_f32_16x16x32_bf16 v[68:71], a[112:115], a[68:71], v[68:71]
 buffer_load_dwordx4 v227, s[8:11], s31 offen offset:3072 lds
 v_mfma_f32_16x16x32_bf16 v[44:47], a[112:115], a[64:67], v[44:47]
 buffer_load_dwordx4 v[208:211], v199, s[8:11], 0 offen offset:2048
 v_mfma_f32_16x16x32_bf16 v[20:23], a[112:115], a[60:63], v[20:23]
 v_mfma_f32_16x16x32_bf16 a[160:163], a[116:119], a[60:63], a[160:163]
 buffer_load_dwordx4 v[212:215], v199, s[8:11], 0 offen offset:3072
 v_mfma_f32_16x16x32_bf16 a[164:167], a[116:119], a[64:67], a[164:167]
 s_xor_b32 s6, s44, 1024
 v_mfma_f32_16x16x32_bf16 a[168:171], a[116:119], a[68:71], a[168:171]
 s_add_u32 s6, s6, 512
 v_mfma_f32_16x16x32_bf16 a[172:175], a[116:119], a[72:75], a[172:175]
 v_mfma_f32_16x16x32_bf16 a[176:179], a[116:119], a[76:79], a[176:179]
 buffer_load_dword v251, v247, s[8:11], s6 offen
 v_mfma_f32_16x16x32_bf16 a[180:183], a[116:119], a[80:83], a[180:183]
 s_add_u32 s6, s43, 1835008
 v_mfma_f32_16x16x32_bf16 a[184:187], a[116:119], a[84:87], a[184:187]
 buffer_load_dword v251, v252, s[12:15], s6 offen
 v_mfma_f32_16x16x32_bf16 a[188:191], a[116:119], a[88:91], a[188:191]
 s_waitcnt vmcnt(25) lgkmcnt(0)
 s_barrier
 v_mfma_f32_16x16x32_bf16 v[0:3], a[32:35], a[0:3], v[0:3]
 ds_read_b64_tr_b16 a[92:93], v238 offset:12288
 v_mfma_f32_16x16x32_bf16 v[24:27], a[32:35], a[4:7], v[24:27]
 ds_read_b64_tr_b16 a[94:95], v238 offset:12800
 v_mfma_f32_16x16x32_bf16 v[48:51], a[32:35], a[8:11], v[48:51]
 ds_read_b128 a[60:63], v242
 v_mfma_f32_16x16x32_bf16 v[72:75], a[32:35], a[12:15], v[72:75]
 ds_read_b128 a[64:67], v242 offset:2048
 v_mfma_f32_16x16x32_bf16 v[96:99], a[32:35], a[16:19], v[96:99]
 ds_read_b128 a[68:71], v242 offset:4096
 v_mfma_f32_16x16x32_bf16 v[120:123], a[32:35], a[20:23], v[120:123]
 ds_read_b128 a[72:75], v242 offset:6144
 v_mfma_f32_16x16x32_bf16 v[144:147], a[32:35], a[24:27], v[144:147]
 ds_read_b128 a[76:79], v242 offset:8192
 v_mfma_f32_16x16x32_bf16 v[168:171], a[32:35], a[28:31], v[168:171]
 ds_read_b128 a[80:83], v242 offset:10240
 v_mfma_f32_16x16x32_bf16 v[172:175], a[36:39], a[28:31], v[172:175]
 ds_read_b128 a[84:87], v242 offset:12288
 v_mfma_f32_16x16x32_bf16 v[148:151], a[36:39], a[24:27], v[148:151]
 ds_read_b128 a[88:91], v242 offset:14336
 v_mfma_f32_16x16x32_bf16 v[124:127], a[36:39], a[20:23], v[124:127]
 ds_read_b64_tr_b16 a[96:97], v239 offset:12288
 v_mfma_f32_16x16x32_bf16 v[100:103], a[36:39], a[16:19], v[100:103]
 ds_read_b64_tr_b16 a[98:99], v239 offset:12800
 v_mfma_f32_16x16x32_bf16 v[76:79], a[36:39], a[12:15], v[76:79]
 ds_read_b64_tr_b16 a[100:101], v238 offset:13312
 v_mfma_f32_16x16x32_bf16 v[52:55], a[36:39], a[8:11], v[52:55]
 ds_read_b64_tr_b16 a[102:103], v238 offset:13824
 v_mfma_f32_16x16x32_bf16 v[28:31], a[36:39], a[4:7], v[28:31]
 ds_read_b64_tr_b16 a[104:105], v239 offset:13312
 v_mfma_f32_16x16x32_bf16 v[4:7], a[36:39], a[0:3], v[4:7]
 ds_read_b64_tr_b16 a[106:107], v239 offset:13824
 v_mfma_f32_16x16x32_bf16 v[8:11], a[40:43], a[0:3], v[8:11]
 ds_read_b64_tr_b16 a[108:109], v238 offset:14336
 v_mfma_f32_16x16x32_bf16 v[32:35], a[40:43], a[4:7], v[32:35]
 ds_read_b64_tr_b16 a[110:111], v238 offset:14848
 v_mfma_f32_16x16x32_bf16 v[56:59], a[40:43], a[8:11], v[56:59]
 ds_read_b64_tr_b16 a[112:113], v239 offset:14336
 v_mfma_f32_16x16x32_bf16 v[80:83], a[40:43], a[12:15], v[80:83]
 ds_read_b64_tr_b16 a[114:115], v239 offset:14848
 v_mfma_f32_16x16x32_bf16 v[104:107], a[40:43], a[16:19], v[104:107]
 ds_read_b64_tr_b16 a[116:117], v243 offset:2048
 v_mfma_f32_16x16x32_bf16 v[128:131], a[40:43], a[20:23], v[128:131]
 ds_read_b64_tr_b16 a[118:119], v243 offset:2304
 v_mfma_f32_16x16x32_bf16 v[152:155], a[40:43], a[24:27], v[152:155]
 s_cmp_eq_u32 s88, 0
 s_cselect_b32 s4, s75, s5
 v_mfma_f32_16x16x32_bf16 v[176:179], a[40:43], a[28:31], v[176:179]
 s_cmp_eq_u32 s88, 1
 s_cbranch_scc1 L1F_d4
L1F_d4_r:
 v_mfma_f32_16x16x32_bf16 v[180:183], a[44:47], a[28:31], v[180:183]
 buffer_store_dwordx4 a[156:159], v192, s[92:95], s4 offen sc1
 v_mfma_f32_16x16x32_bf16 v[156:159], a[44:47], a[24:27], v[156:159]
 v_mfma_f32_16x16x32_bf16 v[132:135], a[44:47], a[20:23], v[132:135]
 s_add_u32 m0, s38, 0
 v_mfma_f32_16x16x32_bf16 v[108:111], a[44:47], a[16:19], v[108:111]
 v_mfma_f32_16x16x32_bf16 v[84:87], a[44:47], a[12:15], v[84:87]
 buffer_load_dwordx4 v232, s[12:15], s32 offen lds
 v_mfma_f32_16x16x32_bf16 v[60:63], a[44:47], a[8:11], v[60:63]
 v_mfma_f32_16x16x32_bf16 v[36:39], a[44:47], a[4:7], v[36:39]
 buffer_load_dwordx4 v233, s[12:15], s32 offen offset:1024 lds
 v_mfma_f32_16x16x32_bf16 v[12:15], a[44:47], a[0:3], v[12:15]
 v_mfma_f32_16x16x32_bf16 v[16:19], a[48:51], a[0:3], v[16:19]
 buffer_load_dwordx4 v234, s[12:15], s32 offen offset:2048 lds
 v_mfma_f32_16x16x32_bf16 v[40:43], a[48:51], a[4:7], v[40:43]
 v_mfma_f32_16x16x32_bf16 v[64:67], a[48:51], a[8:11], v[64:67]
 s_add_u32 s32, s32, 229376
 v_mfma_f32_16x16x32_bf16 v[88:91], a[48:51], a[12:15], v[88:91]
 v_mfma_f32_16x16x32_bf16 v[112:115], a[48:51], a[16:19], v[112:115]
 s_add_u32 m0, s37, 40960
 v_mfma_f32_16x16x32_bf16 v[136:139], a[48:51], a[20:23], v[136:139]
 v_mfma_f32_16x16x32_bf16 v[160:163], a[48:51], a[24:27], v[160:163]
 v_mfma_f32_16x16x32_bf16 v[184:187], a[48:51], a[28:31], v[184:187]
 buffer_load_dwordx4 v228, s[8:11], s31 offen lds
 v_mfma_f32_16x16x32_bf16 v[188:191], a[52:55], a[28:31], v[188:191]
 v_mfma_f32_16x16x32_bf16 v[164:167], a[52:55], a[24:27], v[164:167]
 buffer_load_dwordx4 v229, s[8:11], s31 offen offset:1024 lds
 v_mfma_f32_16x16x32_bf16 v[140:143], a[52:55], a[20:23], v[140:143]
 v_mfma_f32_16x16x32_bf16 v[116:119], a[52:55], a[16:19], v[116:119]
 buffer_load_dwordx4 v230, s[8:11], s31 offen offset:2048 lds
 v_mfma_f32_16x16x32_bf16 v[92:95], a[52:55], a[12:15], v[92:95]
 v_mfma_f32_16x16x32_bf16 v[68:71], a[52:55], a[8:11], v[68:71]
 buffer_load_dwordx4 v231, s[8:11], s31 offen offset:3072 lds
 v_mfma_f32_16x16x32_bf16 v[44:47], a[52:55], a[4:7], v[44:47]
 v_mfma_f32_16x16x32_bf16 v[20:23], a[52:55], a[0:3], v[20:23]
 s_add_u32 m0, s42, 36864
 v_mfma_f32_16x16x32_bf16 a[160:163], a[56:59], a[0:3], a[160:163]
 v_mfma_f32_16x16x32_bf16 a[164:167], a[56:59], a[4:7], a[164:167]
 buffer_load_dwordx4 v235, s[12:15], s33 offen lds
 v_mfma_f32_16x16x32_bf16 a[168:171], a[56:59], a[8:11], a[168:171]
 v_mfma_f32_16x16x32_bf16 a[172:175], a[56:59], a[12:15], a[172:175]
 s_add_u32 s33, s33, 458752
 v_mfma_f32_16x16x32_bf16 a[176:179], a[56:59], a[16:19], a[176:179]
 v_mfma_f32_16x16x32_bf16 a[180:183], a[56:59], a[20:23], a[180:183]
 s_add_u32 s31, s31, 128
 v_mfma_f32_16x16x32_bf16 a[184:187], a[56:59], a[24:27], a[184:187]
 v_mfma_f32_16x16x32_bf16 a[188:191], a[56:59], a[28:31], a[188:191]
 s_waitcnt vmcnt(20) lgkmcnt(0)
 s_barrier
 v_mfma_f32_16x16x32_bf16 v[0:3], a[92:95], a[60:63], v[0:3]
 ds_read_b64_tr_b16 a[32:33], v238 offset:24576
 v_mfma_f32_16x16x32_bf16 v[24:27], a[92:95], a[64:67], v[24:27]
 ds_read_b64_tr_b16 a[34:35], v238 offset:25088
 v_mfma_f32_16x16x32_bf16 v[48:51], a[92:95], a[68:71], v[48:51]
 ds_read_b128 a[0:3], v236
 v_mfma_f32_16x16x32_bf16 v[72:75], a[92:95], a[72:75], v[72:75]
 ds_read_b128 a[4:7], v236 offset:2048
 v_mfma_f32_16x16x32_bf16 v[96:99], a[92:95], a[76:79], v[96:99]
 ds_read_b128 a[8:11], v236 offset:4096
 v_mfma_f32_16x16x32_bf16 v[120:123], a[92:95], a[80:83], v[120:123]
 ds_read_b128 a[12:15], v236 offset:6144
 v_mfma_f32_16x16x32_bf16 v[144:147], a[92:95], a[84:87], v[144:147]
 ds_read_b128 a[16:19], v236 offset:8192
 v_mfma_f32_16x16x32_bf16 v[168:171], a[92:95], a[88:91], v[168:171]
 ds_read_b128 a[20:23], v236 offset:10240
 v_mfma_f32_16x16x32_bf16 v[172:175], a[96:99], a[88:91], v[172:175]
 ds_read_b128 a[24:27], v236 offset:12288
 v_mfma_f32_16x16x32_bf16 v[148:151], a[96:99], a[84:87], v[148:151]
 ds_read_b128 a[28:31], v236 offset:14336
 v_mfma_f32_16x16x32_bf16 v[124:127], a[96:99], a[80:83], v[124:127]
 ds_read_b64_tr_b16 a[36:37], v239 offset:24576
 v_mfma_f32_16x16x32_bf16 v[100:103], a[96:99], a[76:79], v[100:103]
 ds_read_b64_tr_b16 a[38:39], v239 offset:25088
 v_mfma_f32_16x16x32_bf16 v[76:79], a[96:99], a[72:75], v[76:79]
 ds_read_b64_tr_b16 a[40:41], v238 offset:25600
 v_mfma_f32_16x16x32_bf16 v[52:55], a[96:99], a[68:71], v[52:55]
 ds_read_b64_tr_b16 a[42:43], v238 offset:26112
 s_cmp_eq_u32 s88, 1
 s_cbranch_scc1 L1F_d5
L1F_d5_r:
 v_mfma_f32_16x16x32_bf16 v[28:31], a[96:99], a[64:67], v[28:31]
 ds_read_b64_tr_b16 a[44:45], v239 offset:25600
 v_and_b32 v216, 0xffff0000, v200
 v_mfma_f32_16x16x32_bf16 v[4:7], a[96:99], a[60:63], v[4:7]
 ds_read_b64_tr_b16 a[46:47], v239 offset:26112
 v_lshlrev_b32_e64 v200, 16, v200
 v_mfma_f32_16x16x32_bf16 v[8:11], a[100:103], a[60:63], v[8:11]
 ds_read_b64_tr_b16 a[48:49], v238 offset:26624
 v_and_b32 v217, 0xffff0000, v201
 v_mfma_f32_16x16x32_bf16 v[32:35], a[100:103], a[64:67], v[32:35]
 ds_read_b64_tr_b16 a[50:51], v238 offset:27136
 v_lshlrev_b32_e64 v201, 16, v201
 v_mfma_f32_16x16x32_bf16 v[56:59], a[100:103], a[68:71], v[56:59]
 ds_read_b64_tr_b16 a[52:53], v239 offset:26624
 v_and_b32 v218, 0xffff0000, v202
 v_mfma_f32_16x16x32_bf16 v[80:83], a[100:103], a[72:75], v[80:83]
 ds_read_b64_tr_b16 a[54:55], v239 offset:27136
 v_lshlrev_b32_e64 v202, 16, v202
 v_mfma_f32_16x16x32_bf16 v[104:107], a[100:103], a[76:79], v[104:107]
 ds_read_b64_tr_b16 a[56:57], v240
 v_and_b32 v219, 0xffff0000, v203
 v_mfma_f32_16x16x32_bf16 v[128:131], a[100:103], a[80:83], v[128:131]
 ds_read_b64_tr_b16 a[58:59], v240 offset:256
 v_lshlrev_b32_e64 v203, 16, v203
 v_mfma_f32_16x16x32_bf16 v[152:155], a[100:103], a[84:87], v[152:155]
 s_add_u32 m0, s38, 12288
 v_mfma_f32_16x16x32_bf16 v[176:179], a[100:103], a[88:91], v[176:179]
 v_and_b32 v220, 0xffff0000, v204
 v_mfma_f32_16x16x32_bf16 v[180:183], a[104:107], a[88:91], v[180:183]
 buffer_load_dwordx4 v232, s[12:15], s32 offen lds
 v_mfma_f32_16x16x32_bf16 v[156:159], a[104:107], a[84:87], v[156:159]
 v_lshlrev_b32_e64 v204, 16, v204
 v_mfma_f32_16x16x32_bf16 v[132:135], a[104:107], a[80:83], v[132:135]
 buffer_load_dwordx4 v233, s[12:15], s32 offen offset:1024 lds
 v_mfma_f32_16x16x32_bf16 v[108:111], a[104:107], a[76:79], v[108:111]
 v_and_b32 v221, 0xffff0000, v205
 v_mfma_f32_16x16x32_bf16 v[84:87], a[104:107], a[72:75], v[84:87]
 buffer_load_dwordx4 v234, s[12:15], s32 offen offset:2048 lds
 v_mfma_f32_16x16x32_bf16 v[60:63], a[104:107], a[68:71], v[60:63]
 v_lshlrev_b32_e64 v205, 16, v205
 v_mfma_f32_16x16x32_bf16 v[36:39], a[104:107], a[64:67], v[36:39]
 v_and_b32 v222, 0xffff0000, v206
 v_mfma_f32_16x16x32_bf16 v[12:15], a[104:107], a[60:63], v[12:15]
 s_add_u32 s32, s32, 229376
 v_mfma_f32_16x16x32_bf16 v[16:19], a[108:111], a[60:63], v[16:19]
 v_lshlrev_b32_e64 v206, 16, v206
 v_mfma_f32_16x16x32_bf16 v[40:43], a[108:111], a[64:67], v[40:43]
 s_add_u32 m0, s37, 73728
 v_mfma_f32_16x16x32_bf16 v[64:67], a[108:111], a[68:71], v[64:67]
 v_and_b32 v223, 0xffff0000, v207
 v_mfma_f32_16x16x32_bf16 v[88:91], a[108:111], a[72:75], v[88:91]
 buffer_load_dwordx4 v224, s[8:11], s31 offen lds
 v_mfma_f32_16x16x32_bf16 v[112:115], a[108:111], a[76:79], v[112:115]
 v_lshlrev_b32_e64 v207, 16, v207
 v_mfma_f32_16x16x32_bf16 v[136:139], a[108:111], a[80:83], v[136:139]
 buffer_load_dwordx4 v225, s[8:11], s31 offen offset:1024 lds
 v_mfma_f32_16x16x32_bf16 v[160:163], a[108:111], a[84:87], v[160:163]
 v_add_f32_e64 v244, v200, v201
 v_mfma_f32_16x16x32_bf16 v[184:187], a[108:111], a[88:91], v[184:187]
 v_add_f32_e64 v245, v216, v217
 v_mfma_f32_16x16x32_bf16 v[188:191], a[112:115], a[88:91], v[188:191]
 buffer_load_dwordx4 v226, s[8:11], s31 offen offset:2048 lds
 v_mfma_f32_16x16x32_bf16 v[164:167], a[112:115], a[84:87], v[164:167]
 v_add_f32_e64 v244, v244, v202
 v_mfma_f32_16x16x32_bf16 v[140:143], a[112:115], a[80:83], v[140:143]
 buffer_load_dwordx4 v227, s[8:11], s31 offen offset:3072 lds
 v_mfma_f32_16x16x32_bf16 v[116:119], a[112:115], a[76:79], v[116:119]
 v_add_f32_e64 v245, v245, v218
 v_mfma_f32_16x16x32_bf16 v[92:95], a[112:115], a[72:75], v[92:95]
 s_xor_b32 s6, s44, 1024
 v_mfma_f32_16x16x32_bf16 v[68:71], a[112:115], a[68:71], v[68:71]
 v_add_f32_e64 v244, v244, v203
 v_mfma_f32_16x16x32_bf16 v[44:47], a[112:115], a[64:67], v[44:47]
 s_add_u32 s6, s6, 640
 v_mfma_f32_16x16x32_bf16 v[20:23], a[112:115], a[60:63], v[20:23]
 v_add_f32_e64 v245, v245, v219
 v_mfma_f32_16x16x32_bf16 a[160:163], a[116:119], a[60:63], a[160:163]
 v_add_f32_e64 v244, v244, v204
 v_mfma_f32_16x16x32_bf16 a[164:167], a[116:119], a[64:67], a[164:167]
 buffer_load_dword v251, v247, s[8:11], s6 offen
 v_mfma_f32_16x16x32_bf16 a[168:171], a[116:119], a[68:71], a[168:171]
 v_add_f32_e64 v245, v245, v220
 v_mfma_f32_16x16x32_bf16 a[172:175], a[116:119], a[72:75], a[172:175]
 s_add_u32 s6, s43, 2293760
 v_mfma_f32_16x16x32_bf16 a[176:179], a[116:119], a[76:79], a[176:179]
 v_add_f32_e64 v244, v244, v205
 v_mfma_f32_16x16x32_bf16 a[180:183], a[116:119], a[80:83], a[180:183]
 buffer_load_dword v251, v252, s[12:15], s6 offen
 v_mfma_f32_16x16x32_bf16 a[184:187], a[116:119], a[84:87], a[184:187]
 v_add_f32_e64 v245, v245, v221
 v_mfma_f32_16x16x32_bf16 a[188:191], a[116:119], a[88:91], a[188:191]
 v_add_f32_e64 v244, v244, v206
 s_waitcnt vmcnt(17) lgkmcnt(0)
 s_barrier
 v_mfma_f32_16x16x32_bf16 v[0:3], a[32:35], a[0:3], v[0:3]
 ds_read_b64_tr_b16 a[92:93], v238 offset:36864
 v_mfma_f32_16x16x32_bf16 v[24:27], a[32:35], a[4:7], v[24:27]
 ds_read_b64_tr_b16 a[94:95], v238 offset:37376
 v_mfma_f32_16x16x32_bf16 v[48:51], a[32:35], a[8:11], v[48:51]
 ds_read_b128 a[60:63], v237
 v_mfma_f32_16x16x32_bf16 v[72:75], a[32:35], a[12:15], v[72:75]
 ds_read_b128 a[64:67], v237 offset:2048
 v_mfma_f32_16x16x32_bf16 v[96:99], a[32:35], a[16:19], v[96:99]
 ds_read_b128 a[68:71], v237 offset:4096
 v_mfma_f32_16x16x32_bf16 v[120:123], a[32:35], a[20:23], v[120:123]
 ds_read_b128 a[72:75], v237 offset:6144
 v_mfma_f32_16x16x32_bf16 v[144:147], a[32:35], a[24:27], v[144:147]
 ds_read_b128 a[76:79], v237 offset:8192
 v_mfma_f32_16x16x32_bf16 v[168:171], a[32:35], a[28:31], v[168:171]
 ds_read_b128 a[80:83], v237 offset:10240
 v_mfma_f32_16x16x32_bf16 v[172:175], a[36:39], a[28:31], v[172:175]
 ds_read_b128 a[84:87], v237 offset:12288
 v_mfma_f32_16x16x32_bf16 v[148:151], a[36:39], a[24:27], v[148:151]
 ds_read_b128 a[88:91], v237 offset:14336
 v_mfma_f32_16x16x32_bf16 v[124:127], a[36:39], a[20:23], v[124:127]
 ds_read_b64_tr_b16 a[96:97], v239 offset:36864
 v_mfma_f32_16x16x32_bf16 v[100:103], a[36:39], a[16:19], v[100:103]
 ds_read_b64_tr_b16 a[98:99], v239 offset:37376
 v_mfma_f32_16x16x32_bf16 v[76:79], a[36:39], a[12:15], v[76:79]
 ds_read_b64_tr_b16 a[100:101], v238 offset:37888
 s_cmp_eq_u32 s88, 1
 s_cbranch_scc1 L1F_d6
L1F_d6_r:
 v_mfma_f32_16x16x32_bf16 v[52:55], a[36:39], a[8:11], v[52:55]
 ds_read_b64_tr_b16 a[102:103], v238 offset:38400
 v_add_f32_e64 v245, v245, v222
 v_mfma_f32_16x16x32_bf16 v[28:31], a[36:39], a[4:7], v[28:31]
 ds_read_b64_tr_b16 a[104:105], v239 offset:37888
 v_add_f32_e64 v244, v244, v207
 v_mfma_f32_16x16x32_bf16 v[4:7], a[36:39], a[0:3], v[4:7]
 ds_read_b64_tr_b16 a[106:107], v239 offset:38400
 v_add_f32_e64 v245, v245, v223
 v_mfma_f32_16x16x32_bf16 v[8:11], a[40:43], a[0:3], v[8:11]
 ds_read_b64_tr_b16 a[108:109], v238 offset:38912
 v_add_f32_e64 v244, v244, v245
 v_mfma_f32_16x16x32_bf16 v[32:35], a[40:43], a[4:7], v[32:35]
 ds_read_b64_tr_b16 a[110:111], v238 offset:39424
 v_add_f32_dpp v244, v244, v244 quad_perm:[1,0,3,2] row_mask:0xf bank_mask:0xf
 v_mfma_f32_16x16x32_bf16 v[56:59], a[40:43], a[8:11], v[56:59]
 ds_read_b64_tr_b16 a[112:113], v239 offset:38912
 v_add_f32_dpp v244, v244, v244 quad_perm:[2,3,0,1] row_mask:0xf bank_mask:0xf
 v_mfma_f32_16x16x32_bf16 v[80:83], a[40:43], a[12:15], v[80:83]
 ds_read_b64_tr_b16 a[114:115], v239 offset:39424
 v_add_f32_dpp v244, v244, v244 row_half_mirror row_mask:0xf bank_mask:0xf
 v_mfma_f32_16x16x32_bf16 v[104:107], a[40:43], a[16:19], v[104:107]
 ds_read_b64_tr_b16 a[116:117], v240 offset:2048
 v_add_f32_dpp v244, v244, v244 row_mirror row_mask:0xf bank_mask:0xf
 v_mfma_f32_16x16x32_bf16 v[128:131], a[40:43], a[20:23], v[128:131]
 ds_read_b64_tr_b16 a[118:119], v240 offset:2304
 v_mov_b32_e64 v245, v244
 v_mfma_f32_16x16x32_bf16 v[152:155], a[40:43], a[24:27], v[152:155]
 s_cmp_eq_u32 s88, 0
 s_cselect_b32 s4, 0, s5
 v_mfma_f32_16x16x32_bf16 v[176:179], a[40:43], a[28:31], v[176:179]
 v_permlane16_swap_b32_e64 v244, v245
 v_mfma_f32_16x16x32_bf16 v[180:183], a[44:47], a[28:31], v[180:183]
 buffer_atomic_add v194, v195, s[96:99], s4 offen sc1
 v_mfma_f32_16x16x32_bf16 v[156:159], a[44:47], a[24:27], v[156:159]
 v_add_f32_e64 v244, v244, v245
 v_mfma_f32_16x16x32_bf16 v[132:135], a[44:47], a[20:23], v[132:135]
 s_add_u32 m0, s38, 24576
 v_mfma_f32_16x16x32_bf16 v[108:111], a[44:47], a[16:19], v[108:111]
 v_mov_b32_e64 v245, v244
 v_mfma_f32_16x16x32_bf16 v[84:87], a[44:47], a[12:15], v[84:87]
 buffer_load_dwordx4 v232, s[12:15], s32 offen lds
 v_mfma_f32_16x16x32_bf16 v[60:63], a[44:47], a[8:11], v[60:63]
 v_permlane32_swap_b32_e64 v244, v245
 v_mfma_f32_16x16x32_bf16 v[36:39], a[44:47], a[4:7], v[36:39]
 buffer_load_dwordx4 v233, s[12:15], s32 offen offset:1024 lds
 v_mfma_f32_16x16x32_bf16 v[12:15], a[44:47], a[0:3], v[12:15]
 v_add_f32_e64 v244, v244, v245
 v_mfma_f32_16x16x32_bf16 v[16:19], a[48:51], a[0:3], v[16:19]
 buffer_load_dwordx4 v234, s[12:15], s32 offen offset:2048 lds
 v_mfma_f32_16x16x32_bf16 v[40:43], a[48:51], a[4:7], v[40:43]
 v_mul_f32 v246, 0x3a800000, v244
 v_mfma_f32_16x16x32_bf16 v[64:67], a[48:51], a[8:11], v[64:67]
 s_add_u32 s32, s32, 229376
 v_mfma_f32_16x16x32_bf16 v[88:91], a[48:51], a[12:15], v[88:91]
 v_sub_f32_e64 v200, v200, v246
 v_mfma_f32_16x16x32_bf16 v[112:115], a[48:51], a[16:19], v[112:115]
 s_add_u32 m0, s37, 77824
 v_mfma_f32_16x16x32_bf16 v[136:139], a[48:51], a[20:23], v[136:139]
 v_sub_f32_e64 v216, v216, v246
 v_mfma_f32_16x16x32_bf16 v[160:163], a[48:51], a[24:27], v[160:163]
 v_sub_f32_e64 v201, v201, v246
 v_mfma_f32_16x16x32_bf16 v[184:187], a[48:51], a[28:31], v[184:187]
 buffer_load_dwordx4 v228, s[8:11], s31 offen lds
 v_mfma_f32_16x16x32_bf16 v[188:191], a[52:55], a[28:31], v[188:191]
 v_sub_f32_e64 v217, v217, v246
 v_mfma_f32_16x16x32_bf16 v[164:167], a[52:55], a[24:27], v[164:167]
 buffer_load_dwordx4 v229, s[8:11], s31 offen offset:1024 lds
 v_mfma_f32_16x16x32_bf16 v[140:143], a[52:55], a[20:23], v[140:143]
 v_sub_f32_e64 v202, v202, v246
 v_mfma_f32_16x16x32_bf16 v[116:119], a[52:55], a[16:19], v[116:119]
 buffer_load_dwordx4 v230, s[8:11], s31 offen offset:2048 lds
 v_mfma_f32_16x16x32_bf16 v[92:95], a[52:55], a[12:15], v[92:95]
 v_sub_f32_e64 v218, v218, v246
 v_mfma_f32_16x16x32_bf16 v[68:71], a[52:55], a[8:11], v[68:71]
 buffer_load_dwordx4 v231, s[8:11], s31 offen offset:3072 lds
 v_mfma_f32_16x16x32_bf16 v[44:47], a[52:55], a[4:7], v[44:47]
 v_sub_f32_e64 v203, v203, v246
 v_mfma_f32_16x16x32_bf16 v[20:23], a[52:55], a[0:3], v[20:23]
 s_add_u32 m0, s42, 73728
 v_mfma_f32_16x16x32_bf16 a[160:163], a[56:59], a[0:3], a[160:163]
 v_sub_f32_e64 v219, v219, v246
 v_mfma_f32_16x16x32_bf16 a[164:167], a[56:59], a[4:7], a[164:167]
 buffer_load_dwordx4 v235, s[12:15], s33 offen lds
 v_mfma_f32_16x16x32_bf16 a[168:171], a[56:59], a[8:11], a[168:171]
 v_sub_f32_e64 v204, v204, v246
 v_mfma_f32_16x16x32_bf16 a[172:175], a[56:59], a[12:15], a[172:175]
 s_add_u32 s33, s33, 458752
 v_mfma_f32_16x16x32_bf16 a[176:179], a[56:59], a[16:19], a[176:179]
 v_sub_f32_e64 v220, v220, v246
 v_mfma_f32_16x16x32_bf16 a[180:183], a[56:59], a[20:23], a[180:183]
 s_add_u32 s31, s31, 128
 v_mfma_f32_16x16x32_bf16 a[184:187], a[56:59], a[24:27], a[184:187]
 v_sub_f32_e64 v205, v205, v246
 v_mfma_f32_16x16x32_bf16 a[188:191], a[56:59], a[28:31], a[188:191]
 v_sub_f32_e64 v221, v221, v246
 s_waitcnt vmcnt(18) lgkmcnt(0)
 s_barrier
 v_mfma_f32_16x16x32_bf16 v[0:3], a[92:95], a[60:63], v[0:3]
 ds_read_b64_tr_b16 a[32:33], v238
 v_mfma_f32_16x16x32_bf16 v[24:27], a[92:95], a[64:67], v[24:27]
 ds_read_b64_tr_b16 a[34:35], v238 offset:512
 v_mfma_f32_16x16x32_bf16 v[48:51], a[92:95], a[68:71], v[48:51]
 ds_read_b128 a[0:3], v236 offset:36864
 v_mfma_f32_16x16x32_bf16 v[72:75], a[92:95], a[72:75], v[72:75]
 ds_read_b128 a[4:7], v236 offset:38912
 v_mfma_f32_16x16x32_bf16 v[96:99], a[92:95], a[76:79], v[96:99]
 ds_read_b128 a[8:11], v236 offset:40960
 v_mfma_f32_16x16x32_bf16 v[120:123], a[92:95], a[80:83], v[120:123]
 ds_read_b128 a[12:15], v236 offset:43008
 v_mfma_f32_16x16x32_bf16 v[144:147], a[92:95], a[84:87], v[144:147]
 ds_read_b128 a[16:19], v236 offset:45056
 v_mfma_f32_16x16x32_bf16 v[168:171], a[92:95], a[88:91], v[168:171]
 ds_read_b128 a[20:23], v236 offset:47104
 v_mfma_f32_16x16x32_bf16 v[172:175], a[96:99], a[88:91], v[172:175]
 ds_read_b128 a[24:27], v236 offset:49152
 v_mfma_f32_16x16x32_bf16 v[148:151], a[96:99], a[84:87], v[148:151]
 ds_read_b128 a[28:31], v236 offset:51200
 v_mfma_f32_16x16x32_bf16 v[124:127], a[96:99], a[80:83], v[124:127]
 ds_read_b64_tr_b16 a[36:37], v239
 v_mfma_f32_16x16x32_bf16 v[100:103], a[96:99], a[76:79], v[100:103]
 ds_read_b64_tr_b16 a[38:39], v239 offset:512
 v_mfma_f32_16x16x32_bf16 v[76:79], a[96:99], a[72:75], v[76:79]
 ds_read_b64_tr_b16 a[40:41], v238 offset:1024
 v_mfma_f32_16x16x32_bf16 v[52:55], a[96:99], a[68:71], v[52:55]
 ds_read_b64_tr_b16 a[42:43], v238 offset:1536
 s_cmp_eq_u32 s88, 1
 s_cbranch_scc1 L1F_d7
L1F_d7_r:
 v_mfma_f32_16x16x32_bf16 v[28:31], a[96:99], a[64:67], v[28:31]
 ds_read_b64_tr_b16 a[44:45], v239 offset:1024
 v_sub_f32_e64 v206, v206, v246
 v_mfma_f32_16x16x32_bf16 v[4:7], a[96:99], a[60:63], v[4:7]
 ds_read_b64_tr_b16 a[46:47], v239 offset:1536
 v_sub_f32_e64 v222, v222, v246
 v_mfma_f32_16x16x32_bf16 v[8:11], a[100:103], a[60:63], v[8:11]
 ds_read_b64_tr_b16 a[48:49], v238 offset:2048
 v_sub_f32_e64 v207, v207, v246
 v_mfma_f32_16x16x32_bf16 v[32:35], a[100:103], a[64:67], v[32:35]
 ds_read_b64_tr_b16 a[50:51], v238 offset:2560
 v_sub_f32_e64 v223, v223, v246
 v_mfma_f32_16x16x32_bf16 v[56:59], a[100:103], a[68:71], v[56:59]
 ds_read_b64_tr_b16 a[52:53], v239 offset:2048
 v_mul_f32_e64 v244, v200, v200
 v_mfma_f32_16x16x32_bf16 v[80:83], a[100:103], a[72:75], v[80:83]
 ds_read_b64_tr_b16 a[54:55], v239 offset:2560
 v_mul_f32_e64 v245, v216, v216
 v_mfma_f32_16x16x32_bf16 v[104:107], a[100:103], a[76:79], v[104:107]
 ds_read_b64_tr_b16 a[56:57], v240 offset:36864
 v_fmac_f32_e64 v244, v201, v201
 v_mfma_f32_16x16x32_bf16 v[128:131], a[100:103], a[80:83], v[128:131]
 ds_read_b64_tr_b16 a[58:59], v240 offset:37120
 v_fmac_f32_e64 v245, v217, v217
 v_mfma_f32_16x16x32_bf16 v[152:155], a[100:103], a[84:87], v[152:155]
 s_add_u32 m0, s38, 36864
 v_mfma_f32_16x16x32_bf16 v[176:179], a[100:103], a[88:91], v[176:179]
 v_fmac_f32_e64 v244, v202, v202
 v_mfma_f32_16x16x32_bf16 v[180:183], a[104:107], a[88:91], v[180:183]
 buffer_load_dwordx4 v232, s[12:15], s32 offen lds
 v_mfma_f32_16x16x32_bf16 v[156:159], a[104:107], a[84:87], v[156:159]
 v_fmac_f32_e64 v245, v218, v218
 v_mfma_f32_16x16x32_bf16 v[132:135], a[104:107], a[80:83], v[132:135]
 buffer_load_dwordx4 v233, s[12:15], s32 offen offset:1024 lds
 v_mfma_f32_16x16x32_bf16 v[108:111], a[104:107], a[76:79], v[108:111]
 v_fmac_f32_e64 v244, v203, v203
 v_mfma_f32_16x16x32_bf16 v[84:87], a[104:107], a[72:75], v[84:87]
 buffer_load_dwordx4 v234, s[12:15], s32 offen offset:2048 lds
 v_mfma_f32_16x16x32_bf16 v[60:63], a[104:107], a[68:71], v[60:63]
 v_fmac_f32_e64 v245, v219, v219
 v_mfma_f32_16x16x32_bf16 v[36:39], a[104:107], a[64:67], v[36:39]
 v_fmac_f32_e64 v244, v204, v204
 v_mfma_f32_16x16x32_bf16 v[12:15], a[104:107], a[60:63], v[12:15]
 s_add_u32 s32, s32, 229376
 v_mfma_f32_16x16x32_bf16 v[16:19], a[108:111], a[60:63], v[16:19]
 v_fmac_f32_e64 v245, v220, v220
 v_mfma_f32_16x16x32_bf16 v[40:43], a[108:111], a[64:67], v[40:43]
 s_add_u32 m0, s37, 0
 v_mfma_f32_16x16x32_bf16 v[64:67], a[108:111], a[68:71], v[64:67]
 v_fmac_f32 v244, v205, v205
 v_mfma_f32_16x16x32_bf16 v[88:91], a[108:111], a[72:75], v[88:91]
 buffer_load_dwordx4 v224, s[8:11], s31 offen lds
 v_mfma_f32_16x16x32_bf16 v[112:115], a[108:111], a[76:79], v[112:115]
 v_fmac_f32_e64 v245, v221, v221
 v_mfma_f32_16x16x32_bf16 v[136:139], a[108:111], a[80:83], v[136:139]
 buffer_load_dwordx4 v225, s[8:11], s31 offen offset:1024 lds
 v_mfma_f32_16x16x32_bf16 v[160:163], a[108:111], a[84:87], v[160:163]
 v_fmac_f32_e64 v244, v206, v206
 v_mfma_f32_16x16x32_bf16 v[184:187], a[108:111], a[88:91], v[184:187]
 v_fmac_f32_e64 v245, v222, v222
 v_mfma_f32_16x16x32_bf16 v[188:191], a[112:115], a[88:91], v[188:191]
 buffer_load_dwordx4 v226, s[8:11], s31 offen offset:2048 lds
 v_mfma_f32_16x16x32_bf16 v[164:167], a[112:115], a[84:87], v[164:167]
 v_fmac_f32_e64 v244, v207, v207
 v_mfma_f32_16x16x32_bf16 v[140:143], a[112:115], a[80:83], v[140:143]
 buffer_load_dwordx4 v227, s[8:11], s31 offen offset:3072 lds
 v_mfma_f32_16x16x32_bf16 v[116:119], a[112:115], a[76:79], v[116:119]
 v_fmac_f32_e64 v245, v223, v223
 v_mfma_f32_16x16x32_bf16 v[92:95], a[112:115], a[72:75], v[92:95]
 s_xor_b32 s6, s44, 1024
 v_mfma_f32_16x16x32_bf16 v[68:71], a[112:115], a[68:71], v[68:71]
 v_add_f32_e64 v244, v244, v245
 v_mfma_f32_16x16x32_bf16 v[44:47], a[112:115], a[64:67], v[44:47]
 s_add_u32 s6, s6, 768
 v_mfma_f32_16x16x32_bf16 v[20:23], a[112:115], a[60:63], v[20:23]
 v_add_f32_dpp v244, v244, v244 quad_perm:[1,0,3,2] row_mask:0xf bank_mask:0xf
 v_mfma_f32_16x16x32_bf16 a[160:163], a[116:119], a[60:63], a[160:163]
 s_nop 0
 v_add_f32_dpp v244, v244, v244 quad_perm:[2,3,0,1] row_mask:0xf bank_mask:0xf
 v_mfma_f32_16x16x32_bf16 a[164:167], a[116:119], a[64:67], a[164:167]
 buffer_load_dword v251, v247, s[8:11], s6 offen
 v_mfma_f32_16x16x32_bf16 a[168:171], a[116:119], a[68:71], a[168:171]
 v_add_f32_dpp v244, v244, v244 row_half_mirror row_mask:0xf bank_mask:0xf
 v_mfma_f32_16x16x32_bf16 a[172:175], a[116:119], a[72:75], a[172:175]
 s_add_u32 s6, s43, 2752512
 v_mfma_f32_16x16x32_bf16 a[176:179], a[116:119], a[76:79], a[176:179]
 v_add_f32_dpp v244, v244, v244 row_mirror row_mask:0xf bank_mask:0xf
 v_mfma_f32_16x16x32_bf16 a[180:183], a[116:119], a[80:83], a[180:183]
 buffer_load_dword v251, v252, s[12:15], s6 offen
 v_mfma_f32_16x16x32_bf16 a[184:187], a[116:119], a[84:87], a[184:187]
 v_mov_b32 v245, v244
 v_mfma_f32_16x16x32_bf16 a[188:191], a[116:119], a[88:91], a[188:191]
 s_nop 0
 v_permlane16_swap_b32 v244, v245
 s_waitcnt vmcnt(24) lgkmcnt(0)
 s_barrier
 v_mfma_f32_16x16x32_bf16 v[0:3], a[32:35], a[0:3], v[0:3]
 ds_read_b64_tr_b16 a[92:93], v238 offset:12288
 v_mfma_f32_16x16x32_bf16 v[24:27], a[32:35], a[4:7], v[24:27]
 ds_read_b64_tr_b16 a[94:95], v238 offset:12800
 v_mfma_f32_16x16x32_bf16 v[48:51], a[32:35], a[8:11], v[48:51]
 ds_read_b128 a[60:63], v237 offset:36864
 v_mfma_f32_16x16x32_bf16 v[72:75], a[32:35], a[12:15], v[72:75]
 ds_read_b128 a[64:67], v237 offset:38912
 v_mfma_f32_16x16x32_bf16 v[96:99], a[32:35], a[16:19], v[96:99]
 ds_read_b128 a[68:71], v237 offset:40960
 v_mfma_f32_16x16x32_bf16 v[120:123], a[32:35], a[20:23], v[120:123]
 ds_read_b128 a[72:75], v237 offset:43008
 v_mfma_f32_16x16x32_bf16 v[144:147], a[32:35], a[24:27], v[144:147]
 ds_read_b128 a[76:79], v237 offset:45056
 v_mfma_f32_16x16x32_bf16 v[168:171], a[32:35], a[28:31], v[168:171]
 ds_read_b128 a[80:83], v237 offset:47104
 v_mfma_f32_16x16x32_bf16 v[172:175], a[36:39], a[28:31], v[172:175]
 ds_read_b128 a[84:87], v237 offset:49152
 v_mfma_f32_16x16x32_bf16 v[148:151], a[36:39], a[24:27], v[148:151]
 ds_read_b128 a[88:91], v237 offset:51200
 v_mfma_f32_16x16x32_bf16 v[124:127], a[36:39], a[20:23], v[124:127]
 ds_read_b64_tr_b16 a[96:97], v239 offset:12288
 v_mfma_f32_16x16x32_bf16 v[100:103], a[36:39], a[16:19], v[100:103]
 ds_read_b64_tr_b16 a[98:99], v239 offset:12800
 s_cmp_eq_u32 s88, 2
 s_cbranch_scc1 L1F_d8
L1F_d8_r:
 v_mfma_f32_16x16x32_bf16 v[76:79], a[36:39], a[12:15], v[76:79]
 ds_read_b64_tr_b16 a[100:101], v238 offset:13312
 v_add_f32_e64 v244, v244, v245
 v_mfma_f32_16x16x32_bf16 v[52:55], a[36:39], a[8:11], v[52:55]
 ds_read_b64_tr_b16 a[102:103], v238 offset:13824
 v_mov_b32_e64 v245, v244
 v_mfma_f32_16x16x32_bf16 v[28:31], a[36:39], a[4:7], v[28:31]
 ds_read_b64_tr_b16 a[104:105], v239 offset:13312
 v_permlane32_swap_b32_e64 v244, v245
 v_mfma_f32_16x16x32_bf16 v[4:7], a[36:39], a[0:3], v[4:7]
 ds_read_b64_tr_b16 a[106:107], v239 offset:13824
 v_add_f32_e64 v244, v244, v245
 v_mfma_f32_16x16x32_bf16 v[8:11], a[40:43], a[0:3], v[8:11]
 ds_read_b64_tr_b16 a[108:109], v238 offset:14336
 v_mul_f32 v244, 0x3a800000, v244
 v_mfma_f32_16x16x32_bf16 v[32:35], a[40:43], a[4:7], v[32:35]
 ds_read_b64_tr_b16 a[110:111], v238 offset:14848
 v_cvt_pk_bf16_f32 v244, v244, v244
 v_mfma_f32_16x16x32_bf16 v[56:59], a[40:43], a[8:11], v[56:59]
 ds_read_b64_tr_b16 a[112:113], v239 offset:14336
 v_and_b32 v244, 0xffff0000, v244
 v_mfma_f32_16x16x32_bf16 v[80:83], a[40:43], a[12:15], v[80:83]
 ds_read_b64_tr_b16 a[114:115], v239 offset:14848
 v_add_f32 v244, 0x3727c5ac, v244
 v_mfma_f32_16x16x32_bf16 v[104:107], a[40:43], a[16:19], v[104:107]
 ds_read_b64_tr_b16 a[116:117], v240 offset:38912
 v_cvt_pk_bf16_f32 v244, v244, v244
 v_mfma_f32_16x16x32_bf16 v[128:131], a[40:43], a[20:23], v[128:131]
 ds_read_b64_tr_b16 a[118:119], v240 offset:39168
 v_and_b32 v244, 0xffff0000, v244
 v_mfma_f32_16x16x32_bf16 v[152:155], a[40:43], a[24:27], v[152:155]
 s_cmp_eq_u32 s88, 1
 s_cselect_b32 s4, s75, s5
 v_mfma_f32_16x16x32_bf16 v[176:179], a[40:43], a[28:31], v[176:179]
 v_sqrt_f32_e64 v244, v244
 v_mfma_f32_16x16x32_bf16 v[180:183], a[44:47], a[28:31], v[180:183]
 buffer_store_dwordx4 a[156:159], v192, s[92:95], s4 offen sc1
 v_mfma_f32_16x16x32_bf16 v[156:159], a[44:47], a[24:27], v[156:159]
 v_lshrrev_b32_e64 v245, 3, v255
 v_mfma_f32_16x16x32_bf16 v[132:135], a[44:47], a[20:23], v[132:135]
 s_add_u32 m0, s38, 0
 v_mfma_f32_16x16x32_bf16 v[108:111], a[44:47], a[16:19], v[108:111]
 v_cvt_pk_bf16_f32 v248, v246, v244
 v_mfma_f32_16x16x32_bf16 v[84:87], a[44:47], a[12:15], v[84:87]
 buffer_load_dwordx4 v232, s[12:15], s32 offen lds
 v_mfma_f32_16x16x32_bf16 v[60:63], a[44:47], a[8:11], v[60:63]
 v_and_b32 v216, 0xffff0000, v208
 v_mfma_f32_16x16x32_bf16 v[36:39], a[44:47], a[4:7], v[36:39]
 buffer_load_dwordx4 v233, s[12:15], s32 offen offset:1024 lds
 v_mfma_f32_16x16x32_bf16 v[12:15], a[44:47], a[0:3], v[12:15]
 v_lshlrev_b32 v208, 16, v208
 v_mfma_f32_16x16x32_bf16 v[16:19], a[48:51], a[0:3], v[16:19]
 buffer_load_dwordx4 v234, s[12:15], s32 offen offset:2048 lds
 v_mfma_f32_16x16x32_bf16 v[40:43], a[48:51], a[4:7], v[40:43]
 v_and_b32 v217, 0xffff0000, v209
 v_mfma_f32_16x16x32_bf16 v[64:67], a[48:51], a[8:11], v[64:67]
 s_add_u32 s32, s32, 229376
 v_mfma_f32_16x16x32_bf16 v[88:91], a[48:51], a[12:15], v[88:91]
 v_lshlrev_b32_e64 v209, 16, v209
 v_mfma_f32_16x16x32_bf16 v[112:115], a[48:51], a[16:19], v[112:115]
 s_add_u32 m0, s37, 4096
 v_mfma_f32_16x16x32_bf16 v[136:139], a[48:51], a[20:23], v[136:139]
 v_and_b32 v218, 0xffff0000, v210
 v_mfma_f32_16x16x32_bf16 v[160:163], a[48:51], a[24:27], v[160:163]
 v_lshlrev_b32_e64 v210, 16, v210
 v_mfma_f32_16x16x32_bf16 v[184:187], a[48:51], a[28:31], v[184:187]
 buffer_load_dwordx4 v228, s[8:11], s31 offen lds
 v_mfma_f32_16x16x32_bf16 v[188:191], a[52:55], a[28:31], v[188:191]
 v_and_b32 v219, 0xffff0000, v211
 v_mfma_f32_16x16x32_bf16 v[164:167], a[52:55], a[24:27], v[164:167]
 buffer_load_dwordx4 v229, s[8:11], s31 offen offset:1024 lds
 v_mfma_f32_16x16x32_bf16 v[140:143], a[52:55], a[20:23], v[140:143]
 v_lshlrev_b32_e64 v211, 16, v211
 v_mfma_f32_16x16x32_bf16 v[116:119], a[52:55], a[16:19], v[116:119]
 buffer_load_dwordx4 v230, s[8:11], s31 offen offset:2048 lds
 v_mfma_f32_16x16x32_bf16 v[92:95], a[52:55], a[12:15], v[92:95]
 v_and_b32 v220, 0xffff0000, v212
 v_mfma_f32_16x16x32_bf16 v[68:71], a[52:55], a[8:11], v[68:71]
 buffer_load_dwordx4 v231, s[8:11], s31 offen offset:3072 lds
 v_mfma_f32_16x16x32_bf16 v[44:47], a[52:55], a[4:7], v[44:47]
 v_lshlrev_b32_e64 v212, 16, v212
 v_mfma_f32_16x16x32_bf16 v[20:23], a[52:55], a[0:3], v[20:23]
 s_add_u32 m0, s42, 0
 v_mfma_f32_16x16x32_bf16 a[160:163], a[56:59], a[0:3], a[160:163]
 v_and_b32 v221, 0xffff0000, v213
 v_mfma_f32_16x16x32_bf16 a[164:167], a[56:59], a[4:7], a[164:167]
 buffer_load_dwordx4 v235, s[12:15], s33 offen lds
 v_mfma_f32_16x16x32_bf16 a[168:171], a[56:59], a[8:11], a[168:171]
 v_lshlrev_b32 v213, 16, v213
 v_mfma_f32_16x16x32_bf16 a[172:175], a[56:59], a[12:15], a[172:175]
 s_add_u32 s33, s33, 458752
 v_mfma_f32_16x16x32_bf16 a[176:179], a[56:59], a[16:19], a[176:179]
 v_and_b32 v222, 0xffff0000, v214
 v_mfma_f32_16x16x32_bf16 a[180:183], a[56:59], a[20:23], a[180:183]
 s_add_u32 s31, s31, 128
 v_mfma_f32_16x16x32_bf16 a[184:187], a[56:59], a[24:27], a[184:187]
 v_lshlrev_b32_e64 v214, 16, v214
 v_mfma_f32_16x16x32_bf16 a[188:191], a[56:59], a[28:31], a[188:191]
 v_and_b32 v223, 0xffff0000, v215
 s_waitcnt vmcnt(18) lgkmcnt(0)
 s_barrier
 v_mfma_f32_16x16x32_bf16 v[0:3], a[92:95], a[60:63], v[0:3]
 ds_read_b64_tr_b16 a[32:33], v238 offset:24576
 v_mfma_f32_16x16x32_bf16 v[24:27], a[92:95], a[64:67], v[24:27]
 ds_read_b64_tr_b16 a[34:35], v238 offset:25088
 v_mfma_f32_16x16x32_bf16 v[48:51], a[92:95], a[68:71], v[48:51]
 ds_read_b128 a[0:3], v241
 v_mfma_f32_16x16x32_bf16 v[72:75], a[92:95], a[72:75], v[72:75]
 ds_read_b128 a[4:7], v241 offset:2048
 v_mfma_f32_16x16x32_bf16 v[96:99], a[92:95], a[76:79], v[96:99]
 ds_read_b128 a[8:11], v241 offset:4096
 v_mfma_f32_16x16x32_bf16 v[120:123], a[92:95], a[80:83], v[120:123]
 ds_read_b128 a[12:15], v241 offset:6144
 v_mfma_f32_16x16x32_bf16 v[144:147], a[92:95], a[84:87], v[144:147]
 ds_read_b128 a[16:19], v241 offset:8192
 v_mfma_f32_16x16x32_bf16 v[168:171], a[92:95], a[88:91], v[168:171]
 ds_read_b128 a[20:23], v241 offset:10240
 v_mfma_f32_16x16x32_bf16 v[172:175], a[96:99], a[88:91], v[172:175]
 ds_read_b128 a[24:27], v241 offset:12288
 v_mfma_f32_16x16x32_bf16 v[148:151], a[96:99], a[84:87], v[148:151]
 ds_read_b128 a[28:31], v241 offset:14336
 v_mfma_f32_16x16x32_bf16 v[124:127], a[96:99], a[80:83], v[124:127]
 ds_read_b64_tr_b16 a[36:37], v239 offset:24576
 v_mfma_f32_16x16x32_bf16 v[100:103], a[96:99], a[76:79], v[100:103]
 ds_read_b64_tr_b16 a[38:39], v239 offset:25088
 v_mfma_f32_16x16x32_bf16 v[76:79], a[96:99], a[72:75], v[76:79]
 ds_read_b64_tr_b16 a[40:41], v238 offset:25600
 v_mfma_f32_16x16x32_bf16 v[52:55], a[96:99], a[68:71], v[52:55]
 ds_read_b64_tr_b16 a[42:43], v238 offset:26112
 s_cmp_eq_u32 s88, 2
 s_cbranch_scc1 L1F_d9
L1F_d9_r:
 v_mfma_f32_16x16x32_bf16 v[28:31], a[96:99], a[64:67], v[28:31]
 ds_read_b64_tr_b16 a[44:45], v239 offset:25600
 v_lshlrev_b32_e64 v215, 16, v215
 v_mfma_f32_16x16x32_bf16 v[4:7], a[96:99], a[60:63], v[4:7]
 ds_read_b64_tr_b16 a[46:47], v239 offset:26112
 v_add_f32_e64 v244, v208, v209
 v_mfma_f32_16x16x32_bf16 v[8:11], a[100:103], a[60:63], v[8:11]
 ds_read_b64_tr_b16 a[48:49], v238 offset:26624
 v_add_f32_e64 v245, v216, v217
 v_mfma_f32_16x16x32_bf16 v[32:35], a[100:103], a[64:67], v[32:35]
 ds_read_b64_tr_b16 a[50:51], v238 offset:27136
 v_add_f32_e64 v244, v244, v210
 v_mfma_f32_16x16x32_bf16 v[56:59], a[100:103], a[68:71], v[56:59]
 ds_read_b64_tr_b16 a[52:53], v239 offset:26624
 v_add_f32_e64 v245, v245, v218
 v_mfma_f32_16x16x32_bf16 v[80:83], a[100:103], a[72:75], v[80:83]
 ds_read_b64_tr_b16 a[54:55], v239 offset:27136
 v_add_f32_e64 v244, v244, v211
 v_mfma_f32_16x16x32_bf16 v[104:107], a[100:103], a[76:79], v[104:107]
 ds_read_b64_tr_b16 a[56:57], v243
 v_add_f32_e64 v245, v245, v219
 v_mfma_f32_16x16x32_bf16 v[128:131], a[100:103], a[80:83], v[128:131]
 ds_read_b64_tr_b16 a[58:59], v243 offset:256
 v_add_f32_e64 v244, v244, v212
 v_mfma_f32_16x16x32_bf16 v[152:155], a[100:103], a[84:87], v[152:155]
 s_add_u32 m0, s38, 12288
 v_mfma_f32_16x16x32_bf16 v[176:179], a[100:103], a[88:91], v[176:179]
 v_add_f32_e64 v245, v245, v220
 v_mfma_f32_16x16x32_bf16 v[180:183], a[104:107], a[88:91], v[180:183]
 buffer_load_dwordx4 v232, s[12:15], s32 offen lds
 v_mfma_f32_16x16x32_bf16 v[156:159], a[104:107], a[84:87], v[156:159]
 v_add_f32_e64 v244, v244, v213
 v_mfma_f32_16x16x32_bf16 v[132:135], a[104:107], a[80:83], v[132:135]
 buffer_load_dwordx4 v233, s[12:15], s32 offen offset:1024 lds
 v_mfma_f32_16x16x32_bf16 v[108:111], a[104:107], a[76:79], v[108:111]
 v_add_f32_e64 v245, v245, v221
 v_mfma_f32_16x16x32_bf16 v[84:87], a[104:107], a[72:75], v[84:87]
 buffer_load_dwordx4 v234, s[12:15], s32 offen offset:2048 lds
 v_mfma_f32_16x16x32_bf16 v[60:63], a[104:107], a[68:71], v[60:63]
 v_add_f32_e64 v244, v244, v214
 v_mfma_f32_16x16x32_bf16 v[36:39], a[104:107], a[64:67], v[36:39]
 v_add_f32_e64 v245, v245, v222
 v_mfma_f32_16x16x32_bf16 v[12:15], a[104:107], a[60:63], v[12:15]
 s_add_u32 s32, s32, 229376
 v_mfma_f32_16x16x32_bf16 v[16:19], a[108:111], a[60:63], v[16:19]
 v_add_f32_e64 v244, v244, v215
 v_mfma_f32_16x16x32_bf16 v[40:43], a[108:111], a[64:67], v[40:43]
 s_add_u32 m0, s37, 36864
 v_mfma_f32_16x16x32_bf16 v[64:67], a[108:111], a[68:71], v[64:67]
 v_add_f32_e64 v245, v245, v223
 v_mfma_f32_16x16x32_bf16 v[88:91], a[108:111], a[72:75], v[88:91]
 buffer_load_dwordx4 v224, s[8:11], s31 offen lds
 v_mfma_f32_16x16x32_bf16 v[112:115], a[108:111], a[76:79], v[112:115]
 v_add_f32_e64 v244, v244, v245
 v_mfma_f32_16x16x32_bf16 v[136:139], a[108:111], a[80:83], v[136:139]
 buffer_load_dwordx4 v225, s[8:11], s31 offen offset:1024 lds
 v_mfma_f32_16x16x32_bf16 v[160:163], a[108:111], a[84:87], v[160:163]
 v_add_f32_dpp v244, v244, v244 quad_perm:[1,0,3,2] row_mask:0xf bank_mask:0xf
 v_mfma_f32_16x16x32_bf16 v[184:187], a[108:111], a[88:91], v[184:187]
 s_nop 0
 v_add_f32_dpp v244, v244, v244 quad_perm:[2,3,0,1] row_mask:0xf bank_mask:0xf
 v_mfma_f32_16x16x32_bf16 v[188:191], a[112:115], a[88:91], v[188:191]
 buffer_load_dwordx4 v226, s[8:11], s31 offen offset:2048 lds
 v_mfma_f32_16x16x32_bf16 v[164:167], a[112:115], a[84:87], v[164:167]
 v_add_f32_dpp v244, v244, v244 row_half_mirror row_mask:0xf bank_mask:0xf
 v_mfma_f32_16x16x32_bf16 v[140:143], a[112:115], a[80:83], v[140:143]
 buffer_load_dwordx4 v227, s[8:11], s31 offen offset:3072 lds
 v_mfma_f32_16x16x32_bf16 v[116:119], a[112:115], a[76:79], v[116:119]
 v_add_f32_dpp v244, v244, v244 row_mirror row_mask:0xf bank_mask:0xf
 v_mfma_f32_16x16x32_bf16 v[92:95], a[112:115], a[72:75], v[92:95]
 s_xor_b32 s6, s44, 1024
 v_mfma_f32_16x16x32_bf16 v[68:71], a[112:115], a[68:71], v[68:71]
 v_mov_b32 v245, v244
 v_mfma_f32_16x16x32_bf16 v[44:47], a[112:115], a[64:67], v[44:47]
 s_add_u32 s6, s6, 896
 v_mfma_f32_16x16x32_bf16 v[20:23], a[112:115], a[60:63], v[20:23]
 v_permlane16_swap_b32_e64 v244, v245
 v_mfma_f32_16x16x32_bf16 a[160:163], a[116:119], a[60:63], a[160:163]
 v_add_f32_e64 v244, v244, v245
 v_mfma_f32_16x16x32_bf16 a[164:167], a[116:119], a[64:67], a[164:167]
 buffer_load_dword v251, v247, s[8:11], s6 offen
 v_mfma_f32_16x16x32_bf16 a[168:171], a[116:119], a[68:71], a[168:171]
 v_mov_b32_e64 v245, v244
 v_mfma_f32_16x16x32_bf16 a[172:175], a[116:119], a[72:75], a[172:175]
 s_add_u32 s6, s43, 3211264
 v_mfma_f32_16x16x32_bf16 a[176:179], a[116:119], a[76:79], a[176:179]
 v_permlane32_swap_b32_e64 v244, v245
 v_mfma_f32_16x16x32_bf16 a[180:183], a[116:119], a[80:83], a[180:183]
 buffer_load_dword v251, v252, s[12:15], s6 offen
 v_mfma_f32_16x16x32_bf16 a[184:187], a[116:119], a[84:87], a[184:187]
 v_add_f32_e64 v244, v244, v245
 v_mfma_f32_16x16x32_bf16 a[188:191], a[116:119], a[88:91], a[188:191]
 v_mul_f32 v246, 0x3a800000, v244
 s_waitcnt vmcnt(17) lgkmcnt(0)
 s_barrier
 v_mfma_f32_16x16x32_bf16 v[0:3], a[32:35], a[0:3], v[0:3]
 ds_read_b64_tr_b16 a[92:93], v238 offset:36864
 v_mfma_f32_16x16x32_bf16 v[24:27], a[32:35], a[4:7], v[24:27]
 ds_read_b64_tr_b16 a[94:95], v238 offset:37376
 v_mfma_f32_16x16x32_bf16 v[48:51], a[32:35], a[8:11], v[48:51]
 ds_read_b128 a[60:63], v242
 v_mfma_f32_16x16x32_bf16 v[72:75], a[32:35], a[12:15], v[72:75]
 ds_read_b128 a[64:67], v242 offset:2048
 v_mfma_f32_16x16x32_bf16 v[96:99], a[32:35], a[16:19], v[96:99]
 ds_read_b128 a[68:71], v242 offset:4096
 v_mfma_f32_16x16x32_bf16 v[120:123], a[32:35], a[20:23], v[120:123]
 ds_read_b128 a[72:75], v242 offset:6144
 v_mfma_f32_16x16x32_bf16 v[144:147], a[32:35], a[24:27], v[144:147]
 ds_read_b128 a[76:79], v242 offset:8192
 v_mfma_f32_16x16x32_bf16 v[168:171], a[32:35], a[28:31], v[168:171]
 ds_read_b128 a[80:83], v242 offset:10240
 v_mfma_f32_16x16x32_bf16 v[172:175], a[36:39], a[28:31], v[172:175]
 ds_read_b128 a[84:87], v242 offset:12288
 v_mfma_f32_16x16x32_bf16 v[148:151], a[36:39], a[24:27], v[148:151]
 ds_read_b128 a[88:91], v242 offset:14336
 v_mfma_f32_16x16x32_bf16 v[124:127], a[36:39], a[20:23], v[124:127]
 ds_read_b64_tr_b16 a[96:97], v239 offset:36864
 v_mfma_f32_16x16x32_bf16 v[100:103], a[36:39], a[16:19], v[100:103]
 ds_read_b64_tr_b16 a[98:99], v239 offset:37376
 v_mfma_f32_16x16x32_bf16 v[76:79], a[36:39], a[12:15], v[76:79]
 ds_read_b64_tr_b16 a[100:101], v238 offset:37888
 s_cmp_eq_u32 s88, 2
 s_cbranch_scc1 L1F_d10
L1F_d10_r:
 v_mfma_f32_16x16x32_bf16 v[52:55], a[36:39], a[8:11], v[52:55]
 ds_read_b64_tr_b16 a[102:103], v238 offset:38400
 v_sub_f32_e64 v208, v208, v246
 v_mfma_f32_16x16x32_bf16 v[28:31], a[36:39], a[4:7], v[28:31]
 ds_read_b64_tr_b16 a[104:105], v239 offset:37888
 v_sub_f32_e64 v216, v216, v246
 v_mfma_f32_16x16x32_bf16 v[4:7], a[36:39], a[0:3], v[4:7]
 ds_read_b64_tr_b16 a[106:107], v239 offset:38400
 v_sub_f32_e64 v209, v209, v246
 v_mfma_f32_16x16x32_bf16 v[8:11], a[40:43], a[0:3], v[8:11]
 ds_read_b64_tr_b16 a[108:109], v238 offset:38912
 v_sub_f32_e64 v217, v217, v246
 v_mfma_f32_16x16x32_bf16 v[32:35], a[40:43], a[4:7], v[32:35]
 ds_read_b64_tr_b16 a[110:111], v238 offset:39424
 v_sub_f32_e64 v210, v210, v246
 v_mfma_f32_16x16x32_bf16 v[56:59], a[40:43], a[8:11], v[56:59]
 ds_read_b64_tr_b16 a[112:113], v239 offset:38912
 v_sub_f32_e64 v218, v218, v246
 v_mfma_f32_16x16x32_bf16 v[80:83], a[40:43], a[12:15], v[80:83]
 ds_read_b64_tr_b16 a[114:115], v239 offset:39424
 v_sub_f32_e64 v211, v211, v246
 v_mfma_f32_16x16x32_bf16 v[104:107], a[40:43], a[16:19], v[104:107]
 ds_read_b64_tr_b16 a[116:117], v243 offset:2048
 v_sub_f32_e64 v219, v219, v246
 v_mfma_f32_16x16x32_bf16 v[128:131], a[40:43], a[20:23], v[128:131]
 ds_read_b64_tr_b16 a[118:119], v243 offset:2304
 v_sub_f32_e64 v212, v212, v246
 v_mfma_f32_16x16x32_bf16 v[152:155], a[40:43], a[24:27], v[152:155]
 s_cmp_eq_u32 s88, 1
 s_cselect_b32 s4, 0, s5
 v_mfma_f32_16x16x32_bf16 v[176:179], a[40:43], a[28:31], v[176:179]
 v_sub_f32_e64 v220, v220, v246
 v_mfma_f32_16x16x32_bf16 v[180:183], a[44:47], a[28:31], v[180:183]
 buffer_atomic_add v194, v195, s[96:99], s4 offen sc1
 v_mfma_f32_16x16x32_bf16 v[156:159], a[44:47], a[24:27], v[156:159]
 v_sub_f32_e64 v213, v213, v246
 v_mfma_f32_16x16x32_bf16 v[132:135], a[44:47], a[20:23], v[132:135]
 s_add_u32 m0, s38, 24576
 v_mfma_f32_16x16x32_bf16 v[108:111], a[44:47], a[16:19], v[108:111]
 v_sub_f32_e64 v221, v221, v246
 v_mfma_f32_16x16x32_bf16 v[84:87], a[44:47], a[12:15], v[84:87]
 buffer_load_dwordx4 v232, s[12:15], s32 offen lds
 v_mfma_f32_16x16x32_bf16 v[60:63], a[44:47], a[8:11], v[60:63]
 v_sub_f32_e64 v214, v214, v246
 v_mfma_f32_16x16x32_bf16 v[36:39], a[44:47], a[4:7], v[36:39]
 buffer_load_dwordx4 v233, s[12:15], s32 offen offset:1024 lds
 v_mfma_f32_16x16x32_bf16 v[12:15], a[44:47], a[0:3], v[12:15]
 v_sub_f32_e64 v222, v222, v246
 v_mfma_f32_16x16x32_bf16 v[16:19], a[48:51], a[0:3], v[16:19]
 buffer_load_dwordx4 v234, s[12:15], s32 offen offset:2048 lds
 v_mfma_f32_16x16x32_bf16 v[40:43], a[48:51], a[4:7], v[40:43]
 v_sub_f32_e64 v215, v215, v246
 v_mfma_f32_16x16x32_bf16 v[64:67], a[48:51], a[8:11], v[64:67]
 s_add_u32 s32, s32, 229376
 v_mfma_f32_16x16x32_bf16 v[88:91], a[48:51], a[12:15], v[88:91]
 v_sub_f32_e64 v223, v223, v246
 v_mfma_f32_16x16x32_bf16 v[112:115], a[48:51], a[16:19], v[112:115]
 s_add_u32 m0, s37, 40960
 v_mfma_f32_16x16x32_bf16 v[136:139], a[48:51], a[20:23], v[136:139]
 v_mul_f32_e64 v244, v208, v208
 v_mfma_f32_16x16x32_bf16 v[160:163], a[48:51], a[24:27], v[160:163]
 v_mul_f32_e64 v245, v216, v216
 v_mfma_f32_16x16x32_bf16 v[184:187], a[48:51], a[28:31], v[184:187]
 buffer_load_dwordx4 v228, s[8:11], s31 offen lds
 v_mfma_f32_16x16x32_bf16 v[188:191], a[52:55], a[28:31], v[188:191]
 v_fmac_f32_e64 v244, v209, v209
 v_mfma_f32_16x16x32_bf16 v[164:167], a[52:55], a[24:27], v[164:167]
 buffer_load_dwordx4 v229, s[8:11], s31 offen offset:1024 lds
 v_mfma_f32_16x16x32_bf16 v[140:143], a[52:55], a[20:23], v[140:143]
 v_fmac_f32_e64 v245, v217, v217
 v_mfma_f32_16x16x32_bf16 v[116:119], a[52:55], a[16:19], v[116:119]
 buffer_load_dwordx4 v230, s[8:11], s31 offen offset:2048 lds
 v_mfma_f32_16x16x32_bf16 v[92:95], a[52:55], a[12:15], v[92:95]
 v_fmac_f32_e64 v244, v210, v210
 v_mfma_f32_16x16x32_bf16 v[68:71], a[52:55], a[8:11], v[68:71]
 buffer_load_dwordx4 v231, s[8:11], s31 offen offset:3072 lds
 v_mfma_f32_16x16x32_bf16 v[44:47], a[52:55], a[4:7], v[44:47]
 v_fmac_f32_e64 v245, v218, v218
 v_mfma_f32_16x16x32_bf16 v[20:23], a[52:55], a[0:3], v[20:23]
 s_add_u32 m0, s42, 36864
 v_mfma_f32_16x16x32_bf16 a[160:163], a[56:59], a[0:3], a[160:163]
 v_fmac_f32_e64 v244, v211, v211
 v_mfma_f32_16x16x32_bf16 a[164:167], a[56:59], a[4:7], a[164:167]
 buffer_load_dwordx4 v235, s[12:15], s33 offen lds
 v_mfma_f32_16x16x32_bf16 a[168:171], a[56:59], a[8:11], a[168:171]
 v_fmac_f32_e64 v245, v219, v219
 v_mfma_f32_16x16x32_bf16 a[172:175], a[56:59], a[12:15], a[172:175]
 s_mov_b32 s33, s45
 v_mfma_f32_16x16x32_bf16 a[176:179], a[56:59], a[16:19], a[176:179]
 v_fmac_f32 v244, v212, v212
 v_mfma_f32_16x16x32_bf16 a[180:183], a[56:59], a[20:23], a[180:183]
 s_mov_b32 s31, s44
 v_mfma_f32_16x16x32_bf16 a[184:187], a[56:59], a[24:27], a[184:187]
 v_fmac_f32 v245, v220, v220
 v_mfma_f32_16x16x32_bf16 a[188:191], a[56:59], a[28:31], a[188:191]
 v_fmac_f32_e64 v244, v213, v213
 s_waitcnt vmcnt(18) lgkmcnt(0)
 s_barrier
 v_mfma_f32_16x16x32_bf16 v[0:3], a[92:95], a[60:63], v[0:3]
 ds_read_b64_tr_b16 a[32:33], v238
 v_mfma_f32_16x16x32_bf16 v[24:27], a[92:95], a[64:67], v[24:27]
 ds_read_b64_tr_b16 a[34:35], v238 offset:512
 v_mfma_f32_16x16x32_bf16 v[48:51], a[92:95], a[68:71], v[48:51]
 ds_read_b128 a[0:3], v236
 v_mfma_f32_16x16x32_bf16 v[72:75], a[92:95], a[72:75], v[72:75]
 ds_read_b128 a[4:7], v236 offset:2048
 v_mfma_f32_16x16x32_bf16 v[96:99], a[92:95], a[76:79], v[96:99]
 ds_read_b128 a[8:11], v236 offset:4096
 v_mfma_f32_16x16x32_bf16 v[120:123], a[92:95], a[80:83], v[120:123]
 ds_read_b128 a[12:15], v236 offset:6144
 v_mfma_f32_16x16x32_bf16 v[144:147], a[92:95], a[84:87], v[144:147]
 ds_read_b128 a[16:19], v236 offset:8192
 v_mfma_f32_16x16x32_bf16 v[168:171], a[92:95], a[88:91], v[168:171]
 ds_read_b128 a[20:23], v236 offset:10240
 v_mfma_f32_16x16x32_bf16 v[172:175], a[96:99], a[88:91], v[172:175]
 ds_read_b128 a[24:27], v236 offset:12288
 v_mfma_f32_16x16x32_bf16 v[148:151], a[96:99], a[84:87], v[148:151]
 ds_read_b128 a[28:31], v236 offset:14336
 v_mfma_f32_16x16x32_bf16 v[124:127], a[96:99], a[80:83], v[124:127]
 ds_read_b64_tr_b16 a[36:37], v239
 v_mfma_f32_16x16x32_bf16 v[100:103], a[96:99], a[76:79], v[100:103]
 ds_read_b64_tr_b16 a[38:39], v239 offset:512
 v_mfma_f32_16x16x32_bf16 v[76:79], a[96:99], a[72:75], v[76:79]
 ds_read_b64_tr_b16 a[40:41], v238 offset:1024
 v_mfma_f32_16x16x32_bf16 v[52:55], a[96:99], a[68:71], v[52:55]
 ds_read_b64_tr_b16 a[42:43], v238 offset:1536
 v_mfma_f32_16x16x32_bf16 v[28:31], a[96:99], a[64:67], v[28:31]
 ds_read_b64_tr_b16 a[44:45], v239 offset:1024
 v_mfma_f32_16x16x32_bf16 v[4:7], a[96:99], a[60:63], v[4:7]
 ds_read_b64_tr_b16 a[46:47], v239 offset:1536
 v_mfma_f32_16x16x32_bf16 v[8:11], a[100:103], a[60:63], v[8:11]
 ds_read_b64_tr_b16 a[48:49], v238 offset:2048
 v_mfma_f32_16x16x32_bf16 v[32:35], a[100:103], a[64:67], v[32:35]
 ds_read_b64_tr_b16 a[50:51], v238 offset:2560
 s_cmp_eq_u32 s88, 2
 s_cbranch_scc1 L1F_d11
L1F_d11_r:
 v_mfma_f32_16x16x32_bf16 v[56:59], a[100:103], a[68:71], v[56:59]
 ds_read_b64_tr_b16 a[52:53], v239 offset:2048
 v_fmac_f32_e64 v245, v221, v221
 v_mfma_f32_16x16x32_bf16 v[80:83], a[100:103], a[72:75], v[80:83]
 ds_read_b64_tr_b16 a[54:55], v239 offset:2560
 v_fmac_f32_e64 v244, v214, v214
 v_mfma_f32_16x16x32_bf16 v[104:107], a[100:103], a[76:79], v[104:107]
 ds_read_b64_tr_b16 a[56:57], v240
 v_fmac_f32_e64 v245, v222, v222
 v_mfma_f32_16x16x32_bf16 v[128:131], a[100:103], a[80:83], v[128:131]
 ds_read_b64_tr_b16 a[58:59], v240 offset:256
 v_fmac_f32_e64 v244, v215, v215
 v_mfma_f32_16x16x32_bf16 v[152:155], a[100:103], a[84:87], v[152:155]
 s_add_u32 m0, s38, 36864
 v_mfma_f32_16x16x32_bf16 v[176:179], a[100:103], a[88:91], v[176:179]
 v_fmac_f32_e64 v245, v223, v223
 v_mfma_f32_16x16x32_bf16 v[180:183], a[104:107], a[88:91], v[180:183]
 v_add_f32_e64 v244, v244, v245
 v_mfma_f32_16x16x32_bf16 v[156:159], a[104:107], a[84:87], v[156:159]
 buffer_load_dwordx4 v232, s[12:15], s32 offen lds
 v_mfma_f32_16x16x32_bf16 v[132:135], a[104:107], a[80:83], v[132:135]
 v_add_f32_dpp v244, v244, v244 quad_perm:[1,0,3,2] row_mask:0xf bank_mask:0xf
 v_mfma_f32_16x16x32_bf16 v[108:111], a[104:107], a[76:79], v[108:111]
 s_nop 0
 v_add_f32_dpp v244, v244, v244 quad_perm:[2,3,0,1] row_mask:0xf bank_mask:0xf
 v_mfma_f32_16x16x32_bf16 v[84:87], a[104:107], a[72:75], v[84:87]
 buffer_load_dwordx4 v233, s[12:15], s32 offen offset:1024 lds
 v_mfma_f32_16x16x32_bf16 v[60:63], a[104:107], a[68:71], v[60:63]
 v_add_f32_dpp v244, v244, v244 row_half_mirror row_mask:0xf bank_mask:0xf
 v_mfma_f32_16x16x32_bf16 v[36:39], a[104:107], a[64:67], v[36:39]
 s_nop 0
 v_add_f32_dpp v244, v244, v244 row_mirror row_mask:0xf bank_mask:0xf
 v_mfma_f32_16x16x32_bf16 v[12:15], a[104:107], a[60:63], v[12:15]
 v_mov_b32_e64 v245, v244
 v_mfma_f32_16x16x32_bf16 v[16:19], a[108:111], a[60:63], v[16:19]
 buffer_load_dwordx4 v234, s[12:15], s32 offen offset:2048 lds
 v_mfma_f32_16x16x32_bf16 v[40:43], a[108:111], a[64:67], v[40:43]
 v_permlane16_swap_b32_e64 v244, v245
 v_mfma_f32_16x16x32_bf16 v[64:67], a[108:111], a[68:71], v[64:67]
 v_add_f32_e64 v244, v244, v245
 v_mfma_f32_16x16x32_bf16 v[88:91], a[108:111], a[72:75], v[88:91]
 s_mov_b32 s32, s45
 v_mfma_f32_16x16x32_bf16 v[112:115], a[108:111], a[76:79], v[112:115]
 v_mov_b32 v245, v244
 v_mfma_f32_16x16x32_bf16 v[136:139], a[108:111], a[80:83], v[136:139]
 s_nop 0
 v_permlane32_swap_b32 v244, v245
 v_mfma_f32_16x16x32_bf16 v[160:163], a[108:111], a[84:87], v[160:163]
 v_add_f32_e64 v244, v244, v245
 v_mfma_f32_16x16x32_bf16 v[184:187], a[108:111], a[88:91], v[184:187]
 s_add_u32 m0, s37, 73728
 v_mfma_f32_16x16x32_bf16 v[188:191], a[112:115], a[88:91], v[188:191]
 v_mul_f32 v244, 0x3a800000, v244
 v_mfma_f32_16x16x32_bf16 v[164:167], a[112:115], a[84:87], v[164:167]
 v_cvt_pk_bf16_f32 v244, v244, v244
 v_mfma_f32_16x16x32_bf16 v[140:143], a[112:115], a[80:83], v[140:143]
 buffer_load_dwordx4 v224, s[8:11], s31 offen lds
 v_mfma_f32_16x16x32_bf16 v[116:119], a[112:115], a[76:79], v[116:119]
 v_and_b32 v244, 0xffff0000, v244
 v_mfma_f32_16x16x32_bf16 v[92:95], a[112:115], a[72:75], v[92:95]
 v_add_f32 v244, 0x3727c5ac, v244
 v_mfma_f32_16x16x32_bf16 v[68:71], a[112:115], a[68:71], v[68:71]
 buffer_load_dwordx4 v225, s[8:11], s31 offen offset:1024 lds
 v_mfma_f32_16x16x32_bf16 v[44:47], a[112:115], a[64:67], v[44:47]
 v_cvt_pk_bf16_f32 v244, v244, v244
 v_mfma_f32_16x16x32_bf16 v[20:23], a[112:115], a[60:63], v[20:23]
 v_and_b32 v244, 0xffff0000, v244
 v_mfma_f32_16x16x32_bf16 a[160:163], a[116:119], a[60:63], a[160:163]
 v_sqrt_f32_e64 v244, v244
 v_mfma_f32_16x16x32_bf16 a[164:167], a[116:119], a[64:67], a[164:167]
 buffer_load_dwordx4 v226, s[8:11], s31 offen offset:2048 lds
 v_mfma_f32_16x16x32_bf16 a[168:171], a[116:119], a[68:71], a[168:171]
 v_lshrrev_b32_e64 v245, 3, v255
 v_mfma_f32_16x16x32_bf16 a[172:175], a[116:119], a[72:75], a[172:175]
 v_cvt_pk_bf16_f32 v249, v246, v244
 v_mfma_f32_16x16x32_bf16 a[176:179], a[116:119], a[76:79], a[176:179]
 buffer_load_dwordx4 v227, s[8:11], s31 offen offset:3072 lds
 v_mfma_f32_16x16x32_bf16 a[180:183], a[116:119], a[80:83], a[180:183]
 v_lshlrev_b32_e64 v245, 20, v245
 v_mfma_f32_16x16x32_bf16 a[184:187], a[116:119], a[84:87], a[184:187]
 v_lshl_add_u32 v245, v255, 4, v245
 v_mfma_f32_16x16x32_bf16 a[188:191], a[116:119], a[88:91], a[188:191]
 buffer_store_dwordx4 v[248:251], v245, s[92:95], s74 offen sc1
 s_waitcnt vmcnt(23) lgkmcnt(0)
 s_barrier
 v_mfma_f32_16x16x32_bf16 v[0:3], a[32:35], a[0:3], v[0:3]
 ds_read_b64_tr_b16 a[92:93], v238 offset:12288
 v_mfma_f32_16x16x32_bf16 v[24:27], a[32:35], a[4:7], v[24:27]
 ds_read_b64_tr_b16 a[94:95], v238 offset:12800
 v_mfma_f32_16x16x32_bf16 v[48:51], a[32:35], a[8:11], v[48:51]
 ds_read_b128 a[60:63], v237
 v_mfma_f32_16x16x32_bf16 v[72:75], a[32:35], a[12:15], v[72:75]
 ds_read_b128 a[64:67], v237 offset:2048
 v_mfma_f32_16x16x32_bf16 v[96:99], a[32:35], a[16:19], v[96:99]
 ds_read_b128 a[68:71], v237 offset:4096
 v_mfma_f32_16x16x32_bf16 v[120:123], a[32:35], a[20:23], v[120:123]
 ds_read_b128 a[72:75], v237 offset:6144
 v_mfma_f32_16x16x32_bf16 v[144:147], a[32:35], a[24:27], v[144:147]
 ds_read_b128 a[76:79], v237 offset:8192
 v_mfma_f32_16x16x32_bf16 v[168:171], a[32:35], a[28:31], v[168:171]
 ds_read_b128 a[80:83], v237 offset:10240
 v_mfma_f32_16x16x32_bf16 v[172:175], a[36:39], a[28:31], v[172:175]
 ds_read_b128 a[84:87], v237 offset:12288
 v_mfma_f32_16x16x32_bf16 v[148:151], a[36:39], a[24:27], v[148:151]
 ds_read_b128 a[88:91], v237 offset:14336
 v_mfma_f32_16x16x32_bf16 v[124:127], a[36:39], a[20:23], v[124:127]
 ds_read_b64_tr_b16 a[96:97], v239 offset:12288
 v_mfma_f32_16x16x32_bf16 v[100:103], a[36:39], a[16:19], v[100:103]
 ds_read_b64_tr_b16 a[98:99], v239 offset:12800
 v_mfma_f32_16x16x32_bf16 v[76:79], a[36:39], a[12:15], v[76:79]
 ds_read_b64_tr_b16 a[100:101], v238 offset:13312
 v_mfma_f32_16x16x32_bf16 v[52:55], a[36:39], a[8:11], v[52:55]
 ds_read_b64_tr_b16 a[102:103], v238 offset:13824
 v_mfma_f32_16x16x32_bf16 v[28:31], a[36:39], a[4:7], v[28:31]
 ds_read_b64_tr_b16 a[104:105], v239 offset:13312
 v_mfma_f32_16x16x32_bf16 v[4:7], a[36:39], a[0:3], v[4:7]
 ds_read_b64_tr_b16 a[106:107], v239 offset:13824
 v_mfma_f32_16x16x32_bf16 v[8:11], a[40:43], a[0:3], v[8:11]
 ds_read_b64_tr_b16 a[108:109], v238 offset:14336
 v_mfma_f32_16x16x32_bf16 v[32:35], a[40:43], a[4:7], v[32:35]
 ds_read_b64_tr_b16 a[110:111], v238 offset:14848
 v_mfma_f32_16x16x32_bf16 v[56:59], a[40:43], a[8:11], v[56:59]
 ds_read_b64_tr_b16 a[112:113], v239 offset:14336
 v_mfma_f32_16x16x32_bf16 v[80:83], a[40:43], a[12:15], v[80:83]
 ds_read_b64_tr_b16 a[114:115], v239 offset:14848
 v_mfma_f32_16x16x32_bf16 v[104:107], a[40:43], a[16:19], v[104:107]
 ds_read_b64_tr_b16 a[116:117], v240 offset:2048
 v_mfma_f32_16x16x32_bf16 v[128:131], a[40:43], a[20:23], v[128:131]
 ds_read_b64_tr_b16 a[118:119], v240 offset:2304
 v_mfma_f32_16x16x32_bf16 v[152:155], a[40:43], a[24:27], v[152:155]
 s_cmp_eq_u32 s88, 2
 s_cselect_b32 s4, s75, s5
 v_mfma_f32_16x16x32_bf16 v[176:179], a[40:43], a[28:31], v[176:179]
 buffer_store_dwordx4 a[156:159], v192, s[92:95], s4 offen sc1
 v_mfma_f32_16x16x32_bf16 v[180:183], a[44:47], a[28:31], v[180:183]
 s_add_u32 m0, s38, 0
 v_mfma_f32_16x16x32_bf16 v[156:159], a[44:47], a[24:27], v[156:159]
 s_cmp_eq_u32 s88, 3
 s_cbranch_scc1 L1F_d12
L1F_d12_r:
 v_mfma_f32_16x16x32_bf16 v[132:135], a[44:47], a[20:23], v[132:135]
 buffer_load_dwordx4 v232, s[12:15], s32 offen lds
 v_mfma_f32_16x16x32_bf16 v[108:111], a[44:47], a[16:19], v[108:111]
 buffer_load_dwordx4 v233, s[12:15], s32 offen offset:1024 lds
 v_mfma_f32_16x16x32_bf16 v[84:87], a[44:47], a[12:15], v[84:87]
 v_mfma_f32_16x16x32_bf16 v[60:63], a[44:47], a[8:11], v[60:63]
 buffer_load_dwordx4 v234, s[12:15], s32 offen offset:2048 lds
 v_mfma_f32_16x16x32_bf16 v[36:39], a[44:47], a[4:7], v[36:39]
 s_add_u32 s32, s32, 229376
 v_mfma_f32_16x16x32_bf16 v[12:15], a[44:47], a[0:3], v[12:15]
 v_mfma_f32_16x16x32_bf16 v[16:19], a[48:51], a[0:3], v[16:19]
 s_add_u32 m0, s37, 77824
 v_mfma_f32_16x16x32_bf16 v[40:43], a[48:51], a[4:7], v[40:43]
 buffer_load_dwordx4 v228, s[8:11], s31 offen lds
 v_mfma_f32_16x16x32_bf16 v[64:67], a[48:51], a[8:11], v[64:67]
 v_mfma_f32_16x16x32_bf16 v[88:91], a[48:51], a[12:15], v[88:91]
 buffer_load_dwordx4 v229, s[8:11], s31 offen offset:1024 lds
 v_mfma_f32_16x16x32_bf16 v[112:115], a[48:51], a[16:19], v[112:115]
 buffer_load_dwordx4 v230, s[8:11], s31 offen offset:2048 lds
 v_mfma_f32_16x16x32_bf16 v[136:139], a[48:51], a[20:23], v[136:139]
 v_mfma_f32_16x16x32_bf16 v[160:163], a[48:51], a[24:27], v[160:163]
 buffer_load_dwordx4 v231, s[8:11], s31 offen offset:3072 lds
 v_mfma_f32_16x16x32_bf16 v[184:187], a[48:51], a[28:31], v[184:187]
 s_add_u32 m0, s42, 73728
 v_mfma_f32_16x16x32_bf16 v[188:191], a[52:55], a[28:31], v[188:191]
 v_mfma_f32_16x16x32_bf16 v[164:167], a[52:55], a[24:27], v[164:167]
 buffer_load_dwordx4 v235, s[12:15], s33 offen lds
 v_mfma_f32_16x16x32_bf16 v[140:143], a[52:55], a[20:23], v[140:143]
 s_add_u32 s33, s33, 458752
 v_mfma_f32_16x16x32_bf16 v[116:119], a[52:55], a[16:19], v[116:119]
 v_mfma_f32_16x16x32_bf16 v[92:95], a[52:55], a[12:15], v[92:95]
 s_add_u32 s31, s31, 128
 v_mfma_f32_16x16x32_bf16 v[68:71], a[52:55], a[8:11], v[68:71]
 v_min_u32 v223, 15, v255
 v_mfma_f32_16x16x32_bf16 v[44:47], a[52:55], a[4:7], v[44:47]
 v_mfma_f32_16x16x32_bf16 v[20:23], a[52:55], a[0:3], v[20:23]
 s_bfe_u32 s6, s2, 0x20006
 s_lshl_b32 s6, s6, 2
 v_mfma_f32_16x16x32_bf16 a[160:163], a[56:59], a[0:3], a[160:163]
 s_add_u32 s6, s6, s28
 s_lshl_b32 s6, s6, 4
 v_mfma_f32_16x16x32_bf16 a[164:167], a[56:59], a[4:7], a[164:167]
 v_mfma_f32_16x16x32_bf16 a[168:171], a[56:59], a[8:11], a[168:171]
 v_add_lshl_u32 v223, v223, s6, 7
 v_mfma_f32_16x16x32_bf16 a[172:175], a[56:59], a[12:15], a[172:175]
 v_min_u32 v223, L_end-L_ct5-2048, v223
 v_mfma_f32_16x16x32_bf16 a[176:179], a[56:59], a[16:19], a[176:179]
 v_mfma_f32_16x16x32_bf16 a[180:183], a[56:59], a[20:23], a[180:183]
 s_getpc_b64 s[6:7]
L_ct5:
 s_add_u32 s6, s6, 2048
 s_addc_u32 s7, s7, 0
 v_mfma_f32_16x16x32_bf16 a[184:187], a[56:59], a[24:27], a[184:187]
 global_load_dword v251, v223, s[6:7]
 v_mfma_f32_16x16x32_bf16 a[188:191], a[56:59], a[28:31], a[188:191]
 s_waitcnt vmcnt(10) lgkmcnt(0)
 s_barrier
 v_mfma_f32_16x16x32_bf16 v[0:3], a[92:95], a[60:63], v[0:3]
 ds_read_b64_tr_b16 a[32:33], v238 offset:24576
 v_mfma_f32_16x16x32_bf16 v[24:27], a[92:95], a[64:67], v[24:27]
 ds_read_b64_tr_b16 a[34:35], v238 offset:25088
 v_mfma_f32_16x16x32_bf16 v[48:51], a[92:95], a[68:71], v[48:51]
 ds_read_b128 a[0:3], v236 offset:36864
 v_mfma_f32_16x16x32_bf16 v[72:75], a[92:95], a[72:75], v[72:75]
 ds_read_b128 a[4:7], v236 offset:38912
 v_mfma_f32_16x16x32_bf16 v[96:99], a[92:95], a[76:79], v[96:99]
 ds_read_b128 a[8:11], v236 offset:40960
 v_mfma_f32_16x16x32_bf16 v[120:123], a[92:95], a[80:83], v[120:123]
 ds_read_b128 a[12:15], v236 offset:43008
 v_mfma_f32_16x16x32_bf16 v[144:147], a[92:95], a[84:87], v[144:147]
 ds_read_b128 a[16:19], v236 offset:45056
 v_mfma_f32_16x16x32_bf16 v[168:171], a[92:95], a[88:91], v[168:171]
 ds_read_b128 a[20:23], v236 offset:47104
 v_mfma_f32_16x16x32_bf16 v[172:175], a[96:99], a[88:91], v[172:175]
 ds_read_b128 a[24:27], v236 offset:49152
 v_mfma_f32_16x16x32_bf16 v[148:151], a[96:99], a[84:87], v[148:151]
 ds_read_b128 a[28:31], v236 offset:51200
 v_mfma_f32_16x16x32_bf16 v[124:127], a[96:99], a[80:83], v[124:127]
 ds_read_b64_tr_b16 a[36:37], v239 offset:24576
 v_mfma_f32_16x16x32_bf16 v[100:103], a[96:99], a[76:79], v[100:103]
 ds_read_b64_tr_b16 a[38:39], v239 offset:25088
 v_mfma_f32_16x16x32_bf16 v[76:79], a[96:99], a[72:75], v[76:79]
 ds_read_b64_tr_b16 a[40:41], v238 offset:25600
 v_mfma_f32_16x16x32_bf16 v[52:55], a[96:99], a[68:71], v[52:55]
 ds_read_b64_tr_b16 a[42:43], v238 offset:26112
 v_mfma_f32_16x16x32_bf16 v[28:31], a[96:99], a[64:67], v[28:31]
 ds_read_b64_tr_b16 a[44:45], v239 offset:25600
 v_mfma_f32_16x16x32_bf16 v[4:7], a[96:99], a[60:63], v[4:7]
 ds_read_b64_tr_b16 a[46:47], v239 offset:26112
 v_mfma_f32_16x16x32_bf16 v[8:11], a[100:103], a[60:63], v[8:11]
 ds_read_b64_tr_b16 a[48:49], v238 offset:26624
 v_mfma_f32_16x16x32_bf16 v[32:35], a[100:103], a[64:67], v[32:35]
 ds_read_b64_tr_b16 a[50:51], v238 offset:27136
 v_mfma_f32_16x16x32_bf16 v[56:59], a[100:103], a[68:71], v[56:59]
 ds_read_b64_tr_b16 a[52:53], v239 offset:26624
 v_mfma_f32_16x16x32_bf16 v[80:83], a[100:103], a[72:75], v[80:83]
 ds_read_b64_tr_b16 a[54:55], v239 offset:27136
 v_mfma_f32_16x16x32_bf16 v[104:107], a[100:103], a[76:79], v[104:107]
 ds_read_b64_tr_b16 a[56:57], v240 offset:36864
 v_mfma_f32_16x16x32_bf16 v[128:131], a[100:103], a[80:83], v[128:131]
 ds_read_b64_tr_b16 a[58:59], v240 offset:37120
 v_mfma_f32_16x16x32_bf16 v[152:155], a[100:103], a[84:87], v[152:155]
 s_cmp_eq_u32 s88, 0
 s_cselect_b32 s4, 0, s5
 v_mfma_f32_16x16x32_bf16 v[176:179], a[100:103], a[88:91], v[176:179]
 s_cmp_eq_u32 s88, 3
 s_cbranch_scc1 L1F_d13
L1F_d13_r:
 v_mfma_f32_16x16x32_bf16 v[180:183], a[104:107], a[88:91], v[180:183]
 buffer_atomic_add v194, v193, s[96:99], s4 offen sc1
 v_mfma_f32_16x16x32_bf16 v[156:159], a[104:107], a[84:87], v[156:159]
 v_mfma_f32_16x16x32_bf16 v[132:135], a[104:107], a[80:83], v[132:135]
 s_add_u32 m0, s38, 12288
 v_mfma_f32_16x16x32_bf16 v[108:111], a[104:107], a[76:79], v[108:111]
 v_mfma_f32_16x16x32_bf16 v[84:87], a[104:107], a[72:75], v[84:87]
 buffer_load_dwordx4 v232, s[12:15], s32 offen lds
 v_mfma_f32_16x16x32_bf16 v[60:63], a[104:107], a[68:71], v[60:63]
 v_mfma_f32_16x16x32_bf16 v[36:39], a[104:107], a[64:67], v[36:39]
 buffer_load_dwordx4 v233, s[12:15], s32 offen offset:1024 lds
 v_mfma_f32_16x16x32_bf16 v[12:15], a[104:107], a[60:63], v[12:15]
 v_mfma_f32_16x16x32_bf16 v[16:19], a[108:111], a[60:63], v[16:19]
 buffer_load_dwordx4 v234, s[12:15], s32 offen offset:2048 lds
 v_mfma_f32_16x16x32_bf16 v[40:43], a[108:111], a[64:67], v[40:43]
 v_mfma_f32_16x16x32_bf16 v[64:67], a[108:111], a[68:71], v[64:67]
 s_add_u32 s32, s32, 229376
 v_mfma_f32_16x16x32_bf16 v[88:91], a[108:111], a[72:75], v[88:91]
 v_mfma_f32_16x16x32_bf16 v[112:115], a[108:111], a[76:79], v[112:115]
 s_add_u32 m0, s37, 0
 v_mfma_f32_16x16x32_bf16 v[136:139], a[108:111], a[80:83], v[136:139]
 v_mfma_f32_16x16x32_bf16 v[160:163], a[108:111], a[84:87], v[160:163]
 buffer_load_dwordx4 v224, s[8:11], s31 offen lds
 v_mfma_f32_16x16x32_bf16 v[184:187], a[108:111], a[88:91], v[184:187]
 v_mfma_f32_16x16x32_bf16 v[188:191], a[112:115], a[88:91], v[188:191]
 buffer_load_dwordx4 v225, s[8:11], s31 offen offset:1024 lds
 v_mfma_f32_16x16x32_bf16 v[164:167], a[112:115], a[84:87], v[164:167]
 v_mfma_f32_16x16x32_bf16 v[140:143], a[112:115], a[80:83], v[140:143]
 buffer_load_dwordx4 v226, s[8:11], s31 offen offset:2048 lds
 v_mfma_f32_16x16x32_bf16 v[116:119], a[112:115], a[76:79], v[116:119]
 v_mfma_f32_16x16x32_bf16 v[92:95], a[112:115], a[72:75], v[92:95]
 buffer_load_dwordx4 v227, s[8:11], s31 offen offset:3072 lds
 v_mfma_f32_16x16x32_bf16 v[68:71], a[112:115], a[68:71], v[68:71]
 v_mfma_f32_16x16x32_bf16 v[44:47], a[112:115], a[64:67], v[44:47]
 s_mov_b32 s20, s60
 v_mfma_f32_16x16x32_bf16 v[20:23], a[112:115], a[60:63], v[20:23]
 v_mfma_f32_16x16x32_bf16 a[160:163], a[116:119], a[60:63], a[160:163]
 s_mov_b32 s21, s61
 v_mfma_f32_16x16x32_bf16 a[164:167], a[116:119], a[64:67], a[164:167]
 v_mfma_f32_16x16x32_bf16 a[168:171], a[116:119], a[68:71], a[168:171]
 s_mov_b32 s22, 0x700000
 v_mfma_f32_16x16x32_bf16 a[172:175], a[116:119], a[72:75], a[172:175]
 v_mfma_f32_16x16x32_bf16 a[176:179], a[116:119], a[76:79], a[176:179]
 s_mov_b32 s24, s26
 v_mfma_f32_16x16x32_bf16 a[180:183], a[116:119], a[80:83], a[180:183]
 v_mfma_f32_16x16x32_bf16 a[184:187], a[116:119], a[84:87], a[184:187]
 buffer_load_dword v251, v250, s[20:23], s24 offen
 v_mfma_f32_16x16x32_bf16 a[188:191], a[116:119], a[88:91], a[188:191]
 s_waitcnt vmcnt(18) lgkmcnt(0)
 s_barrier
 v_mfma_f32_16x16x32_bf16 v[0:3], a[32:35], a[0:3], v[0:3]
 ds_read_b64_tr_b16 a[92:93], v238 offset:36864
 v_mfma_f32_16x16x32_bf16 v[24:27], a[32:35], a[4:7], v[24:27]
 ds_read_b64_tr_b16 a[94:95], v238 offset:37376
 v_mfma_f32_16x16x32_bf16 v[48:51], a[32:35], a[8:11], v[48:51]
 ds_read_b128 a[60:63], v237 offset:36864
 v_mfma_f32_16x16x32_bf16 v[72:75], a[32:35], a[12:15], v[72:75]
 ds_read_b128 a[64:67], v237 offset:38912
 v_mfma_f32_16x16x32_bf16 v[96:99], a[32:35], a[16:19], v[96:99]
 ds_read_b128 a[68:71], v237 offset:40960
 v_mfma_f32_16x16x32_bf16 v[120:123], a[32:35], a[20:23], v[120:123]
 ds_read_b128 a[72:75], v237 offset:43008
 v_mfma_f32_16x16x32_bf16 v[144:147], a[32:35], a[24:27], v[144:147]
 ds_read_b128 a[76:79], v237 offset:45056
 v_mfma_f32_16x16x32_bf16 v[168:171], a[32:35], a[28:31], v[168:171]
 ds_read_b128 a[80:83], v237 offset:47104
 v_mfma_f32_16x16x32_bf16 v[172:175], a[36:39], a[28:31], v[172:175]
 ds_read_b128 a[84:87], v237 offset:49152
 v_mfma_f32_16x16x32_bf16 v[148:151], a[36:39], a[24:27], v[148:151]
 ds_read_b128 a[88:91], v237 offset:51200
 v_mfma_f32_16x16x32_bf16 v[124:127], a[36:39], a[20:23], v[124:127]
 ds_read_b64_tr_b16 a[96:97], v239 offset:36864
 v_mfma_f32_16x16x32_bf16 v[100:103], a[36:39], a[16:19], v[100:103]
 ds_read_b64_tr_b16 a[98:99], v239 offset:37376
 v_mfma_f32_16x16x32_bf16 v[76:79], a[36:39], a[12:15], v[76:79]
 ds_read_b64_tr_b16 a[100:101], v238 offset:37888
 v_mfma_f32_16x16x32_bf16 v[52:55], a[36:39], a[8:11], v[52:55]
 ds_read_b64_tr_b16 a[102:103], v238 offset:38400
 v_mfma_f32_16x16x32_bf16 v[28:31], a[36:39], a[4:7], v[28:31]
 ds_read_b64_tr_b16 a[104:105], v239 offset:37888
 v_mfma_f32_16x16x32_bf16 v[4:7], a[36:39], a[0:3], v[4:7]
 ds_read_b64_tr_b16 a[106:107], v239 offset:38400
 v_mfma_f32_16x16x32_bf16 v[8:11], a[40:43], a[0:3], v[8:11]
 ds_read_b64_tr_b16 a[108:109], v238 offset:38912
 v_mfma_f32_16x16x32_bf16 v[32:35], a[40:43], a[4:7], v[32:35]
 ds_read_b64_tr_b16 a[110:111], v238 offset:39424
 v_mfma_f32_16x16x32_bf16 v[56:59], a[40:43], a[8:11], v[56:59]
 ds_read_b64_tr_b16 a[112:113], v239 offset:38912
 v_mfma_f32_16x16x32_bf16 v[80:83], a[40:43], a[12:15], v[80:83]
 ds_read_b64_tr_b16 a[114:115], v239 offset:39424
 v_mfma_f32_16x16x32_bf16 v[104:107], a[40:43], a[16:19], v[104:107]
 ds_read_b64_tr_b16 a[116:117], v240 offset:38912
 v_mfma_f32_16x16x32_bf16 v[128:131], a[40:43], a[20:23], v[128:131]
 ds_read_b64_tr_b16 a[118:119], v240 offset:39168
 v_mfma_f32_16x16x32_bf16 v[152:155], a[40:43], a[24:27], v[152:155]
 s_cmp_eq_u32 s88, 1
 s_cselect_b32 s4, 0, s5
 v_mfma_f32_16x16x32_bf16 v[176:179], a[40:43], a[28:31], v[176:179]
 buffer_atomic_add v194, v193, s[96:99], s4 offen sc1
 v_mfma_f32_16x16x32_bf16 v[180:183], a[44:47], a[28:31], v[180:183]
 s_cmp_eq_u32 s88, 3
 s_cbranch_scc1 L1F_d14
L1F_d14_r:
 v_mfma_f32_16x16x32_bf16 v[156:159], a[44:47], a[24:27], v[156:159]
 s_cmp_eq_u32 s88, 2
 s_cselect_b32 s4, 0, s5
 v_mfma_f32_16x16x32_bf16 v[132:135], a[44:47], a[20:23], v[132:135]
 v_mfma_f32_16x16x32_bf16 v[108:111], a[44:47], a[16:19], v[108:111]
 buffer_atomic_add v194, v195, s[96:99], s4 offen sc1
 v_mfma_f32_16x16x32_bf16 v[84:87], a[44:47], a[12:15], v[84:87]
 v_mfma_f32_16x16x32_bf16 v[60:63], a[44:47], a[8:11], v[60:63]
 s_add_u32 m0, s38, 24576
 v_mfma_f32_16x16x32_bf16 v[36:39], a[44:47], a[4:7], v[36:39]
 v_mfma_f32_16x16x32_bf16 v[12:15], a[44:47], a[0:3], v[12:15]
 buffer_load_dwordx4 v232, s[12:15], s32 offen lds
 v_mfma_f32_16x16x32_bf16 v[16:19], a[48:51], a[0:3], v[16:19]
 v_mfma_f32_16x16x32_bf16 v[40:43], a[48:51], a[4:7], v[40:43]
 buffer_load_dwordx4 v233, s[12:15], s32 offen offset:1024 lds
 v_mfma_f32_16x16x32_bf16 v[64:67], a[48:51], a[8:11], v[64:67]
 v_mfma_f32_16x16x32_bf16 v[88:91], a[48:51], a[12:15], v[88:91]
 buffer_load_dwordx4 v234, s[12:15], s32 offen offset:2048 lds
 v_mfma_f32_16x16x32_bf16 v[112:115], a[48:51], a[16:19], v[112:115]
 v_mfma_f32_16x16x32_bf16 v[136:139], a[48:51], a[20:23], v[136:139]
 s_add_u32 s32, s32, 229376
 v_mfma_f32_16x16x32_bf16 v[160:163], a[48:51], a[24:27], v[160:163]
 v_mfma_f32_16x16x32_bf16 v[184:187], a[48:51], a[28:31], v[184:187]
 s_add_u32 m0, s37, 4096
 v_mfma_f32_16x16x32_bf16 v[188:191], a[52:55], a[28:31], v[188:191]
 buffer_load_dwordx4 v228, s[8:11], s31 offen lds
 v_mfma_f32_16x16x32_bf16 v[164:167], a[52:55], a[24:27], v[164:167]
 v_mfma_f32_16x16x32_bf16 v[140:143], a[52:55], a[20:23], v[140:143]
 buffer_load_dwordx4 v229, s[8:11], s31 offen offset:1024 lds
 v_mfma_f32_16x16x32_bf16 v[116:119], a[52:55], a[16:19], v[116:119]
 v_mfma_f32_16x16x32_bf16 v[92:95], a[52:55], a[12:15], v[92:95]
 buffer_load_dwordx4 v230, s[8:11], s31 offen offset:2048 lds
 v_mfma_f32_16x16x32_bf16 v[68:71], a[52:55], a[8:11], v[68:71]
 v_mfma_f32_16x16x32_bf16 v[44:47], a[52:55], a[4:7], v[44:47]
 buffer_load_dwordx4 v231, s[8:11], s31 offen offset:3072 lds
 v_mfma_f32_16x16x32_bf16 v[20:23], a[52:55], a[0:3], v[20:23]
 v_mfma_f32_16x16x32_bf16 a[160:163], a[56:59], a[0:3], a[160:163]
 s_add_u32 m0, s42, 0
 v_mfma_f32_16x16x32_bf16 a[164:167], a[56:59], a[4:7], a[164:167]
 v_mfma_f32_16x16x32_bf16 a[168:171], a[56:59], a[8:11], a[168:171]
 buffer_load_dwordx4 v235, s[12:15], s33 offen lds
 v_mfma_f32_16x16x32_bf16 a[172:175], a[56:59], a[12:15], a[172:175]
 v_mfma_f32_16x16x32_bf16 a[176:179], a[56:59], a[16:19], a[176:179]
 s_add_u32 s33, s33, 458752
 v_mfma_f32_16x16x32_bf16 a[180:183], a[56:59], a[20:23], a[180:183]
 v_mfma_f32_16x16x32_bf16 a[184:187], a[56:59], a[24:27], a[184:187]
 s_add_u32 s31, s31, 128
 v_mfma_f32_16x16x32_bf16 a[188:191], a[56:59], a[28:31], a[188:191]
 s_waitcnt vmcnt(20) lgkmcnt(0)
 s_barrier
 v_mfma_f32_16x16x32_bf16 v[0:3], a[92:95], a[60:63], v[0:3]
 ds_read_b64_tr_b16 a[32:33], v238
 v_mfma_f32_16x16x32_bf16 v[24:27], a[92:95], a[64:67], v[24:27]
 ds_read_b64_tr_b16 a[34:35], v238 offset:512
 v_mfma_f32_16x16x32_bf16 v[48:51], a[92:95], a[68:71], v[48:51]
 ds_read_b128 a[0:3], v241
 v_mfma_f32_16x16x32_bf16 v[72:75], a[92:95], a[72:75], v[72:75]
 ds_read_b128 a[4:7], v241 offset:2048
 v_mfma_f32_16x16x32_bf16 v[96:99], a[92:95], a[76:79], v[96:99]
 ds_read_b128 a[8:11], v241 offset:4096
 v_mfma_f32_16x16x32_bf16 v[120:123], a[92:95], a[80:83], v[120:123]
 ds_read_b128 a[12:15], v241 offset:6144
 v_mfma_f32_16x16x32_bf16 v[144:147], a[92:95], a[84:87], v[144:147]
 ds_read_b128 a[16:19], v241 offset:8192
 v_mfma_f32_16x16x32_bf16 v[168:171], a[92:95], a[88:91], v[168:171]
 ds_read_b128 a[20:23], v241 offset:10240
 v_mfma_f32_16x16x32_bf16 v[172:175], a[96:99], a[88:91], v[172:175]
 ds_read_b128 a[24:27], v241 offset:12288
 v_mfma_f32_16x16x32_bf16 v[148:151], a[96:99], a[84:87], v[148:151]
 ds_read_b128 a[28:31], v241 offset:14336
 v_mfma_f32_16x16x32_bf16 v[124:127], a[96:99], a[80:83], v[124:127]
 ds_read_b64_tr_b16 a[36:37], v239
 v_mfma_f32_16x16x32_bf16 v[100:103], a[96:99], a[76:79], v[100:103]
 ds_read_b64_tr_b16 a[38:39], v239 offset:512
 v_mfma_f32_16x16x32_bf16 v[76:79], a[96:99], a[72:75], v[76:79]
 ds_read_b64_tr_b16 a[40:41], v238 offset:1024
 v_mfma_f32_16x16x32_bf16 v[52:55], a[96:99], a[68:71], v[52:55]
 ds_read_b64_tr_b16 a[42:43], v238 offset:1536
 v_mfma_f32_16x16x32_bf16 v[28:31], a[96:99], a[64:67], v[28:31]
 ds_read_b64_tr_b16 a[44:45], v239 offset:1024
 v_mfma_f32_16x16x32_bf16 v[4:7], a[96:99], a[60:63], v[4:7]
 ds_read_b64_tr_b16 a[46:47], v239 offset:1536
 v_mfma_f32_16x16x32_bf16 v[8:11], a[100:103], a[60:63], v[8:11]
 ds_read_b64_tr_b16 a[48:49], v238 offset:2048
 v_mfma_f32_16x16x32_bf16 v[32:35], a[100:103], a[64:67], v[32:35]
 ds_read_b64_tr_b16 a[50:51], v238 offset:2560
 v_mfma_f32_16x16x32_bf16 v[56:59], a[100:103], a[68:71], v[56:59]
 ds_read_b64_tr_b16 a[52:53], v239 offset:2048
 v_mfma_f32_16x16x32_bf16 v[80:83], a[100:103], a[72:75], v[80:83]
 ds_read_b64_tr_b16 a[54:55], v239 offset:2560
 v_mfma_f32_16x16x32_bf16 v[104:107], a[100:103], a[76:79], v[104:107]
 ds_read_b64_tr_b16 a[56:57], v243
 v_mfma_f32_16x16x32_bf16 v[128:131], a[100:103], a[80:83], v[128:131]
 ds_read_b64_tr_b16 a[58:59], v243 offset:256
 v_mfma_f32_16x16x32_bf16 v[152:155], a[100:103], a[84:87], v[152:155]
 s_cmp_eq_u32 s88, 2
 s_cselect_b32 s4, 0, s5
 v_mfma_f32_16x16x32_bf16 v[176:179], a[100:103], a[88:91], v[176:179]
 s_cmp_eq_u32 s88, 3
 s_cbranch_scc1 L1F_d15
L1F_d15_r:
 v_mfma_f32_16x16x32_bf16 v[180:183], a[104:107], a[88:91], v[180:183]
 buffer_atomic_add v194, v193, s[96:99], s4 offen sc1
 v_mfma_f32_16x16x32_bf16 v[156:159], a[104:107], a[84:87], v[156:159]
 v_mfma_f32_16x16x32_bf16 v[132:135], a[104:107], a[80:83], v[132:135]
 s_add_u32 m0, s38, 36864
 v_mfma_f32_16x16x32_bf16 v[108:111], a[104:107], a[76:79], v[108:111]
 v_mfma_f32_16x16x32_bf16 v[84:87], a[104:107], a[72:75], v[84:87]
 v_mfma_f32_16x16x32_bf16 v[60:63], a[104:107], a[68:71], v[60:63]
 buffer_load_dwordx4 v232, s[12:15], s32 offen lds
 v_mfma_f32_16x16x32_bf16 v[36:39], a[104:107], a[64:67], v[36:39]
 v_mfma_f32_16x16x32_bf16 v[12:15], a[104:107], a[60:63], v[12:15]
 buffer_load_dwordx4 v233, s[12:15], s32 offen offset:1024 lds
 v_mfma_f32_16x16x32_bf16 v[16:19], a[108:111], a[60:63], v[16:19]
 v_mfma_f32_16x16x32_bf16 v[40:43], a[108:111], a[64:67], v[40:43]
 v_mfma_f32_16x16x32_bf16 v[64:67], a[108:111], a[68:71], v[64:67]
 buffer_load_dwordx4 v234, s[12:15], s32 offen offset:2048 lds
 v_mfma_f32_16x16x32_bf16 v[88:91], a[108:111], a[72:75], v[88:91]
 v_mfma_f32_16x16x32_bf16 v[112:115], a[108:111], a[76:79], v[112:115]
 s_add_u32 s32, s32, 229376
 v_mfma_f32_16x16x32_bf16 v[136:139], a[108:111], a[80:83], v[136:139]
 v_mfma_f32_16x16x32_bf16 v[160:163], a[108:111], a[84:87], v[160:163]
 v_mfma_f32_16x16x32_bf16 v[184:187], a[108:111], a[88:91], v[184:187]
 s_add_u32 m0, s37, 36864
 v_mfma_f32_16x16x32_bf16 v[188:191], a[112:115], a[88:91], v[188:191]
 v_mfma_f32_16x16x32_bf16 v[164:167], a[112:115], a[84:87], v[164:167]
 buffer_load_dwordx4 v224, s[8:11], s31 offen lds
 v_mfma_f32_16x16x32_bf16 v[140:143], a[112:115], a[80:83], v[140:143]
 v_mfma_f32_16x16x32_bf16 v[116:119], a[112:115], a[76:79], v[116:119]
 buffer_load_dwordx4 v225, s[8:11], s31 offen offset:1024 lds
 v_mfma_f32_16x16x32_bf16 v[92:95], a[112:115], a[72:75], v[92:95]
 v_mfma_f32_16x16x32_bf16 v[68:71], a[112:115], a[68:71], v[68:71]
 v_mfma_f32_16x16x32_bf16 v[44:47], a[112:115], a[64:67], v[44:47]
 buffer_load_dwordx4 v226, s[8:11], s31 offen offset:2048 lds
 v_mfma_f32_16x16x32_bf16 v[20:23], a[112:115], a[60:63], v[20:23]
 v_mfma_f32_16x16x32_bf16 a[160:163], a[116:119], a[60:63], a[160:163]
 buffer_load_dwordx4 v227, s[8:11], s31 offen offset:3072 lds
 v_mfma_f32_16x16x32_bf16 a[164:167], a[116:119], a[64:67], a[164:167]
 v_mfma_f32_16x16x32_bf16 a[168:171], a[116:119], a[68:71], a[168:171]
 v_mfma_f32_16x16x32_bf16 a[172:175], a[116:119], a[72:75], a[172:175]
 s_add_u32 s24, s24, 2097152
 v_mfma_f32_16x16x32_bf16 a[176:179], a[116:119], a[76:79], a[176:179]
 v_mfma_f32_16x16x32_bf16 a[180:183], a[116:119], a[80:83], a[180:183]
 buffer_load_dword v251, v250, s[20:23], s24 offen
 v_mfma_f32_16x16x32_bf16 a[184:187], a[116:119], a[84:87], a[184:187]
 v_mfma_f32_16x16x32_bf16 a[188:191], a[116:119], a[88:91], a[188:191]
 s_waitcnt vmcnt(24) lgkmcnt(0)
 s_barrier
 v_mfma_f32_16x16x32_bf16 v[0:3], a[32:35], a[0:3], v[0:3]
 ds_read_b64_tr_b16 a[92:93], v238 offset:12288
 v_mfma_f32_16x16x32_bf16 v[24:27], a[32:35], a[4:7], v[24:27]
 ds_read_b64_tr_b16 a[94:95], v238 offset:12800
 v_mfma_f32_16x16x32_bf16 v[48:51], a[32:35], a[8:11], v[48:51]
 ds_read_b128 a[60:63], v242
 v_mfma_f32_16x16x32_bf16 v[72:75], a[32:35], a[12:15], v[72:75]
 ds_read_b128 a[64:67], v242 offset:2048
 v_mfma_f32_16x16x32_bf16 v[96:99], a[32:35], a[16:19], v[96:99]
 ds_read_b128 a[68:71], v242 offset:4096
 v_mfma_f32_16x16x32_bf16 v[120:123], a[32:35], a[20:23], v[120:123]
 ds_read_b128 a[72:75], v242 offset:6144
 v_mfma_f32_16x16x32_bf16 v[144:147], a[32:35], a[24:27], v[144:147]
 ds_read_b128 a[76:79], v242 offset:8192
 v_mfma_f32_16x16x32_bf16 v[168:171], a[32:35], a[28:31], v[168:171]
 ds_read_b128 a[80:83], v242 offset:10240
 v_mfma_f32_16x16x32_bf16 v[172:175], a[36:39], a[28:31], v[172:175]
 ds_read_b128 a[84:87], v242 offset:12288
 v_mfma_f32_16x16x32_bf16 v[148:151], a[36:39], a[24:27], v[148:151]
 ds_read_b128 a[88:91], v242 offset:14336
 v_mfma_f32_16x16x32_bf16 v[124:127], a[36:39], a[20:23], v[124:127]
 ds_read_b64_tr_b16 a[96:97], v239 offset:12288
 v_mfma_f32_16x16x32_bf16 v[100:103], a[36:39], a[16:19], v[100:103]
 ds_read_b64_tr_b16 a[98:99], v239 offset:12800
 v_mfma_f32_16x16x32_bf16 v[76:79], a[36:39], a[12:15], v[76:79]
 ds_read_b64_tr_b16 a[100:101], v238 offset:13312
 v_mfma_f32_16x16x32_bf16 v[52:55], a[36:39], a[8:11], v[52:55]
 ds_read_b64_tr_b16 a[102:103], v238 offset:13824
 v_mfma_f32_16x16x32_bf16 v[28:31], a[36:39], a[4:7], v[28:31]
 ds_read_b64_tr_b16 a[104:105], v239 offset:13312
 v_mfma_f32_16x16x32_bf16 v[4:7], a[36:39], a[0:3], v[4:7]
 ds_read_b64_tr_b16 a[106:107], v239 offset:13824
 v_mfma_f32_16x16x32_bf16 v[8:11], a[40:43], a[0:3], v[8:11]
 ds_read_b64_tr_b16 a[108:109], v238 offset:14336
 v_mfma_f32_16x16x32_bf16 v[32:35], a[40:43], a[4:7], v[32:35]
 ds_read_b64_tr_b16 a[110:111], v238 offset:14848
 v_mfma_f32_16x16x32_bf16 v[56:59], a[40:43], a[8:11], v[56:59]
 ds_read_b64_tr_b16 a[112:113], v239 offset:14336
 v_mfma_f32_16x16x32_bf16 v[80:83], a[40:43], a[12:15], v[80:83]
 ds_read_b64_tr_b16 a[114:115], v239 offset:14848
 v_mfma_f32_16x16x32_bf16 v[104:107], a[40:43], a[16:19], v[104:107]
 ds_read_b64_tr_b16 a[116:117], v243 offset:2048
 v_mfma_f32_16x16x32_bf16 v[128:131], a[40:43], a[20:23], v[128:131]
 ds_read_b64_tr_b16 a[118:119], v243 offset:2304
 v_mfma_f32_16x16x32_bf16 v[152:155], a[40:43], a[24:27], v[152:155]
 s_cmp_eq_u32 s88, 3
 s_cselect_b32 s4, 0, s5
 v_mfma_f32_16x16x32_bf16 v[176:179], a[40:43], a[28:31], v[176:179]
 buffer_atomic_add v194, v193, s[96:99], s4 offen sc1
 v_mfma_f32_16x16x32_bf16 v[180:183], a[44:47], a[28:31], v[180:183]
 v_mfma_f32_16x16x32_bf16 v[156:159], a[44:47], a[24:27], v[156:159]
 s_cmp_eq_u32 s88, 3
 s_cselect_b32 s4, s75, s5
 v_mfma_f32_16x16x32_bf16 v[132:135], a[44:47], a[20:23], v[132:135]
 v_mfma_f32_16x16x32_bf16 v[108:111], a[44:47], a[16:19], v[108:111]
 buffer_store_dwordx4 a[156:159], v192, s[92:95], s4 offen sc1
 v_mfma_f32_16x16x32_bf16 v[84:87], a[44:47], a[12:15], v[84:87]
 v_mfma_f32_16x16x32_bf16 v[60:63], a[44:47], a[8:11], v[60:63]
 s_add_u32 m0, s38, 0
 v_mfma_f32_16x16x32_bf16 v[36:39], a[44:47], a[4:7], v[36:39]
 v_mfma_f32_16x16x32_bf16 v[12:15], a[44:47], a[0:3], v[12:15]
 buffer_load_dwordx4 v232, s[12:15], s32 offen lds
 v_mfma_f32_16x16x32_bf16 v[16:19], a[48:51], a[0:3], v[16:19]
 v_mfma_f32_16x16x32_bf16 v[40:43], a[48:51], a[4:7], v[40:43]
 buffer_load_dwordx4 v233, s[12:15], s32 offen offset:1024 lds
 v_mfma_f32_16x16x32_bf16 v[64:67], a[48:51], a[8:11], v[64:67]
 v_mfma_f32_16x16x32_bf16 v[88:91], a[48:51], a[12:15], v[88:91]
 buffer_load_dwordx4 v234, s[12:15], s32 offen offset:2048 lds
 v_mfma_f32_16x16x32_bf16 v[112:115], a[48:51], a[16:19], v[112:115]
 v_mfma_f32_16x16x32_bf16 v[136:139], a[48:51], a[20:23], v[136:139]
 s_add_u32 s32, s32, 229376
 v_mfma_f32_16x16x32_bf16 v[160:163], a[48:51], a[24:27], v[160:163]
 v_mfma_f32_16x16x32_bf16 v[184:187], a[48:51], a[28:31], v[184:187]
 s_add_u32 m0, s37, 40960
 v_mfma_f32_16x16x32_bf16 v[188:191], a[52:55], a[28:31], v[188:191]
 buffer_load_dwordx4 v228, s[8:11], s31 offen lds
 v_mfma_f32_16x16x32_bf16 v[164:167], a[52:55], a[24:27], v[164:167]
 v_mfma_f32_16x16x32_bf16 v[140:143], a[52:55], a[20:23], v[140:143]
 buffer_load_dwordx4 v229, s[8:11], s31 offen offset:1024 lds
 v_mfma_f32_16x16x32_bf16 v[116:119], a[52:55], a[16:19], v[116:119]
 v_mfma_f32_16x16x32_bf16 v[92:95], a[52:55], a[12:15], v[92:95]
 buffer_load_dwordx4 v230, s[8:11], s31 offen offset:2048 lds
 v_mfma_f32_16x16x32_bf16 v[68:71], a[52:55], a[8:11], v[68:71]
 v_mfma_f32_16x16x32_bf16 v[44:47], a[52:55], a[4:7], v[44:47]
 buffer_load_dwordx4 v231, s[8:11], s31 offen offset:3072 lds
 v_mfma_f32_16x16x32_bf16 v[20:23], a[52:55], a[0:3], v[20:23]
 v_mfma_f32_16x16x32_bf16 a[160:163], a[56:59], a[0:3], a[160:163]
 s_add_u32 m0, s42, 36864
 v_mfma_f32_16x16x32_bf16 a[164:167], a[56:59], a[4:7], a[164:167]
 v_mfma_f32_16x16x32_bf16 a[168:171], a[56:59], a[8:11], a[168:171]
 buffer_load_dwordx4 v235, s[12:15], s33 offen lds
 v_mfma_f32_16x16x32_bf16 a[172:175], a[56:59], a[12:15], a[172:175]
 v_mfma_f32_16x16x32_bf16 a[176:179], a[56:59], a[16:19], a[176:179]
 s_add_u32 s33, s33, 458752
 v_mfma_f32_16x16x32_bf16 a[180:183], a[56:59], a[20:23], a[180:183]
 v_mfma_f32_16x16x32_bf16 a[184:187], a[56:59], a[24:27], a[184:187]
 s_add_u32 s31, s31, 128
 v_mfma_f32_16x16x32_bf16 a[188:191], a[56:59], a[28:31], a[188:191]
 s_waitcnt vmcnt(19) lgkmcnt(0)
 s_barrier
 v_mfma_f32_16x16x32_bf16 v[0:3], a[92:95], a[60:63], v[0:3]
 ds_read_b64_tr_b16 a[32:33], v238 offset:24576
 v_mfma_f32_16x16x32_bf16 v[24:27], a[92:95], a[64:67], v[24:27]
 ds_read_b64_tr_b16 a[34:35], v238 offset:25088
 v_mfma_f32_16x16x32_bf16 v[48:51], a[92:95], a[68:71], v[48:51]
 ds_read_b128 a[0:3], v236
 v_mfma_f32_16x16x32_bf16 v[72:75], a[92:95], a[72:75], v[72:75]
 ds_read_b128 a[4:7], v236 offset:2048
 v_mfma_f32_16x16x32_bf16 v[96:99], a[92:95], a[76:79], v[96:99]
 ds_read_b128 a[8:11], v236 offset:4096
 v_mfma_f32_16x16x32_bf16 v[120:123], a[92:95], a[80:83], v[120:123]
 ds_read_b128 a[12:15], v236 offset:6144
 v_mfma_f32_16x16x32_bf16 v[144:147], a[92:95], a[84:87], v[144:147]
 ds_read_b128 a[16:19], v236 offset:8192
 v_mfma_f32_16x16x32_bf16 v[168:171], a[92:95], a[88:91], v[168:171]
 ds_read_b128 a[20:23], v236 offset:10240
 v_mfma_f32_16x16x32_bf16 v[172:175], a[96:99], a[88:91], v[172:175]
 ds_read_b128 a[24:27], v236 offset:12288
 v_mfma_f32_16x16x32_bf16 v[148:151], a[96:99], a[84:87], v[148:151]
 ds_read_b128 a[28:31], v236 offset:14336
 v_mfma_f32_16x16x32_bf16 v[124:127], a[96:99], a[80:83], v[124:127]
 ds_read_b64_tr_b16 a[36:37], v239 offset:24576
 v_mfma_f32_16x16x32_bf16 v[100:103], a[96:99], a[76:79], v[100:103]
 ds_read_b64_tr_b16 a[38:39], v239 offset:25088
 v_mfma_f32_16x16x32_bf16 v[76:79], a[96:99], a[72:75], v[76:79]
 ds_read_b64_tr_b16 a[40:41], v238 offset:25600
 v_mfma_f32_16x16x32_bf16 v[52:55], a[96:99], a[68:71], v[52:55]
 ds_read_b64_tr_b16 a[42:43], v238 offset:26112
 v_mfma_f32_16x16x32_bf16 v[28:31], a[96:99], a[64:67], v[28:31]
 ds_read_b64_tr_b16 a[44:45], v239 offset:25600
 v_mfma_f32_16x16x32_bf16 v[4:7], a[96:99], a[60:63], v[4:7]
 ds_read_b64_tr_b16 a[46:47], v239 offset:26112
 v_mfma_f32_16x16x32_bf16 v[8:11], a[100:103], a[60:63], v[8:11]
 ds_read_b64_tr_b16 a[48:49], v238 offset:26624
 v_mfma_f32_16x16x32_bf16 v[32:35], a[100:103], a[64:67], v[32:35]
 ds_read_b64_tr_b16 a[50:51], v238 offset:27136
 v_mfma_f32_16x16x32_bf16 v[56:59], a[100:103], a[68:71], v[56:59]
 ds_read_b64_tr_b16 a[52:53], v239 offset:26624
 v_mfma_f32_16x16x32_bf16 v[80:83], a[100:103], a[72:75], v[80:83]
 ds_read_b64_tr_b16 a[54:55], v239 offset:27136
 v_mfma_f32_16x16x32_bf16 v[104:107], a[100:103], a[76:79], v[104:107]
 ds_read_b64_tr_b16 a[56:57], v240
 v_mfma_f32_16x16x32_bf16 v[128:131], a[100:103], a[80:83], v[128:131]
 ds_read_b64_tr_b16 a[58:59], v240 offset:256
 v_mfma_f32_16x16x32_bf16 v[152:155], a[100:103], a[84:87], v[152:155]
 s_add_u32 m0, s38, 12288
 v_mfma_f32_16x16x32_bf16 v[176:179], a[100:103], a[88:91], v[176:179]
 v_mfma_f32_16x16x32_bf16 v[180:183], a[104:107], a[88:91], v[180:183]
 buffer_load_dwordx4 v232, s[12:15], s32 offen lds
 v_mfma_f32_16x16x32_bf16 v[156:159], a[104:107], a[84:87], v[156:159]
 v_mfma_f32_16x16x32_bf16 v[132:135], a[104:107], a[80:83], v[132:135]
 v_mfma_f32_16x16x32_bf16 v[108:111], a[104:107], a[76:79], v[108:111]
 buffer_load_dwordx4 v233, s[12:15], s32 offen offset:1024 lds
 v_mfma_f32_16x16x32_bf16 v[84:87], a[104:107], a[72:75], v[84:87]
 v_mfma_f32_16x16x32_bf16 v[60:63], a[104:107], a[68:71], v[60:63]
 v_mfma_f32_16x16x32_bf16 v[36:39], a[104:107], a[64:67], v[36:39]
 buffer_load_dwordx4 v234, s[12:15], s32 offen offset:2048 lds
 v_mfma_f32_16x16x32_bf16 v[12:15], a[104:107], a[60:63], v[12:15]
 v_mfma_f32_16x16x32_bf16 v[16:19], a[108:111], a[60:63], v[16:19]
 v_mfma_f32_16x16x32_bf16 v[40:43], a[108:111], a[64:67], v[40:43]
 s_add_u32 s32, s32, 229376
 v_mfma_f32_16x16x32_bf16 v[64:67], a[108:111], a[68:71], v[64:67]
 v_mfma_f32_16x16x32_bf16 v[88:91], a[108:111], a[72:75], v[88:91]
 v_mfma_f32_16x16x32_bf16 v[112:115], a[108:111], a[76:79], v[112:115]
 s_add_u32 m0, s37, 73728
 v_mfma_f32_16x16x32_bf16 v[136:139], a[108:111], a[80:83], v[136:139]
 v_mfma_f32_16x16x32_bf16 v[160:163], a[108:111], a[84:87], v[160:163]
 v_mfma_f32_16x16x32_bf16 v[184:187], a[108:111], a[88:91], v[184:187]
 buffer_load_dwordx4 v224, s[8:11], s31 offen lds
 v_mfma_f32_16x16x32_bf16 v[188:191], a[112:115], a[88:91], v[188:191]
 v_mfma_f32_16x16x32_bf16 v[164:167], a[112:115], a[84:87], v[164:167]
 buffer_load_dwordx4 v225, s[8:11], s31 offen offset:1024 lds
 v_mfma_f32_16x16x32_bf16 v[140:143], a[112:115], a[80:83], v[140:143]
 v_mfma_f32_16x16x32_bf16 v[116:119], a[112:115], a[76:79], v[116:119]
 v_mfma_f32_16x16x32_bf16 v[92:95], a[112:115], a[72:75], v[92:95]
 buffer_load_dwordx4 v226, s[8:11], s31 offen offset:2048 lds
 v_mfma_f32_16x16x32_bf16 v[68:71], a[112:115], a[68:71], v[68:71]
 v_mfma_f32_16x16x32_bf16 v[44:47], a[112:115], a[64:67], v[44:47]
 v_mfma_f32_16x16x32_bf16 v[20:23], a[112:115], a[60:63], v[20:23]
 buffer_load_dwordx4 v227, s[8:11], s31 offen offset:3072 lds
 v_mfma_f32_16x16x32_bf16 a[160:163], a[116:119], a[60:63], a[160:163]
 v_mfma_f32_16x16x32_bf16 a[164:167], a[116:119], a[64:67], a[164:167]
 v_mfma_f32_16x16x32_bf16 a[168:171], a[116:119], a[68:71], a[168:171]
 s_add_u32 s24, s24, 2097152
 v_mfma_f32_16x16x32_bf16 a[172:175], a[116:119], a[72:75], a[172:175]
 v_mfma_f32_16x16x32_bf16 a[176:179], a[116:119], a[76:79], a[176:179]
 v_mfma_f32_16x16x32_bf16 a[180:183], a[116:119], a[80:83], a[180:183]
 buffer_load_dword v251, v250, s[20:23], s24 offen
 v_mfma_f32_16x16x32_bf16 a[184:187], a[116:119], a[84:87], a[184:187]
 v_mfma_f32_16x16x32_bf16 a[188:191], a[116:119], a[88:91], a[188:191]
 s_waitcnt vmcnt(16) lgkmcnt(0)
 s_barrier
 v_mfma_f32_16x16x32_bf16 v[0:3], a[32:35], a[0:3], v[0:3]
 ds_read_b64_tr_b16 a[92:93], v238 offset:36864
 v_mfma_f32_16x16x32_bf16 v[24:27], a[32:35], a[4:7], v[24:27]
 ds_read_b64_tr_b16 a[94:95], v238 offset:37376
 v_mfma_f32_16x16x32_bf16 v[48:51], a[32:35], a[8:11], v[48:51]
 ds_read_b128 a[60:63], v237
 v_mfma_f32_16x16x32_bf16 v[72:75], a[32:35], a[12:15], v[72:75]
 ds_read_b128 a[64:67], v237 offset:2048
 v_mfma_f32_16x16x32_bf16 v[96:99], a[32:35], a[16:19], v[96:99]
 ds_read_b128 a[68:71], v237 offset:4096
 v_mfma_f32_16x16x32_bf16 v[120:123], a[32:35], a[20:23], v[120:123]
 ds_read_b128 a[72:75], v237 offset:6144
 v_mfma_f32_16x16x32_bf16 v[144:147], a[32:35], a[24:27], v[144:147]
 ds_read_b128 a[76:79], v237 offset:8192
 v_mfma_f32_16x16x32_bf16 v[168:171], a[32:35], a[28:31], v[168:171]
 ds_read_b128 a[80:83], v237 offset:10240
 v_mfma_f32_16x16x32_bf16 v[172:175], a[36:39], a[28:31], v[172:175]
 ds_read_b128 a[84:87], v237 offset:12288
 v_mfma_f32_16x16x32_bf16 v[148:151], a[36:39], a[24:27], v[148:151]
 ds_read_b128 a[88:91], v237 offset:14336
 v_mfma_f32_16x16x32_bf16 v[124:127], a[36:39], a[20:23], v[124:127]
 ds_read_b64_tr_b16 a[96:97], v239 offset:36864
 v_mfma_f32_16x16x32_bf16 v[100:103], a[36:39], a[16:19], v[100:103]
 ds_read_b64_tr_b16 a[98:99], v239 offset:37376
 v_mfma_f32_16x16x32_bf16 v[76:79], a[36:39], a[12:15], v[76:79]
 ds_read_b64_tr_b16 a[100:101], v238 offset:37888
 v_mfma_f32_16x16x32_bf16 v[52:55], a[36:39], a[8:11], v[52:55]
 ds_read_b64_tr_b16 a[102:103], v238 offset:38400
 v_mfma_f32_16x16x32_bf16 v[28:31], a[36:39], a[4:7], v[28:31]
 ds_read_b64_tr_b16 a[104:105], v239 offset:37888
 v_mfma_f32_16x16x32_bf16 v[4:7], a[36:39], a[0:3], v[4:7]
 ds_read_b64_tr_b16 a[106:107], v239 offset:38400
 v_mfma_f32_16x16x32_bf16 v[8:11], a[40:43], a[0:3], v[8:11]
 ds_read_b64_tr_b16 a[108:109], v238 offset:38912
 v_mfma_f32_16x16x32_bf16 v[32:35], a[40:43], a[4:7], v[32:35]
 ds_read_b64_tr_b16 a[110:111], v238 offset:39424
 v_mfma_f32_16x16x32_bf16 v[56:59], a[40:43], a[8:11], v[56:59]
 ds_read_b64_tr_b16 a[112:113], v239 offset:38912
 v_mfma_f32_16x16x32_bf16 v[80:83], a[40:43], a[12:15], v[80:83]
 ds_read_b64_tr_b16 a[114:115], v239 offset:39424
 v_mfma_f32_16x16x32_bf16 v[104:107], a[40:43], a[16:19], v[104:107]
 ds_read_b64_tr_b16 a[116:117], v240 offset:2048
 v_mfma_f32_16x16x32_bf16 v[128:131], a[40:43], a[20:23], v[128:131]
 ds_read_b64_tr_b16 a[118:119], v240 offset:2304
 v_mfma_f32_16x16x32_bf16 v[152:155], a[40:43], a[24:27], v[152:155]
 s_cmp_eq_u32 s88, 3
 s_cselect_b32 s4, 0, s5
 v_mfma_f32_16x16x32_bf16 v[176:179], a[40:43], a[28:31], v[176:179]
 v_mfma_f32_16x16x32_bf16 v[180:183], a[44:47], a[28:31], v[180:183]
 buffer_atomic_add v194, v195, s[96:99], s4 offen sc1
 v_mfma_f32_16x16x32_bf16 v[156:159], a[44:47], a[24:27], v[156:159]
 v_mfma_f32_16x16x32_bf16 v[132:135], a[44:47], a[20:23], v[132:135]
 s_add_u32 m0, s38, 24576
 v_mfma_f32_16x16x32_bf16 v[108:111], a[44:47], a[16:19], v[108:111]
 v_mfma_f32_16x16x32_bf16 v[84:87], a[44:47], a[12:15], v[84:87]
 buffer_load_dwordx4 v232, s[12:15], s32 offen lds
 v_mfma_f32_16x16x32_bf16 v[60:63], a[44:47], a[8:11], v[60:63]
 v_mfma_f32_16x16x32_bf16 v[36:39], a[44:47], a[4:7], v[36:39]
 buffer_load_dwordx4 v233, s[12:15], s32 offen offset:1024 lds
 v_mfma_f32_16x16x32_bf16 v[12:15], a[44:47], a[0:3], v[12:15]
 v_mfma_f32_16x16x32_bf16 v[16:19], a[48:51], a[0:3], v[16:19]
 buffer_load_dwordx4 v234, s[12:15], s32 offen offset:2048 lds
 v_mfma_f32_16x16x32_bf16 v[40:43], a[48:51], a[4:7], v[40:43]
 v_mfma_f32_16x16x32_bf16 v[64:67], a[48:51], a[8:11], v[64:67]
 s_add_u32 s32, s32, 229376
 v_mfma_f32_16x16x32_bf16 v[88:91], a[48:51], a[12:15], v[88:91]
 v_mfma_f32_16x16x32_bf16 v[112:115], a[48:51], a[16:19], v[112:115]
 s_add_u32 m0, s37, 77824
 v_mfma_f32_16x16x32_bf16 v[136:139], a[48:51], a[20:23], v[136:139]
 v_mfma_f32_16x16x32_bf16 v[160:163], a[48:51], a[24:27], v[160:163]
 v_mfma_f32_16x16x32_bf16 v[184:187], a[48:51], a[28:31], v[184:187]
 buffer_load_dwordx4 v228, s[8:11], s31 offen lds
 v_mfma_f32_16x16x32_bf16 v[188:191], a[52:55], a[28:31], v[188:191]
 v_mfma_f32_16x16x32_bf16 v[164:167], a[52:55], a[24:27], v[164:167]
 buffer_load_dwordx4 v229, s[8:11], s31 offen offset:1024 lds
 v_mfma_f32_16x16x32_bf16 v[140:143], a[52:55], a[20:23], v[140:143]
 v_mfma_f32_16x16x32_bf16 v[116:119], a[52:55], a[16:19], v[116:119]
 buffer_load_dwordx4 v230, s[8:11], s31 offen offset:2048 lds
 v_mfma_f32_16x16x32_bf16 v[92:95], a[52:55], a[12:15], v[92:95]
 v_mfma_f32_16x16x32_bf16 v[68:71], a[52:55], a[8:11], v[68:71]
 buffer_load_dwordx4 v231, s[8:11], s31 offen offset:3072 lds
 v_mfma_f32_16x16x32_bf16 v[44:47], a[52:55], a[4:7], v[44:47]
 v_mfma_f32_16x16x32_bf16 v[20:23], a[52:55], a[0:3], v[20:23]
 s_add_u32 m0, s42, 73728
 v_mfma_f32_16x16x32_bf16 a[160:163], a[56:59], a[0:3], a[160:163]
 v_mfma_f32_16x16x32_bf16 a[164:167], a[56:59], a[4:7], a[164:167]
 buffer_load_dwordx4 v235, s[12:15], s33 offen lds
 v_mfma_f32_16x16x32_bf16 a[168:171], a[56:59], a[8:11], a[168:171]
 v_mfma_f32_16x16x32_bf16 a[172:175], a[56:59], a[12:15], a[172:175]
 s_add_u32 s33, s33, 458752
 v_mfma_f32_16x16x32_bf16 a[176:179], a[56:59], a[16:19], a[176:179]
 v_mfma_f32_16x16x32_bf16 a[180:183], a[56:59], a[20:23], a[180:183]
 s_add_u32 s31, s31, 128
 v_mfma_f32_16x16x32_bf16 a[184:187], a[56:59], a[24:27], a[184:187]
 v_mfma_f32_16x16x32_bf16 a[188:191], a[56:59], a[28:31], a[188:191]
 s_waitcnt vmcnt(17) lgkmcnt(0)
 s_barrier
 v_mfma_f32_16x16x32_bf16 v[0:3], a[92:95], a[60:63], v[0:3]
 ds_read_b64_tr_b16 a[32:33], v238
 v_mfma_f32_16x16x32_bf16 v[24:27], a[92:95], a[64:67], v[24:27]
 ds_read_b64_tr_b16 a[34:35], v238 offset:512
 v_mfma_f32_16x16x32_bf16 v[48:51], a[92:95], a[68:71], v[48:51]
 ds_read_b128 a[0:3], v236 offset:36864
 v_mfma_f32_16x16x32_bf16 v[72:75], a[92:95], a[72:75], v[72:75]
 ds_read_b128 a[4:7], v236 offset:38912
 v_mfma_f32_16x16x32_bf16 v[96:99], a[92:95], a[76:79], v[96:99]
 ds_read_b128 a[8:11], v236 offset:40960
 v_mfma_f32_16x16x32_bf16 v[120:123], a[92:95], a[80:83], v[120:123]
 ds_read_b128 a[12:15], v236 offset:43008
 v_mfma_f32_16x16x32_bf16 v[144:147], a[92:95], a[84:87], v[144:147]
 ds_read_b128 a[16:19], v236 offset:45056
 v_mfma_f32_16x16x32_bf16 v[168:171], a[92:95], a[88:91], v[168:171]
 ds_read_b128 a[20:23], v236 offset:47104
 v_mfma_f32_16x16x32_bf16 v[172:175], a[96:99], a[88:91], v[172:175]
 ds_read_b128 a[24:27], v236 offset:49152
 v_mfma_f32_16x16x32_bf16 v[148:151], a[96:99], a[84:87], v[148:151]
 ds_read_b128 a[28:31], v236 offset:51200
 v_mfma_f32_16x16x32_bf16 v[124:127], a[96:99], a[80:83], v[124:127]
 ds_read_b64_tr_b16 a[36:37], v239
 v_mfma_f32_16x16x32_bf16 v[100:103], a[96:99], a[76:79], v[100:103]
 ds_read_b64_tr_b16 a[38:39], v239 offset:512
 v_mfma_f32_16x16x32_bf16 v[76:79], a[96:99], a[72:75], v[76:79]
 ds_read_b64_tr_b16 a[40:41], v238 offset:1024
 v_mfma_f32_16x16x32_bf16 v[52:55], a[96:99], a[68:71], v[52:55]
 ds_read_b64_tr_b16 a[42:43], v238 offset:1536
 v_mfma_f32_16x16x32_bf16 v[28:31], a[96:99], a[64:67], v[28:31]
 ds_read_b64_tr_b16 a[44:45], v239 offset:1024
 v_mfma_f32_16x16x32_bf16 v[4:7], a[96:99], a[60:63], v[4:7]
 ds_read_b64_tr_b16 a[46:47], v239 offset:1536
 v_mfma_f32_16x16x32_bf16 v[8:11], a[100:103], a[60:63], v[8:11]
 ds_read_b64_tr_b16 a[48:49], v238 offset:2048
 v_mfma_f32_16x16x32_bf16 v[32:35], a[100:103], a[64:67], v[32:35]
 ds_read_b64_tr_b16 a[50:51], v238 offset:2560
 v_mfma_f32_16x16x32_bf16 v[56:59], a[100:103], a[68:71], v[56:59]
 ds_read_b64_tr_b16 a[52:53], v239 offset:2048
 v_mfma_f32_16x16x32_bf16 v[80:83], a[100:103], a[72:75], v[80:83]
 ds_read_b64_tr_b16 a[54:55], v239 offset:2560
 v_mfma_f32_16x16x32_bf16 v[104:107], a[100:103], a[76:79], v[104:107]
 ds_read_b64_tr_b16 a[56:57], v240 offset:36864
 v_mfma_f32_16x16x32_bf16 v[128:131], a[100:103], a[80:83], v[128:131]
 ds_read_b64_tr_b16 a[58:59], v240 offset:37120
 v_mfma_f32_16x16x32_bf16 v[152:155], a[100:103], a[84:87], v[152:155]
 s_add_u32 m0, s38, 36864
 v_mfma_f32_16x16x32_bf16 v[176:179], a[100:103], a[88:91], v[176:179]
 v_mfma_f32_16x16x32_bf16 v[180:183], a[104:107], a[88:91], v[180:183]
 buffer_load_dwordx4 v232, s[12:15], s32 offen lds
 v_mfma_f32_16x16x32_bf16 v[156:159], a[104:107], a[84:87], v[156:159]
 v_mfma_f32_16x16x32_bf16 v[132:135], a[104:107], a[80:83], v[132:135]
 v_mfma_f32_16x16x32_bf16 v[108:111], a[104:107], a[76:79], v[108:111]
 buffer_load_dwordx4 v233, s[12:15], s32 offen offset:1024 lds
 v_mfma_f32_16x16x32_bf16 v[84:87], a[104:107], a[72:75], v[84:87]
 v_mfma_f32_16x16x32_bf16 v[60:63], a[104:107], a[68:71], v[60:63]
 v_mfma_f32_16x16x32_bf16 v[36:39], a[104:107], a[64:67], v[36:39]
 buffer_load_dwordx4 v234, s[12:15], s32 offen offset:2048 lds
 v_mfma_f32_16x16x32_bf16 v[12:15], a[104:107], a[60:63], v[12:15]
 v_mfma_f32_16x16x32_bf16 v[16:19], a[108:111], a[60:63], v[16:19]
 v_mfma_f32_16x16x32_bf16 v[40:43], a[108:111], a[64:67], v[40:43]
 s_add_u32 s32, s32, 229376
 v_mfma_f32_16x16x32_bf16 v[64:67], a[108:111], a[68:71], v[64:67]
 v_mfma_f32_16x16x32_bf16 v[88:91], a[108:111], a[72:75], v[88:91]
 v_mfma_f32_16x16x32_bf16 v[112:115], a[108:111], a[76:79], v[112:115]
 s_add_u32 m0, s37, 0
 v_mfma_f32_16x16x32_bf16 v[136:139], a[108:111], a[80:83], v[136:139]
 v_mfma_f32_16x16x32_bf16 v[160:163], a[108:111], a[84:87], v[160:163]
 v_mfma_f32_16x16x32_bf16 v[184:187], a[108:111], a[88:91], v[184:187]
 buffer_load_dwordx4 v224, s[8:11], s31 offen lds
 v_mfma_f32_16x16x32_bf16 v[188:191], a[112:115], a[88:91], v[188:191]
 v_mfma_f32_16x16x32_bf16 v[164:167], a[112:115], a[84:87], v[164:167]
 buffer_load_dwordx4 v225, s[8:11], s31 offen offset:1024 lds
 v_mfma_f32_16x16x32_bf16 v[140:143], a[112:115], a[80:83], v[140:143]
 v_mfma_f32_16x16x32_bf16 v[116:119], a[112:115], a[76:79], v[116:119]
 v_mfma_f32_16x16x32_bf16 v[92:95], a[112:115], a[72:75], v[92:95]
 buffer_load_dwordx4 v226, s[8:11], s31 offen offset:2048 lds
 v_mfma_f32_16x16x32_bf16 v[68:71], a[112:115], a[68:71], v[68:71]
 v_mfma_f32_16x16x32_bf16 v[44:47], a[112:115], a[64:67], v[44:47]
 v_mfma_f32_16x16x32_bf16 v[20:23], a[112:115], a[60:63], v[20:23]
 buffer_load_dwordx4 v227, s[8:11], s31 offen offset:3072 lds
 v_mfma_f32_16x16x32_bf16 a[160:163], a[116:119], a[60:63], a[160:163]
 v_mfma_f32_16x16x32_bf16 a[164:167], a[116:119], a[64:67], a[164:167]
 v_mfma_f32_16x16x32_bf16 a[168:171], a[116:119], a[68:71], a[168:171]
 s_add_u32 s24, s24, 2097152
 v_mfma_f32_16x16x32_bf16 a[172:175], a[116:119], a[72:75], a[172:175]
 v_mfma_f32_16x16x32_bf16 a[176:179], a[116:119], a[76:79], a[176:179]
 v_mfma_f32_16x16x32_bf16 a[180:183], a[116:119], a[80:83], a[180:183]
 buffer_load_dword v251, v250, s[20:23], s24 offen
 v_mfma_f32_16x16x32_bf16 a[184:187], a[116:119], a[84:87], a[184:187]
 v_mfma_f32_16x16x32_bf16 a[188:191], a[116:119], a[88:91], a[188:191]
 s_waitcnt vmcnt(22) lgkmcnt(0)
 s_barrier
 v_mfma_f32_16x16x32_bf16 v[0:3], a[32:35], a[0:3], v[0:3]
 ds_read_b64_tr_b16 a[92:93], v238 offset:12288
 v_mfma_f32_16x16x32_bf16 v[24:27], a[32:35], a[4:7], v[24:27]
 ds_read_b64_tr_b16 a[94:95], v238 offset:12800
 v_mfma_f32_16x16x32_bf16 v[48:51], a[32:35], a[8:11], v[48:51]
 ds_read_b128 a[60:63], v237 offset:36864
 v_mfma_f32_16x16x32_bf16 v[72:75], a[32:35], a[12:15], v[72:75]
 ds_read_b128 a[64:67], v237 offset:38912
 v_mfma_f32_16x16x32_bf16 v[96:99], a[32:35], a[16:19], v[96:99]
 ds_read_b128 a[68:71], v237 offset:40960
 v_mfma_f32_16x16x32_bf16 v[120:123], a[32:35], a[20:23], v[120:123]
 ds_read_b128 a[72:75], v237 offset:43008
 v_mfma_f32_16x16x32_bf16 v[144:147], a[32:35], a[24:27], v[144:147]
 ds_read_b128 a[76:79], v237 offset:45056
 v_mfma_f32_16x16x32_bf16 v[168:171], a[32:35], a[28:31], v[168:171]
 ds_read_b128 a[80:83], v237 offset:47104
 v_mfma_f32_16x16x32_bf16 v[172:175], a[36:39], a[28:31], v[172:175]
 ds_read_b128 a[84:87], v237 offset:49152
 v_mfma_f32_16x16x32_bf16 v[148:151], a[36:39], a[24:27], v[148:151]
 ds_read_b128 a[88:91], v237 offset:51200
 v_mfma_f32_16x16x32_bf16 v[124:127], a[36:39], a[20:23], v[124:127]
 ds_read_b64_tr_b16 a[96:97], v239 offset:12288
 v_mfma_f32_16x16x32_bf16 v[100:103], a[36:39], a[16:19], v[100:103]
 ds_read_b64_tr_b16 a[98:99], v239 offset:12800
 v_mfma_f32_16x16x32_bf16 v[76:79], a[36:39], a[12:15], v[76:79]
 ds_read_b64_tr_b16 a[100:101], v238 offset:13312
 v_mfma_f32_16x16x32_bf16 v[52:55], a[36:39], a[8:11], v[52:55]
 ds_read_b64_tr_b16 a[102:103], v238 offset:13824
 v_mfma_f32_16x16x32_bf16 v[28:31], a[36:39], a[4:7], v[28:31]
 ds_read_b64_tr_b16 a[104:105], v239 offset:13312
 v_mfma_f32_16x16x32_bf16 v[4:7], a[36:39], a[0:3], v[4:7]
 ds_read_b64_tr_b16 a[106:107], v239 offset:13824
 v_mfma_f32_16x16x32_bf16 v[8:11], a[40:43], a[0:3], v[8:11]
 ds_read_b64_tr_b16 a[108:109], v238 offset:14336
 v_mfma_f32_16x16x32_bf16 v[32:35], a[40:43], a[4:7], v[32:35]
 ds_read_b64_tr_b16 a[110:111], v238 offset:14848
 v_mfma_f32_16x16x32_bf16 v[56:59], a[40:43], a[8:11], v[56:59]
 ds_read_b64_tr_b16 a[112:113], v239 offset:14336
 v_mfma_f32_16x16x32_bf16 v[80:83], a[40:43], a[12:15], v[80:83]
 ds_read_b64_tr_b16 a[114:115], v239 offset:14848
 v_mfma_f32_16x16x32_bf16 v[104:107], a[40:43], a[16:19], v[104:107]
 ds_read_b64_tr_b16 a[116:117], v240 offset:38912
 v_mfma_f32_16x16x32_bf16 v[128:131], a[40:43], a[20:23], v[128:131]
 ds_read_b64_tr_b16 a[118:119], v240 offset:39168
 v_mfma_f32_16x16x32_bf16 v[152:155], a[40:43], a[24:27], v[152:155]
 s_add_u32 m0, s38, 0
 v_mfma_f32_16x16x32_bf16 v[176:179], a[40:43], a[28:31], v[176:179]
 v_mfma_f32_16x16x32_bf16 v[180:183], a[44:47], a[28:31], v[180:183]
 buffer_load_dwordx4 v232, s[12:15], s32 offen lds
 v_mfma_f32_16x16x32_bf16 v[156:159], a[44:47], a[24:27], v[156:159]
 v_mfma_f32_16x16x32_bf16 v[132:135], a[44:47], a[20:23], v[132:135]
 buffer_load_dwordx4 v233, s[12:15], s32 offen offset:1024 lds
 v_mfma_f32_16x16x32_bf16 v[108:111], a[44:47], a[16:19], v[108:111]
 v_mfma_f32_16x16x32_bf16 v[84:87], a[44:47], a[12:15], v[84:87]
 v_mfma_f32_16x16x32_bf16 v[60:63], a[44:47], a[8:11], v[60:63]
 buffer_load_dwordx4 v234, s[12:15], s32 offen offset:2048 lds
 v_mfma_f32_16x16x32_bf16 v[36:39], a[44:47], a[4:7], v[36:39]
 v_mfma_f32_16x16x32_bf16 v[12:15], a[44:47], a[0:3], v[12:15]
 s_add_u32 s32, s32, 229376
 v_mfma_f32_16x16x32_bf16 v[16:19], a[48:51], a[0:3], v[16:19]
 v_mfma_f32_16x16x32_bf16 v[40:43], a[48:51], a[4:7], v[40:43]
 v_mfma_f32_16x16x32_bf16 v[64:67], a[48:51], a[8:11], v[64:67]
 s_add_u32 m0, s37, 4096
 v_mfma_f32_16x16x32_bf16 v[88:91], a[48:51], a[12:15], v[88:91]
 v_mfma_f32_16x16x32_bf16 v[112:115], a[48:51], a[16:19], v[112:115]
 buffer_load_dwordx4 v228, s[8:11], s31 offen lds
 v_mfma_f32_16x16x32_bf16 v[136:139], a[48:51], a[20:23], v[136:139]
 v_mfma_f32_16x16x32_bf16 v[160:163], a[48:51], a[24:27], v[160:163]
 v_mfma_f32_16x16x32_bf16 v[184:187], a[48:51], a[28:31], v[184:187]
 buffer_load_dwordx4 v229, s[8:11], s31 offen offset:1024 lds
 v_mfma_f32_16x16x32_bf16 v[188:191], a[52:55], a[28:31], v[188:191]
 v_mfma_f32_16x16x32_bf16 v[164:167], a[52:55], a[24:27], v[164:167]
 buffer_load_dwordx4 v230, s[8:11], s31 offen offset:2048 lds
 v_mfma_f32_16x16x32_bf16 v[140:143], a[52:55], a[20:23], v[140:143]
 v_mfma_f32_16x16x32_bf16 v[116:119], a[52:55], a[16:19], v[116:119]
 buffer_load_dwordx4 v231, s[8:11], s31 offen offset:3072 lds
 v_mfma_f32_16x16x32_bf16 v[92:95], a[52:55], a[12:15], v[92:95]
 v_mfma_f32_16x16x32_bf16 v[68:71], a[52:55], a[8:11], v[68:71]
 v_mfma_f32_16x16x32_bf16 v[44:47], a[52:55], a[4:7], v[44:47]
 s_add_u32 m0, s42, 0
 v_mfma_f32_16x16x32_bf16 v[20:23], a[52:55], a[0:3], v[20:23]
 v_mfma_f32_16x16x32_bf16 a[160:163], a[56:59], a[0:3], a[160:163]
 buffer_load_dwordx4 v235, s[12:15], s33 offen lds
 v_mfma_f32_16x16x32_bf16 a[164:167], a[56:59], a[4:7], a[164:167]
 v_mfma_f32_16x16x32_bf16 a[168:171], a[56:59], a[8:11], a[168:171]
 v_mfma_f32_16x16x32_bf16 a[172:175], a[56:59], a[12:15], a[172:175]
 s_add_u32 s33, s33, 458752
 v_mfma_f32_16x16x32_bf16 a[176:179], a[56:59], a[16:19], a[176:179]
 v_mfma_f32_16x16x32_bf16 a[180:183], a[56:59], a[20:23], a[180:183]
 s_add_u32 s31, s31, 128
 v_mfma_f32_16x16x32_bf16 a[184:187], a[56:59], a[24:27], a[184:187]
 v_mfma_f32_16x16x32_bf16 a[188:191], a[56:59], a[28:31], a[188:191]
 s_waitcnt vmcnt(16) lgkmcnt(0)
 s_barrier
 v_mfma_f32_16x16x32_bf16 v[0:3], a[92:95], a[60:63], v[0:3]
 ds_read_b64_tr_b16 a[32:33], v238 offset:24576
 v_mfma_f32_16x16x32_bf16 v[24:27], a[92:95], a[64:67], v[24:27]
 ds_read_b64_tr_b16 a[34:35], v238 offset:25088
 v_mfma_f32_16x16x32_bf16 v[48:51], a[92:95], a[68:71], v[48:51]
 ds_read_b128 a[0:3], v241
 v_mfma_f32_16x16x32_bf16 v[72:75], a[92:95], a[72:75], v[72:75]
 ds_read_b128 a[4:7], v241 offset:2048
 v_mfma_f32_16x16x32_bf16 v[96:99], a[92:95], a[76:79], v[96:99]
 ds_read_b128 a[8:11], v241 offset:4096
 v_mfma_f32_16x16x32_bf16 v[120:123], a[92:95], a[80:83], v[120:123]
 ds_read_b128 a[12:15], v241 offset:6144
 v_mfma_f32_16x16x32_bf16 v[144:147], a[92:95], a[84:87], v[144:147]
 ds_read_b128 a[16:19], v241 offset:8192
 v_mfma_f32_16x16x32_bf16 v[168:171], a[92:95], a[88:91], v[168:171]
 ds_read_b128 a[20:23], v241 offset:10240
 v_mfma_f32_16x16x32_bf16 v[172:175], a[96:99], a[88:91], v[172:175]
 ds_read_b128 a[24:27], v241 offset:12288
 v_mfma_f32_16x16x32_bf16 v[148:151], a[96:99], a[84:87], v[148:151]
 ds_read_b128 a[28:31], v241 offset:14336
 v_mfma_f32_16x16x32_bf16 v[124:127], a[96:99], a[80:83], v[124:127]
 ds_read_b64_tr_b16 a[36:37], v239 offset:24576
 v_mfma_f32_16x16x32_bf16 v[100:103], a[96:99], a[76:79], v[100:103]
 ds_read_b64_tr_b16 a[38:39], v239 offset:25088
 v_mfma_f32_16x16x32_bf16 v[76:79], a[96:99], a[72:75], v[76:79]
 ds_read_b64_tr_b16 a[40:41], v238 offset:25600
 v_mfma_f32_16x16x32_bf16 v[52:55], a[96:99], a[68:71], v[52:55]
 ds_read_b64_tr_b16 a[42:43], v238 offset:26112
 v_mfma_f32_16x16x32_bf16 v[28:31], a[96:99], a[64:67], v[28:31]
 ds_read_b64_tr_b16 a[44:45], v239 offset:25600
 v_mfma_f32_16x16x32_bf16 v[4:7], a[96:99], a[60:63], v[4:7]
 ds_read_b64_tr_b16 a[46:47], v239 offset:26112
 v_mfma_f32_16x16x32_bf16 v[8:11], a[100:103], a[60:63], v[8:11]
 ds_read_b64_tr_b16 a[48:49], v238 offset:26624
 v_mfma_f32_16x16x32_bf16 v[32:35], a[100:103], a[64:67], v[32:35]
 ds_read_b64_tr_b16 a[50:51], v238 offset:27136
 v_mfma_f32_16x16x32_bf16 v[56:59], a[100:103], a[68:71], v[56:59]
 ds_read_b64_tr_b16 a[52:53], v239 offset:26624
 v_mfma_f32_16x16x32_bf16 v[80:83], a[100:103], a[72:75], v[80:83]
 ds_read_b64_tr_b16 a[54:55], v239 offset:27136
 v_mfma_f32_16x16x32_bf16 v[104:107], a[100:103], a[76:79], v[104:107]
 ds_read_b64_tr_b16 a[56:57], v243
 v_mfma_f32_16x16x32_bf16 v[128:131], a[100:103], a[80:83], v[128:131]
 ds_read_b64_tr_b16 a[58:59], v243 offset:256
 v_mfma_f32_16x16x32_bf16 v[152:155], a[100:103], a[84:87], v[152:155]
 s_add_u32 m0, s38, 12288
 v_mfma_f32_16x16x32_bf16 v[176:179], a[100:103], a[88:91], v[176:179]
 v_mfma_f32_16x16x32_bf16 v[180:183], a[104:107], a[88:91], v[180:183]
 buffer_load_dwordx4 v232, s[12:15], s32 offen lds
 v_mfma_f32_16x16x32_bf16 v[156:159], a[104:107], a[84:87], v[156:159]
 v_mfma_f32_16x16x32_bf16 v[132:135], a[104:107], a[80:83], v[132:135]
 buffer_load_dwordx4 v233, s[12:15], s32 offen offset:1024 lds
 v_mfma_f32_16x16x32_bf16 v[108:111], a[104:107], a[76:79], v[108:111]
 v_mfma_f32_16x16x32_bf16 v[84:87], a[104:107], a[72:75], v[84:87]
 buffer_load_dwordx4 v234, s[12:15], s32 offen offset:2048 lds
 v_mfma_f32_16x16x32_bf16 v[60:63], a[104:107], a[68:71], v[60:63]
 v_mfma_f32_16x16x32_bf16 v[36:39], a[104:107], a[64:67], v[36:39]
 v_mfma_f32_16x16x32_bf16 v[12:15], a[104:107], a[60:63], v[12:15]
 s_add_u32 s32, s32, 229376
 v_mfma_f32_16x16x32_bf16 v[16:19], a[108:111], a[60:63], v[16:19]
 v_mfma_f32_16x16x32_bf16 v[40:43], a[108:111], a[64:67], v[40:43]
 s_add_u32 m0, s37, 36864
 v_mfma_f32_16x16x32_bf16 v[64:67], a[108:111], a[68:71], v[64:67]
 v_mfma_f32_16x16x32_bf16 v[88:91], a[108:111], a[72:75], v[88:91]
 buffer_load_dwordx4 v224, s[8:11], s31 offen lds
 v_mfma_f32_16x16x32_bf16 v[112:115], a[108:111], a[76:79], v[112:115]
 v_mfma_f32_16x16x32_bf16 v[136:139], a[108:111], a[80:83], v[136:139]
 buffer_load_dwordx4 v225, s[8:11], s31 offen offset:1024 lds
 v_mfma_f32_16x16x32_bf16 v[160:163], a[108:111], a[84:87], v[160:163]
 v_mfma_f32_16x16x32_bf16 v[184:187], a[108:111], a[88:91], v[184:187]
 v_mfma_f32_16x16x32_bf16 v[188:191], a[112:115], a[88:91], v[188:191]
 buffer_load_dwordx4 v226, s[8:11], s31 offen offset:2048 lds
 v_mfma_f32_16x16x32_bf16 v[164:167], a[112:115], a[84:87], v[164:167]
 v_mfma_f32_16x16x32_bf16 v[140:143], a[112:115], a[80:83], v[140:143]
 buffer_load_dwordx4 v227, s[8:11], s31 offen offset:3072 lds
 v_mfma_f32_16x16x32_bf16 v[116:119], a[112:115], a[76:79], v[116:119]
 v_mfma_f32_16x16x32_bf16 v[92:95], a[112:115], a[72:75], v[92:95]
 s_mov_b32 s20, s54
 v_mfma_f32_16x16x32_bf16 v[68:71], a[112:115], a[68:71], v[68:71]
 v_mfma_f32_16x16x32_bf16 v[44:47], a[112:115], a[64:67], v[44:47]
 s_mov_b32 s21, s55
 v_mfma_f32_16x16x32_bf16 v[20:23], a[112:115], a[60:63], v[20:23]
 v_mfma_f32_16x16x32_bf16 a[160:163], a[116:119], a[60:63], a[160:163]
 v_mfma_f32_16x16x32_bf16 a[164:167], a[116:119], a[64:67], a[164:167]
 s_mov_b32 s22, 0x200000
 v_mfma_f32_16x16x32_bf16 a[168:171], a[116:119], a[68:71], a[168:171]
 v_mfma_f32_16x16x32_bf16 a[172:175], a[116:119], a[72:75], a[172:175]
 s_mov_b32 s24, s26
 v_mfma_f32_16x16x32_bf16 a[176:179], a[116:119], a[76:79], a[176:179]
 v_mfma_f32_16x16x32_bf16 a[180:183], a[116:119], a[80:83], a[180:183]
 buffer_load_dword v251, v250, s[20:23], s24 offen
 v_mfma_f32_16x16x32_bf16 a[184:187], a[116:119], a[84:87], a[184:187]
 v_mfma_f32_16x16x32_bf16 a[188:191], a[116:119], a[88:91], a[188:191]
 s_waitcnt vmcnt(21) lgkmcnt(0)
 s_barrier
 v_mfma_f32_16x16x32_bf16 v[0:3], a[32:35], a[0:3], v[0:3]
 ds_read_b64_tr_b16 a[92:93], v238 offset:36864
 v_mfma_f32_16x16x32_bf16 v[24:27], a[32:35], a[4:7], v[24:27]
 ds_read_b64_tr_b16 a[94:95], v238 offset:37376
 v_mfma_f32_16x16x32_bf16 v[48:51], a[32:35], a[8:11], v[48:51]
 ds_read_b128 a[60:63], v242
 v_mfma_f32_16x16x32_bf16 v[72:75], a[32:35], a[12:15], v[72:75]
 ds_read_b128 a[64:67], v242 offset:2048
 v_mfma_f32_16x16x32_bf16 v[96:99], a[32:35], a[16:19], v[96:99]
 ds_read_b128 a[68:71], v242 offset:4096
 v_mfma_f32_16x16x32_bf16 v[120:123], a[32:35], a[20:23], v[120:123]
 ds_read_b128 a[72:75], v242 offset:6144
 v_mfma_f32_16x16x32_bf16 v[144:147], a[32:35], a[24:27], v[144:147]
 ds_read_b128 a[76:79], v242 offset:8192
 v_mfma_f32_16x16x32_bf16 v[168:171], a[32:35], a[28:31], v[168:171]
 ds_read_b128 a[80:83], v242 offset:10240
 v_mfma_f32_16x16x32_bf16 v[172:175], a[36:39], a[28:31], v[172:175]
 ds_read_b128 a[84:87], v242 offset:12288
 v_mfma_f32_16x16x32_bf16 v[148:151], a[36:39], a[24:27], v[148:151]
 ds_read_b128 a[88:91], v242 offset:14336
 v_mfma_f32_16x16x32_bf16 v[124:127], a[36:39], a[20:23], v[124:127]
 ds_read_b64_tr_b16 a[96:97], v239 offset:36864
 v_mfma_f32_16x16x32_bf16 v[100:103], a[36:39], a[16:19], v[100:103]
 ds_read_b64_tr_b16 a[98:99], v239 offset:37376
 v_mfma_f32_16x16x32_bf16 v[76:79], a[36:39], a[12:15], v[76:79]
 ds_read_b64_tr_b16 a[100:101], v238 offset:37888
 v_mfma_f32_16x16x32_bf16 v[52:55], a[36:39], a[8:11], v[52:55]
 ds_read_b64_tr_b16 a[102:103], v238 offset:38400
 v_mfma_f32_16x16x32_bf16 v[28:31], a[36:39], a[4:7], v[28:31]
 ds_read_b64_tr_b16 a[104:105], v239 offset:37888
 v_mfma_f32_16x16x32_bf16 v[4:7], a[36:39], a[0:3], v[4:7]
 ds_read_b64_tr_b16 a[106:107], v239 offset:38400
 v_mfma_f32_16x16x32_bf16 v[8:11], a[40:43], a[0:3], v[8:11]
 ds_read_b64_tr_b16 a[108:109], v238 offset:38912
 v_mfma_f32_16x16x32_bf16 v[32:35], a[40:43], a[4:7], v[32:35]
 ds_read_b64_tr_b16 a[110:111], v238 offset:39424
 v_mfma_f32_16x16x32_bf16 v[56:59], a[40:43], a[8:11], v[56:59]
 ds_read_b64_tr_b16 a[112:113], v239 offset:38912
 s_lshl_b32 s6, s41, 13
 v_mfma_f32_16x16x32_bf16 v[80:83], a[40:43], a[12:15], v[80:83]
 ds_read_b64_tr_b16 a[114:115], v239 offset:39424
 s_lshl_b32 s3, s40, 4
 v_mfma_f32_16x16x32_bf16 v[104:107], a[40:43], a[16:19], v[104:107]
 ds_read_b64_tr_b16 a[116:117], v243 offset:2048
 s_lshl_b32 s7, s29, 3
 v_mfma_f32_16x16x32_bf16 v[128:131], a[40:43], a[20:23], v[128:131]
 ds_read_b64_tr_b16 a[118:119], v243 offset:2304
 s_add_u32 s3, s3, s7
 v_mfma_f32_16x16x32_bf16 v[152:155], a[40:43], a[24:27], v[152:155]
 s_add_u32 m0, s38, 24576
 v_mfma_f32_16x16x32_bf16 v[176:179], a[40:43], a[28:31], v[176:179]
 s_mul_i32 s3, s3, 172032
 v_mfma_f32_16x16x32_bf16 v[180:183], a[44:47], a[28:31], v[180:183]
 buffer_load_dwordx4 v232, s[12:15], s32 offen lds
 v_mfma_f32_16x16x32_bf16 v[156:159], a[44:47], a[24:27], v[156:159]
 s_add_u32 s6, s6, s3
 v_mfma_f32_16x16x32_bf16 v[132:135], a[44:47], a[20:23], v[132:135]
 buffer_load_dwordx4 v233, s[12:15], s32 offen offset:1024 lds
 v_mfma_f32_16x16x32_bf16 v[108:111], a[44:47], a[16:19], v[108:111]
 s_mov_b32 s3, 172032
 v_mfma_f32_16x16x32_bf16 v[84:87], a[44:47], a[12:15], v[84:87]
 v_mul_u32_u24_e64 v247, s3, v255
 v_mfma_f32_16x16x32_bf16 v[60:63], a[44:47], a[8:11], v[60:63]
 buffer_load_dwordx4 v234, s[12:15], s32 offen offset:2048 lds
 v_mfma_f32_16x16x32_bf16 v[36:39], a[44:47], a[4:7], v[36:39]
 v_add_u32_e64 v247, s6, v247
 v_mfma_f32_16x16x32_bf16 v[12:15], a[44:47], a[0:3], v[12:15]
 s_add_u32 s32, s32, 229376
 v_mfma_f32_16x16x32_bf16 v[16:19], a[48:51], a[0:3], v[16:19]
 v_bfe_u32 v246, v255, 1, 2
 v_mfma_f32_16x16x32_bf16 v[40:43], a[48:51], a[4:7], v[40:43]
 v_mul_u32_u24_e64 v246, s3, v246
 v_mfma_f32_16x16x32_bf16 v[64:67], a[48:51], a[8:11], v[64:67]
 s_add_u32 m0, s37, 40960
 v_mfma_f32_16x16x32_bf16 v[88:91], a[48:51], a[12:15], v[88:91]
 v_and_b32_e64 v245, 1, v255
 v_mfma_f32_16x16x32_bf16 v[112:115], a[48:51], a[16:19], v[112:115]
 buffer_load_dwordx4 v228, s[8:11], s31 offen lds
 v_mfma_f32_16x16x32_bf16 v[136:139], a[48:51], a[20:23], v[136:139]
 v_lshl_add_u32 v246, v245, 14, v246
 v_mfma_f32_16x16x32_bf16 v[160:163], a[48:51], a[24:27], v[160:163]
 s_lshl_b32 s6, s40, 4
 v_mfma_f32_16x16x32_bf16 v[184:187], a[48:51], a[28:31], v[184:187]
 buffer_load_dwordx4 v229, s[8:11], s31 offen offset:1024 lds
 v_mfma_f32_16x16x32_bf16 v[188:191], a[52:55], a[28:31], v[188:191]
 s_lshl_b32 s7, s28, 2
 v_mfma_f32_16x16x32_bf16 v[164:167], a[52:55], a[24:27], v[164:167]
 buffer_load_dwordx4 v230, s[8:11], s31 offen offset:2048 lds
 v_mfma_f32_16x16x32_bf16 v[140:143], a[52:55], a[20:23], v[140:143]
 s_add_u32 s6, s6, s7
 v_mfma_f32_16x16x32_bf16 v[116:119], a[52:55], a[16:19], v[116:119]
 buffer_load_dwordx4 v231, s[8:11], s31 offen offset:3072 lds
 v_mfma_f32_16x16x32_bf16 v[92:95], a[52:55], a[12:15], v[92:95]
 s_mul_i32 s6, s6, 172032
 v_mfma_f32_16x16x32_bf16 v[68:71], a[52:55], a[8:11], v[68:71]
 s_lshl_b32 s7, s39, 15
 v_mfma_f32_16x16x32_bf16 v[44:47], a[52:55], a[4:7], v[44:47]
 s_add_u32 m0, s42, 36864
 v_mfma_f32_16x16x32_bf16 v[20:23], a[52:55], a[0:3], v[20:23]
 s_add_u32 s6, s6, s7
 v_mfma_f32_16x16x32_bf16 a[160:163], a[56:59], a[0:3], a[160:163]
 buffer_load_dwordx4 v235, s[12:15], s33 offen lds
 v_mfma_f32_16x16x32_bf16 a[164:167], a[56:59], a[4:7], a[164:167]
 v_add_u32 v246, s6, v246
 v_mfma_f32_16x16x32_bf16 a[168:171], a[56:59], a[8:11], a[168:171]
 v_cmp_gt_u32 vcc, 8, v255
 v_mfma_f32_16x16x32_bf16 a[172:175], a[56:59], a[12:15], a[172:175]
 s_add_u32 s33, s33, 458752
 v_mfma_f32_16x16x32_bf16 a[176:179], a[56:59], a[16:19], a[176:179]
 v_lshrrev_b32 v245, 4, v255
 v_mfma_f32_16x16x32_bf16 a[180:183], a[56:59], a[20:23], a[180:183]
 s_add_u32 s31, s31, 128
 v_mfma_f32_16x16x32_bf16 a[184:187], a[56:59], a[24:27], a[184:187]
 v_cndmask_b32_e64 v247, v246, v247, vcc
 v_mfma_f32_16x16x32_bf16 a[188:191], a[56:59], a[28:31], a[188:191]
 v_lshl_add_u32 v247, v245, 28, v247
 s_waitcnt vmcnt(16) lgkmcnt(0)
 s_barrier
 v_mfma_f32_16x16x32_bf16 v[0:3], a[92:95], a[60:63], v[0:3]
 ds_read_b64_tr_b16 a[32:33], v238
 v_mfma_f32_16x16x32_bf16 v[24:27], a[92:95], a[64:67], v[24:27]
 ds_read_b64_tr_b16 a[34:35], v238 offset:512
 v_mfma_f32_16x16x32_bf16 v[48:51], a[92:95], a[68:71], v[48:51]
 ds_read_b128 a[0:3], v236
 v_mfma_f32_16x16x32_bf16 v[72:75], a[92:95], a[72:75], v[72:75]
 ds_read_b128 a[4:7], v236 offset:2048
 v_mfma_f32_16x16x32_bf16 v[96:99], a[92:95], a[76:79], v[96:99]
 ds_read_b128 a[8:11], v236 offset:4096
 v_mfma_f32_16x16x32_bf16 v[120:123], a[92:95], a[80:83], v[120:123]
 ds_read_b128 a[12:15], v236 offset:6144
 v_mfma_f32_16x16x32_bf16 v[144:147], a[92:95], a[84:87], v[144:147]
 ds_read_b128 a[16:19], v236 offset:8192
 v_mfma_f32_16x16x32_bf16 v[168:171], a[92:95], a[88:91], v[168:171]
 ds_read_b128 a[20:23], v236 offset:10240
 v_mfma_f32_16x16x32_bf16 v[172:175], a[96:99], a[88:91], v[172:175]
 ds_read_b128 a[24:27], v236 offset:12288
 v_mfma_f32_16x16x32_bf16 v[148:151], a[96:99], a[84:87], v[148:151]
 ds_read_b128 a[28:31], v236 offset:14336
 v_mfma_f32_16x16x32_bf16 v[124:127], a[96:99], a[80:83], v[124:127]
 ds_read_b64_tr_b16 a[36:37], v239
 v_mfma_f32_16x16x32_bf16 v[100:103], a[96:99], a[76:79], v[100:103]
 ds_read_b64_tr_b16 a[38:39], v239 offset:512
 v_mfma_f32_16x16x32_bf16 v[76:79], a[96:99], a[72:75], v[76:79]
 ds_read_b64_tr_b16 a[40:41], v238 offset:1024
 v_mfma_f32_16x16x32_bf16 v[52:55], a[96:99], a[68:71], v[52:55]
 ds_read_b64_tr_b16 a[42:43], v238 offset:1536
 v_mfma_f32_16x16x32_bf16 v[28:31], a[96:99], a[64:67], v[28:31]
 ds_read_b64_tr_b16 a[44:45], v239 offset:1024
 v_mfma_f32_16x16x32_bf16 v[4:7], a[96:99], a[60:63], v[4:7]
 ds_read_b64_tr_b16 a[46:47], v239 offset:1536
 v_mfma_f32_16x16x32_bf16 v[8:11], a[100:103], a[60:63], v[8:11]
 ds_read_b64_tr_b16 a[48:49], v238 offset:2048
 v_mfma_f32_16x16x32_bf16 v[32:35], a[100:103], a[64:67], v[32:35]
 ds_read_b64_tr_b16 a[50:51], v238 offset:2560
 v_mfma_f32_16x16x32_bf16 v[56:59], a[100:103], a[68:71], v[56:59]
 ds_read_b64_tr_b16 a[52:53], v239 offset:2048
 v_mfma_f32_16x16x32_bf16 v[80:83], a[100:103], a[72:75], v[80:83]
 ds_read_b64_tr_b16 a[54:55], v239 offset:2560
 v_mfma_f32_16x16x32_bf16 v[104:107], a[100:103], a[76:79], v[104:107]
 ds_read_b64_tr_b16 a[56:57], v240
 v_mfma_f32_16x16x32_bf16 v[128:131], a[100:103], a[80:83], v[128:131]
 ds_read_b64_tr_b16 a[58:59], v240 offset:256
 v_mfma_f32_16x16x32_bf16 v[152:155], a[100:103], a[84:87], v[152:155]
 s_add_u32 m0, s38, 36864
 v_mfma_f32_16x16x32_bf16 v[176:179], a[100:103], a[88:91], v[176:179]
 v_min_u32_e64 v196, 8, v255
 v_mfma_f32_16x16x32_bf16 v[180:183], a[104:107], a[88:91], v[180:183]
 v_mfma_f32_16x16x32_bf16 v[156:159], a[104:107], a[84:87], v[156:159]
 buffer_load_dwordx4 v232, s[12:15], s32 offen lds
 v_mfma_f32_16x16x32_bf16 v[132:135], a[104:107], a[80:83], v[132:135]
 s_lshl_b32 s3, s81, 4
 v_mfma_f32_16x16x32_bf16 v[108:111], a[104:107], a[76:79], v[108:111]
 v_mfma_f32_16x16x32_bf16 v[84:87], a[104:107], a[72:75], v[84:87]
 buffer_load_dwordx4 v233, s[12:15], s32 offen offset:1024 lds
 v_mfma_f32_16x16x32_bf16 v[60:63], a[104:107], a[68:71], v[60:63]
 v_mfma_f32_16x16x32_bf16 v[36:39], a[104:107], a[64:67], v[36:39]
 s_add_u32 s3, s3, s41
 v_mfma_f32_16x16x32_bf16 v[12:15], a[104:107], a[60:63], v[12:15]
 buffer_load_dwordx4 v234, s[12:15], s32 offen offset:2048 lds
 v_mfma_f32_16x16x32_bf16 v[16:19], a[108:111], a[60:63], v[16:19]
 v_mfma_f32_16x16x32_bf16 v[40:43], a[108:111], a[64:67], v[40:43]
 s_add_u32 s3, s3, 24
 v_mfma_f32_16x16x32_bf16 v[64:67], a[108:111], a[68:71], v[64:67]
 s_add_u32 s32, s32, 229376
 v_mfma_f32_16x16x32_bf16 v[88:91], a[108:111], a[72:75], v[88:91]
 v_mfma_f32_16x16x32_bf16 v[112:115], a[108:111], a[76:79], v[112:115]
 v_mfma_f32_16x16x32_bf16 v[136:139], a[108:111], a[80:83], v[136:139]
 s_add_u32 m0, s37, 73728
 v_mfma_f32_16x16x32_bf16 v[160:163], a[108:111], a[84:87], v[160:163]
 v_lshrrev_b32 v197, 3, v196
 v_mfma_f32_16x16x32_bf16 v[184:187], a[108:111], a[88:91], v[184:187]
 v_mfma_f32_16x16x32_bf16 v[188:191], a[112:115], a[88:91], v[188:191]
 buffer_load_dwordx4 v224, s[8:11], s31 offen lds
 v_mfma_f32_16x16x32_bf16 v[164:167], a[112:115], a[84:87], v[164:167]
 v_mad_u32_u24 v196, v197, s3, v196
 v_mfma_f32_16x16x32_bf16 v[140:143], a[112:115], a[80:83], v[140:143]
 v_mfma_f32_16x16x32_bf16 v[116:119], a[112:115], a[76:79], v[116:119]
 buffer_load_dwordx4 v225, s[8:11], s31 offen offset:1024 lds
 v_mfma_f32_16x16x32_bf16 v[92:95], a[112:115], a[72:75], v[92:95]
 v_mfma_f32_16x16x32_bf16 v[68:71], a[112:115], a[68:71], v[68:71]
 v_mul_u32_u24_e64 v197, 24, v197
 v_mfma_f32_16x16x32_bf16 v[44:47], a[112:115], a[64:67], v[44:47]
 buffer_load_dwordx4 v226, s[8:11], s31 offen offset:2048 lds
 v_mfma_f32_16x16x32_bf16 v[20:23], a[112:115], a[60:63], v[20:23]
 v_mfma_f32_16x16x32_bf16 a[160:163], a[116:119], a[60:63], a[160:163]
 v_lshlrev_b32_e64 v196, 2, v196
 v_mfma_f32_16x16x32_bf16 a[164:167], a[116:119], a[64:67], a[164:167]
 buffer_load_dwordx4 v227, s[8:11], s31 offen offset:3072 lds
 v_mfma_f32_16x16x32_bf16 a[168:171], a[116:119], a[68:71], a[168:171]
 v_mfma_f32_16x16x32_bf16 a[172:175], a[116:119], a[72:75], a[172:175]
 v_mfma_f32_16x16x32_bf16 a[176:179], a[116:119], a[76:79], a[176:179]
 buffer_load_dword v251, v247, s[16:19], 0 offen offset:384
 v_mfma_f32_16x16x32_bf16 a[180:183], a[116:119], a[80:83], a[180:183]
 v_sub_u32_e64 v197, 32, v197
 v_mfma_f32_16x16x32_bf16 a[184:187], a[116:119], a[84:87], a[184:187]
 v_mfma_f32_16x16x32_bf16 a[188:191], a[116:119], a[88:91], a[188:191]
 s_waitcnt vmcnt(21) lgkmcnt(0)
 s_barrier
 v_mfma_f32_16x16x32_bf16 v[0:3], a[32:35], a[0:3], v[0:3]
 ds_read_b64_tr_b16 a[92:93], v238 offset:12288
 v_mfma_f32_16x16x32_bf16 v[24:27], a[32:35], a[4:7], v[24:27]
 ds_read_b64_tr_b16 a[94:95], v238 offset:12800
 v_mfma_f32_16x16x32_bf16 v[48:51], a[32:35], a[8:11], v[48:51]
 ds_read_b128 a[60:63], v237
 v_mfma_f32_16x16x32_bf16 v[72:75], a[32:35], a[12:15], v[72:75]
 ds_read_b128 a[64:67], v237 offset:2048
 v_mfma_f32_16x16x32_bf16 v[96:99], a[32:35], a[16:19], v[96:99]
 ds_read_b128 a[68:71], v237 offset:4096
 v_mfma_f32_16x16x32_bf16 v[120:123], a[32:35], a[20:23], v[120:123]
 ds_read_b128 a[72:75], v237 offset:6144
 v_mfma_f32_16x16x32_bf16 v[144:147], a[32:35], a[24:27], v[144:147]
 ds_read_b128 a[76:79], v237 offset:8192
 v_mfma_f32_16x16x32_bf16 v[168:171], a[32:35], a[28:31], v[168:171]
 ds_read_b128 a[80:83], v237 offset:10240
 v_mfma_f32_16x16x32_bf16 v[172:175], a[36:39], a[28:31], v[172:175]
 ds_read_b128 a[84:87], v237 offset:12288
 v_mfma_f32_16x16x32_bf16 v[148:151], a[36:39], a[24:27], v[148:151]
 ds_read_b128 a[88:91], v237 offset:14336
 v_mfma_f32_16x16x32_bf16 v[124:127], a[36:39], a[20:23], v[124:127]
 ds_read_b64_tr_b16 a[96:97], v239 offset:12288
 v_mfma_f32_16x16x32_bf16 v[100:103], a[36:39], a[16:19], v[100:103]
 ds_read_b64_tr_b16 a[98:99], v239 offset:12800
 v_mfma_f32_16x16x32_bf16 v[76:79], a[36:39], a[12:15], v[76:79]
 ds_read_b64_tr_b16 a[100:101], v238 offset:13312
 v_mfma_f32_16x16x32_bf16 v[52:55], a[36:39], a[8:11], v[52:55]
 ds_read_b64_tr_b16 a[102:103], v238 offset:13824
 v_mfma_f32_16x16x32_bf16 v[28:31], a[36:39], a[4:7], v[28:31]
 ds_read_b64_tr_b16 a[104:105], v239 offset:13312
 v_mfma_f32_16x16x32_bf16 v[4:7], a[36:39], a[0:3], v[4:7]
 ds_read_b64_tr_b16 a[106:107], v239 offset:13824
 v_mfma_f32_16x16x32_bf16 v[8:11], a[40:43], a[0:3], v[8:11]
 ds_read_b64_tr_b16 a[108:109], v238 offset:14336
 v_mfma_f32_16x16x32_bf16 v[32:35], a[40:43], a[4:7], v[32:35]
 ds_read_b64_tr_b16 a[110:111], v238 offset:14848
 v_mfma_f32_16x16x32_bf16 v[56:59], a[40:43], a[8:11], v[56:59]
 ds_read_b64_tr_b16 a[112:113], v239 offset:14336
 v_mfma_f32_16x16x32_bf16 v[80:83], a[40:43], a[12:15], v[80:83]
 ds_read_b64_tr_b16 a[114:115], v239 offset:14848
 v_mfma_f32_16x16x32_bf16 v[104:107], a[40:43], a[16:19], v[104:107]
 ds_read_b64_tr_b16 a[116:117], v240 offset:2048
 v_mfma_f32_16x16x32_bf16 v[128:131], a[40:43], a[20:23], v[128:131]
 ds_read_b64_tr_b16 a[118:119], v240 offset:2304
 v_mfma_f32_16x16x32_bf16 v[152:155], a[40:43], a[24:27], v[152:155]
 s_add_u32 m0, s38, 0
 v_mfma_f32_16x16x32_bf16 v[176:179], a[40:43], a[28:31], v[176:179]
 v_mfma_f32_16x16x32_bf16 v[180:183], a[44:47], a[28:31], v[180:183]
 buffer_load_dwordx4 v232, s[12:15], s32 offen lds
 v_mfma_f32_16x16x32_bf16 v[156:159], a[44:47], a[24:27], v[156:159]
 v_mfma_f32_16x16x32_bf16 v[132:135], a[44:47], a[20:23], v[132:135]
 buffer_load_dwordx4 v233, s[12:15], s32 offen offset:1024 lds
 v_mfma_f32_16x16x32_bf16 v[108:111], a[44:47], a[16:19], v[108:111]
 v_mfma_f32_16x16x32_bf16 v[84:87], a[44:47], a[12:15], v[84:87]
 buffer_load_dwordx4 v234, s[12:15], s32 offen offset:2048 lds
 v_mfma_f32_16x16x32_bf16 v[60:63], a[44:47], a[8:11], v[60:63]
 v_mfma_f32_16x16x32_bf16 v[36:39], a[44:47], a[4:7], v[36:39]
 v_mfma_f32_16x16x32_bf16 v[12:15], a[44:47], a[0:3], v[12:15]
 s_add_u32 s32, s32, 229376
 v_mfma_f32_16x16x32_bf16 v[16:19], a[48:51], a[0:3], v[16:19]
 v_mfma_f32_16x16x32_bf16 v[40:43], a[48:51], a[4:7], v[40:43]
 s_add_u32 m0, s37, 77824
 v_mfma_f32_16x16x32_bf16 v[64:67], a[48:51], a[8:11], v[64:67]
 v_mfma_f32_16x16x32_bf16 v[88:91], a[48:51], a[12:15], v[88:91]
 buffer_load_dwordx4 v228, s[8:11], s31 offen lds
 v_mfma_f32_16x16x32_bf16 v[112:115], a[48:51], a[16:19], v[112:115]
 v_mfma_f32_16x16x32_bf16 v[136:139], a[48:51], a[20:23], v[136:139]
 buffer_load_dwordx4 v229, s[8:11], s31 offen offset:1024 lds
 v_mfma_f32_16x16x32_bf16 v[160:163], a[48:51], a[24:27], v[160:163]
 v_mfma_f32_16x16x32_bf16 v[184:187], a[48:51], a[28:31], v[184:187]
 v_mfma_f32_16x16x32_bf16 v[188:191], a[52:55], a[28:31], v[188:191]
 buffer_load_dwordx4 v230, s[8:11], s31 offen offset:2048 lds
 v_mfma_f32_16x16x32_bf16 v[164:167], a[52:55], a[24:27], v[164:167]
 v_mfma_f32_16x16x32_bf16 v[140:143], a[52:55], a[20:23], v[140:143]
 buffer_load_dwordx4 v231, s[8:11], s31 offen offset:3072 lds
 v_mfma_f32_16x16x32_bf16 v[116:119], a[52:55], a[16:19], v[116:119]
 v_mfma_f32_16x16x32_bf16 v[92:95], a[52:55], a[12:15], v[92:95]
 s_add_u32 m0, s42, 73728
 v_mfma_f32_16x16x32_bf16 v[68:71], a[52:55], a[8:11], v[68:71]
 v_mfma_f32_16x16x32_bf16 v[44:47], a[52:55], a[4:7], v[44:47]
 buffer_load_dwordx4 v235, s[12:15], s33 offen lds
 v_mfma_f32_16x16x32_bf16 v[20:23], a[52:55], a[0:3], v[20:23]
 v_mfma_f32_16x16x32_bf16 a[160:163], a[56:59], a[0:3], a[160:163]
 v_mfma_f32_16x16x32_bf16 a[164:167], a[56:59], a[4:7], a[164:167]
 s_add_u32 s33, s33, 458752
 v_mfma_f32_16x16x32_bf16 a[168:171], a[56:59], a[8:11], a[168:171]
 v_mfma_f32_16x16x32_bf16 a[172:175], a[56:59], a[12:15], a[172:175]
 s_add_u32 s31, s31, 128
 v_mfma_f32_16x16x32_bf16 a[176:179], a[56:59], a[16:19], a[176:179]
 v_mfma_f32_16x16x32_bf16 a[180:183], a[56:59], a[20:23], a[180:183]
 buffer_load_dword v195, v196, s[96:99], 0 offen sc1
 v_mfma_f32_16x16x32_bf16 a[184:187], a[56:59], a[24:27], a[184:187]
 v_mfma_f32_16x16x32_bf16 a[188:191], a[56:59], a[28:31], a[188:191]
 s_waitcnt vmcnt(17) lgkmcnt(0)
 s_barrier
 v_mfma_f32_16x16x32_bf16 v[0:3], a[92:95], a[60:63], v[0:3]
 ds_read_b64_tr_b16 a[32:33], v238 offset:24576
 v_mfma_f32_16x16x32_bf16 v[24:27], a[92:95], a[64:67], v[24:27]
 ds_read_b64_tr_b16 a[34:35], v238 offset:25088
 v_mfma_f32_16x16x32_bf16 v[48:51], a[92:95], a[68:71], v[48:51]
 ds_read_b128 a[0:3], v236 offset:36864
 v_mfma_f32_16x16x32_bf16 v[72:75], a[92:95], a[72:75], v[72:75]
 ds_read_b128 a[4:7], v236 offset:38912
 v_mfma_f32_16x16x32_bf16 v[96:99], a[92:95], a[76:79], v[96:99]
 ds_read_b128 a[8:11], v236 offset:40960
 v_mfma_f32_16x16x32_bf16 v[120:123], a[92:95], a[80:83], v[120:123]
 ds_read_b128 a[12:15], v236 offset:43008
 v_mfma_f32_16x16x32_bf16 v[144:147], a[92:95], a[84:87], v[144:147]
 ds_read_b128 a[16:19], v236 offset:45056
 v_mfma_f32_16x16x32_bf16 v[168:171], a[92:95], a[88:91], v[168:171]
 ds_read_b128 a[20:23], v236 offset:47104
 v_mfma_f32_16x16x32_bf16 v[172:175], a[96:99], a[88:91], v[172:175]
 ds_read_b128 a[24:27], v236 offset:49152
 v_mfma_f32_16x16x32_bf16 v[148:151], a[96:99], a[84:87], v[148:151]
 ds_read_b128 a[28:31], v236 offset:51200
 v_mfma_f32_16x16x32_bf16 v[124:127], a[96:99], a[80:83], v[124:127]
 ds_read_b64_tr_b16 a[36:37], v239 offset:24576
 v_mfma_f32_16x16x32_bf16 v[100:103], a[96:99], a[76:79], v[100:103]
 ds_read_b64_tr_b16 a[38:39], v239 offset:25088
 v_mfma_f32_16x16x32_bf16 v[76:79], a[96:99], a[72:75], v[76:79]
 ds_read_b64_tr_b16 a[40:41], v238 offset:25600
 v_mfma_f32_16x16x32_bf16 v[52:55], a[96:99], a[68:71], v[52:55]
 ds_read_b64_tr_b16 a[42:43], v238 offset:26112
 v_mfma_f32_16x16x32_bf16 v[28:31], a[96:99], a[64:67], v[28:31]
 ds_read_b64_tr_b16 a[44:45], v239 offset:25600
 v_mfma_f32_16x16x32_bf16 v[4:7], a[96:99], a[60:63], v[4:7]
 ds_read_b64_tr_b16 a[46:47], v239 offset:26112
 v_mfma_f32_16x16x32_bf16 v[8:11], a[100:103], a[60:63], v[8:11]
 ds_read_b64_tr_b16 a[48:49], v238 offset:26624
 v_mfma_f32_16x16x32_bf16 v[32:35], a[100:103], a[64:67], v[32:35]
 ds_read_b64_tr_b16 a[50:51], v238 offset:27136
 v_mfma_f32_16x16x32_bf16 v[56:59], a[100:103], a[68:71], v[56:59]
 ds_read_b64_tr_b16 a[52:53], v239 offset:26624
 v_mfma_f32_16x16x32_bf16 v[80:83], a[100:103], a[72:75], v[80:83]
 ds_read_b64_tr_b16 a[54:55], v239 offset:27136
 v_mfma_f32_16x16x32_bf16 v[104:107], a[100:103], a[76:79], v[104:107]
 ds_read_b64_tr_b16 a[56:57], v240 offset:36864
 v_mfma_f32_16x16x32_bf16 v[128:131], a[100:103], a[80:83], v[128:131]
 ds_read_b64_tr_b16 a[58:59], v240 offset:37120
 v_mfma_f32_16x16x32_bf16 v[152:155], a[100:103], a[84:87], v[152:155]
 s_add_u32 m0, s38, 12288
 v_mfma_f32_16x16x32_bf16 v[176:179], a[100:103], a[88:91], v[176:179]
 v_mfma_f32_16x16x32_bf16 v[180:183], a[104:107], a[88:91], v[180:183]
 buffer_load_dwordx4 v232, s[12:15], s32 offen lds
 v_mfma_f32_16x16x32_bf16 v[156:159], a[104:107], a[84:87], v[156:159]
 v_mfma_f32_16x16x32_bf16 v[132:135], a[104:107], a[80:83], v[132:135]
 buffer_load_dwordx4 v233, s[12:15], s32 offen offset:1024 lds
 v_mfma_f32_16x16x32_bf16 v[108:111], a[104:107], a[76:79], v[108:111]
 v_mfma_f32_16x16x32_bf16 v[84:87], a[104:107], a[72:75], v[84:87]
 buffer_load_dwordx4 v234, s[12:15], s32 offen offset:2048 lds
 v_mfma_f32_16x16x32_bf16 v[60:63], a[104:107], a[68:71], v[60:63]
 v_mfma_f32_16x16x32_bf16 v[36:39], a[104:107], a[64:67], v[36:39]
 s_add_u32 s32, s32, 229376
 v_mfma_f32_16x16x32_bf16 v[12:15], a[104:107], a[60:63], v[12:15]
 v_mfma_f32_16x16x32_bf16 v[16:19], a[108:111], a[60:63], v[16:19]
 s_add_u32 m0, s37, 0
 v_mfma_f32_16x16x32_bf16 v[40:43], a[108:111], a[64:67], v[40:43]
 v_mfma_f32_16x16x32_bf16 v[64:67], a[108:111], a[68:71], v[64:67]
 buffer_load_dwordx4 v224, s[8:11], s31 offen lds
 v_mfma_f32_16x16x32_bf16 v[88:91], a[108:111], a[72:75], v[88:91]
 v_mfma_f32_16x16x32_bf16 v[112:115], a[108:111], a[76:79], v[112:115]
 buffer_load_dwordx4 v225, s[8:11], s31 offen offset:1024 lds
 v_mfma_f32_16x16x32_bf16 v[136:139], a[108:111], a[80:83], v[136:139]
 v_mfma_f32_16x16x32_bf16 v[160:163], a[108:111], a[84:87], v[160:163]
 buffer_load_dwordx4 v226, s[8:11], s31 offen offset:2048 lds
 v_mfma_f32_16x16x32_bf16 v[184:187], a[108:111], a[88:91], v[184:187]
 v_mfma_f32_16x16x32_bf16 v[188:191], a[112:115], a[88:91], v[188:191]
 buffer_load_dwordx4 v227, s[8:11], s31 offen offset:3072 lds
 v_mfma_f32_16x16x32_bf16 v[164:167], a[112:115], a[84:87], v[164:167]
 v_mfma_f32_16x16x32_bf16 v[140:143], a[112:115], a[80:83], v[140:143]
 v_min_u32_e64 v247, 15, v255
 v_mfma_f32_16x16x32_bf16 v[116:119], a[112:115], a[76:79], v[116:119]
 v_mfma_f32_16x16x32_bf16 v[92:95], a[112:115], a[72:75], v[92:95]
 s_bfe_u32 s6, s2, 0x20006
 s_lshl_b32 s6, s6, 2
 v_mfma_f32_16x16x32_bf16 v[68:71], a[112:115], a[68:71], v[68:71]
 v_mfma_f32_16x16x32_bf16 v[44:47], a[112:115], a[64:67], v[44:47]
 s_add_u32 s6, s6, s28
 s_lshl_b32 s6, s6, 4
 v_mfma_f32_16x16x32_bf16 v[20:23], a[112:115], a[60:63], v[20:23]
 v_mfma_f32_16x16x32_bf16 a[160:163], a[116:119], a[60:63], a[160:163]
 v_add_lshl_u32 v247, v247, s6, 7
 v_mfma_f32_16x16x32_bf16 a[164:167], a[116:119], a[64:67], a[164:167]
 v_mfma_f32_16x16x32_bf16 a[168:171], a[116:119], a[68:71], a[168:171]
 v_min_u32 v247, L_end-L_ct6-2048, v247
 v_mfma_f32_16x16x32_bf16 a[172:175], a[116:119], a[72:75], a[172:175]
 v_mfma_f32_16x16x32_bf16 a[176:179], a[116:119], a[76:79], a[176:179]
 s_getpc_b64 s[6:7]
L_ct6:
 s_add_u32 s6, s6, 2048
 s_addc_u32 s7, s7, 0
 v_mfma_f32_16x16x32_bf16 a[180:183], a[116:119], a[80:83], a[180:183]
 v_mfma_f32_16x16x32_bf16 a[184:187], a[116:119], a[84:87], a[184:187]
 global_load_dword v251, v247, s[6:7]
 v_mfma_f32_16x16x32_bf16 a[188:191], a[116:119], a[88:91], a[188:191]
 s_waitcnt vmcnt(22) lgkmcnt(0)
 s_barrier
 v_mfma_f32_16x16x32_bf16 v[0:3], a[32:35], a[0:3], v[0:3]
 ds_read_b64_tr_b16 a[92:93], v238 offset:36864
 v_mfma_f32_16x16x32_bf16 v[24:27], a[32:35], a[4:7], v[24:27]
 ds_read_b64_tr_b16 a[94:95], v238 offset:37376
 v_mfma_f32_16x16x32_bf16 v[48:51], a[32:35], a[8:11], v[48:51]
 ds_read_b128 a[60:63], v237 offset:36864
 v_mfma_f32_16x16x32_bf16 v[72:75], a[32:35], a[12:15], v[72:75]
 ds_read_b128 a[64:67], v237 offset:38912
 v_mfma_f32_16x16x32_bf16 v[96:99], a[32:35], a[16:19], v[96:99]
 ds_read_b128 a[68:71], v237 offset:40960
 v_mfma_f32_16x16x32_bf16 v[120:123], a[32:35], a[20:23], v[120:123]
 ds_read_b128 a[72:75], v237 offset:43008
 v_mfma_f32_16x16x32_bf16 v[144:147], a[32:35], a[24:27], v[144:147]
 ds_read_b128 a[76:79], v237 offset:45056
 v_mfma_f32_16x16x32_bf16 v[168:171], a[32:35], a[28:31], v[168:171]
 ds_read_b128 a[80:83], v237 offset:47104
 v_mfma_f32_16x16x32_bf16 v[172:175], a[36:39], a[28:31], v[172:175]
 ds_read_b128 a[84:87], v237 offset:49152
 v_mfma_f32_16x16x32_bf16 v[148:151], a[36:39], a[24:27], v[148:151]
 ds_read_b128 a[88:91], v237 offset:51200
 v_mfma_f32_16x16x32_bf16 v[124:127], a[36:39], a[20:23], v[124:127]
 ds_read_b64_tr_b16 a[96:97], v239 offset:36864
 v_mfma_f32_16x16x32_bf16 v[100:103], a[36:39], a[16:19], v[100:103]
 ds_read_b64_tr_b16 a[98:99], v239 offset:37376
 v_mfma_f32_16x16x32_bf16 v[76:79], a[36:39], a[12:15], v[76:79]
 ds_read_b64_tr_b16 a[100:101], v238 offset:37888
 v_mfma_f32_16x16x32_bf16 v[52:55], a[36:39], a[8:11], v[52:55]
 ds_read_b64_tr_b16 a[102:103], v238 offset:38400
 v_mfma_f32_16x16x32_bf16 v[28:31], a[36:39], a[4:7], v[28:31]
 ds_read_b64_tr_b16 a[104:105], v239 offset:37888
 v_mfma_f32_16x16x32_bf16 v[4:7], a[36:39], a[0:3], v[4:7]
 ds_read_b64_tr_b16 a[106:107], v239 offset:38400
 v_mfma_f32_16x16x32_bf16 v[8:11], a[40:43], a[0:3], v[8:11]
 ds_read_b64_tr_b16 a[108:109], v238 offset:38912
 v_mfma_f32_16x16x32_bf16 v[32:35], a[40:43], a[4:7], v[32:35]
 ds_read_b64_tr_b16 a[110:111], v238 offset:39424
 v_mfma_f32_16x16x32_bf16 v[56:59], a[40:43], a[8:11], v[56:59]
 ds_read_b64_tr_b16 a[112:113], v239 offset:38912
 v_mfma_f32_16x16x32_bf16 v[80:83], a[40:43], a[12:15], v[80:83]
 ds_read_b64_tr_b16 a[114:115], v239 offset:39424
 v_mfma_f32_16x16x32_bf16 v[104:107], a[40:43], a[16:19], v[104:107]
 ds_read_b64_tr_b16 a[116:117], v240 offset:38912
 v_mfma_f32_16x16x32_bf16 v[128:131], a[40:43], a[20:23], v[128:131]
 ds_read_b64_tr_b16 a[118:119], v240 offset:39168
 v_mfma_f32_16x16x32_bf16 v[152:155], a[40:43], a[24:27], v[152:155]
 s_add_u32 m0, s38, 24576
 v_mfma_f32_16x16x32_bf16 v[176:179], a[40:43], a[28:31], v[176:179]
 buffer_load_dwordx4 v232, s[12:15], s32 offen lds
 v_mfma_f32_16x16x32_bf16 v[180:183], a[44:47], a[28:31], v[180:183]
 v_mfma_f32_16x16x32_bf16 v[156:159], a[44:47], a[24:27], v[156:159]
 buffer_load_dwordx4 v233, s[12:15], s32 offen offset:1024 lds
 v_mfma_f32_16x16x32_bf16 v[132:135], a[44:47], a[20:23], v[132:135]
 v_mfma_f32_16x16x32_bf16 v[108:111], a[44:47], a[16:19], v[108:111]
 buffer_load_dwordx4 v234, s[12:15], s32 offen offset:2048 lds
 v_mfma_f32_16x16x32_bf16 v[84:87], a[44:47], a[12:15], v[84:87]
 v_mfma_f32_16x16x32_bf16 v[60:63], a[44:47], a[8:11], v[60:63]
 s_add_u32 s32, s32, 229376
 v_mfma_f32_16x16x32_bf16 v[36:39], a[44:47], a[4:7], v[36:39]
 s_add_u32 m0, s37, 4096
 v_mfma_f32_16x16x32_bf16 v[12:15], a[44:47], a[0:3], v[12:15]
 v_mfma_f32_16x16x32_bf16 v[16:19], a[48:51], a[0:3], v[16:19]
 buffer_load_dwordx4 v228, s[8:11], s31 offen lds
 v_mfma_f32_16x16x32_bf16 v[40:43], a[48:51], a[4:7], v[40:43]
 v_mfma_f32_16x16x32_bf16 v[64:67], a[48:51], a[8:11], v[64:67]
 buffer_load_dwordx4 v229, s[8:11], s31 offen offset:1024 lds
 v_mfma_f32_16x16x32_bf16 v[88:91], a[48:51], a[12:15], v[88:91]
 v_mfma_f32_16x16x32_bf16 v[112:115], a[48:51], a[16:19], v[112:115]
 buffer_load_dwordx4 v230, s[8:11], s31 offen offset:2048 lds
 v_mfma_f32_16x16x32_bf16 v[136:139], a[48:51], a[20:23], v[136:139]
 v_mfma_f32_16x16x32_bf16 v[160:163], a[48:51], a[24:27], v[160:163]
 buffer_load_dwordx4 v231, s[8:11], s31 offen offset:3072 lds
 v_mfma_f32_16x16x32_bf16 v[184:187], a[48:51], a[28:31], v[184:187]
 s_add_u32 m0, s42, 0
 v_mfma_f32_16x16x32_bf16 v[188:191], a[52:55], a[28:31], v[188:191]
 v_mfma_f32_16x16x32_bf16 v[164:167], a[52:55], a[24:27], v[164:167]
 buffer_load_dwordx4 v235, s[12:15], s33 offen lds
 v_mfma_f32_16x16x32_bf16 v[140:143], a[52:55], a[20:23], v[140:143]
 v_mfma_f32_16x16x32_bf16 v[116:119], a[52:55], a[16:19], v[116:119]
 v_min_u32_e64 v247, 15, v255
 v_mfma_f32_16x16x32_bf16 v[92:95], a[52:55], a[12:15], v[92:95]
 v_mfma_f32_16x16x32_bf16 v[68:71], a[52:55], a[8:11], v[68:71]
 s_bfe_u32 s6, s2, 0x20006
 s_lshl_b32 s6, s6, 2
 v_mfma_f32_16x16x32_bf16 v[44:47], a[52:55], a[4:7], v[44:47]
 v_mfma_f32_16x16x32_bf16 v[20:23], a[52:55], a[0:3], v[20:23]
 s_add_u32 s6, s6, s28
 s_lshl_b32 s6, s6, 4
 v_mfma_f32_16x16x32_bf16 a[160:163], a[56:59], a[0:3], a[160:163]
 v_add_lshl_u32 v247, v247, s6, 7
 v_mfma_f32_16x16x32_bf16 a[164:167], a[56:59], a[4:7], a[164:167]
 v_mfma_f32_16x16x32_bf16 a[168:171], a[56:59], a[8:11], a[168:171]
 v_min_u32 v247, L_end-L_P2, v247
 v_mfma_f32_16x16x32_bf16 a[172:175], a[56:59], a[12:15], a[172:175]
 v_mfma_f32_16x16x32_bf16 a[176:179], a[56:59], a[16:19], a[176:179]
 s_getpc_b64 s[6:7]
L_ct7:
 s_add_u32 s6, s6, L_P2-L_ct7
 s_addc_u32 s7, s7, -1
 v_mfma_f32_16x16x32_bf16 a[180:183], a[56:59], a[20:23], a[180:183]
 v_mfma_f32_16x16x32_bf16 a[184:187], a[56:59], a[24:27], a[184:187]
 global_load_dword v251, v247, s[6:7]
 v_mfma_f32_16x16x32_bf16 a[188:191], a[56:59], a[28:31], a[188:191]
 s_waitcnt vmcnt(17) lgkmcnt(0)
 s_barrier
 v_mfma_f32_16x16x32_bf16 v[0:3], a[92:95], a[60:63], v[0:3]
 v_cmp_gt_u32 vcc, v197, v195
 v_mfma_f32_16x16x32_bf16 v[24:27], a[92:95], a[64:67], v[24:27]
 s_lshl_b32 s74, s28, 8
 v_mfma_f32_16x16x32_bf16 v[48:51], a[92:95], a[68:71], v[48:51]
 s_nop 0
 v_mfma_f32_16x16x32_bf16 v[72:75], a[92:95], a[72:75], v[72:75]
 s_cbranch_vccnz L1F_sp0
L1F_sok:
 v_mfma_f32_16x16x32_bf16 v[96:99], a[92:95], a[76:79], v[96:99]
 v_lshl_add_u32 v195, v255, 2, s74
 v_mfma_f32_16x16x32_bf16 v[120:123], a[92:95], a[80:83], v[120:123]
 ds_read_b64_tr_b16 a[32:33], v238
 v_mfma_f32_16x16x32_bf16 v[144:147], a[92:95], a[84:87], v[144:147]
 ds_read_b64_tr_b16 a[34:35], v238 offset:512
 v_mfma_f32_16x16x32_bf16 v[168:171], a[92:95], a[88:91], v[168:171]
 ds_read_b128 a[0:3], v241
 v_mfma_f32_16x16x32_bf16 v[172:175], a[96:99], a[88:91], v[172:175]
 ds_read_b128 a[4:7], v241 offset:2048
 v_mfma_f32_16x16x32_bf16 v[148:151], a[96:99], a[84:87], v[148:151]
 ds_read_b128 a[8:11], v241 offset:4096
 v_mfma_f32_16x16x32_bf16 v[124:127], a[96:99], a[80:83], v[124:127]
 ds_read_b128 a[12:15], v241 offset:6144
 v_mfma_f32_16x16x32_bf16 v[100:103], a[96:99], a[76:79], v[100:103]
 ds_read_b128 a[16:19], v241 offset:8192
 v_mfma_f32_16x16x32_bf16 v[76:79], a[96:99], a[72:75], v[76:79]
 ds_read_b128 a[20:23], v241 offset:10240
 v_mfma_f32_16x16x32_bf16 v[52:55], a[96:99], a[68:71], v[52:55]
 ds_read_b128 a[24:27], v241 offset:12288
 v_mfma_f32_16x16x32_bf16 v[28:31], a[96:99], a[64:67], v[28:31]
 ds_read_b128 a[28:31], v241 offset:14336
 v_mfma_f32_16x16x32_bf16 v[4:7], a[96:99], a[60:63], v[4:7]
 ds_read_b64_tr_b16 a[36:37], v239
 v_mfma_f32_16x16x32_bf16 v[8:11], a[100:103], a[60:63], v[8:11]
 ds_read_b64_tr_b16 a[38:39], v239 offset:512
 v_mfma_f32_16x16x32_bf16 v[32:35], a[100:103], a[64:67], v[32:35]
 ds_read_b64_tr_b16 a[40:41], v238 offset:1024
 v_mfma_f32_16x16x32_bf16 v[56:59], a[100:103], a[68:71], v[56:59]
 ds_read_b64_tr_b16 a[42:43], v238 offset:1536
 v_mfma_f32_16x16x32_bf16 v[80:83], a[100:103], a[72:75], v[80:83]
 ds_read_b64_tr_b16 a[44:45], v239 offset:1024
 v_mfma_f32_16x16x32_bf16 v[104:107], a[100:103], a[76:79], v[104:107]
 ds_read_b64_tr_b16 a[46:47], v239 offset:1536
 v_mfma_f32_16x16x32_bf16 v[128:131], a[100:103], a[80:83], v[128:131]
 ds_read_b64_tr_b16 a[48:49], v238 offset:2048
 v_mfma_f32_16x16x32_bf16 v[152:155], a[100:103], a[84:87], v[152:155]
 ds_read_b64_tr_b16 a[50:51], v238 offset:2560
 v_mfma_f32_16x16x32_bf16 v[176:179], a[100:103], a[88:91], v[176:179]
 ds_read_b64_tr_b16 a[52:53], v239 offset:2048
 v_mfma_f32_16x16x32_bf16 v[180:183], a[104:107], a[88:91], v[180:183]
 ds_read_b64_tr_b16 a[54:55], v239 offset:2560
 v_mfma_f32_16x16x32_bf16 v[156:159], a[104:107], a[84:87], v[156:159]
 ds_read_b64_tr_b16 a[56:57], v243
 v_mfma_f32_16x16x32_bf16 v[132:135], a[104:107], a[80:83], v[132:135]
 ds_read_b64_tr_b16 a[58:59], v243 offset:256
 v_mfma_f32_16x16x32_bf16 v[108:111], a[104:107], a[76:79], v[108:111]
 s_add_u32 m0, s38, 36864
 v_mfma_f32_16x16x32_bf16 v[84:87], a[104:107], a[72:75], v[84:87]
 buffer_load_dwordx4 v232, s[12:15], s32 offen lds
 v_mfma_f32_16x16x32_bf16 v[60:63], a[104:107], a[68:71], v[60:63]
 v_mfma_f32_16x16x32_bf16 v[36:39], a[104:107], a[64:67], v[36:39]
 buffer_load_dwordx4 v233, s[12:15], s32 offen offset:1024 lds
 v_mfma_f32_16x16x32_bf16 v[12:15], a[104:107], a[60:63], v[12:15]
 v_mfma_f32_16x16x32_bf16 v[16:19], a[108:111], a[60:63], v[16:19]
 buffer_load_dwordx4 v234, s[12:15], s32 offen offset:2048 lds
 v_mfma_f32_16x16x32_bf16 v[40:43], a[108:111], a[64:67], v[40:43]
 v_and_b32 v204, 4, v195
 v_mfma_f32_16x16x32_bf16 v[64:67], a[108:111], a[68:71], v[64:67]
 v_mfma_f32_16x16x32_bf16 v[88:91], a[108:111], a[72:75], v[88:91]
 v_and_b32_e64 v203, -8, v195
 v_mfma_f32_16x16x32_bf16 v[112:115], a[108:111], a[76:79], v[112:115]
 v_mfma_f32_16x16x32_bf16 v[136:139], a[108:111], a[80:83], v[136:139]
 v_lshl_add_u32 v204, v203, 4, v204
 v_mfma_f32_16x16x32_bf16 v[160:163], a[108:111], a[84:87], v[160:163]
 buffer_load_dword v204, v204, s[92:95], s72 offen sc1
 v_mfma_f32_16x16x32_bf16 v[184:187], a[108:111], a[88:91], v[184:187]
 v_mfma_f32_16x16x32_bf16 v[188:191], a[112:115], a[88:91], v[188:191]
 buffer_load_dword v196, v195, s[92:95], s73 offen sc1
 v_mfma_f32_16x16x32_bf16 v[164:167], a[112:115], a[84:87], v[164:167]
 v_mfma_f32_16x16x32_bf16 v[140:143], a[112:115], a[80:83], v[140:143]
 buffer_load_dword v197, v195, s[92:95], s73 offen offset:1024 sc1
 v_mfma_f32_16x16x32_bf16 v[116:119], a[112:115], a[76:79], v[116:119]
 v_mfma_f32_16x16x32_bf16 v[92:95], a[112:115], a[72:75], v[92:95]
 buffer_load_dword v198, v195, s[92:95], s73 offen offset:2048 sc1
 v_mfma_f32_16x16x32_bf16 v[68:71], a[112:115], a[68:71], v[68:71]
 buffer_load_dword v199, v195, s[92:95], s73 offen offset:3072 sc1
 v_mfma_f32_16x16x32_bf16 v[44:47], a[112:115], a[64:67], v[44:47]
 v_mfma_f32_16x16x32_bf16 v[20:23], a[112:115], a[60:63], v[20:23]
 s_add_u32 s73, s73, 4096
 v_mfma_f32_16x16x32_bf16 a[160:163], a[116:119], a[60:63], a[160:163]
 v_mfma_f32_16x16x32_bf16 a[164:167], a[116:119], a[64:67], a[164:167]
 buffer_load_dword v200, v195, s[92:95], s73 offen sc1
 v_mfma_f32_16x16x32_bf16 a[168:171], a[116:119], a[68:71], a[168:171]
 buffer_load_dword v201, v195, s[92:95], s73 offen offset:1024 sc1
 v_mfma_f32_16x16x32_bf16 a[172:175], a[116:119], a[72:75], a[172:175]
 v_mfma_f32_16x16x32_bf16 a[176:179], a[116:119], a[76:79], a[176:179]
 buffer_load_dword v202, v195, s[92:95], s73 offen offset:2048 sc1
 v_mfma_f32_16x16x32_bf16 a[180:183], a[116:119], a[80:83], a[180:183]
 v_mfma_f32_16x16x32_bf16 a[184:187], a[116:119], a[84:87], a[184:187]
 buffer_load_dword v203, v195, s[92:95], s73 offen offset:3072 sc1
 v_mfma_f32_16x16x32_bf16 a[188:191], a[116:119], a[88:91], a[188:191]
 s_waitcnt vmcnt(26) lgkmcnt(0)
 s_barrier
 v_mfma_f32_16x16x32_bf16 v[0:3], a[32:35], a[0:3], v[0:3]
 ds_read_b64_tr_b16 a[92:93], v238 offset:12288
 v_mfma_f32_16x16x32_bf16 v[24:27], a[32:35], a[4:7], v[24:27]
 ds_read_b64_tr_b16 a[94:95], v238 offset:12800
 v_mfma_f32_16x16x32_bf16 v[48:51], a[32:35], a[8:11], v[48:51]
 ds_read_b128 a[60:63], v242
 v_mfma_f32_16x16x32_bf16 v[72:75], a[32:35], a[12:15], v[72:75]
 ds_read_b128 a[64:67], v242 offset:2048
 v_mfma_f32_16x16x32_bf16 v[96:99], a[32:35], a[16:19], v[96:99]
 ds_read_b128 a[68:71], v242 offset:4096
 v_mfma_f32_16x16x32_bf16 v[120:123], a[32:35], a[20:23], v[120:123]
 ds_read_b128 a[72:75], v242 offset:6144
 v_mfma_f32_16x16x32_bf16 v[144:147], a[32:35], a[24:27], v[144:147]
 ds_read_b128 a[76:79], v242 offset:8192
 v_mfma_f32_16x16x32_bf16 v[168:171], a[32:35], a[28:31], v[168:171]
 ds_read_b128 a[80:83], v242 offset:10240
 v_mfma_f32_16x16x32_bf16 v[172:175], a[36:39], a[28:31], v[172:175]
 ds_read_b128 a[84:87], v242 offset:12288
 v_mfma_f32_16x16x32_bf16 v[148:151], a[36:39], a[24:27], v[148:151]
 ds_read_b128 a[88:91], v242 offset:14336
 v_mfma_f32_16x16x32_bf16 v[124:127], a[36:39], a[20:23], v[124:127]
 ds_read_b64_tr_b16 a[96:97], v239 offset:12288
 v_mfma_f32_16x16x32_bf16 v[100:103], a[36:39], a[16:19], v[100:103]
 ds_read_b64_tr_b16 a[98:99], v239 offset:12800
 v_mfma_f32_16x16x32_bf16 v[76:79], a[36:39], a[12:15], v[76:79]
 ds_read_b64_tr_b16 a[100:101], v238 offset:13312
 v_mfma_f32_16x16x32_bf16 v[52:55], a[36:39], a[8:11], v[52:55]
 ds_read_b64_tr_b16 a[102:103], v238 offset:13824
 v_mfma_f32_16x16x32_bf16 v[28:31], a[36:39], a[4:7], v[28:31]
 ds_read_b64_tr_b16 a[104:105], v239 offset:13312
 v_mfma_f32_16x16x32_bf16 v[4:7], a[36:39], a[0:3], v[4:7]
 ds_read_b64_tr_b16 a[106:107], v239 offset:13824
 v_mfma_f32_16x16x32_bf16 v[8:11], a[40:43], a[0:3], v[8:11]
 ds_read_b64_tr_b16 a[108:109], v238 offset:14336
 v_mfma_f32_16x16x32_bf16 v[32:35], a[40:43], a[4:7], v[32:35]
 ds_read_b64_tr_b16 a[110:111], v238 offset:14848
 v_mfma_f32_16x16x32_bf16 v[56:59], a[40:43], a[8:11], v[56:59]
 ds_read_b64_tr_b16 a[112:113], v239 offset:14336
 v_mfma_f32_16x16x32_bf16 v[80:83], a[40:43], a[12:15], v[80:83]
 ds_read_b64_tr_b16 a[114:115], v239 offset:14848
 v_mfma_f32_16x16x32_bf16 v[104:107], a[40:43], a[16:19], v[104:107]
 ds_read_b64_tr_b16 a[116:117], v243 offset:2048
 v_mfma_f32_16x16x32_bf16 v[128:131], a[40:43], a[20:23], v[128:131]
 ds_read_b64_tr_b16 a[118:119], v243 offset:2304
 v_and_b32_e64 v248, 15, v255
 v_mfma_f32_16x16x32_bf16 v[152:155], a[40:43], a[24:27], v[152:155]
 s_lshl_b32 s3, s29, 9
 v_mfma_f32_16x16x32_bf16 v[176:179], a[40:43], a[28:31], v[176:179]
 s_add_u32 s3, s3, 160768
 v_mfma_f32_16x16x32_bf16 v[180:183], a[44:47], a[28:31], v[180:183]
 v_lshl_add_u32 v248, v248, 2, s3
 v_mfma_f32_16x16x32_bf16 v[156:159], a[44:47], a[24:27], v[156:159]
 v_lshrrev_b32 v249, 4, v255
 v_mfma_f32_16x16x32_bf16 v[132:135], a[44:47], a[20:23], v[132:135]
 s_lshl_b32 s3, s30, 7
 v_mfma_f32_16x16x32_bf16 v[108:111], a[44:47], a[16:19], v[108:111]
 s_add_u32 s3, s3, 159744
 v_mfma_f32_16x16x32_bf16 v[84:87], a[44:47], a[12:15], v[84:87]
 v_lshl_add_u32 v249, v249, 4, s3
 v_mfma_f32_16x16x32_bf16 v[60:63], a[44:47], a[8:11], v[60:63]
 s_sub_u32 s12, s60, 4096
 v_mfma_f32_16x16x32_bf16 v[36:39], a[44:47], a[4:7], v[36:39]
 s_subb_u32 s13, s61, 0
 v_mfma_f32_16x16x32_bf16 v[12:15], a[44:47], a[0:3], v[12:15]
 s_mov_b32 s14, 0x701000
 v_mfma_f32_16x16x32_bf16 v[16:19], a[48:51], a[0:3], v[16:19]
 s_mov_b32 s15, 0x20000
 v_mfma_f32_16x16x32_bf16 v[40:43], a[48:51], a[4:7], v[40:43]
 v_lshrrev_b32_e64 v246, 3, v255
 v_mfma_f32_16x16x32_bf16 v[64:67], a[48:51], a[8:11], v[64:67]
 s_lshl_b32 s3, s28, 4
 v_mfma_f32_16x16x32_bf16 v[88:91], a[48:51], a[12:15], v[88:91]
 v_add_u32 v246, s3, v246
 v_mfma_f32_16x16x32_bf16 v[112:115], a[48:51], a[16:19], v[112:115]
 v_lshlrev_b32_e64 v244, 11, v246
 v_mfma_f32_16x16x32_bf16 v[136:139], a[48:51], a[20:23], v[136:139]
 v_lshrrev_b32_e64 v246, 4, v255
 v_mfma_f32_16x16x32_bf16 v[160:163], a[48:51], a[24:27], v[160:163]
 v_lshlrev_b32_e64 v246, 1, v246
 v_mfma_f32_16x16x32_bf16 v[184:187], a[48:51], a[28:31], v[184:187]
 v_and_b32_e64 v247, 7, v255
 v_mfma_f32_16x16x32_bf16 v[188:191], a[52:55], a[28:31], v[188:191]
 v_xor_b32_e64 v246, v246, v247
 v_mfma_f32_16x16x32_bf16 v[164:167], a[52:55], a[24:27], v[164:167]
 v_lshl_add_u32 v244, v246, 4, v244
 v_mfma_f32_16x16x32_bf16 v[140:143], a[52:55], a[20:23], v[140:143]
 s_lshl_b32 s3, s83, 8
 v_mfma_f32_16x16x32_bf16 v[116:119], a[52:55], a[16:19], v[116:119]
 s_add_u32 s3, s3, 4096
 v_mfma_f32_16x16x32_bf16 v[92:95], a[52:55], a[12:15], v[92:95]
 s_and_b32 s4, s39, 1
 v_mfma_f32_16x16x32_bf16 v[68:71], a[52:55], a[8:11], v[68:71]
 s_lshl_b32 s4, s4, 7
 v_mfma_f32_16x16x32_bf16 v[44:47], a[52:55], a[4:7], v[44:47]
 s_sub_u32 s6, s3, s4
 v_mfma_f32_16x16x32_bf16 v[20:23], a[52:55], a[0:3], v[20:23]
 s_add_u32 s3, s3, s4
 v_mfma_f32_16x16x32_bf16 a[160:163], a[56:59], a[0:3], a[160:163]
 v_add_u32 v245, s6, v244
 v_mfma_f32_16x16x32_bf16 a[164:167], a[56:59], a[4:7], a[164:167]
 v_add_u32_e64 v244, s3, v244
 v_mfma_f32_16x16x32_bf16 a[168:171], a[56:59], a[8:11], a[168:171]
 v_add_u32 v245, 0xfffffc80, v245
 v_mfma_f32_16x16x32_bf16 a[172:175], a[56:59], a[12:15], a[172:175]
 v_add_u32 v246, 14336, v244
 v_mfma_f32_16x16x32_bf16 a[176:179], a[56:59], a[16:19], a[176:179]
 v_add_u32 v247, 14336, v245
 v_mfma_f32_16x16x32_bf16 a[180:183], a[56:59], a[20:23], a[180:183]
 s_mul_i32 s33, s39, 1835008
 v_mfma_f32_16x16x32_bf16 a[184:187], a[56:59], a[24:27], a[184:187]
 s_lshl_b32 s34, s28, 12
 v_mfma_f32_16x16x32_bf16 a[188:191], a[56:59], a[28:31], a[188:191]
 s_mov_b32 s37, s34
 s_waitcnt vmcnt(13) lgkmcnt(0)
 s_barrier
 v_mfma_f32_16x16x32_bf16 v[0:3], a[92:95], a[60:63], v[0:3]
 ds_read_b64_tr_b16 a[32:33], v238 offset:24576
 v_mfma_f32_16x16x32_bf16 v[24:27], a[92:95], a[64:67], v[24:27]
 ds_read_b64_tr_b16 a[34:35], v238 offset:25088
 v_mfma_f32_16x16x32_bf16 v[48:51], a[92:95], a[68:71], v[48:51]
 ds_read_b128 a[0:3], v236
 v_mfma_f32_16x16x32_bf16 v[72:75], a[92:95], a[72:75], v[72:75]
 ds_read_b128 a[4:7], v236 offset:2048
 v_mfma_f32_16x16x32_bf16 v[96:99], a[92:95], a[76:79], v[96:99]
 ds_read_b128 a[8:11], v236 offset:4096
 v_mfma_f32_16x16x32_bf16 v[120:123], a[92:95], a[80:83], v[120:123]
 ds_read_b128 a[12:15], v236 offset:6144
 v_mfma_f32_16x16x32_bf16 v[144:147], a[92:95], a[84:87], v[144:147]
 ds_read_b128 a[16:19], v236 offset:8192
 v_mfma_f32_16x16x32_bf16 v[168:171], a[92:95], a[88:91], v[168:171]
 ds_read_b128 a[20:23], v236 offset:10240
 v_mfma_f32_16x16x32_bf16 v[172:175], a[96:99], a[88:91], v[172:175]
 ds_read_b128 a[24:27], v236 offset:12288
 v_mfma_f32_16x16x32_bf16 v[148:151], a[96:99], a[84:87], v[148:151]
 ds_read_b128 a[28:31], v236 offset:14336
 v_mfma_f32_16x16x32_bf16 v[124:127], a[96:99], a[80:83], v[124:127]
 ds_read_b64_tr_b16 a[36:37], v239 offset:24576
 v_mfma_f32_16x16x32_bf16 v[100:103], a[96:99], a[76:79], v[100:103]
 ds_read_b64_tr_b16 a[38:39], v239 offset:25088
 v_mfma_f32_16x16x32_bf16 v[76:79], a[96:99], a[72:75], v[76:79]
 ds_read_b64_tr_b16 a[40:41], v238 offset:25600
 v_mfma_f32_16x16x32_bf16 v[52:55], a[96:99], a[68:71], v[52:55]
 ds_read_b64_tr_b16 a[42:43], v238 offset:26112
 v_mfma_f32_16x16x32_bf16 v[28:31], a[96:99], a[64:67], v[28:31]
 ds_read_b64_tr_b16 a[44:45], v239 offset:25600
 v_mfma_f32_16x16x32_bf16 v[4:7], a[96:99], a[60:63], v[4:7]
 ds_read_b64_tr_b16 a[46:47], v239 offset:26112
 v_mfma_f32_16x16x32_bf16 v[8:11], a[100:103], a[60:63], v[8:11]
 ds_read_b64_tr_b16 a[48:49], v238 offset:26624
 v_mfma_f32_16x16x32_bf16 v[32:35], a[100:103], a[64:67], v[32:35]
 ds_read_b64_tr_b16 a[50:51], v238 offset:27136
 v_mfma_f32_16x16x32_bf16 v[56:59], a[100:103], a[68:71], v[56:59]
 ds_read_b64_tr_b16 a[52:53], v239 offset:26624
 v_mfma_f32_16x16x32_bf16 v[80:83], a[100:103], a[72:75], v[80:83]
 ds_read_b64_tr_b16 a[54:55], v239 offset:27136
 v_mfma_f32_16x16x32_bf16 v[104:107], a[100:103], a[76:79], v[104:107]
 ds_read_b64_tr_b16 a[56:57], v240
 v_mfma_f32_16x16x32_bf16 v[128:131], a[100:103], a[80:83], v[128:131]
 ds_read_b64_tr_b16 a[58:59], v240 offset:256
 v_mfma_f32_16x16x32_bf16 v[152:155], a[100:103], a[84:87], v[152:155]
 s_waitcnt vmcnt(0)
 v_add_f32 v196, v196, v197
 v_mfma_f32_16x16x32_bf16 v[176:179], a[100:103], a[88:91], v[176:179]
 v_add_f32_e64 v198, v198, v199
 v_mfma_f32_16x16x32_bf16 v[180:183], a[104:107], a[88:91], v[180:183]
 v_add_f32_e64 v200, v200, v201
 v_mfma_f32_16x16x32_bf16 v[156:159], a[104:107], a[84:87], v[156:159]
 v_add_f32_e64 v202, v202, v203
 v_mfma_f32_16x16x32_bf16 v[132:135], a[104:107], a[80:83], v[132:135]
 v_mfma_f32_16x16x32_bf16 v[108:111], a[104:107], a[76:79], v[108:111]
 v_add_f32_e64 v196, v196, v198
 v_mfma_f32_16x16x32_bf16 v[84:87], a[104:107], a[72:75], v[84:87]
 v_add_f32_e64 v200, v200, v202
 v_mfma_f32_16x16x32_bf16 v[60:63], a[104:107], a[68:71], v[60:63]
 v_and_b32 v198, 0xffff0000, v204
 v_mfma_f32_16x16x32_bf16 v[36:39], a[104:107], a[64:67], v[36:39]
 v_mfma_f32_16x16x32_bf16 v[12:15], a[104:107], a[60:63], v[12:15]
 v_add_f32_e64 v196, v196, v200
 v_mfma_f32_16x16x32_bf16 v[16:19], a[108:111], a[60:63], v[16:19]
 v_rcp_f32_e64 v198, v198
 v_mfma_f32_16x16x32_bf16 v[40:43], a[108:111], a[64:67], v[40:43]
 v_lshlrev_b32_e64 v197, 16, v204
 v_mfma_f32_16x16x32_bf16 v[64:67], a[108:111], a[68:71], v[64:67]
 v_mfma_f32_16x16x32_bf16 v[88:91], a[108:111], a[72:75], v[88:91]
 v_add_u32 v195, 159744, v195
 v_mfma_f32_16x16x32_bf16 v[112:115], a[108:111], a[76:79], v[112:115]
 ds_write_b32 v195, v196
 v_mfma_f32_16x16x32_bf16 v[136:139], a[108:111], a[80:83], v[136:139]
 ds_write_b32 v195, v197 offset:1024
 v_mfma_f32_16x16x32_bf16 v[160:163], a[108:111], a[84:87], v[160:163]
 v_mfma_f32_16x16x32_bf16 v[184:187], a[108:111], a[88:91], v[184:187]
 ds_write_b32 v195, v198 offset:2048
 v_mfma_f32_16x16x32_bf16 v[188:191], a[112:115], a[88:91], v[188:191]
 v_lshrrev_b32_e64 v195, 1, v195
 v_mfma_f32_16x16x32_bf16 v[164:167], a[112:115], a[84:87], v[164:167]
 v_add_u32 v195, 82944, v195
 v_mfma_f32_16x16x32_bf16 v[140:143], a[112:115], a[80:83], v[140:143]
 ds_write_b16_d16_hi v195, v204
 v_mfma_f32_16x16x32_bf16 v[116:119], a[112:115], a[76:79], v[116:119]
 v_mfma_f32_16x16x32_bf16 v[92:95], a[112:115], a[72:75], v[92:95]
 s_add_u32 s4, s37, 49152
 s_and_b32 m0, s4, 0x1ffff
 s_add_u32 s35, s33, 393216
 buffer_load_dwordx4 v244, s[12:15], s35 offen lds
 v_mfma_f32_16x16x32_bf16 v[68:71], a[112:115], a[68:71], v[68:71]
 buffer_load_dwordx4 v245, s[12:15], s35 offen offset:1024 lds
 v_mfma_f32_16x16x32_bf16 v[44:47], a[112:115], a[64:67], v[44:47]
 buffer_load_dwordx4 v246, s[12:15], s35 offen offset:2048 lds
 v_mfma_f32_16x16x32_bf16 v[20:23], a[112:115], a[60:63], v[20:23]
 v_mfma_f32_16x16x32_bf16 a[160:163], a[116:119], a[60:63], a[160:163]
 buffer_load_dwordx4 v247, s[12:15], s35 offen offset:3072 lds
 v_mfma_f32_16x16x32_bf16 a[164:167], a[116:119], a[64:67], a[164:167]
 s_add_u32 s4, s37, 65536
 s_and_b32 m0, s4, 0x1ffff
 s_add_u32 s35, s33, 524288
 buffer_load_dwordx4 v244, s[12:15], s35 offen lds
 v_mfma_f32_16x16x32_bf16 a[168:171], a[116:119], a[68:71], a[168:171]
 buffer_load_dwordx4 v245, s[12:15], s35 offen offset:1024 lds
 v_mfma_f32_16x16x32_bf16 a[172:175], a[116:119], a[72:75], a[172:175]
 v_mfma_f32_16x16x32_bf16 a[176:179], a[116:119], a[76:79], a[176:179]
 buffer_load_dwordx4 v246, s[12:15], s35 offen offset:2048 lds
 v_mfma_f32_16x16x32_bf16 a[180:183], a[116:119], a[80:83], a[180:183]
 buffer_load_dwordx4 v247, s[12:15], s35 offen offset:3072 lds
 v_mfma_f32_16x16x32_bf16 a[184:187], a[116:119], a[84:87], a[184:187]
 s_add_u32 s4, s37, 81920
 s_and_b32 m0, s4, 0x1ffff
 s_add_u32 s35, s33, 655360
 buffer_load_dwordx4 v244, s[12:15], s35 offen lds
 v_mfma_f32_16x16x32_bf16 a[188:191], a[116:119], a[88:91], a[188:191]
 s_waitcnt vmcnt(9) lgkmcnt(0)
 s_barrier
 v_mfma_f32_16x16x32_bf16 v[0:3], a[32:35], a[0:3], v[0:3]
 ds_read_b64_tr_b16 a[92:93], v238 offset:36864
 v_mfma_f32_16x16x32_bf16 v[24:27], a[32:35], a[4:7], v[24:27]
 ds_read_b64_tr_b16 a[94:95], v238 offset:37376
 v_mfma_f32_16x16x32_bf16 v[48:51], a[32:35], a[8:11], v[48:51]
 ds_read_b128 a[60:63], v237
 v_mfma_f32_16x16x32_bf16 v[72:75], a[32:35], a[12:15], v[72:75]
 ds_read_b128 a[64:67], v237 offset:2048
 v_mfma_f32_16x16x32_bf16 v[96:99], a[32:35], a[16:19], v[96:99]
 ds_read_b128 a[68:71], v237 offset:4096
 v_mfma_f32_16x16x32_bf16 v[120:123], a[32:35], a[20:23], v[120:123]
 ds_read_b128 a[72:75], v237 offset:6144
 v_mfma_f32_16x16x32_bf16 v[144:147], a[32:35], a[24:27], v[144:147]
 ds_read_b128 a[76:79], v237 offset:8192
 v_mfma_f32_16x16x32_bf16 v[168:171], a[32:35], a[28:31], v[168:171]
 ds_read_b128 a[80:83], v237 offset:10240
 v_mfma_f32_16x16x32_bf16 v[172:175], a[36:39], a[28:31], v[172:175]
 ds_read_b128 a[84:87], v237 offset:12288
 v_mfma_f32_16x16x32_bf16 v[148:151], a[36:39], a[24:27], v[148:151]
 ds_read_b128 a[88:91], v237 offset:14336
 v_mfma_f32_16x16x32_bf16 v[124:127], a[36:39], a[20:23], v[124:127]
 ds_read_b64_tr_b16 a[96:97], v239 offset:36864
 v_mfma_f32_16x16x32_bf16 v[100:103], a[36:39], a[16:19], v[100:103]
 ds_read_b64_tr_b16 a[98:99], v239 offset:37376
 v_mfma_f32_16x16x32_bf16 v[76:79], a[36:39], a[12:15], v[76:79]
 ds_read_b64_tr_b16 a[100:101], v238 offset:37888
 v_mfma_f32_16x16x32_bf16 v[52:55], a[36:39], a[8:11], v[52:55]
 ds_read_b64_tr_b16 a[102:103], v238 offset:38400
 v_mfma_f32_16x16x32_bf16 v[28:31], a[36:39], a[4:7], v[28:31]
 ds_read_b64_tr_b16 a[104:105], v239 offset:37888
 v_mfma_f32_16x16x32_bf16 v[4:7], a[36:39], a[0:3], v[4:7]
 ds_read_b64_tr_b16 a[106:107], v239 offset:38400
 v_mfma_f32_16x16x32_bf16 v[8:11], a[40:43], a[0:3], v[8:11]
 ds_read_b64_tr_b16 a[108:109], v238 offset:38912
 v_mfma_f32_16x16x32_bf16 v[32:35], a[40:43], a[4:7], v[32:35]
 ds_read_b64_tr_b16 a[110:111], v238 offset:39424
 v_mfma_f32_16x16x32_bf16 v[56:59], a[40:43], a[8:11], v[56:59]
 ds_read_b64_tr_b16 a[112:113], v239 offset:38912
 v_mfma_f32_16x16x32_bf16 v[80:83], a[40:43], a[12:15], v[80:83]
 ds_read_b64_tr_b16 a[114:115], v239 offset:39424
 v_mfma_f32_16x16x32_bf16 v[104:107], a[40:43], a[16:19], v[104:107]
 ds_read_b64_tr_b16 a[116:117], v240 offset:2048
 v_mfma_f32_16x16x32_bf16 v[128:131], a[40:43], a[20:23], v[128:131]
 ds_read_b64_tr_b16 a[118:119], v240 offset:2304
 v_mfma_f32_16x16x32_bf16 v[152:155], a[40:43], a[24:27], v[152:155]
 ds_read_b32 v200, v248 offset:1024
 v_mfma_f32_16x16x32_bf16 v[176:179], a[40:43], a[28:31], v[176:179]
 ds_read_b32 v201, v248 offset:1088
 v_mfma_f32_16x16x32_bf16 v[180:183], a[44:47], a[28:31], v[180:183]
 ds_read_b32 v202, v248 offset:1152
 v_mfma_f32_16x16x32_bf16 v[156:159], a[44:47], a[24:27], v[156:159]
 ds_read_b32 v203, v248 offset:1216
 v_mfma_f32_16x16x32_bf16 v[132:135], a[44:47], a[20:23], v[132:135]
 ds_read_b32 v204, v248 offset:1280
 v_mfma_f32_16x16x32_bf16 v[108:111], a[44:47], a[16:19], v[108:111]
 v_mfma_f32_16x16x32_bf16 v[84:87], a[44:47], a[12:15], v[84:87]
 ds_read_b32 v205, v248 offset:1344
 v_mfma_f32_16x16x32_bf16 v[60:63], a[44:47], a[8:11], v[60:63]
 ds_read_b32 v206, v248 offset:1408
 v_mfma_f32_16x16x32_bf16 v[36:39], a[44:47], a[4:7], v[36:39]
 ds_read_b32 v207, v248 offset:1472
 v_mfma_f32_16x16x32_bf16 v[12:15], a[44:47], a[0:3], v[12:15]
 ds_read_b32 v192, v248
 v_mfma_f32_16x16x32_bf16 v[16:19], a[48:51], a[0:3], v[16:19]
 ds_read_b32 v193, v248 offset:64
 v_mfma_f32_16x16x32_bf16 v[40:43], a[48:51], a[4:7], v[40:43]
 v_mfma_f32_16x16x32_bf16 v[64:67], a[48:51], a[8:11], v[64:67]
 ds_read_b32 v194, v248 offset:128
 v_mfma_f32_16x16x32_bf16 v[88:91], a[48:51], a[12:15], v[88:91]
 ds_read_b32 v195, v248 offset:192
 v_mfma_f32_16x16x32_bf16 v[112:115], a[48:51], a[16:19], v[112:115]
 ds_read_b32 v196, v248 offset:256
 v_mfma_f32_16x16x32_bf16 v[136:139], a[48:51], a[20:23], v[136:139]
 ds_read_b32 v197, v248 offset:320
 v_mfma_f32_16x16x32_bf16 v[160:163], a[48:51], a[24:27], v[160:163]
 v_mfma_f32_16x16x32_bf16 v[184:187], a[48:51], a[28:31], v[184:187]
 ds_read_b32 v198, v248 offset:384
 v_mfma_f32_16x16x32_bf16 v[188:191], a[52:55], a[28:31], v[188:191]
 ds_read_b32 v199, v248 offset:448
 v_mfma_f32_16x16x32_bf16 v[164:167], a[52:55], a[24:27], v[164:167]
 ds_read_b128 v[208:211], v249
 v_mfma_f32_16x16x32_bf16 v[140:143], a[52:55], a[20:23], v[140:143]
 ds_read_b128 v[212:215], v249 offset:64
 v_mfma_f32_16x16x32_bf16 v[116:119], a[52:55], a[16:19], v[116:119]
 ds_read_b128 v[216:219], v249 offset:256
 v_mfma_f32_16x16x32_bf16 v[92:95], a[52:55], a[12:15], v[92:95]
 v_mfma_f32_16x16x32_bf16 v[68:71], a[52:55], a[8:11], v[68:71]
 ds_read_b128 v[220:223], v249 offset:320
 v_mfma_f32_16x16x32_bf16 v[44:47], a[52:55], a[4:7], v[44:47]
 ds_read_b128 v[224:227], v249 offset:512
 v_mfma_f32_16x16x32_bf16 v[20:23], a[52:55], a[0:3], v[20:23]
 ds_read_b128 v[228:231], v249 offset:576
 v_mfma_f32_16x16x32_bf16 a[160:163], a[56:59], a[0:3], a[160:163]
 ds_read_b128 v[232:235], v249 offset:768
 v_mfma_f32_16x16x32_bf16 a[164:167], a[56:59], a[4:7], a[164:167]
 buffer_load_dwordx4 v245, s[12:15], s35 offen offset:1024 lds
 v_mfma_f32_16x16x32_bf16 a[168:171], a[56:59], a[8:11], a[168:171]
 v_mfma_f32_16x16x32_bf16 a[172:175], a[56:59], a[12:15], a[172:175]
 buffer_load_dwordx4 v246, s[12:15], s35 offen offset:2048 lds
 v_mfma_f32_16x16x32_bf16 a[176:179], a[56:59], a[16:19], a[176:179]
 buffer_load_dwordx4 v247, s[12:15], s35 offen offset:3072 lds
 v_mfma_f32_16x16x32_bf16 a[180:183], a[56:59], a[20:23], a[180:183]
 s_add_u32 s4, s37, 98304
 s_and_b32 m0, s4, 0x1ffff
 s_add_u32 s35, s33, 786432
 buffer_load_dwordx4 v244, s[12:15], s35 offen lds
 v_mfma_f32_16x16x32_bf16 a[184:187], a[56:59], a[24:27], a[184:187]
 buffer_load_dwordx4 v245, s[12:15], s35 offen offset:1024 lds
 v_mfma_f32_16x16x32_bf16 a[188:191], a[56:59], a[28:31], a[188:191]
 s_waitcnt lgkmcnt(0)
 s_barrier
 v_mfma_f32_16x16x32_bf16 v[0:3], a[92:95], a[60:63], v[0:3]
 v_mul_f32 v200, 0xbfb8aa3b, v200
 v_mfma_f32_16x16x32_bf16 v[24:27], a[92:95], a[64:67], v[24:27]
 v_mul_f32 v201, 0xbfb8aa3b, v201
 v_mfma_f32_16x16x32_bf16 v[48:51], a[92:95], a[68:71], v[48:51]
 s_add_u32 s4, s37, 0
 s_and_b32 m0, s4, 0x1ffff
 s_add_u32 s35, s33, 0
 buffer_load_dwordx4 v244, s[12:15], s35 offen lds
 v_mfma_f32_16x16x32_bf16 v[72:75], a[92:95], a[72:75], v[72:75]
 v_mul_f32 v202, 0xbfb8aa3b, v202
 v_mfma_f32_16x16x32_bf16 v[96:99], a[92:95], a[76:79], v[96:99]
 v_mul_f32 v203, 0xbfb8aa3b, v203
 v_mfma_f32_16x16x32_bf16 v[120:123], a[92:95], a[80:83], v[120:123]
 v_mul_f32 v204, 0xbfb8aa3b, v204
 v_mfma_f32_16x16x32_bf16 v[144:147], a[92:95], a[84:87], v[144:147]
 buffer_load_dwordx4 v245, s[12:15], s35 offen offset:1024 lds
 v_mfma_f32_16x16x32_bf16 v[168:171], a[92:95], a[88:91], v[168:171]
 v_mul_f32 v205, 0xbfb8aa3b, v205
 v_mfma_f32_16x16x32_bf16 v[172:175], a[96:99], a[88:91], v[172:175]
 v_mul_f32 v206, 0xbfb8aa3b, v206
 v_mfma_f32_16x16x32_bf16 v[148:151], a[96:99], a[84:87], v[148:151]
 v_mul_f32 v207, 0xbfb8aa3b, v207
 v_mfma_f32_16x16x32_bf16 v[124:127], a[96:99], a[80:83], v[124:127]
 v_lshrrev_b32_e64 v236, 3, v255
 v_mfma_f32_16x16x32_bf16 v[100:103], a[96:99], a[76:79], v[100:103]
 buffer_load_dwordx4 v246, s[12:15], s35 offen offset:2048 lds
 v_mfma_f32_16x16x32_bf16 v[76:79], a[96:99], a[72:75], v[76:79]
 v_and_b32_e64 v237, 7, v255
 v_mfma_f32_16x16x32_bf16 v[52:55], a[96:99], a[68:71], v[52:55]
 v_add_u32_e64 v248, s70, v236
 v_mfma_f32_16x16x32_bf16 v[28:31], a[96:99], a[64:67], v[28:31]
 v_mul_u32_u24_e64 v238, 37, v248
 v_mfma_f32_16x16x32_bf16 v[4:7], a[96:99], a[60:63], v[4:7]
 buffer_load_dwordx4 v247, s[12:15], s35 offen offset:3072 lds
 v_mfma_f32_16x16x32_bf16 v[8:11], a[100:103], a[60:63], v[8:11]
 v_lshrrev_b32_e64 v238, 8, v238
 v_mfma_f32_16x16x32_bf16 v[32:35], a[100:103], a[64:67], v[32:35]
 v_add3_u32 v248, v248, v238, -4
 v_mfma_f32_16x16x32_bf16 v[56:59], a[100:103], a[68:71], v[56:59]
 v_lshlrev_b32_e64 v248, 7, v248
 v_mfma_f32_16x16x32_bf16 v[80:83], a[100:103], a[72:75], v[80:83]
 v_lshl_add_u32 v248, v237, 4, v248
 v_mfma_f32_16x16x32_bf16 v[104:107], a[100:103], a[76:79], v[104:107]
 s_add_u32 s4, s37, 16384
 s_and_b32 m0, s4, 0x1ffff
 s_add_u32 s35, s33, 131072
 buffer_load_dwordx4 v244, s[12:15], s35 offen lds
 v_mfma_f32_16x16x32_bf16 v[128:131], a[100:103], a[80:83], v[128:131]
 s_add_u32 s70, s70, 16
 v_mfma_f32_16x16x32_bf16 v[152:155], a[100:103], a[84:87], v[152:155]
 v_add_u32 v249, s70, v236
 v_mfma_f32_16x16x32_bf16 v[176:179], a[100:103], a[88:91], v[176:179]
 v_mul_u32_u24_e64 v238, 37, v249
 v_mfma_f32_16x16x32_bf16 v[180:183], a[104:107], a[88:91], v[180:183]
 buffer_load_dwordx4 v245, s[12:15], s35 offen offset:1024 lds
 v_mfma_f32_16x16x32_bf16 v[156:159], a[104:107], a[84:87], v[156:159]
 v_lshrrev_b32_e64 v238, 8, v238
 v_mfma_f32_16x16x32_bf16 v[132:135], a[104:107], a[80:83], v[132:135]
 v_add3_u32 v249, v249, v238, -4
 v_mfma_f32_16x16x32_bf16 v[108:111], a[104:107], a[76:79], v[108:111]
 v_mfma_f32_16x16x32_bf16 v[84:87], a[104:107], a[72:75], v[84:87]
 v_lshlrev_b32_e64 v249, 7, v249
 v_mfma_f32_16x16x32_bf16 v[60:63], a[104:107], a[68:71], v[60:63]
 v_lshl_add_u32 v249, v237, 4, v249
 v_mfma_f32_16x16x32_bf16 v[36:39], a[104:107], a[64:67], v[36:39]
 buffer_load_dwordx4 v246, s[12:15], s35 offen offset:2048 lds
 v_mfma_f32_16x16x32_bf16 v[12:15], a[104:107], a[60:63], v[12:15]
 s_add_u32 s70, s70, 16
 v_mfma_f32_16x16x32_bf16 v[16:19], a[108:111], a[60:63], v[16:19]
 v_add_u32 v250, s70, v236
 v_mfma_f32_16x16x32_bf16 v[40:43], a[108:111], a[64:67], v[40:43]
 v_mul_u32_u24_e64 v238, 37, v250
 v_mfma_f32_16x16x32_bf16 v[64:67], a[108:111], a[68:71], v[64:67]
 buffer_load_dwordx4 v247, s[12:15], s35 offen offset:3072 lds
 v_mfma_f32_16x16x32_bf16 v[88:91], a[108:111], a[72:75], v[88:91]
 v_lshrrev_b32_e64 v238, 8, v238
 v_mfma_f32_16x16x32_bf16 v[112:115], a[108:111], a[76:79], v[112:115]
 v_add3_u32 v250, v250, v238, -4
 v_mfma_f32_16x16x32_bf16 v[136:139], a[108:111], a[80:83], v[136:139]
 v_lshlrev_b32_e64 v250, 7, v250
 v_mfma_f32_16x16x32_bf16 v[160:163], a[108:111], a[84:87], v[160:163]
 v_lshl_add_u32 v250, v237, 4, v250
 v_mfma_f32_16x16x32_bf16 v[184:187], a[108:111], a[88:91], v[184:187]
 s_add_u32 s4, s37, 32768
 s_and_b32 m0, s4, 0x1ffff
 s_add_u32 s35, s33, 262144
 buffer_load_dwordx4 v244, s[12:15], s35 offen lds
 v_mfma_f32_16x16x32_bf16 v[188:191], a[112:115], a[88:91], v[188:191]
 v_and_b32_e64 v236, 3, v236
 v_mfma_f32_16x16x32_bf16 v[164:167], a[112:115], a[84:87], v[164:167]
 s_lshl_b32 s3, s30, 2
 v_mfma_f32_16x16x32_bf16 v[140:143], a[112:115], a[80:83], v[140:143]
 v_add_u32 v236, s3, v236
 v_mfma_f32_16x16x32_bf16 v[116:119], a[112:115], a[76:79], v[116:119]
 buffer_load_dwordx4 v245, s[12:15], s35 offen offset:1024 lds
 v_mfma_f32_16x16x32_bf16 v[92:95], a[112:115], a[72:75], v[92:95]
 v_add_u32_e64 v251, s71, v236
 v_mfma_f32_16x16x32_bf16 v[68:71], a[112:115], a[68:71], v[68:71]
 v_mul_u32_u24_e64 v238, 37, v251
 v_mfma_f32_16x16x32_bf16 v[44:47], a[112:115], a[64:67], v[44:47]
 v_lshrrev_b32_e64 v238, 8, v238
 v_mfma_f32_16x16x32_bf16 v[20:23], a[112:115], a[60:63], v[20:23]
 v_add3_u32 v251, v251, v238, -4
 v_mfma_f32_16x16x32_bf16 a[160:163], a[116:119], a[60:63], a[160:163]
 buffer_load_dwordx4 v246, s[12:15], s35 offen offset:2048 lds
 v_mfma_f32_16x16x32_bf16 a[164:167], a[116:119], a[64:67], a[164:167]
 v_lshlrev_b32_e64 v251, 7, v251
 v_mfma_f32_16x16x32_bf16 a[168:171], a[116:119], a[68:71], a[168:171]
 v_lshl_add_u32 v251, v237, 4, v251
 v_mfma_f32_16x16x32_bf16 a[172:175], a[116:119], a[72:75], a[172:175]
 v_lshrrev_b32_e64 v236, 5, v255
 v_mfma_f32_16x16x32_bf16 a[176:179], a[116:119], a[76:79], a[176:179]
 buffer_load_dwordx4 v247, s[12:15], s35 offen offset:3072 lds
 v_mfma_f32_16x16x32_bf16 a[180:183], a[116:119], a[80:83], a[180:183]
 s_mov_b32 s3, 172032
 v_mfma_f32_16x16x32_bf16 a[184:187], a[116:119], a[84:87], a[184:187]
 v_mad_u32_u24 v251, v236, s3, v251
 v_mfma_f32_16x16x32_bf16 a[188:191], a[116:119], a[88:91], a[188:191]
 v_pk_fma_f32 v[0:1], v[208:209], v[192:193], v[0:1] op_sel:[0,0,0] op_sel_hi:[1,0,1] neg_lo:[1,0,0] neg_hi:[1,0,0]
 v_pk_fma_f32 v[2:3], v[210:211], v[192:193], v[2:3] op_sel:[0,0,0] op_sel_hi:[1,0,1] neg_lo:[1,0,0] neg_hi:[1,0,0]
 v_pk_fma_f32 v[4:5], v[212:213], v[192:193], v[4:5] op_sel:[0,0,0] op_sel_hi:[1,0,1] neg_lo:[1,0,0] neg_hi:[1,0,0]
 v_pk_fma_f32 v[6:7], v[214:215], v[192:193], v[6:7] op_sel:[0,0,0] op_sel_hi:[1,0,1] neg_lo:[1,0,0] neg_hi:[1,0,0]
 v_pk_mul_f32 v[0:1], v[0:1], v[200:201] op_sel:[0,0] op_sel_hi:[1,0]
 v_pk_mul_f32 v[2:3], v[2:3], v[200:201] op_sel:[0,0] op_sel_hi:[1,0]
 v_pk_mul_f32 v[4:5], v[4:5], v[200:201] op_sel:[0,0] op_sel_hi:[1,0]
 v_pk_mul_f32 v[6:7], v[6:7], v[200:201] op_sel:[0,0] op_sel_hi:[1,0]
 v_exp_f32 v236, v0
 v_exp_f32 v237, v1
 v_exp_f32 v238, v2
 v_exp_f32 v239, v3
 v_exp_f32 v240, v4
 v_exp_f32 v241, v5
 v_exp_f32 v242, v6
 v_exp_f32 v243, v7
 v_pk_add_f32 v[236:237], v[236:237], 1.0 op_sel_hi:[1,0]
 v_pk_add_f32 v[238:239], v[238:239], 1.0 op_sel_hi:[1,0]
 v_pk_add_f32 v[240:241], v[240:241], 1.0 op_sel_hi:[1,0]
 v_pk_add_f32 v[242:243], v[242:243], 1.0 op_sel_hi:[1,0]
 v_rcp_f32 v236, v236
 v_rcp_f32 v237, v237
 v_rcp_f32 v238, v238
 v_rcp_f32 v239, v239
 v_rcp_f32 v240, v240
 v_rcp_f32 v241, v241
 v_rcp_f32 v242, v242
 v_rcp_f32 v243, v243
 v_pk_mul_f32 v[236:237], v[236:237], v[0:1]
 v_pk_mul_f32 v[238:239], v[238:239], v[2:3]
 v_pk_mul_f32 v[240:241], v[240:241], v[4:5]
 v_pk_mul_f32 v[242:243], v[242:243], v[6:7]
 v_cvt_pk_bf16_f32 v0, v236, v237
 v_cvt_pk_bf16_f32 v1, v238, v239
 v_cvt_pk_bf16_f32 v2, v240, v241
 v_cvt_pk_bf16_f32 v3, v242, v243
 buffer_store_dwordx4 v[0:3], v248, s[16:19], s68 offen sc1
 v_pk_fma_f32 v[8:9], v[216:217], v[192:193], v[8:9] op_sel:[0,0,0] op_sel_hi:[1,0,1] neg_lo:[1,0,0] neg_hi:[1,0,0]
 v_pk_fma_f32 v[10:11], v[218:219], v[192:193], v[10:11] op_sel:[0,0,0] op_sel_hi:[1,0,1] neg_lo:[1,0,0] neg_hi:[1,0,0]
 v_pk_fma_f32 v[12:13], v[220:221], v[192:193], v[12:13] op_sel:[0,0,0] op_sel_hi:[1,0,1] neg_lo:[1,0,0] neg_hi:[1,0,0]
 v_pk_fma_f32 v[14:15], v[222:223], v[192:193], v[14:15] op_sel:[0,0,0] op_sel_hi:[1,0,1] neg_lo:[1,0,0] neg_hi:[1,0,0]
 v_pk_mul_f32 v[8:9], v[8:9], v[200:201] op_sel:[0,0] op_sel_hi:[1,0]
 v_pk_mul_f32 v[10:11], v[10:11], v[200:201] op_sel:[0,0] op_sel_hi:[1,0]
 v_pk_mul_f32 v[12:13], v[12:13], v[200:201] op_sel:[0,0] op_sel_hi:[1,0]
 v_pk_mul_f32 v[14:15], v[14:15], v[200:201] op_sel:[0,0] op_sel_hi:[1,0]
 v_exp_f32 v236, v8
 v_exp_f32 v237, v9
 v_exp_f32 v238, v10
 v_exp_f32 v239, v11
 v_exp_f32 v240, v12
 v_exp_f32 v241, v13
 v_exp_f32 v242, v14
 v_exp_f32 v243, v15
 v_pk_add_f32 v[236:237], v[236:237], 1.0 op_sel_hi:[1,0]
 v_pk_add_f32 v[238:239], v[238:239], 1.0 op_sel_hi:[1,0]
 v_pk_add_f32 v[240:241], v[240:241], 1.0 op_sel_hi:[1,0]
 v_pk_add_f32 v[242:243], v[242:243], 1.0 op_sel_hi:[1,0]
 v_rcp_f32 v236, v236
 v_rcp_f32 v237, v237
 v_rcp_f32 v238, v238
 v_rcp_f32 v239, v239
 v_rcp_f32 v240, v240
 v_rcp_f32 v241, v241
 v_rcp_f32 v242, v242
 v_rcp_f32 v243, v243
 v_pk_mul_f32 v[236:237], v[236:237], v[8:9]
 v_pk_mul_f32 v[238:239], v[238:239], v[10:11]
 v_pk_mul_f32 v[240:241], v[240:241], v[12:13]
 v_pk_mul_f32 v[242:243], v[242:243], v[14:15]
 v_cvt_pk_bf16_f32 v8, v236, v237
 v_cvt_pk_bf16_f32 v9, v238, v239
 v_cvt_pk_bf16_f32 v10, v240, v241
 v_cvt_pk_bf16_f32 v11, v242, v243
 buffer_store_dwordx4 v[8:11], v249, s[16:19], s68 offen sc1
 v_pk_fma_f32 v[16:17], v[224:225], v[192:193], v[16:17] op_sel:[0,0,0] op_sel_hi:[1,0,1] neg_lo:[1,0,0] neg_hi:[1,0,0]
 v_pk_fma_f32 v[18:19], v[226:227], v[192:193], v[18:19] op_sel:[0,0,0] op_sel_hi:[1,0,1] neg_lo:[1,0,0] neg_hi:[1,0,0]
 v_pk_fma_f32 v[20:21], v[228:229], v[192:193], v[20:21] op_sel:[0,0,0] op_sel_hi:[1,0,1] neg_lo:[1,0,0] neg_hi:[1,0,0]
 v_pk_fma_f32 v[22:23], v[230:231], v[192:193], v[22:23] op_sel:[0,0,0] op_sel_hi:[1,0,1] neg_lo:[1,0,0] neg_hi:[1,0,0]
 v_pk_mul_f32 v[16:17], v[16:17], v[200:201] op_sel:[0,0] op_sel_hi:[1,0]
 v_pk_mul_f32 v[18:19], v[18:19], v[200:201] op_sel:[0,0] op_sel_hi:[1,0]
 v_pk_mul_f32 v[20:21], v[20:21], v[200:201] op_sel:[0,0] op_sel_hi:[1,0]
 v_pk_mul_f32 v[22:23], v[22:23], v[200:201] op_sel:[0,0] op_sel_hi:[1,0]
 v_exp_f32 v236, v16
 v_exp_f32 v237, v17
 v_exp_f32 v238, v18
 v_exp_f32 v239, v19
 v_exp_f32 v240, v20
 v_exp_f32 v241, v21
 v_exp_f32 v242, v22
 v_exp_f32 v243, v23
 v_pk_add_f32 v[236:237], v[236:237], 1.0 op_sel_hi:[1,0]
 v_pk_add_f32 v[238:239], v[238:239], 1.0 op_sel_hi:[1,0]
 v_pk_add_f32 v[240:241], v[240:241], 1.0 op_sel_hi:[1,0]
 v_pk_add_f32 v[242:243], v[242:243], 1.0 op_sel_hi:[1,0]
 v_rcp_f32 v236, v236
 v_rcp_f32 v237, v237
 v_rcp_f32 v238, v238
 v_rcp_f32 v239, v239
 v_rcp_f32 v240, v240
 v_rcp_f32 v241, v241
 v_rcp_f32 v242, v242
 v_rcp_f32 v243, v243
 v_pk_mul_f32 v[236:237], v[236:237], v[16:17]
 v_pk_mul_f32 v[238:239], v[238:239], v[18:19]
 v_pk_mul_f32 v[240:241], v[240:241], v[20:21]
 v_pk_mul_f32 v[242:243], v[242:243], v[22:23]
 v_cvt_pk_bf16_f32 v16, v236, v237
 v_cvt_pk_bf16_f32 v17, v238, v239
 v_cvt_pk_bf16_f32 v18, v240, v241
 v_cvt_pk_bf16_f32 v19, v242, v243
 buffer_store_dwordx4 v[16:19], v250, s[16:19], s68 offen sc1
 v_accvgpr_read_b32 v240, a160
 v_accvgpr_read_b32 v241, a161
 v_accvgpr_read_b32 v242, a162
 v_accvgpr_read_b32 v243, a163
 v_pk_fma_f32 v[240:241], v[232:233], v[192:193], v[240:241] op_sel:[0,0,0] op_sel_hi:[1,0,1] neg_lo:[1,0,0] neg_hi:[1,0,0]
 v_pk_fma_f32 v[242:243], v[234:235], v[192:193], v[242:243] op_sel:[0,0,0] op_sel_hi:[1,0,1] neg_lo:[1,0,0] neg_hi:[1,0,0]
 v_pk_mul_f32 v[240:241], v[240:241], v[200:201] op_sel:[0,0] op_sel_hi:[1,0]
 v_pk_mul_f32 v[242:243], v[242:243], v[200:201] op_sel:[0,0] op_sel_hi:[1,0]
 v_exp_f32 v236, v240
 v_exp_f32 v237, v241
 v_exp_f32 v238, v242
 v_exp_f32 v239, v243
 v_pk_add_f32 v[236:237], v[236:237], 1.0 op_sel_hi:[1,0]
 v_pk_add_f32 v[238:239], v[238:239], 1.0 op_sel_hi:[1,0]
 v_rcp_f32 v236, v236
 v_rcp_f32 v237, v237
 v_rcp_f32 v238, v238
 v_rcp_f32 v239, v239
 v_pk_mul_f32 v[236:237], v[236:237], v[240:241]
 v_pk_mul_f32 v[238:239], v[238:239], v[242:243]
 v_cvt_pk_bf16_f32 v4, v236, v237
 v_cvt_pk_bf16_f32 v5, v238, v239
 s_add_u32 s68, s68, 172032
 v_pk_fma_f32 v[24:25], v[208:209], v[192:193], v[24:25] op_sel:[0,1,0] op_sel_hi:[1,1,1] neg_lo:[1,0,0] neg_hi:[1,0,0]
 v_pk_fma_f32 v[26:27], v[210:211], v[192:193], v[26:27] op_sel:[0,1,0] op_sel_hi:[1,1,1] neg_lo:[1,0,0] neg_hi:[1,0,0]
 v_pk_fma_f32 v[28:29], v[212:213], v[192:193], v[28:29] op_sel:[0,1,0] op_sel_hi:[1,1,1] neg_lo:[1,0,0] neg_hi:[1,0,0]
 v_pk_fma_f32 v[30:31], v[214:215], v[192:193], v[30:31] op_sel:[0,1,0] op_sel_hi:[1,1,1] neg_lo:[1,0,0] neg_hi:[1,0,0]
 v_pk_mul_f32 v[24:25], v[24:25], v[200:201] op_sel:[0,1] op_sel_hi:[1,1]
 v_pk_mul_f32 v[26:27], v[26:27], v[200:201] op_sel:[0,1] op_sel_hi:[1,1]
 v_pk_mul_f32 v[28:29], v[28:29], v[200:201] op_sel:[0,1] op_sel_hi:[1,1]
 v_pk_mul_f32 v[30:31], v[30:31], v[200:201] op_sel:[0,1] op_sel_hi:[1,1]
 v_exp_f32 v236, v24
 v_exp_f32 v237, v25
 v_exp_f32 v238, v26
 v_exp_f32 v239, v27
 v_exp_f32 v240, v28
 v_exp_f32 v241, v29
 v_exp_f32 v242, v30
 v_exp_f32 v243, v31
 v_pk_add_f32 v[236:237], v[236:237], 1.0 op_sel_hi:[1,0]
 v_pk_add_f32 v[238:239], v[238:239], 1.0 op_sel_hi:[1,0]
 v_pk_add_f32 v[240:241], v[240:241], 1.0 op_sel_hi:[1,0]
 v_pk_add_f32 v[242:243], v[242:243], 1.0 op_sel_hi:[1,0]
 v_rcp_f32 v236, v236
 v_rcp_f32 v237, v237
 v_rcp_f32 v238, v238
 v_rcp_f32 v239, v239
 v_rcp_f32 v240, v240
 v_rcp_f32 v241, v241
 v_rcp_f32 v242, v242
 v_rcp_f32 v243, v243
 v_pk_mul_f32 v[236:237], v[236:237], v[24:25]
 v_pk_mul_f32 v[238:239], v[238:239], v[26:27]
 v_pk_mul_f32 v[240:241], v[240:241], v[28:29]
 v_pk_mul_f32 v[242:243], v[242:243], v[30:31]
 v_cvt_pk_bf16_f32 v24, v236, v237
 v_cvt_pk_bf16_f32 v25, v238, v239
 v_cvt_pk_bf16_f32 v26, v240, v241
 v_cvt_pk_bf16_f32 v27, v242, v243
 buffer_store_dwordx4 v[24:27], v248, s[16:19], s68 offen sc1
 v_pk_fma_f32 v[32:33], v[216:217], v[192:193], v[32:33] op_sel:[0,1,0] op_sel_hi:[1,1,1] neg_lo:[1,0,0] neg_hi:[1,0,0]
 v_pk_fma_f32 v[34:35], v[218:219], v[192:193], v[34:35] op_sel:[0,1,0] op_sel_hi:[1,1,1] neg_lo:[1,0,0] neg_hi:[1,0,0]
 v_pk_fma_f32 v[36:37], v[220:221], v[192:193], v[36:37] op_sel:[0,1,0] op_sel_hi:[1,1,1] neg_lo:[1,0,0] neg_hi:[1,0,0]
 v_pk_fma_f32 v[38:39], v[222:223], v[192:193], v[38:39] op_sel:[0,1,0] op_sel_hi:[1,1,1] neg_lo:[1,0,0] neg_hi:[1,0,0]
 v_pk_mul_f32 v[32:33], v[32:33], v[200:201] op_sel:[0,1] op_sel_hi:[1,1]
 v_pk_mul_f32 v[34:35], v[34:35], v[200:201] op_sel:[0,1] op_sel_hi:[1,1]
 v_pk_mul_f32 v[36:37], v[36:37], v[200:201] op_sel:[0,1] op_sel_hi:[1,1]
 v_pk_mul_f32 v[38:39], v[38:39], v[200:201] op_sel:[0,1] op_sel_hi:[1,1]
 v_exp_f32 v236, v32
 v_exp_f32 v237, v33
 v_exp_f32 v238, v34
 v_exp_f32 v239, v35
 v_exp_f32 v240, v36
 v_exp_f32 v241, v37
 v_exp_f32 v242, v38
 v_exp_f32 v243, v39
 v_pk_add_f32 v[236:237], v[236:237], 1.0 op_sel_hi:[1,0]
 v_pk_add_f32 v[238:239], v[238:239], 1.0 op_sel_hi:[1,0]
 v_pk_add_f32 v[240:241], v[240:241], 1.0 op_sel_hi:[1,0]
 v_pk_add_f32 v[242:243], v[242:243], 1.0 op_sel_hi:[1,0]
 v_rcp_f32 v236, v236
 v_rcp_f32 v237, v237
 v_rcp_f32 v238, v238
 v_rcp_f32 v239, v239
 v_rcp_f32 v240, v240
 v_rcp_f32 v241, v241
 v_rcp_f32 v242, v242
 v_rcp_f32 v243, v243
 v_pk_mul_f32 v[236:237], v[236:237], v[32:33]
 v_pk_mul_f32 v[238:239], v[238:239], v[34:35]
 v_pk_mul_f32 v[240:241], v[240:241], v[36:37]
 v_pk_mul_f32 v[242:243], v[242:243], v[38:39]
 v_cvt_pk_bf16_f32 v32, v236, v237
 v_cvt_pk_bf16_f32 v33, v238, v239
 v_cvt_pk_bf16_f32 v34, v240, v241
 v_cvt_pk_bf16_f32 v35, v242, v243
 buffer_store_dwordx4 v[32:35], v249, s[16:19], s68 offen sc1
 v_pk_fma_f32 v[40:41], v[224:225], v[192:193], v[40:41] op_sel:[0,1,0] op_sel_hi:[1,1,1] neg_lo:[1,0,0] neg_hi:[1,0,0]
 v_pk_fma_f32 v[42:43], v[226:227], v[192:193], v[42:43] op_sel:[0,1,0] op_sel_hi:[1,1,1] neg_lo:[1,0,0] neg_hi:[1,0,0]
 v_pk_fma_f32 v[44:45], v[228:229], v[192:193], v[44:45] op_sel:[0,1,0] op_sel_hi:[1,1,1] neg_lo:[1,0,0] neg_hi:[1,0,0]
 v_pk_fma_f32 v[46:47], v[230:231], v[192:193], v[46:47] op_sel:[0,1,0] op_sel_hi:[1,1,1] neg_lo:[1,0,0] neg_hi:[1,0,0]
 v_pk_mul_f32 v[40:41], v[40:41], v[200:201] op_sel:[0,1] op_sel_hi:[1,1]
 v_pk_mul_f32 v[42:43], v[42:43], v[200:201] op_sel:[0,1] op_sel_hi:[1,1]
 v_pk_mul_f32 v[44:45], v[44:45], v[200:201] op_sel:[0,1] op_sel_hi:[1,1]
 v_pk_mul_f32 v[46:47], v[46:47], v[200:201] op_sel:[0,1] op_sel_hi:[1,1]
 v_exp_f32 v236, v40
 v_exp_f32 v237, v41
 v_exp_f32 v238, v42
 v_exp_f32 v239, v43
 v_exp_f32 v240, v44
 v_exp_f32 v241, v45
 v_exp_f32 v242, v46
 v_exp_f32 v243, v47
 v_pk_add_f32 v[236:237], v[236:237], 1.0 op_sel_hi:[1,0]
 v_pk_add_f32 v[238:239], v[238:239], 1.0 op_sel_hi:[1,0]
 v_pk_add_f32 v[240:241], v[240:241], 1.0 op_sel_hi:[1,0]
 v_pk_add_f32 v[242:243], v[242:243], 1.0 op_sel_hi:[1,0]
 v_rcp_f32 v236, v236
 v_rcp_f32 v237, v237
 v_rcp_f32 v238, v238
 v_rcp_f32 v239, v239
 v_rcp_f32 v240, v240
 v_rcp_f32 v241, v241
 v_rcp_f32 v242, v242
 v_rcp_f32 v243, v243
 v_pk_mul_f32 v[236:237], v[236:237], v[40:41]
 v_pk_mul_f32 v[238:239], v[238:239], v[42:43]
 v_pk_mul_f32 v[240:241], v[240:241], v[44:45]
 v_pk_mul_f32 v[242:243], v[242:243], v[46:47]
 v_cvt_pk_bf16_f32 v40, v236, v237
 v_cvt_pk_bf16_f32 v41, v238, v239
 v_cvt_pk_bf16_f32 v42, v240, v241
 v_cvt_pk_bf16_f32 v43, v242, v243
 buffer_store_dwordx4 v[40:43], v250, s[16:19], s68 offen sc1
 v_accvgpr_read_b32 v240, a164
 v_accvgpr_read_b32 v241, a165
 v_accvgpr_read_b32 v242, a166
 v_accvgpr_read_b32 v243, a167
 v_pk_fma_f32 v[240:241], v[232:233], v[192:193], v[240:241] op_sel:[0,1,0] op_sel_hi:[1,1,1] neg_lo:[1,0,0] neg_hi:[1,0,0]
 v_pk_fma_f32 v[242:243], v[234:235], v[192:193], v[242:243] op_sel:[0,1,0] op_sel_hi:[1,1,1] neg_lo:[1,0,0] neg_hi:[1,0,0]
 v_pk_mul_f32 v[240:241], v[240:241], v[200:201] op_sel:[0,1] op_sel_hi:[1,1]
 v_pk_mul_f32 v[242:243], v[242:243], v[200:201] op_sel:[0,1] op_sel_hi:[1,1]
 v_exp_f32 v236, v240
 v_exp_f32 v237, v241
 v_exp_f32 v238, v242
 v_exp_f32 v239, v243
 v_pk_add_f32 v[236:237], v[236:237], 1.0 op_sel_hi:[1,0]
 v_pk_add_f32 v[238:239], v[238:239], 1.0 op_sel_hi:[1,0]
 v_rcp_f32 v236, v236
 v_rcp_f32 v237, v237
 v_rcp_f32 v238, v238
 v_rcp_f32 v239, v239
 v_pk_mul_f32 v[236:237], v[236:237], v[240:241]
 v_pk_mul_f32 v[238:239], v[238:239], v[242:243]
 v_cvt_pk_bf16_f32 v6, v236, v237
 v_cvt_pk_bf16_f32 v7, v238, v239
 s_nop 0
 v_permlane32_swap_b32 v4, v6
 v_permlane32_swap_b32_e64 v5, v7
 buffer_store_dwordx4 v[4:7], v251, s[16:19], s69 offen sc1
 s_add_u32 s69, s69, 344064
 s_add_u32 s68, s68, 172032
 v_pk_fma_f32 v[48:49], v[208:209], v[194:195], v[48:49] op_sel:[0,0,0] op_sel_hi:[1,0,1] neg_lo:[1,0,0] neg_hi:[1,0,0]
 v_pk_fma_f32 v[50:51], v[210:211], v[194:195], v[50:51] op_sel:[0,0,0] op_sel_hi:[1,0,1] neg_lo:[1,0,0] neg_hi:[1,0,0]
 v_pk_fma_f32 v[52:53], v[212:213], v[194:195], v[52:53] op_sel:[0,0,0] op_sel_hi:[1,0,1] neg_lo:[1,0,0] neg_hi:[1,0,0]
 v_pk_fma_f32 v[54:55], v[214:215], v[194:195], v[54:55] op_sel:[0,0,0] op_sel_hi:[1,0,1] neg_lo:[1,0,0] neg_hi:[1,0,0]
 v_pk_mul_f32 v[48:49], v[48:49], v[202:203] op_sel:[0,0] op_sel_hi:[1,0]
 v_pk_mul_f32 v[50:51], v[50:51], v[202:203] op_sel:[0,0] op_sel_hi:[1,0]
 v_pk_mul_f32 v[52:53], v[52:53], v[202:203] op_sel:[0,0] op_sel_hi:[1,0]
 v_pk_mul_f32 v[54:55], v[54:55], v[202:203] op_sel:[0,0] op_sel_hi:[1,0]
 v_exp_f32 v236, v48
 v_exp_f32 v237, v49
 v_exp_f32 v238, v50
 v_exp_f32 v239, v51
 v_exp_f32 v240, v52
 v_exp_f32 v241, v53
 v_exp_f32 v242, v54
 v_exp_f32 v243, v55
 v_pk_add_f32 v[236:237], v[236:237], 1.0 op_sel_hi:[1,0]
 v_pk_add_f32 v[238:239], v[238:239], 1.0 op_sel_hi:[1,0]
 v_pk_add_f32 v[240:241], v[240:241], 1.0 op_sel_hi:[1,0]
 v_pk_add_f32 v[242:243], v[242:243], 1.0 op_sel_hi:[1,0]
 v_rcp_f32 v236, v236
 v_rcp_f32 v237, v237
 v_rcp_f32 v238, v238
 v_rcp_f32 v239, v239
 v_rcp_f32 v240, v240
 v_rcp_f32 v241, v241
 v_rcp_f32 v242, v242
 v_rcp_f32 v243, v243
 v_pk_mul_f32 v[236:237], v[236:237], v[48:49]
 v_pk_mul_f32 v[238:239], v[238:239], v[50:51]
 v_pk_mul_f32 v[240:241], v[240:241], v[52:53]
 v_pk_mul_f32 v[242:243], v[242:243], v[54:55]
 v_cvt_pk_bf16_f32 v48, v236, v237
 v_cvt_pk_bf16_f32 v49, v238, v239
 v_cvt_pk_bf16_f32 v50, v240, v241
 v_cvt_pk_bf16_f32 v51, v242, v243
 buffer_store_dwordx4 v[48:51], v248, s[16:19], s68 offen sc1
 v_pk_fma_f32 v[56:57], v[216:217], v[194:195], v[56:57] op_sel:[0,0,0] op_sel_hi:[1,0,1] neg_lo:[1,0,0] neg_hi:[1,0,0]
 v_pk_fma_f32 v[58:59], v[218:219], v[194:195], v[58:59] op_sel:[0,0,0] op_sel_hi:[1,0,1] neg_lo:[1,0,0] neg_hi:[1,0,0]
 v_pk_fma_f32 v[60:61], v[220:221], v[194:195], v[60:61] op_sel:[0,0,0] op_sel_hi:[1,0,1] neg_lo:[1,0,0] neg_hi:[1,0,0]
 v_pk_fma_f32 v[62:63], v[222:223], v[194:195], v[62:63] op_sel:[0,0,0] op_sel_hi:[1,0,1] neg_lo:[1,0,0] neg_hi:[1,0,0]
 v_pk_mul_f32 v[56:57], v[56:57], v[202:203] op_sel:[0,0] op_sel_hi:[1,0]
 v_pk_mul_f32 v[58:59], v[58:59], v[202:203] op_sel:[0,0] op_sel_hi:[1,0]
 v_pk_mul_f32 v[60:61], v[60:61], v[202:203] op_sel:[0,0] op_sel_hi:[1,0]
 v_pk_mul_f32 v[62:63], v[62:63], v[202:203] op_sel:[0,0] op_sel_hi:[1,0]
 v_exp_f32 v236, v56
 v_exp_f32 v237, v57
 v_exp_f32 v238, v58
 v_exp_f32 v239, v59
 v_exp_f32 v240, v60
 v_exp_f32 v241, v61
 v_exp_f32 v242, v62
 v_exp_f32 v243, v63
 v_pk_add_f32 v[236:237], v[236:237], 1.0 op_sel_hi:[1,0]
 v_pk_add_f32 v[238:239], v[238:239], 1.0 op_sel_hi:[1,0]
 v_pk_add_f32 v[240:241], v[240:241], 1.0 op_sel_hi:[1,0]
 v_pk_add_f32 v[242:243], v[242:243], 1.0 op_sel_hi:[1,0]
 v_rcp_f32 v236, v236
 v_rcp_f32 v237, v237
 v_rcp_f32 v238, v238
 v_rcp_f32 v239, v239
 v_rcp_f32 v240, v240
 v_rcp_f32 v241, v241
 v_rcp_f32 v242, v242
 v_rcp_f32 v243, v243
 v_pk_mul_f32 v[236:237], v[236:237], v[56:57]
 v_pk_mul_f32 v[238:239], v[238:239], v[58:59]
 v_pk_mul_f32 v[240:241], v[240:241], v[60:61]
 v_pk_mul_f32 v[242:243], v[242:243], v[62:63]
 v_cvt_pk_bf16_f32 v56, v236, v237
 v_cvt_pk_bf16_f32 v57, v238, v239
 v_cvt_pk_bf16_f32 v58, v240, v241
 v_cvt_pk_bf16_f32 v59, v242, v243
 buffer_store_dwordx4 v[56:59], v249, s[16:19], s68 offen sc1
 v_pk_fma_f32 v[64:65], v[224:225], v[194:195], v[64:65] op_sel:[0,0,0] op_sel_hi:[1,0,1] neg_lo:[1,0,0] neg_hi:[1,0,0]
 v_pk_fma_f32 v[66:67], v[226:227], v[194:195], v[66:67] op_sel:[0,0,0] op_sel_hi:[1,0,1] neg_lo:[1,0,0] neg_hi:[1,0,0]
 v_pk_fma_f32 v[68:69], v[228:229], v[194:195], v[68:69] op_sel:[0,0,0] op_sel_hi:[1,0,1] neg_lo:[1,0,0] neg_hi:[1,0,0]
 v_pk_fma_f32 v[70:71], v[230:231], v[194:195], v[70:71] op_sel:[0,0,0] op_sel_hi:[1,0,1] neg_lo:[1,0,0] neg_hi:[1,0,0]
 v_pk_mul_f32 v[64:65], v[64:65], v[202:203] op_sel:[0,0] op_sel_hi:[1,0]
 v_pk_mul_f32 v[66:67], v[66:67], v[202:203] op_sel:[0,0] op_sel_hi:[1,0]
 v_pk_mul_f32 v[68:69], v[68:69], v[202:203] op_sel:[0,0] op_sel_hi:[1,0]
 v_pk_mul_f32 v[70:71], v[70:71], v[202:203] op_sel:[0,0] op_sel_hi:[1,0]
 v_exp_f32 v236, v64
 v_exp_f32 v237, v65
 v_exp_f32 v238, v66
 v_exp_f32 v239, v67
 v_exp_f32 v240, v68
 v_exp_f32 v241, v69
 v_exp_f32 v242, v70
 v_exp_f32 v243, v71
 v_pk_add_f32 v[236:237], v[236:237], 1.0 op_sel_hi:[1,0]
 v_pk_add_f32 v[238:239], v[238:239], 1.0 op_sel_hi:[1,0]
 v_pk_add_f32 v[240:241], v[240:241], 1.0 op_sel_hi:[1,0]
 v_pk_add_f32 v[242:243], v[242:243], 1.0 op_sel_hi:[1,0]
 v_rcp_f32 v236, v236
 v_rcp_f32 v237, v237
 v_rcp_f32 v238, v238
 v_rcp_f32 v239, v239
 v_rcp_f32 v240, v240
 v_rcp_f32 v241, v241
 v_rcp_f32 v242, v242
 v_rcp_f32 v243, v243
 v_pk_mul_f32 v[236:237], v[236:237], v[64:65]
 v_pk_mul_f32 v[238:239], v[238:239], v[66:67]
 v_pk_mul_f32 v[240:241], v[240:241], v[68:69]
 v_pk_mul_f32 v[242:243], v[242:243], v[70:71]
 v_cvt_pk_bf16_f32 v64, v236, v237
 v_cvt_pk_bf16_f32 v65, v238, v239
 v_cvt_pk_bf16_f32 v66, v240, v241
 v_cvt_pk_bf16_f32 v67, v242, v243
 buffer_store_dwordx4 v[64:67], v250, s[16:19], s68 offen sc1
 v_accvgpr_read_b32 v240, a168
 v_accvgpr_read_b32 v241, a169
 v_accvgpr_read_b32 v242, a170
 v_accvgpr_read_b32 v243, a171
 v_pk_fma_f32 v[240:241], v[232:233], v[194:195], v[240:241] op_sel:[0,0,0] op_sel_hi:[1,0,1] neg_lo:[1,0,0] neg_hi:[1,0,0]
 v_pk_fma_f32 v[242:243], v[234:235], v[194:195], v[242:243] op_sel:[0,0,0] op_sel_hi:[1,0,1] neg_lo:[1,0,0] neg_hi:[1,0,0]
 v_pk_mul_f32 v[240:241], v[240:241], v[202:203] op_sel:[0,0] op_sel_hi:[1,0]
 v_pk_mul_f32 v[242:243], v[242:243], v[202:203] op_sel:[0,0] op_sel_hi:[1,0]
 v_exp_f32 v236, v240
 v_exp_f32 v237, v241
 v_exp_f32 v238, v242
 v_exp_f32 v239, v243
 v_pk_add_f32 v[236:237], v[236:237], 1.0 op_sel_hi:[1,0]
 v_pk_add_f32 v[238:239], v[238:239], 1.0 op_sel_hi:[1,0]
 v_rcp_f32 v236, v236
 v_rcp_f32 v237, v237
 v_rcp_f32 v238, v238
 v_rcp_f32 v239, v239
 v_pk_mul_f32 v[236:237], v[236:237], v[240:241]
 v_pk_mul_f32 v[238:239], v[238:239], v[242:243]
 v_cvt_pk_bf16_f32 v52, v236, v237
 v_cvt_pk_bf16_f32 v53, v238, v239
 s_add_u32 s68, s68, 172032
 v_pk_fma_f32 v[72:73], v[208:209], v[194:195], v[72:73] op_sel:[0,1,0] op_sel_hi:[1,1,1] neg_lo:[1,0,0] neg_hi:[1,0,0]
 v_pk_fma_f32 v[74:75], v[210:211], v[194:195], v[74:75] op_sel:[0,1,0] op_sel_hi:[1,1,1] neg_lo:[1,0,0] neg_hi:[1,0,0]
 v_pk_fma_f32 v[76:77], v[212:213], v[194:195], v[76:77] op_sel:[0,1,0] op_sel_hi:[1,1,1] neg_lo:[1,0,0] neg_hi:[1,0,0]
 v_pk_fma_f32 v[78:79], v[214:215], v[194:195], v[78:79] op_sel:[0,1,0] op_sel_hi:[1,1,1] neg_lo:[1,0,0] neg_hi:[1,0,0]
 v_pk_mul_f32 v[72:73], v[72:73], v[202:203] op_sel:[0,1] op_sel_hi:[1,1]
 v_pk_mul_f32 v[74:75], v[74:75], v[202:203] op_sel:[0,1] op_sel_hi:[1,1]
 v_pk_mul_f32 v[76:77], v[76:77], v[202:203] op_sel:[0,1] op_sel_hi:[1,1]
 v_pk_mul_f32 v[78:79], v[78:79], v[202:203] op_sel:[0,1] op_sel_hi:[1,1]
 v_exp_f32 v236, v72
 v_exp_f32 v237, v73
 v_exp_f32 v238, v74
 v_exp_f32 v239, v75
 v_exp_f32 v240, v76
 v_exp_f32 v241, v77
 v_exp_f32 v242, v78
 v_exp_f32 v243, v79
 v_pk_add_f32 v[236:237], v[236:237], 1.0 op_sel_hi:[1,0]
 v_pk_add_f32 v[238:239], v[238:239], 1.0 op_sel_hi:[1,0]
 v_pk_add_f32 v[240:241], v[240:241], 1.0 op_sel_hi:[1,0]
 v_pk_add_f32 v[242:243], v[242:243], 1.0 op_sel_hi:[1,0]
 v_rcp_f32 v236, v236
 v_rcp_f32 v237, v237
 v_rcp_f32 v238, v238
 v_rcp_f32 v239, v239
 v_rcp_f32 v240, v240
 v_rcp_f32 v241, v241
 v_rcp_f32 v242, v242
 v_rcp_f32 v243, v243
 v_pk_mul_f32 v[236:237], v[236:237], v[72:73]
 v_pk_mul_f32 v[238:239], v[238:239], v[74:75]
 v_pk_mul_f32 v[240:241], v[240:241], v[76:77]
 v_pk_mul_f32 v[242:243], v[242:243], v[78:79]
 v_cvt_pk_bf16_f32 v72, v236, v237
 v_cvt_pk_bf16_f32 v73, v238, v239
 v_cvt_pk_bf16_f32 v74, v240, v241
 v_cvt_pk_bf16_f32 v75, v242, v243
 buffer_store_dwordx4 v[72:75], v248, s[16:19], s68 offen sc1
 v_pk_fma_f32 v[80:81], v[216:217], v[194:195], v[80:81] op_sel:[0,1,0] op_sel_hi:[1,1,1] neg_lo:[1,0,0] neg_hi:[1,0,0]
 v_pk_fma_f32 v[82:83], v[218:219], v[194:195], v[82:83] op_sel:[0,1,0] op_sel_hi:[1,1,1] neg_lo:[1,0,0] neg_hi:[1,0,0]
 v_pk_fma_f32 v[84:85], v[220:221], v[194:195], v[84:85] op_sel:[0,1,0] op_sel_hi:[1,1,1] neg_lo:[1,0,0] neg_hi:[1,0,0]
 v_pk_fma_f32 v[86:87], v[222:223], v[194:195], v[86:87] op_sel:[0,1,0] op_sel_hi:[1,1,1] neg_lo:[1,0,0] neg_hi:[1,0,0]
 v_pk_mul_f32 v[80:81], v[80:81], v[202:203] op_sel:[0,1] op_sel_hi:[1,1]
 v_pk_mul_f32 v[82:83], v[82:83], v[202:203] op_sel:[0,1] op_sel_hi:[1,1]
 v_pk_mul_f32 v[84:85], v[84:85], v[202:203] op_sel:[0,1] op_sel_hi:[1,1]
 v_pk_mul_f32 v[86:87], v[86:87], v[202:203] op_sel:[0,1] op_sel_hi:[1,1]
 v_exp_f32 v236, v80
 v_exp_f32 v237, v81
 v_exp_f32 v238, v82
 v_exp_f32 v239, v83
 v_exp_f32 v240, v84
 v_exp_f32 v241, v85
 v_exp_f32 v242, v86
 v_exp_f32 v243, v87
 v_pk_add_f32 v[236:237], v[236:237], 1.0 op_sel_hi:[1,0]
 v_pk_add_f32 v[238:239], v[238:239], 1.0 op_sel_hi:[1,0]
 v_pk_add_f32 v[240:241], v[240:241], 1.0 op_sel_hi:[1,0]
 v_pk_add_f32 v[242:243], v[242:243], 1.0 op_sel_hi:[1,0]
 v_rcp_f32 v236, v236
 v_rcp_f32 v237, v237
 v_rcp_f32 v238, v238
 v_rcp_f32 v239, v239
 v_rcp_f32 v240, v240
 v_rcp_f32 v241, v241
 v_rcp_f32 v242, v242
 v_rcp_f32 v243, v243
 v_pk_mul_f32 v[236:237], v[236:237], v[80:81]
 v_pk_mul_f32 v[238:239], v[238:239], v[82:83]
 v_pk_mul_f32 v[240:241], v[240:241], v[84:85]
 v_pk_mul_f32 v[242:243], v[242:243], v[86:87]
 v_cvt_pk_bf16_f32 v80, v236, v237
 v_cvt_pk_bf16_f32 v81, v238, v239
 v_cvt_pk_bf16_f32 v82, v240, v241
 v_cvt_pk_bf16_f32 v83, v242, v243
 buffer_store_dwordx4 v[80:83], v249, s[16:19], s68 offen sc1
 v_pk_fma_f32 v[88:89], v[224:225], v[194:195], v[88:89] op_sel:[0,1,0] op_sel_hi:[1,1,1] neg_lo:[1,0,0] neg_hi:[1,0,0]
 v_pk_fma_f32 v[90:91], v[226:227], v[194:195], v[90:91] op_sel:[0,1,0] op_sel_hi:[1,1,1] neg_lo:[1,0,0] neg_hi:[1,0,0]
 v_pk_fma_f32 v[92:93], v[228:229], v[194:195], v[92:93] op_sel:[0,1,0] op_sel_hi:[1,1,1] neg_lo:[1,0,0] neg_hi:[1,0,0]
 v_pk_fma_f32 v[94:95], v[230:231], v[194:195], v[94:95] op_sel:[0,1,0] op_sel_hi:[1,1,1] neg_lo:[1,0,0] neg_hi:[1,0,0]
 v_pk_mul_f32 v[88:89], v[88:89], v[202:203] op_sel:[0,1] op_sel_hi:[1,1]
 v_pk_mul_f32 v[90:91], v[90:91], v[202:203] op_sel:[0,1] op_sel_hi:[1,1]
 v_pk_mul_f32 v[92:93], v[92:93], v[202:203] op_sel:[0,1] op_sel_hi:[1,1]
 v_pk_mul_f32 v[94:95], v[94:95], v[202:203] op_sel:[0,1] op_sel_hi:[1,1]
 v_exp_f32 v236, v88
 v_exp_f32 v237, v89
 v_exp_f32 v238, v90
 v_exp_f32 v239, v91
 v_exp_f32 v240, v92
 v_exp_f32 v241, v93
 v_exp_f32 v242, v94
 v_exp_f32 v243, v95
 v_pk_add_f32 v[236:237], v[236:237], 1.0 op_sel_hi:[1,0]
 v_pk_add_f32 v[238:239], v[238:239], 1.0 op_sel_hi:[1,0]
 v_pk_add_f32 v[240:241], v[240:241], 1.0 op_sel_hi:[1,0]
 v_pk_add_f32 v[242:243], v[242:243], 1.0 op_sel_hi:[1,0]
 v_rcp_f32 v236, v236
 v_rcp_f32 v237, v237
 v_rcp_f32 v238, v238
 v_rcp_f32 v239, v239
 v_rcp_f32 v240, v240
 v_rcp_f32 v241, v241
 v_rcp_f32 v242, v242
 v_rcp_f32 v243, v243
 v_pk_mul_f32 v[236:237], v[236:237], v[88:89]
 v_pk_mul_f32 v[238:239], v[238:239], v[90:91]
 v_pk_mul_f32 v[240:241], v[240:241], v[92:93]
 v_pk_mul_f32 v[242:243], v[242:243], v[94:95]
 v_cvt_pk_bf16_f32 v88, v236, v237
 v_cvt_pk_bf16_f32 v89, v238, v239
 v_cvt_pk_bf16_f32 v90, v240, v241
 v_cvt_pk_bf16_f32 v91, v242, v243
 buffer_store_dwordx4 v[88:91], v250, s[16:19], s68 offen sc1
 v_accvgpr_read_b32 v240, a172
 v_accvgpr_read_b32 v241, a173
 v_accvgpr_read_b32 v242, a174
 v_accvgpr_read_b32 v243, a175
 v_pk_fma_f32 v[240:241], v[232:233], v[194:195], v[240:241] op_sel:[0,1,0] op_sel_hi:[1,1,1] neg_lo:[1,0,0] neg_hi:[1,0,0]
 v_pk_fma_f32 v[242:243], v[234:235], v[194:195], v[242:243] op_sel:[0,1,0] op_sel_hi:[1,1,1] neg_lo:[1,0,0] neg_hi:[1,0,0]
 v_pk_mul_f32 v[240:241], v[240:241], v[202:203] op_sel:[0,1] op_sel_hi:[1,1]
 v_pk_mul_f32 v[242:243], v[242:243], v[202:203] op_sel:[0,1] op_sel_hi:[1,1]
 v_exp_f32 v236, v240
 v_exp_f32 v237, v241
 v_exp_f32 v238, v242
 v_exp_f32 v239, v243
 v_pk_add_f32 v[236:237], v[236:237], 1.0 op_sel_hi:[1,0]
 v_pk_add_f32 v[238:239], v[238:239], 1.0 op_sel_hi:[1,0]
 v_rcp_f32 v236, v236
 v_rcp_f32 v237, v237
 v_rcp_f32 v238, v238
 v_rcp_f32 v239, v239
 v_pk_mul_f32 v[236:237], v[236:237], v[240:241]
 v_pk_mul_f32 v[238:239], v[238:239], v[242:243]
 v_cvt_pk_bf16_f32 v54, v236, v237
 v_cvt_pk_bf16_f32 v55, v238, v239
 s_nop 0
 v_permlane32_swap_b32 v52, v54
 v_permlane32_swap_b32_e64 v53, v55
 buffer_store_dwordx4 v[52:55], v251, s[16:19], s69 offen sc1
 s_add_u32 s69, s69, 344064
 s_add_u32 s68, s68, 172032
 v_pk_fma_f32 v[96:97], v[208:209], v[196:197], v[96:97] op_sel:[0,0,0] op_sel_hi:[1,0,1] neg_lo:[1,0,0] neg_hi:[1,0,0]
 v_pk_fma_f32 v[98:99], v[210:211], v[196:197], v[98:99] op_sel:[0,0,0] op_sel_hi:[1,0,1] neg_lo:[1,0,0] neg_hi:[1,0,0]
 v_pk_fma_f32 v[100:101], v[212:213], v[196:197], v[100:101] op_sel:[0,0,0] op_sel_hi:[1,0,1] neg_lo:[1,0,0] neg_hi:[1,0,0]
 v_pk_fma_f32 v[102:103], v[214:215], v[196:197], v[102:103] op_sel:[0,0,0] op_sel_hi:[1,0,1] neg_lo:[1,0,0] neg_hi:[1,0,0]
 v_pk_mul_f32 v[96:97], v[96:97], v[204:205] op_sel:[0,0] op_sel_hi:[1,0]
 v_pk_mul_f32 v[98:99], v[98:99], v[204:205] op_sel:[0,0] op_sel_hi:[1,0]
 v_pk_mul_f32 v[100:101], v[100:101], v[204:205] op_sel:[0,0] op_sel_hi:[1,0]
 v_pk_mul_f32 v[102:103], v[102:103], v[204:205] op_sel:[0,0] op_sel_hi:[1,0]
 v_exp_f32 v236, v96
 v_exp_f32 v237, v97
 v_exp_f32 v238, v98
 v_exp_f32 v239, v99
 v_exp_f32 v240, v100
 v_exp_f32 v241, v101
 v_exp_f32 v242, v102
 v_exp_f32 v243, v103
 v_pk_add_f32 v[236:237], v[236:237], 1.0 op_sel_hi:[1,0]
 v_pk_add_f32 v[238:239], v[238:239], 1.0 op_sel_hi:[1,0]
 v_pk_add_f32 v[240:241], v[240:241], 1.0 op_sel_hi:[1,0]
 v_pk_add_f32 v[242:243], v[242:243], 1.0 op_sel_hi:[1,0]
 v_rcp_f32 v236, v236
 v_rcp_f32 v237, v237
 v_rcp_f32 v238, v238
 v_rcp_f32 v239, v239
 v_rcp_f32 v240, v240
 v_rcp_f32 v241, v241
 v_rcp_f32 v242, v242
 v_rcp_f32 v243, v243
 v_pk_mul_f32 v[236:237], v[236:237], v[96:97]
 v_pk_mul_f32 v[238:239], v[238:239], v[98:99]
 v_pk_mul_f32 v[240:241], v[240:241], v[100:101]
 v_pk_mul_f32 v[242:243], v[242:243], v[102:103]
 v_cvt_pk_bf16_f32 v96, v236, v237
 v_cvt_pk_bf16_f32 v97, v238, v239
 v_cvt_pk_bf16_f32 v98, v240, v241
 v_cvt_pk_bf16_f32 v99, v242, v243
 buffer_store_dwordx4 v[96:99], v248, s[16:19], s68 offen sc1
 v_pk_fma_f32 v[104:105], v[216:217], v[196:197], v[104:105] op_sel:[0,0,0] op_sel_hi:[1,0,1] neg_lo:[1,0,0] neg_hi:[1,0,0]
 v_pk_fma_f32 v[106:107], v[218:219], v[196:197], v[106:107] op_sel:[0,0,0] op_sel_hi:[1,0,1] neg_lo:[1,0,0] neg_hi:[1,0,0]
 v_pk_fma_f32 v[108:109], v[220:221], v[196:197], v[108:109] op_sel:[0,0,0] op_sel_hi:[1,0,1] neg_lo:[1,0,0] neg_hi:[1,0,0]
 v_pk_fma_f32 v[110:111], v[222:223], v[196:197], v[110:111] op_sel:[0,0,0] op_sel_hi:[1,0,1] neg_lo:[1,0,0] neg_hi:[1,0,0]
 v_pk_mul_f32 v[104:105], v[104:105], v[204:205] op_sel:[0,0] op_sel_hi:[1,0]
 v_pk_mul_f32 v[106:107], v[106:107], v[204:205] op_sel:[0,0] op_sel_hi:[1,0]
 v_pk_mul_f32 v[108:109], v[108:109], v[204:205] op_sel:[0,0] op_sel_hi:[1,0]
 v_pk_mul_f32 v[110:111], v[110:111], v[204:205] op_sel:[0,0] op_sel_hi:[1,0]
 v_exp_f32 v236, v104
 v_exp_f32 v237, v105
 v_exp_f32 v238, v106
 v_exp_f32 v239, v107
 v_exp_f32 v240, v108
 v_exp_f32 v241, v109
 v_exp_f32 v242, v110
 v_exp_f32 v243, v111
 v_pk_add_f32 v[236:237], v[236:237], 1.0 op_sel_hi:[1,0]
 v_pk_add_f32 v[238:239], v[238:239], 1.0 op_sel_hi:[1,0]
 v_pk_add_f32 v[240:241], v[240:241], 1.0 op_sel_hi:[1,0]
 v_pk_add_f32 v[242:243], v[242:243], 1.0 op_sel_hi:[1,0]
 v_rcp_f32 v236, v236
 v_rcp_f32 v237, v237
 v_rcp_f32 v238, v238
 v_rcp_f32 v239, v239
 v_rcp_f32 v240, v240
 v_rcp_f32 v241, v241
 v_rcp_f32 v242, v242
 v_rcp_f32 v243, v243
 v_pk_mul_f32 v[236:237], v[236:237], v[104:105]
 v_pk_mul_f32 v[238:239], v[238:239], v[106:107]
 v_pk_mul_f32 v[240:241], v[240:241], v[108:109]
 v_pk_mul_f32 v[242:243], v[242:243], v[110:111]
 v_cvt_pk_bf16_f32 v104, v236, v237
 v_cvt_pk_bf16_f32 v105, v238, v239
 v_cvt_pk_bf16_f32 v106, v240, v241
 v_cvt_pk_bf16_f32 v107, v242, v243
 buffer_store_dwordx4 v[104:107], v249, s[16:19], s68 offen sc1
 v_pk_fma_f32 v[112:113], v[224:225], v[196:197], v[112:113] op_sel:[0,0,0] op_sel_hi:[1,0,1] neg_lo:[1,0,0] neg_hi:[1,0,0]
 v_pk_fma_f32 v[114:115], v[226:227], v[196:197], v[114:115] op_sel:[0,0,0] op_sel_hi:[1,0,1] neg_lo:[1,0,0] neg_hi:[1,0,0]
 v_pk_fma_f32 v[116:117], v[228:229], v[196:197], v[116:117] op_sel:[0,0,0] op_sel_hi:[1,0,1] neg_lo:[1,0,0] neg_hi:[1,0,0]
 v_pk_fma_f32 v[118:119], v[230:231], v[196:197], v[118:119] op_sel:[0,0,0] op_sel_hi:[1,0,1] neg_lo:[1,0,0] neg_hi:[1,0,0]
 v_pk_mul_f32 v[112:113], v[112:113], v[204:205] op_sel:[0,0] op_sel_hi:[1,0]
 v_pk_mul_f32 v[114:115], v[114:115], v[204:205] op_sel:[0,0] op_sel_hi:[1,0]
 v_pk_mul_f32 v[116:117], v[116:117], v[204:205] op_sel:[0,0] op_sel_hi:[1,0]
 v_pk_mul_f32 v[118:119], v[118:119], v[204:205] op_sel:[0,0] op_sel_hi:[1,0]
 v_exp_f32 v236, v112
 v_exp_f32 v237, v113
 v_exp_f32 v238, v114
 v_exp_f32 v239, v115
 v_exp_f32 v240, v116
 v_exp_f32 v241, v117
 v_exp_f32 v242, v118
 v_exp_f32 v243, v119
 v_pk_add_f32 v[236:237], v[236:237], 1.0 op_sel_hi:[1,0]
 v_pk_add_f32 v[238:239], v[238:239], 1.0 op_sel_hi:[1,0]
 v_pk_add_f32 v[240:241], v[240:241], 1.0 op_sel_hi:[1,0]
 v_pk_add_f32 v[242:243], v[242:243], 1.0 op_sel_hi:[1,0]
 v_rcp_f32 v236, v236
 v_rcp_f32 v237, v237
 v_rcp_f32 v238, v238
 v_rcp_f32 v239, v239
 v_rcp_f32 v240, v240
 v_rcp_f32 v241, v241
 v_rcp_f32 v242, v242
 v_rcp_f32 v243, v243
 v_pk_mul_f32 v[236:237], v[236:237], v[112:113]
 v_pk_mul_f32 v[238:239], v[238:239], v[114:115]
 v_pk_mul_f32 v[240:241], v[240:241], v[116:117]
 v_pk_mul_f32 v[242:243], v[242:243], v[118:119]
 v_cvt_pk_bf16_f32 v112, v236, v237
 v_cvt_pk_bf16_f32 v113, v238, v239
 v_cvt_pk_bf16_f32 v114, v240, v241
 v_cvt_pk_bf16_f32 v115, v242, v243
 buffer_store_dwordx4 v[112:115], v250, s[16:19], s68 offen sc1
 v_accvgpr_read_b32 v240, a176
 v_accvgpr_read_b32 v241, a177
 v_accvgpr_read_b32 v242, a178
 v_accvgpr_read_b32 v243, a179
 v_pk_fma_f32 v[240:241], v[232:233], v[196:197], v[240:241] op_sel:[0,0,0] op_sel_hi:[1,0,1] neg_lo:[1,0,0] neg_hi:[1,0,0]
 v_pk_fma_f32 v[242:243], v[234:235], v[196:197], v[242:243] op_sel:[0,0,0] op_sel_hi:[1,0,1] neg_lo:[1,0,0] neg_hi:[1,0,0]
 v_pk_mul_f32 v[240:241], v[240:241], v[204:205] op_sel:[0,0] op_sel_hi:[1,0]
 v_pk_mul_f32 v[242:243], v[242:243], v[204:205] op_sel:[0,0] op_sel_hi:[1,0]
 v_exp_f32 v236, v240
 v_exp_f32 v237, v241
 v_exp_f32 v238, v242
 v_exp_f32 v239, v243
 v_pk_add_f32 v[236:237], v[236:237], 1.0 op_sel_hi:[1,0]
 v_pk_add_f32 v[238:239], v[238:239], 1.0 op_sel_hi:[1,0]
 v_rcp_f32 v236, v236
 v_rcp_f32 v237, v237
 v_rcp_f32 v238, v238
 v_rcp_f32 v239, v239
 v_pk_mul_f32 v[236:237], v[236:237], v[240:241]
 v_pk_mul_f32 v[238:239], v[238:239], v[242:243]
 v_cvt_pk_bf16_f32 v100, v236, v237
 v_cvt_pk_bf16_f32 v101, v238, v239
 s_add_u32 s68, s68, 172032
 v_pk_fma_f32 v[120:121], v[208:209], v[196:197], v[120:121] op_sel:[0,1,0] op_sel_hi:[1,1,1] neg_lo:[1,0,0] neg_hi:[1,0,0]
 v_pk_fma_f32 v[122:123], v[210:211], v[196:197], v[122:123] op_sel:[0,1,0] op_sel_hi:[1,1,1] neg_lo:[1,0,0] neg_hi:[1,0,0]
 v_pk_fma_f32 v[124:125], v[212:213], v[196:197], v[124:125] op_sel:[0,1,0] op_sel_hi:[1,1,1] neg_lo:[1,0,0] neg_hi:[1,0,0]
 v_pk_fma_f32 v[126:127], v[214:215], v[196:197], v[126:127] op_sel:[0,1,0] op_sel_hi:[1,1,1] neg_lo:[1,0,0] neg_hi:[1,0,0]
 v_pk_mul_f32 v[120:121], v[120:121], v[204:205] op_sel:[0,1] op_sel_hi:[1,1]
 v_pk_mul_f32 v[122:123], v[122:123], v[204:205] op_sel:[0,1] op_sel_hi:[1,1]
 v_pk_mul_f32 v[124:125], v[124:125], v[204:205] op_sel:[0,1] op_sel_hi:[1,1]
 v_pk_mul_f32 v[126:127], v[126:127], v[204:205] op_sel:[0,1] op_sel_hi:[1,1]
 v_exp_f32 v236, v120
 v_exp_f32 v237, v121
 v_exp_f32 v238, v122
 v_exp_f32 v239, v123
 v_exp_f32 v240, v124
 v_exp_f32 v241, v125
 v_exp_f32 v242, v126
 v_exp_f32 v243, v127
 v_pk_add_f32 v[236:237], v[236:237], 1.0 op_sel_hi:[1,0]
 v_pk_add_f32 v[238:239], v[238:239], 1.0 op_sel_hi:[1,0]
 v_pk_add_f32 v[240:241], v[240:241], 1.0 op_sel_hi:[1,0]
 v_pk_add_f32 v[242:243], v[242:243], 1.0 op_sel_hi:[1,0]
 v_rcp_f32 v236, v236
 v_rcp_f32 v237, v237
 v_rcp_f32 v238, v238
 v_rcp_f32 v239, v239
 v_rcp_f32 v240, v240
 v_rcp_f32 v241, v241
 v_rcp_f32 v242, v242
 v_rcp_f32 v243, v243
 v_pk_mul_f32 v[236:237], v[236:237], v[120:121]
 v_pk_mul_f32 v[238:239], v[238:239], v[122:123]
 v_pk_mul_f32 v[240:241], v[240:241], v[124:125]
 v_pk_mul_f32 v[242:243], v[242:243], v[126:127]
 v_cvt_pk_bf16_f32 v120, v236, v237
 v_cvt_pk_bf16_f32 v121, v238, v239
 v_cvt_pk_bf16_f32 v122, v240, v241
 v_cvt_pk_bf16_f32 v123, v242, v243
 buffer_store_dwordx4 v[120:123], v248, s[16:19], s68 offen sc1
 v_pk_fma_f32 v[128:129], v[216:217], v[196:197], v[128:129] op_sel:[0,1,0] op_sel_hi:[1,1,1] neg_lo:[1,0,0] neg_hi:[1,0,0]
 v_pk_fma_f32 v[130:131], v[218:219], v[196:197], v[130:131] op_sel:[0,1,0] op_sel_hi:[1,1,1] neg_lo:[1,0,0] neg_hi:[1,0,0]
 v_pk_fma_f32 v[132:133], v[220:221], v[196:197], v[132:133] op_sel:[0,1,0] op_sel_hi:[1,1,1] neg_lo:[1,0,0] neg_hi:[1,0,0]
 v_pk_fma_f32 v[134:135], v[222:223], v[196:197], v[134:135] op_sel:[0,1,0] op_sel_hi:[1,1,1] neg_lo:[1,0,0] neg_hi:[1,0,0]
 v_pk_mul_f32 v[128:129], v[128:129], v[204:205] op_sel:[0,1] op_sel_hi:[1,1]
 v_pk_mul_f32 v[130:131], v[130:131], v[204:205] op_sel:[0,1] op_sel_hi:[1,1]
 v_pk_mul_f32 v[132:133], v[132:133], v[204:205] op_sel:[0,1] op_sel_hi:[1,1]
 v_pk_mul_f32 v[134:135], v[134:135], v[204:205] op_sel:[0,1] op_sel_hi:[1,1]
 v_exp_f32 v236, v128
 v_exp_f32 v237, v129
 v_exp_f32 v238, v130
 v_exp_f32 v239, v131
 v_exp_f32 v240, v132
 v_exp_f32 v241, v133
 v_exp_f32 v242, v134
 v_exp_f32 v243, v135
 v_pk_add_f32 v[236:237], v[236:237], 1.0 op_sel_hi:[1,0]
 v_pk_add_f32 v[238:239], v[238:239], 1.0 op_sel_hi:[1,0]
 v_pk_add_f32 v[240:241], v[240:241], 1.0 op_sel_hi:[1,0]
 v_pk_add_f32 v[242:243], v[242:243], 1.0 op_sel_hi:[1,0]
 v_rcp_f32 v236, v236
 v_rcp_f32 v237, v237
 v_rcp_f32 v238, v238
 v_rcp_f32 v239, v239
 v_rcp_f32 v240, v240
 v_rcp_f32 v241, v241
 v_rcp_f32 v242, v242
 v_rcp_f32 v243, v243
 v_pk_mul_f32 v[236:237], v[236:237], v[128:129]
 v_pk_mul_f32 v[238:239], v[238:239], v[130:131]
 v_pk_mul_f32 v[240:241], v[240:241], v[132:133]
 v_pk_mul_f32 v[242:243], v[242:243], v[134:135]
 v_cvt_pk_bf16_f32 v128, v236, v237
 v_cvt_pk_bf16_f32 v129, v238, v239
 v_cvt_pk_bf16_f32 v130, v240, v241
 v_cvt_pk_bf16_f32 v131, v242, v243
 buffer_store_dwordx4 v[128:131], v249, s[16:19], s68 offen sc1
 v_pk_fma_f32 v[136:137], v[224:225], v[196:197], v[136:137] op_sel:[0,1,0] op_sel_hi:[1,1,1] neg_lo:[1,0,0] neg_hi:[1,0,0]
 v_pk_fma_f32 v[138:139], v[226:227], v[196:197], v[138:139] op_sel:[0,1,0] op_sel_hi:[1,1,1] neg_lo:[1,0,0] neg_hi:[1,0,0]
 v_pk_fma_f32 v[140:141], v[228:229], v[196:197], v[140:141] op_sel:[0,1,0] op_sel_hi:[1,1,1] neg_lo:[1,0,0] neg_hi:[1,0,0]
 v_pk_fma_f32 v[142:143], v[230:231], v[196:197], v[142:143] op_sel:[0,1,0] op_sel_hi:[1,1,1] neg_lo:[1,0,0] neg_hi:[1,0,0]
 v_pk_mul_f32 v[136:137], v[136:137], v[204:205] op_sel:[0,1] op_sel_hi:[1,1]
 v_pk_mul_f32 v[138:139], v[138:139], v[204:205] op_sel:[0,1] op_sel_hi:[1,1]
 v_pk_mul_f32 v[140:141], v[140:141], v[204:205] op_sel:[0,1] op_sel_hi:[1,1]
 v_pk_mul_f32 v[142:143], v[142:143], v[204:205] op_sel:[0,1] op_sel_hi:[1,1]
 v_exp_f32 v236, v136
 v_exp_f32 v237, v137
 v_exp_f32 v238, v138
 v_exp_f32 v239, v139
 v_exp_f32 v240, v140
 v_exp_f32 v241, v141
 v_exp_f32 v242, v142
 v_exp_f32 v243, v143
 v_pk_add_f32 v[236:237], v[236:237], 1.0 op_sel_hi:[1,0]
 v_pk_add_f32 v[238:239], v[238:239], 1.0 op_sel_hi:[1,0]
 v_pk_add_f32 v[240:241], v[240:241], 1.0 op_sel_hi:[1,0]
 v_pk_add_f32 v[242:243], v[242:243], 1.0 op_sel_hi:[1,0]
 v_rcp_f32 v236, v236
 v_rcp_f32 v237, v237
 v_rcp_f32 v238, v238
 v_rcp_f32 v239, v239
 v_rcp_f32 v240, v240
 v_rcp_f32 v241, v241
 v_rcp_f32 v242, v242
 v_rcp_f32 v243, v243
 v_pk_mul_f32 v[236:237], v[236:237], v[136:137]
 v_pk_mul_f32 v[238:239], v[238:239], v[138:139]
 v_pk_mul_f32 v[240:241], v[240:241], v[140:141]
 v_pk_mul_f32 v[242:243], v[242:243], v[142:143]
 v_cvt_pk_bf16_f32 v136, v236, v237
 v_cvt_pk_bf16_f32 v137, v238, v239
 v_cvt_pk_bf16_f32 v138, v240, v241
 v_cvt_pk_bf16_f32 v139, v242, v243
 buffer_store_dwordx4 v[136:139], v250, s[16:19], s68 offen sc1
 v_accvgpr_read_b32 v240, a180
 v_accvgpr_read_b32 v241, a181
 v_accvgpr_read_b32 v242, a182
 v_accvgpr_read_b32 v243, a183
 v_pk_fma_f32 v[240:241], v[232:233], v[196:197], v[240:241] op_sel:[0,1,0] op_sel_hi:[1,1,1] neg_lo:[1,0,0] neg_hi:[1,0,0]
 v_pk_fma_f32 v[242:243], v[234:235], v[196:197], v[242:243] op_sel:[0,1,0] op_sel_hi:[1,1,1] neg_lo:[1,0,0] neg_hi:[1,0,0]
 v_pk_mul_f32 v[240:241], v[240:241], v[204:205] op_sel:[0,1] op_sel_hi:[1,1]
 v_pk_mul_f32 v[242:243], v[242:243], v[204:205] op_sel:[0,1] op_sel_hi:[1,1]
 v_exp_f32 v236, v240
 v_exp_f32 v237, v241
 v_exp_f32 v238, v242
 v_exp_f32 v239, v243
 v_pk_add_f32 v[236:237], v[236:237], 1.0 op_sel_hi:[1,0]
 v_pk_add_f32 v[238:239], v[238:239], 1.0 op_sel_hi:[1,0]
 v_rcp_f32 v236, v236
 v_rcp_f32 v237, v237
 v_rcp_f32 v238, v238
 v_rcp_f32 v239, v239
 v_pk_mul_f32 v[236:237], v[236:237], v[240:241]
 v_pk_mul_f32 v[238:239], v[238:239], v[242:243]
 v_cvt_pk_bf16_f32 v102, v236, v237
 v_cvt_pk_bf16_f32 v103, v238, v239
 s_nop 0
 v_permlane32_swap_b32 v100, v102
 v_permlane32_swap_b32_e64 v101, v103
 buffer_store_dwordx4 v[100:103], v251, s[16:19], s69 offen sc1
 s_add_u32 s69, s69, 344064
 s_add_u32 s68, s68, 172032
 v_pk_fma_f32 v[144:145], v[208:209], v[198:199], v[144:145] op_sel:[0,0,0] op_sel_hi:[1,0,1] neg_lo:[1,0,0] neg_hi:[1,0,0]
 v_pk_fma_f32 v[146:147], v[210:211], v[198:199], v[146:147] op_sel:[0,0,0] op_sel_hi:[1,0,1] neg_lo:[1,0,0] neg_hi:[1,0,0]
 v_pk_fma_f32 v[148:149], v[212:213], v[198:199], v[148:149] op_sel:[0,0,0] op_sel_hi:[1,0,1] neg_lo:[1,0,0] neg_hi:[1,0,0]
 v_pk_fma_f32 v[150:151], v[214:215], v[198:199], v[150:151] op_sel:[0,0,0] op_sel_hi:[1,0,1] neg_lo:[1,0,0] neg_hi:[1,0,0]
 v_pk_mul_f32 v[144:145], v[144:145], v[206:207] op_sel:[0,0] op_sel_hi:[1,0]
 v_pk_mul_f32 v[146:147], v[146:147], v[206:207] op_sel:[0,0] op_sel_hi:[1,0]
 v_pk_mul_f32 v[148:149], v[148:149], v[206:207] op_sel:[0,0] op_sel_hi:[1,0]
 v_pk_mul_f32 v[150:151], v[150:151], v[206:207] op_sel:[0,0] op_sel_hi:[1,0]
 v_exp_f32 v236, v144
 v_exp_f32 v237, v145
 v_exp_f32 v238, v146
 v_exp_f32 v239, v147
 v_exp_f32 v240, v148
 v_exp_f32 v241, v149
 v_exp_f32 v242, v150
 v_exp_f32 v243, v151
 v_pk_add_f32 v[236:237], v[236:237], 1.0 op_sel_hi:[1,0]
 v_pk_add_f32 v[238:239], v[238:239], 1.0 op_sel_hi:[1,0]
 v_pk_add_f32 v[240:241], v[240:241], 1.0 op_sel_hi:[1,0]
 v_pk_add_f32 v[242:243], v[242:243], 1.0 op_sel_hi:[1,0]
 v_rcp_f32 v236, v236
 v_rcp_f32 v237, v237
 v_rcp_f32 v238, v238
 v_rcp_f32 v239, v239
 v_rcp_f32 v240, v240
 v_rcp_f32 v241, v241
 v_rcp_f32 v242, v242
 v_rcp_f32 v243, v243
 v_pk_mul_f32 v[236:237], v[236:237], v[144:145]
 v_pk_mul_f32 v[238:239], v[238:239], v[146:147]
 v_pk_mul_f32 v[240:241], v[240:241], v[148:149]
 v_pk_mul_f32 v[242:243], v[242:243], v[150:151]
 v_cvt_pk_bf16_f32 v144, v236, v237
 v_cvt_pk_bf16_f32 v145, v238, v239
 v_cvt_pk_bf16_f32 v146, v240, v241
 v_cvt_pk_bf16_f32 v147, v242, v243
 buffer_store_dwordx4 v[144:147], v248, s[16:19], s68 offen sc1
 v_pk_fma_f32 v[152:153], v[216:217], v[198:199], v[152:153] op_sel:[0,0,0] op_sel_hi:[1,0,1] neg_lo:[1,0,0] neg_hi:[1,0,0]
 v_pk_fma_f32 v[154:155], v[218:219], v[198:199], v[154:155] op_sel:[0,0,0] op_sel_hi:[1,0,1] neg_lo:[1,0,0] neg_hi:[1,0,0]
 v_pk_fma_f32 v[156:157], v[220:221], v[198:199], v[156:157] op_sel:[0,0,0] op_sel_hi:[1,0,1] neg_lo:[1,0,0] neg_hi:[1,0,0]
 v_pk_fma_f32 v[158:159], v[222:223], v[198:199], v[158:159] op_sel:[0,0,0] op_sel_hi:[1,0,1] neg_lo:[1,0,0] neg_hi:[1,0,0]
 v_pk_mul_f32 v[152:153], v[152:153], v[206:207] op_sel:[0,0] op_sel_hi:[1,0]
 v_pk_mul_f32 v[154:155], v[154:155], v[206:207] op_sel:[0,0] op_sel_hi:[1,0]
 v_pk_mul_f32 v[156:157], v[156:157], v[206:207] op_sel:[0,0] op_sel_hi:[1,0]
 v_pk_mul_f32 v[158:159], v[158:159], v[206:207] op_sel:[0,0] op_sel_hi:[1,0]
 v_exp_f32 v236, v152
 v_exp_f32 v237, v153
 v_exp_f32 v238, v154
 v_exp_f32 v239, v155
 v_exp_f32 v240, v156
 v_exp_f32 v241, v157
 v_exp_f32 v242, v158
 v_exp_f32 v243, v159
 v_pk_add_f32 v[236:237], v[236:237], 1.0 op_sel_hi:[1,0]
 v_pk_add_f32 v[238:239], v[238:239], 1.0 op_sel_hi:[1,0]
 v_pk_add_f32 v[240:241], v[240:241], 1.0 op_sel_hi:[1,0]
 v_pk_add_f32 v[242:243], v[242:243], 1.0 op_sel_hi:[1,0]
 v_rcp_f32 v236, v236
 v_rcp_f32 v237, v237
 v_rcp_f32 v238, v238
 v_rcp_f32 v239, v239
 v_rcp_f32 v240, v240
 v_rcp_f32 v241, v241
 v_rcp_f32 v242, v242
 v_rcp_f32 v243, v243
 v_pk_mul_f32 v[236:237], v[236:237], v[152:153]
 v_pk_mul_f32 v[238:239], v[238:239], v[154:155]
 v_pk_mul_f32 v[240:241], v[240:241], v[156:157]
 v_pk_mul_f32 v[242:243], v[242:243], v[158:159]
 v_cvt_pk_bf16_f32 v152, v236, v237
 v_cvt_pk_bf16_f32 v153, v238, v239
 v_cvt_pk_bf16_f32 v154, v240, v241
 v_cvt_pk_bf16_f32 v155, v242, v243
 buffer_store_dwordx4 v[152:155], v249, s[16:19], s68 offen sc1
 v_pk_fma_f32 v[160:161], v[224:225], v[198:199], v[160:161] op_sel:[0,0,0] op_sel_hi:[1,0,1] neg_lo:[1,0,0] neg_hi:[1,0,0]
 v_pk_fma_f32 v[162:163], v[226:227], v[198:199], v[162:163] op_sel:[0,0,0] op_sel_hi:[1,0,1] neg_lo:[1,0,0] neg_hi:[1,0,0]
 v_pk_fma_f32 v[164:165], v[228:229], v[198:199], v[164:165] op_sel:[0,0,0] op_sel_hi:[1,0,1] neg_lo:[1,0,0] neg_hi:[1,0,0]
 v_pk_fma_f32 v[166:167], v[230:231], v[198:199], v[166:167] op_sel:[0,0,0] op_sel_hi:[1,0,1] neg_lo:[1,0,0] neg_hi:[1,0,0]
 v_pk_mul_f32 v[160:161], v[160:161], v[206:207] op_sel:[0,0] op_sel_hi:[1,0]
 v_pk_mul_f32 v[162:163], v[162:163], v[206:207] op_sel:[0,0] op_sel_hi:[1,0]
 v_pk_mul_f32 v[164:165], v[164:165], v[206:207] op_sel:[0,0] op_sel_hi:[1,0]
 v_pk_mul_f32 v[166:167], v[166:167], v[206:207] op_sel:[0,0] op_sel_hi:[1,0]
 v_exp_f32 v236, v160
 v_exp_f32 v237, v161
 v_exp_f32 v238, v162
 v_exp_f32 v239, v163
 v_exp_f32 v240, v164
 v_exp_f32 v241, v165
 v_exp_f32 v242, v166
 v_exp_f32 v243, v167
 v_pk_add_f32 v[236:237], v[236:237], 1.0 op_sel_hi:[1,0]
 v_pk_add_f32 v[238:239], v[238:239], 1.0 op_sel_hi:[1,0]
 v_pk_add_f32 v[240:241], v[240:241], 1.0 op_sel_hi:[1,0]
 v_pk_add_f32 v[242:243], v[242:243], 1.0 op_sel_hi:[1,0]
 v_rcp_f32 v236, v236
 v_rcp_f32 v237, v237
 v_rcp_f32 v238, v238
 v_rcp_f32 v239, v239
 v_rcp_f32 v240, v240
 v_rcp_f32 v241, v241
 v_rcp_f32 v242, v242
 v_rcp_f32 v243, v243
 v_pk_mul_f32 v[236:237], v[236:237], v[160:161]
 v_pk_mul_f32 v[238:239], v[238:239], v[162:163]
 v_pk_mul_f32 v[240:241], v[240:241], v[164:165]
 v_pk_mul_f32 v[242:243], v[242:243], v[166:167]
 v_cvt_pk_bf16_f32 v160, v236, v237
 v_cvt_pk_bf16_f32 v161, v238, v239
 v_cvt_pk_bf16_f32 v162, v240, v241
 v_cvt_pk_bf16_f32 v163, v242, v243
 buffer_store_dwordx4 v[160:163], v250, s[16:19], s68 offen sc1
 v_accvgpr_read_b32 v240, a184
 v_accvgpr_read_b32 v241, a185
 v_accvgpr_read_b32 v242, a186
 v_accvgpr_read_b32 v243, a187
 v_pk_fma_f32 v[240:241], v[232:233], v[198:199], v[240:241] op_sel:[0,0,0] op_sel_hi:[1,0,1] neg_lo:[1,0,0] neg_hi:[1,0,0]
 v_pk_fma_f32 v[242:243], v[234:235], v[198:199], v[242:243] op_sel:[0,0,0] op_sel_hi:[1,0,1] neg_lo:[1,0,0] neg_hi:[1,0,0]
 v_pk_mul_f32 v[240:241], v[240:241], v[206:207] op_sel:[0,0] op_sel_hi:[1,0]
 v_pk_mul_f32 v[242:243], v[242:243], v[206:207] op_sel:[0,0] op_sel_hi:[1,0]
 v_exp_f32 v236, v240
 v_exp_f32 v237, v241
 v_exp_f32 v238, v242
 v_exp_f32 v239, v243
 v_pk_add_f32 v[236:237], v[236:237], 1.0 op_sel_hi:[1,0]
 v_pk_add_f32 v[238:239], v[238:239], 1.0 op_sel_hi:[1,0]
 v_rcp_f32 v236, v236
 v_rcp_f32 v237, v237
 v_rcp_f32 v238, v238
 v_rcp_f32 v239, v239
 v_pk_mul_f32 v[236:237], v[236:237], v[240:241]
 v_pk_mul_f32 v[238:239], v[238:239], v[242:243]
 v_cvt_pk_bf16_f32 v148, v236, v237
 v_cvt_pk_bf16_f32 v149, v238, v239
 s_add_u32 s68, s68, 172032
 v_pk_fma_f32 v[168:169], v[208:209], v[198:199], v[168:169] op_sel:[0,1,0] op_sel_hi:[1,1,1] neg_lo:[1,0,0] neg_hi:[1,0,0]
 v_pk_fma_f32 v[170:171], v[210:211], v[198:199], v[170:171] op_sel:[0,1,0] op_sel_hi:[1,1,1] neg_lo:[1,0,0] neg_hi:[1,0,0]
 v_pk_fma_f32 v[172:173], v[212:213], v[198:199], v[172:173] op_sel:[0,1,0] op_sel_hi:[1,1,1] neg_lo:[1,0,0] neg_hi:[1,0,0]
 v_pk_fma_f32 v[174:175], v[214:215], v[198:199], v[174:175] op_sel:[0,1,0] op_sel_hi:[1,1,1] neg_lo:[1,0,0] neg_hi:[1,0,0]
 v_pk_mul_f32 v[168:169], v[168:169], v[206:207] op_sel:[0,1] op_sel_hi:[1,1]
 v_pk_mul_f32 v[170:171], v[170:171], v[206:207] op_sel:[0,1] op_sel_hi:[1,1]
 v_pk_mul_f32 v[172:173], v[172:173], v[206:207] op_sel:[0,1] op_sel_hi:[1,1]
 v_pk_mul_f32 v[174:175], v[174:175], v[206:207] op_sel:[0,1] op_sel_hi:[1,1]
 v_exp_f32 v236, v168
 v_exp_f32 v237, v169
 v_exp_f32 v238, v170
 v_exp_f32 v239, v171
 v_exp_f32 v240, v172
 v_exp_f32 v241, v173
 v_exp_f32 v242, v174
 v_exp_f32 v243, v175
 v_pk_add_f32 v[236:237], v[236:237], 1.0 op_sel_hi:[1,0]
 v_pk_add_f32 v[238:239], v[238:239], 1.0 op_sel_hi:[1,0]
 v_pk_add_f32 v[240:241], v[240:241], 1.0 op_sel_hi:[1,0]
 v_pk_add_f32 v[242:243], v[242:243], 1.0 op_sel_hi:[1,0]
 v_rcp_f32 v236, v236
 v_rcp_f32 v237, v237
 v_rcp_f32 v238, v238
 v_rcp_f32 v239, v239
 v_rcp_f32 v240, v240
 v_rcp_f32 v241, v241
 v_rcp_f32 v242, v242
 v_rcp_f32 v243, v243
 v_pk_mul_f32 v[236:237], v[236:237], v[168:169]
 v_pk_mul_f32 v[238:239], v[238:239], v[170:171]
 v_pk_mul_f32 v[240:241], v[240:241], v[172:173]
 v_pk_mul_f32 v[242:243], v[242:243], v[174:175]
 v_cvt_pk_bf16_f32 v168, v236, v237
 v_cvt_pk_bf16_f32 v169, v238, v239
 v_cvt_pk_bf16_f32 v170, v240, v241
 v_cvt_pk_bf16_f32 v171, v242, v243
 buffer_store_dwordx4 v[168:171], v248, s[16:19], s68 offen sc1
 v_pk_fma_f32 v[176:177], v[216:217], v[198:199], v[176:177] op_sel:[0,1,0] op_sel_hi:[1,1,1] neg_lo:[1,0,0] neg_hi:[1,0,0]
 v_pk_fma_f32 v[178:179], v[218:219], v[198:199], v[178:179] op_sel:[0,1,0] op_sel_hi:[1,1,1] neg_lo:[1,0,0] neg_hi:[1,0,0]
 v_pk_fma_f32 v[180:181], v[220:221], v[198:199], v[180:181] op_sel:[0,1,0] op_sel_hi:[1,1,1] neg_lo:[1,0,0] neg_hi:[1,0,0]
 v_pk_fma_f32 v[182:183], v[222:223], v[198:199], v[182:183] op_sel:[0,1,0] op_sel_hi:[1,1,1] neg_lo:[1,0,0] neg_hi:[1,0,0]
 v_pk_mul_f32 v[176:177], v[176:177], v[206:207] op_sel:[0,1] op_sel_hi:[1,1]
 v_pk_mul_f32 v[178:179], v[178:179], v[206:207] op_sel:[0,1] op_sel_hi:[1,1]
 v_pk_mul_f32 v[180:181], v[180:181], v[206:207] op_sel:[0,1] op_sel_hi:[1,1]
 v_pk_mul_f32 v[182:183], v[182:183], v[206:207] op_sel:[0,1] op_sel_hi:[1,1]
 v_exp_f32 v236, v176
 v_exp_f32 v237, v177
 v_exp_f32 v238, v178
 v_exp_f32 v239, v179
 v_exp_f32 v240, v180
 v_exp_f32 v241, v181
 v_exp_f32 v242, v182
 v_exp_f32 v243, v183
 v_pk_add_f32 v[236:237], v[236:237], 1.0 op_sel_hi:[1,0]
 v_pk_add_f32 v[238:239], v[238:239], 1.0 op_sel_hi:[1,0]
 v_pk_add_f32 v[240:241], v[240:241], 1.0 op_sel_hi:[1,0]
 v_pk_add_f32 v[242:243], v[242:243], 1.0 op_sel_hi:[1,0]
 v_rcp_f32 v236, v236
 v_rcp_f32 v237, v237
 v_rcp_f32 v238, v238
 v_rcp_f32 v239, v239
 v_rcp_f32 v240, v240
 v_rcp_f32 v241, v241
 v_rcp_f32 v242, v242
 v_rcp_f32 v243, v243
 v_pk_mul_f32 v[236:237], v[236:237], v[176:177]
 v_pk_mul_f32 v[238:239], v[238:239], v[178:179]
 v_pk_mul_f32 v[240:241], v[240:241], v[180:181]
 v_pk_mul_f32 v[242:243], v[242:243], v[182:183]
 v_cvt_pk_bf16_f32 v176, v236, v237
 v_cvt_pk_bf16_f32 v177, v238, v239
 v_cvt_pk_bf16_f32 v178, v240, v241
 v_cvt_pk_bf16_f32 v179, v242, v243
 buffer_store_dwordx4 v[176:179], v249, s[16:19], s68 offen sc1
 v_pk_fma_f32 v[184:185], v[224:225], v[198:199], v[184:185] op_sel:[0,1,0] op_sel_hi:[1,1,1] neg_lo:[1,0,0] neg_hi:[1,0,0]
 v_pk_fma_f32 v[186:187], v[226:227], v[198:199], v[186:187] op_sel:[0,1,0] op_sel_hi:[1,1,1] neg_lo:[1,0,0] neg_hi:[1,0,0]
 v_pk_fma_f32 v[188:189], v[228:229], v[198:199], v[188:189] op_sel:[0,1,0] op_sel_hi:[1,1,1] neg_lo:[1,0,0] neg_hi:[1,0,0]
 v_pk_fma_f32 v[190:191], v[230:231], v[198:199], v[190:191] op_sel:[0,1,0] op_sel_hi:[1,1,1] neg_lo:[1,0,0] neg_hi:[1,0,0]
 v_pk_mul_f32 v[184:185], v[184:185], v[206:207] op_sel:[0,1] op_sel_hi:[1,1]
 v_pk_mul_f32 v[186:187], v[186:187], v[206:207] op_sel:[0,1] op_sel_hi:[1,1]
 v_pk_mul_f32 v[188:189], v[188:189], v[206:207] op_sel:[0,1] op_sel_hi:[1,1]
 v_pk_mul_f32 v[190:191], v[190:191], v[206:207] op_sel:[0,1] op_sel_hi:[1,1]
 v_exp_f32 v236, v184
 v_exp_f32 v237, v185
 v_exp_f32 v238, v186
 v_exp_f32 v239, v187
 v_exp_f32 v240, v188
 v_exp_f32 v241, v189
 v_exp_f32 v242, v190
 v_exp_f32 v243, v191
 v_pk_add_f32 v[236:237], v[236:237], 1.0 op_sel_hi:[1,0]
 v_pk_add_f32 v[238:239], v[238:239], 1.0 op_sel_hi:[1,0]
 v_pk_add_f32 v[240:241], v[240:241], 1.0 op_sel_hi:[1,0]
 v_pk_add_f32 v[242:243], v[242:243], 1.0 op_sel_hi:[1,0]
 v_rcp_f32 v236, v236
 v_rcp_f32 v237, v237
 v_rcp_f32 v238, v238
 v_rcp_f32 v239, v239
 v_rcp_f32 v240, v240
 v_rcp_f32 v241, v241
 v_rcp_f32 v242, v242
 v_rcp_f32 v243, v243
 v_pk_mul_f32 v[236:237], v[236:237], v[184:185]
 v_pk_mul_f32 v[238:239], v[238:239], v[186:187]
 v_pk_mul_f32 v[240:241], v[240:241], v[188:189]
 v_pk_mul_f32 v[242:243], v[242:243], v[190:191]
 v_cvt_pk_bf16_f32 v184, v236, v237
 v_cvt_pk_bf16_f32 v185, v238, v239
 v_cvt_pk_bf16_f32 v186, v240, v241
 v_cvt_pk_bf16_f32 v187, v242, v243
 buffer_store_dwordx4 v[184:187], v250, s[16:19], s68 offen sc1
 v_accvgpr_read_b32 v240, a188
 v_accvgpr_read_b32 v241, a189
 v_accvgpr_read_b32 v242, a190
 v_accvgpr_read_b32 v243, a191
 v_pk_fma_f32 v[240:241], v[232:233], v[198:199], v[240:241] op_sel:[0,1,0] op_sel_hi:[1,1,1] neg_lo:[1,0,0] neg_hi:[1,0,0]
 v_pk_fma_f32 v[242:243], v[234:235], v[198:199], v[242:243] op_sel:[0,1,0] op_sel_hi:[1,1,1] neg_lo:[1,0,0] neg_hi:[1,0,0]
 v_pk_mul_f32 v[240:241], v[240:241], v[206:207] op_sel:[0,1] op_sel_hi:[1,1]
 v_pk_mul_f32 v[242:243], v[242:243], v[206:207] op_sel:[0,1] op_sel_hi:[1,1]
 v_exp_f32 v236, v240
 v_exp_f32 v237, v241
 v_exp_f32 v238, v242
 v_exp_f32 v239, v243
 v_pk_add_f32 v[236:237], v[236:237], 1.0 op_sel_hi:[1,0]
 v_pk_add_f32 v[238:239], v[238:239], 1.0 op_sel_hi:[1,0]
 v_rcp_f32 v236, v236
 v_rcp_f32 v237, v237
 v_rcp_f32 v238, v238
 v_rcp_f32 v239, v239
 v_pk_mul_f32 v[236:237], v[236:237], v[240:241]
 v_pk_mul_f32 v[238:239], v[238:239], v[242:243]
 v_cvt_pk_bf16_f32 v150, v236, v237
 v_cvt_pk_bf16_f32 v151, v238, v239
 s_nop 0
 v_permlane32_swap_b32 v148, v150
 v_permlane32_swap_b32_e64 v149, v151
 buffer_store_dwordx4 v[148:151], v251, s[16:19], s69 offen sc1
 s_add_u32 s69, s69, 344064
 v_mov_b32_e64 v243, 0
 s_lshl_b32 s4, s40, 2
 s_lshr_b32 s3, s41, 2
 s_add_u32 s4, s4, s3
 s_lshl_b32 s3, s4, 7
 s_add_u32 s3, s3, 8192
 v_lshlrev_b32 v236, 20, v255
 s_lshl_b32 s74, s28, 26
 s_add_u32 s3, s3, s74
 v_add_u32 v236, s3, v236
 v_mov_b32_e64 v237, 1
 s_waitcnt vmcnt(0)
 s_barrier
 buffer_atomic_add v237, v236, s[76:79], 0 offen sc1
 s_branch L_P2
L1F_d0:
 v_mfma_f32_16x16x32_bf16 a[156:159], a[32:35], a[128:131], 0
 v_mfma_f32_16x16x32_bf16 a[156:159], a[36:39], a[132:135], a[156:159]
 v_mfma_f32_16x16x32_bf16 a[156:159], a[40:43], a[136:139], a[156:159]
 v_mfma_f32_16x16x32_bf16 a[156:159], a[44:47], a[140:143], a[156:159]
 v_mfma_f32_16x16x32_bf16 a[156:159], a[48:51], a[144:147], a[156:159]
 v_mfma_f32_16x16x32_bf16 a[156:159], a[52:55], a[148:151], a[156:159]
 v_mfma_f32_16x16x32_bf16 a[156:159], a[56:59], a[152:155], a[156:159]
 s_branch L1F_d0_r
L1F_d1:
 v_mfma_f32_16x16x32_bf16 a[156:159], a[92:95], a[128:131], a[156:159]
 v_mfma_f32_16x16x32_bf16 a[156:159], a[96:99], a[132:135], a[156:159]
 v_mfma_f32_16x16x32_bf16 a[156:159], a[100:103], a[136:139], a[156:159]
 v_mfma_f32_16x16x32_bf16 a[156:159], a[104:107], a[140:143], a[156:159]
 v_mfma_f32_16x16x32_bf16 a[156:159], a[108:111], a[144:147], a[156:159]
 v_mfma_f32_16x16x32_bf16 a[156:159], a[112:115], a[148:151], a[156:159]
 v_mfma_f32_16x16x32_bf16 a[156:159], a[116:119], a[152:155], a[156:159]
 s_branch L1F_d1_r
L1F_d2:
 v_mfma_f32_16x16x32_bf16 a[156:159], a[32:35], a[128:131], a[156:159]
 v_mfma_f32_16x16x32_bf16 a[156:159], a[36:39], a[132:135], a[156:159]
 v_mfma_f32_16x16x32_bf16 a[156:159], a[40:43], a[136:139], a[156:159]
 v_mfma_f32_16x16x32_bf16 a[156:159], a[44:47], a[140:143], a[156:159]
 v_mfma_f32_16x16x32_bf16 a[156:159], a[48:51], a[144:147], a[156:159]
 v_mfma_f32_16x16x32_bf16 a[156:159], a[52:55], a[148:151], a[156:159]
 v_mfma_f32_16x16x32_bf16 a[156:159], a[56:59], a[152:155], a[156:159]
 s_branch L1F_d2_r
L1F_d3:
 v_mfma_f32_16x16x32_bf16 a[156:159], a[92:95], a[128:131], a[156:159]
 v_mfma_f32_16x16x32_bf16 a[156:159], a[96:99], a[132:135], a[156:159]
 v_mfma_f32_16x16x32_bf16 a[156:159], a[100:103], a[136:139], a[156:159]
 v_mfma_f32_16x16x32_bf16 a[156:159], a[104:107], a[140:143], a[156:159]
 v_mfma_f32_16x16x32_bf16 a[156:159], a[108:111], a[144:147], a[156:159]
 v_mfma_f32_16x16x32_bf16 a[156:159], a[112:115], a[148:151], a[156:159]
 v_mfma_f32_16x16x32_bf16 a[156:159], a[116:119], a[152:155], a[156:159]
 s_branch L1F_d3_r
L1F_d4:
 v_mfma_f32_16x16x32_bf16 a[156:159], a[32:35], a[128:131], 0
 v_mfma_f32_16x16x32_bf16 a[156:159], a[36:39], a[132:135], a[156:159]
 v_mfma_f32_16x16x32_bf16 a[156:159], a[40:43], a[136:139], a[156:159]
 v_mfma_f32_16x16x32_bf16 a[156:159], a[44:47], a[140:143], a[156:159]
 v_mfma_f32_16x16x32_bf16 a[156:159], a[48:51], a[144:147], a[156:159]
 v_mfma_f32_16x16x32_bf16 a[156:159], a[52:55], a[148:151], a[156:159]
 v_mfma_f32_16x16x32_bf16 a[156:159], a[56:59], a[152:155], a[156:159]
 s_branch L1F_d4_r
L1F_d5:
 v_mfma_f32_16x16x32_bf16 a[156:159], a[92:95], a[128:131], a[156:159]
 v_mfma_f32_16x16x32_bf16 a[156:159], a[96:99], a[132:135], a[156:159]
 v_mfma_f32_16x16x32_bf16 a[156:159], a[100:103], a[136:139], a[156:159]
 v_mfma_f32_16x16x32_bf16 a[156:159], a[104:107], a[140:143], a[156:159]
 v_mfma_f32_16x16x32_bf16 a[156:159], a[108:111], a[144:147], a[156:159]
 v_mfma_f32_16x16x32_bf16 a[156:159], a[112:115], a[148:151], a[156:159]
 v_mfma_f32_16x16x32_bf16 a[156:159], a[116:119], a[152:155], a[156:159]
 s_branch L1F_d5_r
L1F_d6:
 v_mfma_f32_16x16x32_bf16 a[156:159], a[32:35], a[128:131], a[156:159]
 v_mfma_f32_16x16x32_bf16 a[156:159], a[36:39], a[132:135], a[156:159]
 v_mfma_f32_16x16x32_bf16 a[156:159], a[40:43], a[136:139], a[156:159]
 v_mfma_f32_16x16x32_bf16 a[156:159], a[44:47], a[140:143], a[156:159]
 v_mfma_f32_16x16x32_bf16 a[156:159], a[48:51], a[144:147], a[156:159]
 v_mfma_f32_16x16x32_bf16 a[156:159], a[52:55], a[148:151], a[156:159]
 v_mfma_f32_16x16x32_bf16 a[156:159], a[56:59], a[152:155], a[156:159]
 s_branch L1F_d6_r
L1F_d7:
 v_mfma_f32_16x16x32_bf16 a[156:159], a[92:95], a[128:131], a[156:159]
 v_mfma_f32_16x16x32_bf16 a[156:159], a[96:99], a[132:135], a[156:159]
 v_mfma_f32_16x16x32_bf16 a[156:159], a[100:103], a[136:139], a[156:159]
 v_mfma_f32_16x16x32_bf16 a[156:159], a[104:107], a[140:143], a[156:159]
 v_mfma_f32_16x16x32_bf16 a[156:159], a[108:111], a[144:147], a[156:159]
 v_mfma_f32_16x16x32_bf16 a[156:159], a[112:115], a[148:151], a[156:159]
 v_mfma_f32_16x16x32_bf16 a[156:159], a[116:119], a[152:155], a[156:159]
 s_branch L1F_d7_r
L1F_d8:
 v_mfma_f32_16x16x32_bf16 a[156:159], a[32:35], a[128:131], 0
 v_mfma_f32_16x16x32_bf16 a[156:159], a[36:39], a[132:135], a[156:159]
 v_mfma_f32_16x16x32_bf16 a[156:159], a[40:43], a[136:139], a[156:159]
 v_mfma_f32_16x16x32_bf16 a[156:159], a[44:47], a[140:143], a[156:159]
 v_mfma_f32_16x16x32_bf16 a[156:159], a[48:51], a[144:147], a[156:159]
 v_mfma_f32_16x16x32_bf16 a[156:159], a[52:55], a[148:151], a[156:159]
 v_mfma_f32_16x16x32_bf16 a[156:159], a[56:59], a[152:155], a[156:159]
 s_branch L1F_d8_r
L1F_d9:
 v_mfma_f32_16x16x32_bf16 a[156:159], a[92:95], a[128:131], a[156:159]
 v_mfma_f32_16x16x32_bf16 a[156:159], a[96:99], a[132:135], a[156:159]
 v_mfma_f32_16x16x32_bf16 a[156:159], a[100:103], a[136:139], a[156:159]
 v_mfma_f32_16x16x32_bf16 a[156:159], a[104:107], a[140:143], a[156:159]
 v_mfma_f32_16x16x32_bf16 a[156:159], a[108:111], a[144:147], a[156:159]
 v_mfma_f32_16x16x32_bf16 a[156:159], a[112:115], a[148:151], a[156:159]
 v_mfma_f32_16x16x32_bf16 a[156:159], a[116:119], a[152:155], a[156:159]
 s_branch L1F_d9_r
L1F_d10:
 v_mfma_f32_16x16x32_bf16 a[156:159], a[32:35], a[128:131], a[156:159]
 v_mfma_f32_16x16x32_bf16 a[156:159], a[36:39], a[132:135], a[156:159]
 v_mfma_f32_16x16x32_bf16 a[156:159], a[40:43], a[136:139], a[156:159]
 v_mfma_f32_16x16x32_bf16 a[156:159], a[44:47], a[140:143], a[156:159]
 v_mfma_f32_16x16x32_bf16 a[156:159], a[48:51], a[144:147], a[156:159]
 v_mfma_f32_16x16x32_bf16 a[156:159], a[52:55], a[148:151], a[156:159]
 v_mfma_f32_16x16x32_bf16 a[156:159], a[56:59], a[152:155], a[156:159]
 s_branch L1F_d10_r
L1F_d11:
 v_mfma_f32_16x16x32_bf16 a[156:159], a[92:95], a[128:131], a[156:159]
 v_mfma_f32_16x16x32_bf16 a[156:159], a[96:99], a[132:135], a[156:159]
 v_mfma_f32_16x16x32_bf16 a[156:159], a[100:103], a[136:139], a[156:159]
 v_mfma_f32_16x16x32_bf16 a[156:159], a[104:107], a[140:143], a[156:159]
 v_mfma_f32_16x16x32_bf16 a[156:159], a[108:111], a[144:147], a[156:159]
 v_mfma_f32_16x16x32_bf16 a[156:159], a[112:115], a[148:151], a[156:159]
 v_mfma_f32_16x16x32_bf16 a[156:159], a[116:119], a[152:155], a[156:159]
 s_branch L1F_d11_r
L1F_d12:
 v_mfma_f32_16x16x32_bf16 a[156:159], a[32:35], a[128:131], 0
 v_mfma_f32_16x16x32_bf16 a[156:159], a[36:39], a[132:135], a[156:159]
 v_mfma_f32_16x16x32_bf16 a[156:159], a[40:43], a[136:139], a[156:159]
 v_mfma_f32_16x16x32_bf16 a[156:159], a[44:47], a[140:143], a[156:159]
 v_mfma_f32_16x16x32_bf16 a[156:159], a[48:51], a[144:147], a[156:159]
 v_mfma_f32_16x16x32_bf16 a[156:159], a[52:55], a[148:151], a[156:159]
 v_mfma_f32_16x16x32_bf16 a[156:159], a[56:59], a[152:155], a[156:159]
 s_branch L1F_d12_r
L1F_d13:
 v_mfma_f32_16x16x32_bf16 a[156:159], a[92:95], a[128:131], a[156:159]
 v_mfma_f32_16x16x32_bf16 a[156:159], a[96:99], a[132:135], a[156:159]
 v_mfma_f32_16x16x32_bf16 a[156:159], a[100:103], a[136:139], a[156:159]
 v_mfma_f32_16x16x32_bf16 a[156:159], a[104:107], a[140:143], a[156:159]
 v_mfma_f32_16x16x32_bf16 a[156:159], a[108:111], a[144:147], a[156:159]
 v_mfma_f32_16x16x32_bf16 a[156:159], a[112:115], a[148:151], a[156:159]
 v_mfma_f32_16x16x32_bf16 a[156:159], a[116:119], a[152:155], a[156:159]
 s_branch L1F_d13_r
L1F_d14:
 v_mfma_f32_16x16x32_bf16 a[156:159], a[32:35], a[128:131], a[156:159]
 v_mfma_f32_16x16x32_bf16 a[156:159], a[36:39], a[132:135], a[156:159]
 v_mfma_f32_16x16x32_bf16 a[156:159], a[40:43], a[136:139], a[156:159]
 v_mfma_f32_16x16x32_bf16 a[156:159], a[44:47], a[140:143], a[156:159]
 v_mfma_f32_16x16x32_bf16 a[156:159], a[48:51], a[144:147], a[156:159]
 v_mfma_f32_16x16x32_bf16 a[156:159], a[52:55], a[148:151], a[156:159]
 v_mfma_f32_16x16x32_bf16 a[156:159], a[56:59], a[152:155], a[156:159]
 s_branch L1F_d14_r
L1F_d15:
 v_mfma_f32_16x16x32_bf16 a[156:159], a[92:95], a[128:131], a[156:159]
 v_mfma_f32_16x16x32_bf16 a[156:159], a[96:99], a[132:135], a[156:159]
 v_mfma_f32_16x16x32_bf16 a[156:159], a[100:103], a[136:139], a[156:159]
 v_mfma_f32_16x16x32_bf16 a[156:159], a[104:107], a[140:143], a[156:159]
 v_mfma_f32_16x16x32_bf16 a[156:159], a[108:111], a[144:147], a[156:159]
 v_mfma_f32_16x16x32_bf16 a[156:159], a[112:115], a[148:151], a[156:159]
 v_mfma_f32_16x16x32_bf16 a[156:159], a[116:119], a[152:155], a[156:159]
 s_branch L1F_d15_r
L1F_sp0:
 s_mov_b32 s80, 0
L1F_sp:
 buffer_load_dword v195, v196, s[96:99], 0 offen sc1
 s_waitcnt vmcnt(0)
 v_cmp_gt_u32 vcc, v197, v195
 s_add_u32 s80, s80, 1
 s_cmp_ge_u32 s80, 0x40000
 s_cbranch_scc1 L1F_sok
 s_nop 2
 s_cbranch_vccz L1F_sok
 s_sleep 8
 s_branch L1F_sp
L_end:
 s_endpgm

.section .rodata,"a"
.p2align 6
.amdhsa_kernel recurrent_scan__linear_kernel_hedgehog__dense_activation_silu__prompt_kernel
  .amdhsa_next_free_vgpr 512
  .amdhsa_next_free_sgpr 102
  .amdhsa_accum_offset 256
  .amdhsa_group_segment_fixed_size 0
  .amdhsa_kernarg_size 80
  .amdhsa_user_sgpr_count 2
  .amdhsa_user_sgpr_kernarg_segment_ptr 1
  .amdhsa_system_sgpr_workgroup_id_x 1
  .amdhsa_float_denorm_mode_32 3
.end_amdhsa_kernel
```
